```python
import torch

def _softmax(x, axis=-1):
    return torch.softmax(x, dim=axis)
def _gelu(x):
    return torch.nn.functional.gelu(x, approximate="tanh")
def _silu(x):
    return torch.nn.functional.silu(x)
def _sigmoid(x):
    return torch.sigmoid(x)
def _layernorm(x, axis=-1, eps=1e-5):
    m = x.mean(dim=axis, keepdim=True)
    v = x.var(dim=axis, keepdim=True, unbiased=False)
    return (x - m) / torch.sqrt(v + eps)
def _scatter_add(tgt, idx, src, axis=0):
    return tgt.clone().index_add_(axis, idx, src)
def _segment_sum(src, seg, n):
    out = torch.zeros((n,) + src.shape[1:], dtype=src.dtype)
    return out.index_add_(0, seg, src)
def _pad(x, pw):
    flat = tuple(v for pair in reversed(pw) for v in pair)
    return torch.nn.functional.pad(x, flat)

kernel_name = 'concat_heads__gqa_block_cached__gqa_block_cached__near_ridge'

def setup_inputs():

    _w = (lambda a: (lambda t: t.to(torch.bfloat16) if t.is_floating_point() else t)(torch.as_tensor(a)))
    def _A_setup():
        B, Sq, D = 16, 144, 512
        Hq, Hkv, Sk, Dh = 32, 32, 512, 128
        assert Hq % Hkv == 0, (Hq, Hkv)
        return {
            "x": _w((lambda *s: torch.randn(*s, dtype=torch.bfloat16) * 0.8)(B, Sq, D)),
            "k_cache": _w((lambda *s: torch.randn(*s, dtype=torch.bfloat16) * 0.8)(B, Hkv, Sk, Dh)),
            "v_cache": _w((lambda *s: torch.randn(*s, dtype=torch.bfloat16) * 0.05)(B, Hkv, Sk, Dh)),
            "wq": _w((lambda *s: torch.randn(*s, dtype=torch.bfloat16) * 0.8)(D, Hq * Dh) * (D ** -0.5)),
            "wo": _w((lambda *s: torch.randn(*s, dtype=torch.bfloat16) * 0.05)(Hq * Dh, D) * ((Hq * Dh) ** -0.5)),
        }
    _A_in = _A_setup()

    def _B_setup():
        B, Sq, D = 16, 144, 512
        Hq, Hkv, Sk, Dh = 32, 32, 512, 128
        assert Hq % Hkv == 0, (Hq, Hkv)
        return {
            "x": _w((lambda *s: torch.randn(*s, dtype=torch.bfloat16) * 0.8)(B, Sq, D)),
            "k_cache": _w((lambda *s: torch.randn(*s, dtype=torch.bfloat16) * 0.8)(B, Hkv, Sk, Dh)),
            "v_cache": _w((lambda *s: torch.randn(*s, dtype=torch.bfloat16) * 0.05)(B, Hkv, Sk, Dh)),
            "wq": _w((lambda *s: torch.randn(*s, dtype=torch.bfloat16) * 0.8)(D, Hq * Dh) * (D ** -0.5)),
            "wo": _w((lambda *s: torch.randn(*s, dtype=torch.bfloat16) * 0.05)(Hq * Dh, D) * ((Hq * Dh) ** -0.5)),
        }
    _B_in = _B_setup()

    return {
        "A_x": _A_in["x"],
        "A_k_cache": _A_in["k_cache"],
        "A_v_cache": _A_in["v_cache"],
        "A_wq": _A_in["wq"],
        "A_wo": _A_in["wo"],
        "B_x": _B_in["x"],
        "B_k_cache": _B_in["k_cache"],
        "B_v_cache": _B_in["v_cache"],
        "B_wq": _B_in["wq"],
        "B_wo": _B_in["wo"],
    }

def reference(A_x, A_k_cache, A_v_cache, A_wq, A_wo, B_x, B_k_cache, B_v_cache, B_wq, B_wo):
    def _A_ref(x, k_cache, v_cache, wq, wo):
        B, Sq, D = x.shape
        Hq, Dh = 32, 128
        Hkv = k_cache.shape[1]
        rep = Hq // Hkv
        q = (lambda x, *d: x.permute(*d))((x @ wq).reshape(B, Sq, Hq, Dh), 0, 2, 1, 3)
        k = (lambda x, n, axis: torch.repeat_interleave(x, n, dim=axis))(k_cache, rep, axis=1)
        v = (lambda x, n, axis: torch.repeat_interleave(x, n, dim=axis))(v_cache, rep, axis=1)
        scores = torch.einsum("bhqd,bhkd->bhqk", q, k) * (Dh ** -0.5)
        p = _softmax(scores, axis=-1)
        o = torch.einsum("bhqk,bhkd->bhqd", p, v)
        return (lambda x, *d: x.permute(*d))(o, 0, 2, 1, 3).reshape(B, Sq, Hq * Dh) @ wo

    def _B_ref(x, k_cache, v_cache, wq, wo):
        B, Sq, D = x.shape
        Hq, Dh = 32, 128
        Hkv = k_cache.shape[1]
        rep = Hq // Hkv
        q = (lambda x, *d: x.permute(*d))((x @ wq).reshape(B, Sq, Hq, Dh), 0, 2, 1, 3)
        k = (lambda x, n, axis: torch.repeat_interleave(x, n, dim=axis))(k_cache, rep, axis=1)
        v = (lambda x, n, axis: torch.repeat_interleave(x, n, dim=axis))(v_cache, rep, axis=1)
        scores = torch.einsum("bhqd,bhkd->bhqk", q, k) * (Dh ** -0.5)
        p = _softmax(scores, axis=-1)
        o = torch.einsum("bhqk,bhkd->bhqd", p, v)
        return (lambda x, *d: x.permute(*d))(o, 0, 2, 1, 3).reshape(B, Sq, Hq * Dh) @ wo

    a = _A_ref(A_x, A_k_cache, A_v_cache, A_wq, A_wo)
    b = _B_ref(B_x, B_k_cache, B_v_cache, B_wq, B_wo)
    return torch.concatenate([a, b], axis=-1)
```

```asm
; @launch kernel=concat_heads__gqa_block_cached__gqa_block_cached__near_ridge_kernel grid=(256,1,1) block=(512,1,1) lds=163840
; @launch kernel=oproj_kernel grid=(640,1,1) block=(256,1,1) lds=0
.amdgcn_target "amdgcn-amd-amdhsa--gfx950"
.text
.globl concat_heads__gqa_block_cached__gqa_block_cached__near_ridge_kernel
.p2align 8
.type concat_heads__gqa_block_cached__gqa_block_cached__near_ridge_kernel,@function
concat_heads__gqa_block_cached__gqa_block_cached__near_ridge_kernel:
    s_cmp_ge_u32 s2, 256
    s_cbranch_scc1 L_k1_end
    s_load_dwordx16 s[16:31], s[0:1], 0
    s_load_dwordx8 s[32:39], s[0:1], 64
    s_load_dwordx2 s[40:41], s[0:1], 96
    s_and_b32 s76, s2, 3
    s_lshl_b32 s76, s76, 1
    s_bfe_u32 s74, s2, 0x10003
    s_add_u32 s76, s76, s74
    s_lshl_b32 s76, s76, 2
    s_lshr_b32 s77, s2, 4
    s_bfe_u32 s74, s2, 0x10002
    s_lshl_b32 s74, s74, 4
    s_add_u32 s77, s77, s74
    v_lshrrev_b32 v246, 6, v0
    v_and_b32 v252, 63, v0
    v_readfirstlane_b32 s87, v246
    s_nop 3
    s_mov_b32 s78, 0
    s_mov_b32 s83, 0x3e0293ee
    s_and_b32 s68, s87, 3
    s_lshr_b32 s79, s87, 2
    s_add_u32 s76, s76, s79
    s_mul_i32 s85, s79, 81920
    s_lshl_b32 s69, s68, 10
    s_add_u32 s89, s69, s85
    s_lshl_b32 s88, s87, 10
    s_and_b32 s74, s77, 15
    s_mul_i32 s84, s74, 147456
    s_lshl_b32 s70, s74, 5
    s_add_u32 s70, s70, s76
    s_lshl_b32 s70, s70, 17
    s_lshl_b32 s71, s76, 8
    s_mul_i32 s74, s77, 5
    s_add_u32 s86, s74, 4
    s_add_u32 s74, s74, s68
    s_lshl_b32 s73, s74, 18
    s_lshl_b32 s75, s76, 13
    s_add_u32 s73, s73, s75
    s_lshl_b32 s86, s86, 18
    s_add_u32 s86, s86, s75
    s_lshl_b32 s74, s68, 11
    s_add_u32 s86, s86, s74
    v_lshlrev_b32 v1, 4, v252
    v_bfe_u32 v246, v252, 3, 3
    v_bfe_u32 v247, v252, 0, 3
    v_bfe_u32 v248, v252, 4, 1
    v_lshlrev_b32 v248, 2, v248
    v_xor_b32 v248, v247, v248
    v_lshlrev_b32 v248, 4, v248
    v_lshl_add_u32 v249, v246, 8, v248
    v_add_u32 v243, s74, v249
    s_lshl_b32 s75, s68, 16
    v_lshl_add_u32 v249, v246, 13, v248
    v_add_u32 v6, s75, v249
    v_bfe_u32 v248, v252, 4, 2
    s_and_b32 s75, s68, 1
    s_lshl_b32 s75, s75, 2
    v_add_u32 v248, s75, v248
    v_xor_b32 v248, v247, v248
    v_lshlrev_b32 v248, 4, v248
    v_lshl_add_u32 v249, v246, 8, v248
    v_add_u32 v242, s74, v249
    s_lshl_b32 s75, s87, 13
    v_lshl_add_u32 v249, v246, 10, v248
    v_add_u32 v7, s75, v249
    s_waitcnt lgkmcnt(0)
    s_cmp_lt_u32 s77, 16
    s_cselect_b32 s44, s16, s26
    s_cselect_b32 s45, s17, s27
    s_mov_b32 s46, 2359296
    s_mov_b32 s47, 0x00020000
    s_cselect_b32 s48, s18, s28
    s_cselect_b32 s49, s19, s29
    s_mov_b32 s50, 67108864
    s_mov_b32 s51, 0x00020000
    s_cselect_b32 s52, s20, s30
    s_cselect_b32 s53, s21, s31
    s_mov_b32 s54, 67108864
    s_mov_b32 s55, 0x00020000
    s_cselect_b32 s56, s22, s32
    s_cselect_b32 s57, s23, s33
    s_mov_b32 s58, 4194304
    s_mov_b32 s59, 0x00020000
    s_mov_b32 s64, s40
    s_mov_b32 s65, s41
    s_mov_b32 s66, 289931264
    s_mov_b32 s67, 0x00020000
    s_lshr_b32 s74, s2, 3
    s_mov_b32 s74, 0
    s_add_u32 s8, s74, 0
    s_and_b32 s8, s8, 7
    s_lshl_b32 s8, s8, 14
    s_add_u32 s9, s74, 1
    s_and_b32 s9, s9, 7
    s_lshl_b32 s9, s9, 14
    s_add_u32 s10, s74, 2
    s_and_b32 s10, s10, 7
    s_lshl_b32 s10, s10, 14
    s_add_u32 s11, s74, 3
    s_and_b32 s11, s11, 7
    s_lshl_b32 s11, s11, 14
    s_add_u32 s12, s74, 4
    s_and_b32 s12, s12, 7
    s_lshl_b32 s12, s12, 14
    s_add_u32 s13, s74, 5
    s_and_b32 s13, s13, 7
    s_lshl_b32 s13, s13, 14
    s_add_u32 s14, s74, 6
    s_and_b32 s14, s14, 7
    s_lshl_b32 s14, s14, 14
    s_add_u32 s15, s74, 7
    s_and_b32 s15, s15, 7
    s_lshl_b32 s15, s15, 14
    s_lshr_b32 s97, s2, 4
    v_bfe_u32 v246, v252, 3, 3
    v_bfe_u32 v247, v252, 0, 3
    v_bfe_u32 v248, v252, 4, 2
    v_xor_b32 v248, v247, v248
    v_lshlrev_b32 v248, 4, v248
    v_lshl_add_u32 v185, v246, 10, v248
    s_add_u32 s74, s87, s97
    s_and_b32 s74, s74, 7
    s_lshl_b32 s74, s74, 7
    s_add_u32 s74, s74, s84
    s_add_u32 s74, s74, 131072
    s_lshl_b32 s75, s87, 11
    s_add_u32 m0, s75, 147456
    s_nop 0
    buffer_load_dwordx4 v185, s[44:47], s74 offen offset:0 lds
    v_xor_b32 v185, 64, v185
    s_add_u32 s74, s74, 8192
    s_add_u32 m0, s75, 148480
    s_nop 0
    buffer_load_dwordx4 v185, s[44:47], s74 offen offset:0 lds
    s_add_u32 s98, s97, 0
    s_and_b32 s98, s98, 7
    s_lshl_b32 s99, s98, 7
    s_add_u32 s99, s99, s84
    s_lshl_b32 s98, s98, 19
    s_add_u32 s98, s98, s71
    s_add_u32 m0, s88, 65536
    s_nop 0
    buffer_load_dwordx4 v7, s[44:47], s99 offen offset:0 lds
    s_add_u32 s99, s99, 65536
    s_add_u32 m0, s88, 73728
    s_nop 0
    buffer_load_dwordx4 v7, s[44:47], s99 offen offset:0 lds
    s_add_u32 m0, s89, 16384
    s_nop 0
    buffer_load_dwordx4 v6, s[56:59], s98 offen offset:0 lds
    s_add_u32 m0, s89, 24448
    s_nop 0
    buffer_load_dwordx4 v6, s[56:59], s98 offen offset:128 lds
    s_add_u32 s98, s98, 262144
    s_add_u32 m0, s89, 20480
    s_nop 0
    buffer_load_dwordx4 v6, s[56:59], s98 offen offset:0 lds
    s_add_u32 m0, s89, 28544
    s_nop 0
    buffer_load_dwordx4 v6, s[56:59], s98 offen offset:128 lds
    s_add_u32 s98, s97, 1
    s_and_b32 s98, s98, 7
    s_lshl_b32 s99, s98, 7
    s_add_u32 s99, s99, s84
    s_lshl_b32 s98, s98, 19
    s_add_u32 s98, s98, s71
    s_add_u32 m0, s88, 131072
    s_nop 0
    buffer_load_dwordx4 v7, s[44:47], s99 offen offset:0 lds
    s_add_u32 s99, s99, 65536
    s_add_u32 m0, s88, 139264
    s_nop 0
    buffer_load_dwordx4 v7, s[44:47], s99 offen offset:0 lds
    s_add_u32 m0, s89, 32768
    s_nop 0
    buffer_load_dwordx4 v6, s[56:59], s98 offen offset:0 lds
    s_add_u32 m0, s89, 40832
    s_nop 0
    buffer_load_dwordx4 v6, s[56:59], s98 offen offset:128 lds
    s_add_u32 s98, s98, 262144
    s_add_u32 m0, s89, 36864
    s_nop 0
    buffer_load_dwordx4 v6, s[56:59], s98 offen offset:0 lds
    s_add_u32 m0, s89, 44928
    s_nop 0
    buffer_load_dwordx4 v6, s[56:59], s98 offen offset:128 lds
    v_bfe_u32 v56, v252, 5, 1
    v_bfe_u32 v57, v252, 2, 2
    v_bfe_u32 v58, v252, 0, 1
    v_bfe_u32 v59, v252, 1, 1
    v_bfe_u32 v60, v252, 4, 1
    v_bfe_u32 v61, v252, 3, 1
    v_bfe_u32 v253, v252, 0, 4
    v_bfe_u32 v254, v252, 4, 2
    v_lshlrev_b32 v246, 6, v61
    v_lshl_add_u32 v246, v60, 5, v246
    v_lshl_add_u32 v246, v58, 4, v246
    v_lshl_add_u32 v246, v59, 3, v246
    v_lshl_add_u32 v246, v57, 7, v246
    v_lshl_add_u32 v249, v56, 10, v246
    v_add_u32 v255, s85, v249
    v_lshl_add_u32 v246, v56, 9, v246
    v_add_u32 v238, s85, v246
    v_xor_b32 v239, 64, v238
    v_lshlrev_b32 v247, 6, v61
    v_lshl_add_u32 v247, v59, 4, v247
    v_lshl_add_u32 v247, v58, 3, v247
    v_lshl_add_u32 v247, v57, 7, v247
    v_lshl_add_u32 v248, v60, 9, v247
    v_lshl_add_u32 v248, v56, 10, v248
    s_lshl_b32 s74, s68, 11
    s_add_u32 s75, s74, s85
    v_add_u32 v240, s75, v248
    v_xor_b32 v241, 64, v240
    v_bfe_u32 v246, v252, 0, 5
    v_lshlrev_b32 v246, 7, v246
    v_add_u32 v246, s85, v246
    v_bfe_u32 v247, v252, 1, 3
    v_xor_b32 v247, v247, v56
    v_xor_b32 v248, 0, v247
    v_lshl_add_u32 v232, v248, 4, v246
    v_xor_b32 v248, 2, v247
    v_lshl_add_u32 v233, v248, 4, v246
    v_xor_b32 v248, 4, v247
    v_lshl_add_u32 v234, v248, 4, v246
    v_xor_b32 v248, 6, v247
    v_lshl_add_u32 v235, v248, 4, v246
    v_lshlrev_b32 v246, 7, v253
    v_add_u32 v246, s75, v246
    v_bfe_u32 v247, v252, 1, 3
    v_xor_b32 v247, v247, v254
    v_xor_b32 v248, 0, v247
    v_lshl_add_u32 v236, v248, 4, v246
    v_xor_b32 v248, 4, v247
    v_lshl_add_u32 v237, v248, 4, v246
    s_lshl_b32 s96, s68, 13
    s_add_u32 s96, s96, s85
    s_add_u32 s96, s96, 49152
    v_add_u32 v3, s96, v1
    v_lshlrev_b32 v247, 10, v56
    v_lshl_add_u32 v247, v60, 9, v247
    v_lshl_add_u32 v247, v253, 4, v247
    s_add_u32 s75, s75, 49152
    v_add_u32 v4, s75, v247
    v_mov_b32 v2, v247
    s_add_u32 s96, s85, 16384
    v_lshlrev_b32 v5, 3, v253
    v_add_u32 v5, s96, v5
    v_subrev_u32 v4, 32768, v4
    v_subrev_u32 v251, 32768, v3
    v_mov_b32 v176, v255
    v_xor_b32 v177, 64, v255
    s_lshl_b32 s74, s68, 12
    s_sub_u32 s74, s74, s85
    s_add_u32 s74, s74, 49152
    v_add_u32 v179, s74, v232
    v_add_u32 v180, s74, v233
    v_add_u32 v181, s74, v234
    v_add_u32 v182, s74, v235
    s_lshl_b32 s74, s68, 11
    s_add_u32 s74, s74, s85
    s_sub_u32 s74, 147456, s74
    v_add_u32 v183, s74, v236
    v_add_u32 v184, s74, v237
    v_bfe_u32 v246, v252, 3, 1
    v_lshlrev_b32 v246, 6, v246
    s_and_b32 s74, s68, 1
    s_lshl_b32 s74, s74, 6
    v_xor_b32 v246, s74, v246
    v_bfe_u32 v247, v252, 0, 2
    v_lshl_add_u32 v246, v247, 4, v246
    v_bfe_u32 v247, v252, 2, 2
    v_lshl_add_u32 v246, v247, 7, v246
    v_lshl_add_u32 v246, v254, 10, v246
    s_lshr_b32 s74, s68, 1
    s_lshl_b32 s74, s74, 13
    s_add_u32 s74, s74, s85
    v_add_u32 v178, s74, v246
    s_waitcnt vmcnt(6)
    s_barrier
    ds_read_b128 v[128:131], v179 offset:16384
    ds_read_b128 v[132:135], v180 offset:16384
    ds_read_b128 v[136:139], v181 offset:16384
    ds_read_b128 v[140:143], v182 offset:16384
    ds_read_b128 v[160:163], v183 offset:0
    ds_read_b128 v[164:167], v184 offset:0
    ds_read_b64_tr_b16 v[8:9], v176 offset:16384
    ds_read_b64_tr_b16 v[10:11], v176 offset:16896
    ds_read_b64_tr_b16 v[12:13], v177 offset:16384
    ds_read_b64_tr_b16 v[14:15], v177 offset:16896
    ds_read_b64_tr_b16 v[16:17], v176 offset:24576
    ds_read_b64_tr_b16 v[18:19], v176 offset:25088
    ds_read_b64_tr_b16 v[20:21], v177 offset:24576
    ds_read_b64_tr_b16 v[22:23], v177 offset:25088
    ds_read_b64_tr_b16 v[24:25], v176 offset:18432
    ds_read_b64_tr_b16 v[26:27], v176 offset:18944
    ds_read_b64_tr_b16 v[28:29], v177 offset:18432
    ds_read_b64_tr_b16 v[30:31], v177 offset:18944
    ds_read_b64_tr_b16 v[32:33], v176 offset:26624
    ds_read_b64_tr_b16 v[34:35], v176 offset:27136
    ds_read_b64_tr_b16 v[36:37], v177 offset:26624
    ds_read_b64_tr_b16 v[38:39], v177 offset:27136
    s_waitcnt lgkmcnt(14)
    v_mfma_f32_32x32x16_bf16 v[56:71], v[8:11], v[128:131], 0
    ds_read_b64_tr_b16 v[8:9], v178 offset:16384
    ds_read_b64_tr_b16 v[10:11], v178 offset:16896
    s_add_u32 s98, s97, 2
    s_and_b32 s98, s98, 7
    s_lshl_b32 s99, s98, 7
    s_add_u32 s99, s99, s84
    s_lshl_b32 s98, s98, 19
    s_add_u32 s98, s98, s71
    s_add_u32 m0, s88, 49152
    s_nop 0
    buffer_load_dwordx4 v7, s[44:47], s99 offen offset:0 lds
    s_waitcnt lgkmcnt(14)
    v_mfma_f32_32x32x16_bf16 v[72:87], v[12:15], v[128:131], 0
    ds_read_b64_tr_b16 v[12:13], v178 offset:16392
    ds_read_b64_tr_b16 v[14:15], v178 offset:16904
    s_waitcnt lgkmcnt(14)
    v_mfma_f32_32x32x16_bf16 v[88:103], v[16:19], v[128:131], 0
    ds_read_b64_tr_b16 v[16:17], v176 offset:20480
    ds_read_b64_tr_b16 v[18:19], v176 offset:20992
    s_add_u32 s99, s99, 65536
    s_add_u32 m0, s88, 57344
    s_nop 0
    buffer_load_dwordx4 v7, s[44:47], s99 offen offset:0 lds
    s_waitcnt lgkmcnt(14)
    v_mfma_f32_32x32x16_bf16 v[104:119], v[20:23], v[128:131], 0
    ds_read_b64_tr_b16 v[20:21], v177 offset:20480
    ds_read_b64_tr_b16 v[22:23], v177 offset:20992
    s_waitcnt lgkmcnt(14)
    v_mfma_f32_32x32x16_bf16 v[56:71], v[24:27], v[132:135], v[56:71]
    ds_read_b64_tr_b16 v[24:25], v176 offset:28672
    ds_read_b64_tr_b16 v[26:27], v176 offset:29184
    s_mov_b32 m0, s89
    s_nop 0
    buffer_load_dwordx4 v6, s[56:59], s98 offen offset:0 lds
    s_waitcnt lgkmcnt(14)
    v_mfma_f32_32x32x16_bf16 v[72:87], v[28:31], v[132:135], v[72:87]
    ds_read_b64_tr_b16 v[28:29], v177 offset:28672
    ds_read_b64_tr_b16 v[30:31], v177 offset:29184
    s_waitcnt lgkmcnt(14)
    v_mfma_f32_32x32x16_bf16 v[88:103], v[32:35], v[132:135], v[88:103]
    ds_read_b64_tr_b16 v[32:33], v176 offset:22528
    ds_read_b64_tr_b16 v[34:35], v176 offset:23040
    s_add_u32 m0, s89, 8064
    s_nop 0
    buffer_load_dwordx4 v6, s[56:59], s98 offen offset:128 lds
    s_waitcnt lgkmcnt(14)
    v_mfma_f32_32x32x16_bf16 v[104:119], v[36:39], v[132:135], v[104:119]
    ds_read_b64_tr_b16 v[36:37], v177 offset:22528
    ds_read_b64_tr_b16 v[38:39], v177 offset:23040
    s_waitcnt lgkmcnt(14)
    v_mfma_f32_16x16x32_bf16 v[120:123], v[8:11], v[160:163], 0
    ds_read_b64_tr_b16 v[8:9], v176 offset:30720
    ds_read_b64_tr_b16 v[10:11], v176 offset:31232
    s_waitcnt lgkmcnt(14)
    v_mfma_f32_16x16x32_bf16 v[124:127], v[12:15], v[160:163], 0
    ds_read_b64_tr_b16 v[12:13], v177 offset:30720
    ds_read_b64_tr_b16 v[14:15], v177 offset:31232
    s_waitcnt lgkmcnt(14)
    v_mfma_f32_32x32x16_bf16 v[56:71], v[16:19], v[136:139], v[56:71]
    ds_read_b64_tr_b16 v[16:17], v178 offset:20480
    ds_read_b64_tr_b16 v[18:19], v178 offset:20992
    s_add_u32 s98, s98, 262144
    s_add_u32 m0, s89, 4096
    s_nop 0
    buffer_load_dwordx4 v6, s[56:59], s98 offen offset:0 lds
    s_waitcnt lgkmcnt(14)
    v_mfma_f32_32x32x16_bf16 v[72:87], v[20:23], v[136:139], v[72:87]
    ds_read_b64_tr_b16 v[20:21], v178 offset:20488
    ds_read_b64_tr_b16 v[22:23], v178 offset:21000
    s_waitcnt lgkmcnt(14)
    v_mfma_f32_32x32x16_bf16 v[88:103], v[24:27], v[136:139], v[88:103]
    s_add_u32 m0, s89, 12160
    s_nop 0
    buffer_load_dwordx4 v6, s[56:59], s98 offen offset:128 lds
    s_waitcnt lgkmcnt(12)
    v_mfma_f32_32x32x16_bf16 v[104:119], v[28:31], v[136:139], v[104:119]
    s_waitcnt lgkmcnt(10)
    v_mfma_f32_32x32x16_bf16 v[56:71], v[32:35], v[140:143], v[56:71]
    s_waitcnt lgkmcnt(8)
    v_mfma_f32_32x32x16_bf16 v[72:87], v[36:39], v[140:143], v[72:87]
    s_waitcnt vmcnt(6)
    s_waitcnt lgkmcnt(0)
    s_barrier
    v_add_u32 v179, 0x10000, v179
    v_add_u32 v180, 0x10000, v180
    v_add_u32 v181, 0x10000, v181
    v_add_u32 v182, 0x10000, v182
    ds_read_b128 v[144:147], v179 offset:16384
    ds_read_b128 v[148:151], v180 offset:16384
    ds_read_b128 v[152:155], v181 offset:16384
    ds_read_b128 v[156:159], v182 offset:16384
    ds_read_b128 v[168:171], v183 offset:2048
    ds_read_b128 v[172:175], v184 offset:2048
    ds_read_b64_tr_b16 v[24:25], v176 offset:32768
    ds_read_b64_tr_b16 v[26:27], v176 offset:33280
    ds_read_b64_tr_b16 v[28:29], v177 offset:32768
    ds_read_b64_tr_b16 v[30:31], v177 offset:33280
    ds_read_b64_tr_b16 v[32:33], v176 offset:40960
    ds_read_b64_tr_b16 v[34:35], v176 offset:41472
    ds_read_b64_tr_b16 v[36:37], v177 offset:40960
    ds_read_b64_tr_b16 v[38:39], v177 offset:41472
    v_mfma_f32_32x32x16_bf16 v[88:103], v[8:11], v[140:143], v[88:103]
    ds_read_b64_tr_b16 v[8:9], v176 offset:34816
    ds_read_b64_tr_b16 v[10:11], v176 offset:35328
    s_add_u32 s98, s97, 3
    s_and_b32 s98, s98, 7
    s_lshl_b32 s99, s98, 7
    s_add_u32 s99, s99, s84
    s_lshl_b32 s98, s98, 19
    s_add_u32 s98, s98, s71
    s_add_u32 m0, s88, 65536
    s_nop 0
    buffer_load_dwordx4 v7, s[44:47], s99 offen offset:0 lds
    v_mfma_f32_32x32x16_bf16 v[104:119], v[12:15], v[140:143], v[104:119]
    ds_read_b64_tr_b16 v[12:13], v177 offset:34816
    ds_read_b64_tr_b16 v[14:15], v177 offset:35328
    v_mfma_f32_16x16x32_bf16 v[120:123], v[16:19], v[164:167], v[120:123]
    ds_read_b64_tr_b16 v[16:17], v176 offset:43008
    ds_read_b64_tr_b16 v[18:19], v176 offset:43520
    v_mfma_f32_16x16x32_bf16 v[124:127], v[20:23], v[164:167], v[124:127]
    ds_read_b64_tr_b16 v[20:21], v177 offset:43008
    ds_read_b64_tr_b16 v[22:23], v177 offset:43520
    s_waitcnt lgkmcnt(14)
    v_mfma_f32_32x32x16_bf16 v[56:71], v[24:27], v[144:147], v[56:71]
    ds_read_b64_tr_b16 v[24:25], v178 offset:32768
    ds_read_b64_tr_b16 v[26:27], v178 offset:33280
    s_add_u32 s99, s99, 65536
    s_add_u32 m0, s88, 73728
    s_nop 0
    buffer_load_dwordx4 v7, s[44:47], s99 offen offset:0 lds
    s_waitcnt lgkmcnt(14)
    v_mfma_f32_32x32x16_bf16 v[72:87], v[28:31], v[144:147], v[72:87]
    ds_read_b64_tr_b16 v[28:29], v178 offset:32776
    ds_read_b64_tr_b16 v[30:31], v178 offset:33288
    s_waitcnt lgkmcnt(14)
    v_mfma_f32_32x32x16_bf16 v[88:103], v[32:35], v[144:147], v[88:103]
    ds_read_b64_tr_b16 v[32:33], v176 offset:36864
    ds_read_b64_tr_b16 v[34:35], v176 offset:37376
    s_add_u32 m0, s89, 16384
    s_nop 0
    buffer_load_dwordx4 v6, s[56:59], s98 offen offset:0 lds
    s_waitcnt lgkmcnt(14)
    v_mfma_f32_32x32x16_bf16 v[104:119], v[36:39], v[144:147], v[104:119]
    ds_read_b64_tr_b16 v[36:37], v177 offset:36864
    ds_read_b64_tr_b16 v[38:39], v177 offset:37376
    s_waitcnt lgkmcnt(14)
    v_mfma_f32_32x32x16_bf16 v[56:71], v[8:11], v[148:151], v[56:71]
    ds_read_b64_tr_b16 v[8:9], v176 offset:45056
    ds_read_b64_tr_b16 v[10:11], v176 offset:45568
    s_add_u32 m0, s89, 24448
    s_nop 0
    buffer_load_dwordx4 v6, s[56:59], s98 offen offset:128 lds
    s_waitcnt lgkmcnt(14)
    v_mfma_f32_32x32x16_bf16 v[72:87], v[12:15], v[148:151], v[72:87]
    ds_read_b64_tr_b16 v[12:13], v177 offset:45056
    ds_read_b64_tr_b16 v[14:15], v177 offset:45568
    s_waitcnt lgkmcnt(14)
    v_mfma_f32_32x32x16_bf16 v[88:103], v[16:19], v[148:151], v[88:103]
    ds_read_b64_tr_b16 v[16:17], v176 offset:38912
    ds_read_b64_tr_b16 v[18:19], v176 offset:39424
    s_add_u32 s98, s98, 262144
    s_add_u32 m0, s89, 20480
    s_nop 0
    buffer_load_dwordx4 v6, s[56:59], s98 offen offset:0 lds
    s_waitcnt lgkmcnt(14)
    v_mfma_f32_32x32x16_bf16 v[104:119], v[20:23], v[148:151], v[104:119]
    ds_read_b64_tr_b16 v[20:21], v177 offset:38912
    ds_read_b64_tr_b16 v[22:23], v177 offset:39424
    s_waitcnt lgkmcnt(14)
    v_mfma_f32_16x16x32_bf16 v[120:123], v[24:27], v[168:171], v[120:123]
    ds_read_b64_tr_b16 v[24:25], v176 offset:47104
    ds_read_b64_tr_b16 v[26:27], v176 offset:47616
    s_waitcnt lgkmcnt(14)
    v_mfma_f32_16x16x32_bf16 v[124:127], v[28:31], v[168:171], v[124:127]
    ds_read_b64_tr_b16 v[28:29], v177 offset:47104
    ds_read_b64_tr_b16 v[30:31], v177 offset:47616
    s_waitcnt lgkmcnt(14)
    v_mfma_f32_32x32x16_bf16 v[56:71], v[32:35], v[152:155], v[56:71]
    ds_read_b64_tr_b16 v[32:33], v178 offset:36864
    ds_read_b64_tr_b16 v[34:35], v178 offset:37376
    s_add_u32 m0, s89, 28544
    s_nop 0
    buffer_load_dwordx4 v6, s[56:59], s98 offen offset:128 lds
    s_waitcnt lgkmcnt(14)
    v_mfma_f32_32x32x16_bf16 v[72:87], v[36:39], v[152:155], v[72:87]
    ds_read_b64_tr_b16 v[36:37], v178 offset:36872
    ds_read_b64_tr_b16 v[38:39], v178 offset:37384
    s_waitcnt lgkmcnt(14)
    v_mfma_f32_32x32x16_bf16 v[88:103], v[8:11], v[152:155], v[88:103]
    s_waitcnt lgkmcnt(12)
    v_mfma_f32_32x32x16_bf16 v[104:119], v[12:15], v[152:155], v[104:119]
    s_waitcnt lgkmcnt(10)
    v_mfma_f32_32x32x16_bf16 v[56:71], v[16:19], v[156:159], v[56:71]
    s_waitcnt lgkmcnt(8)
    v_mfma_f32_32x32x16_bf16 v[72:87], v[20:23], v[156:159], v[72:87]
    s_waitcnt vmcnt(6)
    s_waitcnt lgkmcnt(0)
    s_barrier
    v_subrev_u32 v179, 0x10000, v179
    v_subrev_u32 v180, 0x10000, v180
    v_subrev_u32 v181, 0x10000, v181
    v_subrev_u32 v182, 0x10000, v182
    ds_read_b128 v[128:131], v179 offset:0
    ds_read_b128 v[132:135], v180 offset:0
    ds_read_b128 v[136:139], v181 offset:0
    ds_read_b128 v[140:143], v182 offset:0
    ds_read_b128 v[160:163], v183 offset:4096
    ds_read_b128 v[164:167], v184 offset:4096
    ds_read_b64_tr_b16 v[8:9], v176 offset:0
    ds_read_b64_tr_b16 v[10:11], v176 offset:512
    ds_read_b64_tr_b16 v[12:13], v177 offset:0
    ds_read_b64_tr_b16 v[14:15], v177 offset:512
    ds_read_b64_tr_b16 v[16:17], v176 offset:8192
    ds_read_b64_tr_b16 v[18:19], v176 offset:8704
    ds_read_b64_tr_b16 v[20:21], v177 offset:8192
    ds_read_b64_tr_b16 v[22:23], v177 offset:8704
    v_mfma_f32_32x32x16_bf16 v[88:103], v[24:27], v[156:159], v[88:103]
    ds_read_b64_tr_b16 v[24:25], v176 offset:2048
    ds_read_b64_tr_b16 v[26:27], v176 offset:2560
    s_add_u32 s98, s97, 4
    s_and_b32 s98, s98, 7
    s_lshl_b32 s99, s98, 7
    s_add_u32 s99, s99, s84
    s_lshl_b32 s98, s98, 19
    s_add_u32 s98, s98, s71
    s_add_u32 m0, s88, 131072
    s_nop 0
    buffer_load_dwordx4 v7, s[44:47], s99 offen offset:0 lds
    v_mfma_f32_32x32x16_bf16 v[104:119], v[28:31], v[156:159], v[104:119]
    ds_read_b64_tr_b16 v[28:29], v177 offset:2048
    ds_read_b64_tr_b16 v[30:31], v177 offset:2560
    v_mfma_f32_16x16x32_bf16 v[120:123], v[32:35], v[172:175], v[120:123]
    ds_read_b64_tr_b16 v[32:33], v176 offset:10240
    ds_read_b64_tr_b16 v[34:35], v176 offset:10752
    v_mfma_f32_16x16x32_bf16 v[124:127], v[36:39], v[172:175], v[124:127]
    ds_read_b64_tr_b16 v[36:37], v177 offset:10240
    ds_read_b64_tr_b16 v[38:39], v177 offset:10752
    s_waitcnt lgkmcnt(14)
    v_mfma_f32_32x32x16_bf16 v[56:71], v[8:11], v[128:131], v[56:71]
    ds_read_b64_tr_b16 v[8:9], v178 offset:0
    ds_read_b64_tr_b16 v[10:11], v178 offset:512
    s_add_u32 s99, s99, 65536
    s_add_u32 m0, s88, 139264
    s_nop 0
    buffer_load_dwordx4 v7, s[44:47], s99 offen offset:0 lds
    s_waitcnt lgkmcnt(14)
    v_mfma_f32_32x32x16_bf16 v[72:87], v[12:15], v[128:131], v[72:87]
    ds_read_b64_tr_b16 v[12:13], v178 offset:8
    ds_read_b64_tr_b16 v[14:15], v178 offset:520
    s_waitcnt lgkmcnt(14)
    v_mfma_f32_32x32x16_bf16 v[88:103], v[16:19], v[128:131], v[88:103]
    ds_read_b64_tr_b16 v[16:17], v176 offset:4096
    ds_read_b64_tr_b16 v[18:19], v176 offset:4608
    s_add_u32 m0, s89, 32768
    s_nop 0
    buffer_load_dwordx4 v6, s[56:59], s98 offen offset:0 lds
    s_waitcnt lgkmcnt(14)
    v_mfma_f32_32x32x16_bf16 v[104:119], v[20:23], v[128:131], v[104:119]
    ds_read_b64_tr_b16 v[20:21], v177 offset:4096
    ds_read_b64_tr_b16 v[22:23], v177 offset:4608
    s_waitcnt lgkmcnt(14)
    v_mfma_f32_32x32x16_bf16 v[56:71], v[24:27], v[132:135], v[56:71]
    ds_read_b64_tr_b16 v[24:25], v176 offset:12288
    ds_read_b64_tr_b16 v[26:27], v176 offset:12800
    s_add_u32 m0, s89, 40832
    s_nop 0
    buffer_load_dwordx4 v6, s[56:59], s98 offen offset:128 lds
    s_waitcnt lgkmcnt(14)
    v_mfma_f32_32x32x16_bf16 v[72:87], v[28:31], v[132:135], v[72:87]
    ds_read_b64_tr_b16 v[28:29], v177 offset:12288
    ds_read_b64_tr_b16 v[30:31], v177 offset:12800
    s_waitcnt lgkmcnt(14)
    v_mfma_f32_32x32x16_bf16 v[88:103], v[32:35], v[132:135], v[88:103]
    ds_read_b64_tr_b16 v[32:33], v176 offset:6144
    ds_read_b64_tr_b16 v[34:35], v176 offset:6656
    s_add_u32 s98, s98, 262144
    s_add_u32 m0, s89, 36864
    s_nop 0
    buffer_load_dwordx4 v6, s[56:59], s98 offen offset:0 lds
    s_waitcnt lgkmcnt(14)
    v_mfma_f32_32x32x16_bf16 v[104:119], v[36:39], v[132:135], v[104:119]
    ds_read_b64_tr_b16 v[36:37], v177 offset:6144
    ds_read_b64_tr_b16 v[38:39], v177 offset:6656
    s_waitcnt lgkmcnt(14)
    v_mfma_f32_16x16x32_bf16 v[120:123], v[8:11], v[160:163], v[120:123]
    ds_read_b64_tr_b16 v[8:9], v176 offset:14336
    ds_read_b64_tr_b16 v[10:11], v176 offset:14848
    s_waitcnt lgkmcnt(14)
    v_mfma_f32_16x16x32_bf16 v[124:127], v[12:15], v[160:163], v[124:127]
    ds_read_b64_tr_b16 v[12:13], v177 offset:14336
    ds_read_b64_tr_b16 v[14:15], v177 offset:14848
    s_waitcnt lgkmcnt(14)
    v_mfma_f32_32x32x16_bf16 v[56:71], v[16:19], v[136:139], v[56:71]
    ds_read_b64_tr_b16 v[16:17], v178 offset:4096
    ds_read_b64_tr_b16 v[18:19], v178 offset:4608
    s_add_u32 m0, s89, 44928
    s_nop 0
    buffer_load_dwordx4 v6, s[56:59], s98 offen offset:128 lds
    s_waitcnt lgkmcnt(14)
    v_mfma_f32_32x32x16_bf16 v[72:87], v[20:23], v[136:139], v[72:87]
    ds_read_b64_tr_b16 v[20:21], v178 offset:4104
    ds_read_b64_tr_b16 v[22:23], v178 offset:4616
    s_waitcnt lgkmcnt(14)
    v_mfma_f32_32x32x16_bf16 v[88:103], v[24:27], v[136:139], v[88:103]
    s_waitcnt lgkmcnt(12)
    v_mfma_f32_32x32x16_bf16 v[104:119], v[28:31], v[136:139], v[104:119]
    s_waitcnt lgkmcnt(10)
    v_mfma_f32_32x32x16_bf16 v[56:71], v[32:35], v[140:143], v[56:71]
    s_waitcnt lgkmcnt(8)
    v_mfma_f32_32x32x16_bf16 v[72:87], v[36:39], v[140:143], v[72:87]
    s_waitcnt vmcnt(6)
    s_waitcnt lgkmcnt(0)
    s_barrier
    ds_read_b128 v[144:147], v179 offset:16384
    ds_read_b128 v[148:151], v180 offset:16384
    ds_read_b128 v[152:155], v181 offset:16384
    ds_read_b128 v[156:159], v182 offset:16384
    ds_read_b128 v[168:171], v183 offset:6144
    ds_read_b128 v[172:175], v184 offset:6144
    ds_read_b64_tr_b16 v[24:25], v176 offset:16384
    ds_read_b64_tr_b16 v[26:27], v176 offset:16896
    ds_read_b64_tr_b16 v[28:29], v177 offset:16384
    ds_read_b64_tr_b16 v[30:31], v177 offset:16896
    ds_read_b64_tr_b16 v[32:33], v176 offset:24576
    ds_read_b64_tr_b16 v[34:35], v176 offset:25088
    ds_read_b64_tr_b16 v[36:37], v177 offset:24576
    ds_read_b64_tr_b16 v[38:39], v177 offset:25088
    v_mfma_f32_32x32x16_bf16 v[88:103], v[8:11], v[140:143], v[88:103]
    ds_read_b64_tr_b16 v[8:9], v176 offset:18432
    ds_read_b64_tr_b16 v[10:11], v176 offset:18944
    s_add_u32 s98, s97, 5
    s_and_b32 s98, s98, 7
    s_lshl_b32 s99, s98, 7
    s_add_u32 s99, s99, s84
    s_lshl_b32 s98, s98, 19
    s_add_u32 s98, s98, s71
    s_add_u32 m0, s88, 49152
    s_nop 0
    buffer_load_dwordx4 v7, s[44:47], s99 offen offset:0 lds
    v_mfma_f32_32x32x16_bf16 v[104:119], v[12:15], v[140:143], v[104:119]
    ds_read_b64_tr_b16 v[12:13], v177 offset:18432
    ds_read_b64_tr_b16 v[14:15], v177 offset:18944
    v_mfma_f32_16x16x32_bf16 v[120:123], v[16:19], v[164:167], v[120:123]
    ds_read_b64_tr_b16 v[16:17], v176 offset:26624
    ds_read_b64_tr_b16 v[18:19], v176 offset:27136
    v_mfma_f32_16x16x32_bf16 v[124:127], v[20:23], v[164:167], v[124:127]
    ds_read_b64_tr_b16 v[20:21], v177 offset:26624
    ds_read_b64_tr_b16 v[22:23], v177 offset:27136
    s_waitcnt lgkmcnt(14)
    v_mfma_f32_32x32x16_bf16 v[56:71], v[24:27], v[144:147], v[56:71]
    ds_read_b64_tr_b16 v[24:25], v178 offset:16384
    ds_read_b64_tr_b16 v[26:27], v178 offset:16896
    s_add_u32 s99, s99, 65536
    s_add_u32 m0, s88, 57344
    s_nop 0
    buffer_load_dwordx4 v7, s[44:47], s99 offen offset:0 lds
    s_waitcnt lgkmcnt(14)
    v_mfma_f32_32x32x16_bf16 v[72:87], v[28:31], v[144:147], v[72:87]
    ds_read_b64_tr_b16 v[28:29], v178 offset:16392
    ds_read_b64_tr_b16 v[30:31], v178 offset:16904
    s_waitcnt lgkmcnt(14)
    v_mfma_f32_32x32x16_bf16 v[88:103], v[32:35], v[144:147], v[88:103]
    ds_read_b64_tr_b16 v[32:33], v176 offset:20480
    ds_read_b64_tr_b16 v[34:35], v176 offset:20992
    s_mov_b32 m0, s89
    s_nop 0
    buffer_load_dwordx4 v6, s[56:59], s98 offen offset:0 lds
    s_waitcnt lgkmcnt(14)
    v_mfma_f32_32x32x16_bf16 v[104:119], v[36:39], v[144:147], v[104:119]
    ds_read_b64_tr_b16 v[36:37], v177 offset:20480
    ds_read_b64_tr_b16 v[38:39], v177 offset:20992
    s_waitcnt lgkmcnt(14)
    v_mfma_f32_32x32x16_bf16 v[56:71], v[8:11], v[148:151], v[56:71]
    ds_read_b64_tr_b16 v[8:9], v176 offset:28672
    ds_read_b64_tr_b16 v[10:11], v176 offset:29184
    s_add_u32 m0, s89, 8064
    s_nop 0
    buffer_load_dwordx4 v6, s[56:59], s98 offen offset:128 lds
    s_waitcnt lgkmcnt(14)
    v_mfma_f32_32x32x16_bf16 v[72:87], v[12:15], v[148:151], v[72:87]
    ds_read_b64_tr_b16 v[12:13], v177 offset:28672
    ds_read_b64_tr_b16 v[14:15], v177 offset:29184
    s_waitcnt lgkmcnt(14)
    v_mfma_f32_32x32x16_bf16 v[88:103], v[16:19], v[148:151], v[88:103]
    ds_read_b64_tr_b16 v[16:17], v176 offset:22528
    ds_read_b64_tr_b16 v[18:19], v176 offset:23040
    s_add_u32 s98, s98, 262144
    s_add_u32 m0, s89, 4096
    s_nop 0
    buffer_load_dwordx4 v6, s[56:59], s98 offen offset:0 lds
    s_waitcnt lgkmcnt(14)
    v_mfma_f32_32x32x16_bf16 v[104:119], v[20:23], v[148:151], v[104:119]
    ds_read_b64_tr_b16 v[20:21], v177 offset:22528
    ds_read_b64_tr_b16 v[22:23], v177 offset:23040
    s_waitcnt lgkmcnt(14)
    v_mfma_f32_16x16x32_bf16 v[120:123], v[24:27], v[168:171], v[120:123]
    ds_read_b64_tr_b16 v[24:25], v176 offset:30720
    ds_read_b64_tr_b16 v[26:27], v176 offset:31232
    s_waitcnt lgkmcnt(14)
    v_mfma_f32_16x16x32_bf16 v[124:127], v[28:31], v[168:171], v[124:127]
    ds_read_b64_tr_b16 v[28:29], v177 offset:30720
    ds_read_b64_tr_b16 v[30:31], v177 offset:31232
    s_waitcnt lgkmcnt(14)
    v_mfma_f32_32x32x16_bf16 v[56:71], v[32:35], v[152:155], v[56:71]
    ds_read_b64_tr_b16 v[32:33], v178 offset:20480
    ds_read_b64_tr_b16 v[34:35], v178 offset:20992
    s_add_u32 m0, s89, 12160
    s_nop 0
    buffer_load_dwordx4 v6, s[56:59], s98 offen offset:128 lds
    s_waitcnt lgkmcnt(14)
    v_mfma_f32_32x32x16_bf16 v[72:87], v[36:39], v[152:155], v[72:87]
    ds_read_b64_tr_b16 v[36:37], v178 offset:20488
    ds_read_b64_tr_b16 v[38:39], v178 offset:21000
    s_waitcnt lgkmcnt(14)
    v_mfma_f32_32x32x16_bf16 v[88:103], v[8:11], v[152:155], v[88:103]
    s_waitcnt lgkmcnt(12)
    v_mfma_f32_32x32x16_bf16 v[104:119], v[12:15], v[152:155], v[104:119]
    s_waitcnt lgkmcnt(10)
    v_mfma_f32_32x32x16_bf16 v[56:71], v[16:19], v[156:159], v[56:71]
    s_waitcnt lgkmcnt(8)
    v_mfma_f32_32x32x16_bf16 v[72:87], v[20:23], v[156:159], v[72:87]
    s_waitcnt vmcnt(6)
    s_waitcnt lgkmcnt(0)
    s_barrier
    v_add_u32 v179, 0x10000, v179
    v_add_u32 v180, 0x10000, v180
    v_add_u32 v181, 0x10000, v181
    v_add_u32 v182, 0x10000, v182
    ds_read_b128 v[128:131], v179 offset:16384
    ds_read_b128 v[132:135], v180 offset:16384
    ds_read_b128 v[136:139], v181 offset:16384
    ds_read_b128 v[140:143], v182 offset:16384
    ds_read_b128 v[160:163], v183 offset:8192
    ds_read_b128 v[164:167], v184 offset:8192
    ds_read_b64_tr_b16 v[8:9], v176 offset:32768
    ds_read_b64_tr_b16 v[10:11], v176 offset:33280
    ds_read_b64_tr_b16 v[12:13], v177 offset:32768
    ds_read_b64_tr_b16 v[14:15], v177 offset:33280
    ds_read_b64_tr_b16 v[16:17], v176 offset:40960
    ds_read_b64_tr_b16 v[18:19], v176 offset:41472
    ds_read_b64_tr_b16 v[20:21], v177 offset:40960
    ds_read_b64_tr_b16 v[22:23], v177 offset:41472
    v_mfma_f32_32x32x16_bf16 v[88:103], v[24:27], v[156:159], v[88:103]
    ds_read_b64_tr_b16 v[24:25], v176 offset:34816
    ds_read_b64_tr_b16 v[26:27], v176 offset:35328
    s_add_u32 s98, s97, 6
    s_and_b32 s98, s98, 7
    s_lshl_b32 s99, s98, 7
    s_add_u32 s99, s99, s84
    s_lshl_b32 s98, s98, 19
    s_add_u32 s98, s98, s71
    s_add_u32 m0, s88, 65536
    s_nop 0
    buffer_load_dwordx4 v7, s[44:47], s99 offen offset:0 lds
    v_mfma_f32_32x32x16_bf16 v[104:119], v[28:31], v[156:159], v[104:119]
    ds_read_b64_tr_b16 v[28:29], v177 offset:34816
    ds_read_b64_tr_b16 v[30:31], v177 offset:35328
    v_mfma_f32_16x16x32_bf16 v[120:123], v[32:35], v[172:175], v[120:123]
    ds_read_b64_tr_b16 v[32:33], v176 offset:43008
    ds_read_b64_tr_b16 v[34:35], v176 offset:43520
    v_mfma_f32_16x16x32_bf16 v[124:127], v[36:39], v[172:175], v[124:127]
    ds_read_b64_tr_b16 v[36:37], v177 offset:43008
    ds_read_b64_tr_b16 v[38:39], v177 offset:43520
    s_waitcnt lgkmcnt(14)
    v_mfma_f32_32x32x16_bf16 v[56:71], v[8:11], v[128:131], v[56:71]
    ds_read_b64_tr_b16 v[8:9], v178 offset:32768
    ds_read_b64_tr_b16 v[10:11], v178 offset:33280
    s_add_u32 s99, s99, 65536
    s_add_u32 m0, s88, 73728
    s_nop 0
    buffer_load_dwordx4 v7, s[44:47], s99 offen offset:0 lds
    s_waitcnt lgkmcnt(14)
    v_mfma_f32_32x32x16_bf16 v[72:87], v[12:15], v[128:131], v[72:87]
    ds_read_b64_tr_b16 v[12:13], v178 offset:32776
    ds_read_b64_tr_b16 v[14:15], v178 offset:33288
    s_waitcnt lgkmcnt(14)
    v_mfma_f32_32x32x16_bf16 v[88:103], v[16:19], v[128:131], v[88:103]
    ds_read_b64_tr_b16 v[16:17], v176 offset:36864
    ds_read_b64_tr_b16 v[18:19], v176 offset:37376
    s_add_u32 m0, s89, 16384
    s_nop 0
    buffer_load_dwordx4 v6, s[56:59], s98 offen offset:0 lds
    s_waitcnt lgkmcnt(14)
    v_mfma_f32_32x32x16_bf16 v[104:119], v[20:23], v[128:131], v[104:119]
    ds_read_b64_tr_b16 v[20:21], v177 offset:36864
    ds_read_b64_tr_b16 v[22:23], v177 offset:37376
    s_waitcnt lgkmcnt(14)
    v_mfma_f32_32x32x16_bf16 v[56:71], v[24:27], v[132:135], v[56:71]
    ds_read_b64_tr_b16 v[24:25], v176 offset:45056
    ds_read_b64_tr_b16 v[26:27], v176 offset:45568
    s_add_u32 m0, s89, 24448
    s_nop 0
    buffer_load_dwordx4 v6, s[56:59], s98 offen offset:128 lds
    s_waitcnt lgkmcnt(14)
    v_mfma_f32_32x32x16_bf16 v[72:87], v[28:31], v[132:135], v[72:87]
    ds_read_b64_tr_b16 v[28:29], v177 offset:45056
    ds_read_b64_tr_b16 v[30:31], v177 offset:45568
    s_waitcnt lgkmcnt(14)
    v_mfma_f32_32x32x16_bf16 v[88:103], v[32:35], v[132:135], v[88:103]
    ds_read_b64_tr_b16 v[32:33], v176 offset:38912
    ds_read_b64_tr_b16 v[34:35], v176 offset:39424
    s_add_u32 s98, s98, 262144
    s_add_u32 m0, s89, 20480
    s_nop 0
    buffer_load_dwordx4 v6, s[56:59], s98 offen offset:0 lds
    s_waitcnt lgkmcnt(14)
    v_mfma_f32_32x32x16_bf16 v[104:119], v[36:39], v[132:135], v[104:119]
    ds_read_b64_tr_b16 v[36:37], v177 offset:38912
    ds_read_b64_tr_b16 v[38:39], v177 offset:39424
    s_waitcnt lgkmcnt(14)
    v_mfma_f32_16x16x32_bf16 v[120:123], v[8:11], v[160:163], v[120:123]
    ds_read_b64_tr_b16 v[8:9], v176 offset:47104
    ds_read_b64_tr_b16 v[10:11], v176 offset:47616
    s_waitcnt lgkmcnt(14)
    v_mfma_f32_16x16x32_bf16 v[124:127], v[12:15], v[160:163], v[124:127]
    ds_read_b64_tr_b16 v[12:13], v177 offset:47104
    ds_read_b64_tr_b16 v[14:15], v177 offset:47616
    s_waitcnt lgkmcnt(14)
    v_mfma_f32_32x32x16_bf16 v[56:71], v[16:19], v[136:139], v[56:71]
    ds_read_b64_tr_b16 v[16:17], v178 offset:36864
    ds_read_b64_tr_b16 v[18:19], v178 offset:37376
    s_add_u32 m0, s89, 28544
    s_nop 0
    buffer_load_dwordx4 v6, s[56:59], s98 offen offset:128 lds
    s_waitcnt lgkmcnt(14)
    v_mfma_f32_32x32x16_bf16 v[72:87], v[20:23], v[136:139], v[72:87]
    ds_read_b64_tr_b16 v[20:21], v178 offset:36872
    ds_read_b64_tr_b16 v[22:23], v178 offset:37384
    s_waitcnt lgkmcnt(14)
    v_mfma_f32_32x32x16_bf16 v[88:103], v[24:27], v[136:139], v[88:103]
    s_waitcnt lgkmcnt(12)
    v_mfma_f32_32x32x16_bf16 v[104:119], v[28:31], v[136:139], v[104:119]
    s_waitcnt lgkmcnt(10)
    v_mfma_f32_32x32x16_bf16 v[56:71], v[32:35], v[140:143], v[56:71]
    s_waitcnt lgkmcnt(8)
    v_mfma_f32_32x32x16_bf16 v[72:87], v[36:39], v[140:143], v[72:87]
    s_waitcnt vmcnt(6)
    s_waitcnt lgkmcnt(0)
    s_barrier
    v_subrev_u32 v179, 0x10000, v179
    v_subrev_u32 v180, 0x10000, v180
    v_subrev_u32 v181, 0x10000, v181
    v_subrev_u32 v182, 0x10000, v182
    ds_read_b128 v[144:147], v179 offset:0
    ds_read_b128 v[148:151], v180 offset:0
    ds_read_b128 v[152:155], v181 offset:0
    ds_read_b128 v[156:159], v182 offset:0
    ds_read_b128 v[168:171], v183 offset:10240
    ds_read_b128 v[172:175], v184 offset:10240
    ds_read_b64_tr_b16 v[24:25], v176 offset:0
    ds_read_b64_tr_b16 v[26:27], v176 offset:512
    ds_read_b64_tr_b16 v[28:29], v177 offset:0
    ds_read_b64_tr_b16 v[30:31], v177 offset:512
    ds_read_b64_tr_b16 v[32:33], v176 offset:8192
    ds_read_b64_tr_b16 v[34:35], v176 offset:8704
    ds_read_b64_tr_b16 v[36:37], v177 offset:8192
    ds_read_b64_tr_b16 v[38:39], v177 offset:8704
    v_mfma_f32_32x32x16_bf16 v[88:103], v[8:11], v[140:143], v[88:103]
    ds_read_b64_tr_b16 v[8:9], v176 offset:2048
    ds_read_b64_tr_b16 v[10:11], v176 offset:2560
    s_add_u32 s98, s97, 7
    s_and_b32 s98, s98, 7
    s_lshl_b32 s99, s98, 7
    s_add_u32 s99, s99, s84
    s_lshl_b32 s98, s98, 19
    s_add_u32 s98, s98, s71
    s_add_u32 m0, s88, 131072
    s_nop 0
    buffer_load_dwordx4 v7, s[44:47], s99 offen offset:0 lds
    v_mfma_f32_32x32x16_bf16 v[104:119], v[12:15], v[140:143], v[104:119]
    ds_read_b64_tr_b16 v[12:13], v177 offset:2048
    ds_read_b64_tr_b16 v[14:15], v177 offset:2560
    v_mfma_f32_16x16x32_bf16 v[120:123], v[16:19], v[164:167], v[120:123]
    ds_read_b64_tr_b16 v[16:17], v176 offset:10240
    ds_read_b64_tr_b16 v[18:19], v176 offset:10752
    v_mfma_f32_16x16x32_bf16 v[124:127], v[20:23], v[164:167], v[124:127]
    ds_read_b64_tr_b16 v[20:21], v177 offset:10240
    ds_read_b64_tr_b16 v[22:23], v177 offset:10752
    s_waitcnt lgkmcnt(14)
    v_mfma_f32_32x32x16_bf16 v[56:71], v[24:27], v[144:147], v[56:71]
    ds_read_b64_tr_b16 v[24:25], v178 offset:0
    ds_read_b64_tr_b16 v[26:27], v178 offset:512
    s_add_u32 s99, s99, 65536
    s_add_u32 m0, s88, 139264
    s_nop 0
    buffer_load_dwordx4 v7, s[44:47], s99 offen offset:0 lds
    s_waitcnt lgkmcnt(14)
    v_mfma_f32_32x32x16_bf16 v[72:87], v[28:31], v[144:147], v[72:87]
    ds_read_b64_tr_b16 v[28:29], v178 offset:8
    ds_read_b64_tr_b16 v[30:31], v178 offset:520
    s_waitcnt lgkmcnt(14)
    v_mfma_f32_32x32x16_bf16 v[88:103], v[32:35], v[144:147], v[88:103]
    ds_read_b64_tr_b16 v[32:33], v176 offset:4096
    ds_read_b64_tr_b16 v[34:35], v176 offset:4608
    s_add_u32 m0, s89, 32768
    s_nop 0
    buffer_load_dwordx4 v6, s[56:59], s98 offen offset:0 lds
    s_waitcnt lgkmcnt(14)
    v_mfma_f32_32x32x16_bf16 v[104:119], v[36:39], v[144:147], v[104:119]
    ds_read_b64_tr_b16 v[36:37], v177 offset:4096
    ds_read_b64_tr_b16 v[38:39], v177 offset:4608
    s_waitcnt lgkmcnt(14)
    v_mfma_f32_32x32x16_bf16 v[56:71], v[8:11], v[148:151], v[56:71]
    ds_read_b64_tr_b16 v[8:9], v176 offset:12288
    ds_read_b64_tr_b16 v[10:11], v176 offset:12800
    s_add_u32 m0, s89, 40832
    s_nop 0
    buffer_load_dwordx4 v6, s[56:59], s98 offen offset:128 lds
    s_waitcnt lgkmcnt(14)
    v_mfma_f32_32x32x16_bf16 v[72:87], v[12:15], v[148:151], v[72:87]
    ds_read_b64_tr_b16 v[12:13], v177 offset:12288
    ds_read_b64_tr_b16 v[14:15], v177 offset:12800
    s_waitcnt lgkmcnt(14)
    v_mfma_f32_32x32x16_bf16 v[88:103], v[16:19], v[148:151], v[88:103]
    ds_read_b64_tr_b16 v[16:17], v176 offset:6144
    ds_read_b64_tr_b16 v[18:19], v176 offset:6656
    s_add_u32 s98, s98, 262144
    s_add_u32 m0, s89, 36864
    s_nop 0
    buffer_load_dwordx4 v6, s[56:59], s98 offen offset:0 lds
    s_waitcnt lgkmcnt(14)
    v_mfma_f32_32x32x16_bf16 v[104:119], v[20:23], v[148:151], v[104:119]
    ds_read_b64_tr_b16 v[20:21], v177 offset:6144
    ds_read_b64_tr_b16 v[22:23], v177 offset:6656
    s_waitcnt lgkmcnt(14)
    v_mfma_f32_16x16x32_bf16 v[120:123], v[24:27], v[168:171], v[120:123]
    ds_read_b64_tr_b16 v[24:25], v176 offset:14336
    ds_read_b64_tr_b16 v[26:27], v176 offset:14848
    s_waitcnt lgkmcnt(14)
    v_mfma_f32_16x16x32_bf16 v[124:127], v[28:31], v[168:171], v[124:127]
    ds_read_b64_tr_b16 v[28:29], v177 offset:14336
    ds_read_b64_tr_b16 v[30:31], v177 offset:14848
    s_waitcnt lgkmcnt(14)
    v_mfma_f32_32x32x16_bf16 v[56:71], v[32:35], v[152:155], v[56:71]
    ds_read_b64_tr_b16 v[32:33], v178 offset:4096
    ds_read_b64_tr_b16 v[34:35], v178 offset:4608
    s_add_u32 m0, s89, 44928
    s_nop 0
    buffer_load_dwordx4 v6, s[56:59], s98 offen offset:128 lds
    s_waitcnt lgkmcnt(14)
    v_mfma_f32_32x32x16_bf16 v[72:87], v[36:39], v[152:155], v[72:87]
    ds_read_b64_tr_b16 v[36:37], v178 offset:4104
    ds_read_b64_tr_b16 v[38:39], v178 offset:4616
    s_waitcnt lgkmcnt(14)
    v_mfma_f32_32x32x16_bf16 v[88:103], v[8:11], v[152:155], v[88:103]
    s_waitcnt lgkmcnt(12)
    v_mfma_f32_32x32x16_bf16 v[104:119], v[12:15], v[152:155], v[104:119]
    s_waitcnt lgkmcnt(10)
    v_mfma_f32_32x32x16_bf16 v[56:71], v[16:19], v[156:159], v[56:71]
    s_waitcnt lgkmcnt(8)
    v_mfma_f32_32x32x16_bf16 v[72:87], v[20:23], v[156:159], v[72:87]
    s_waitcnt vmcnt(6)
    s_waitcnt lgkmcnt(0)
    s_barrier
    ds_read_b128 v[128:131], v179 offset:16384
    ds_read_b128 v[132:135], v180 offset:16384
    ds_read_b128 v[136:139], v181 offset:16384
    ds_read_b128 v[140:143], v182 offset:16384
    ds_read_b128 v[160:163], v183 offset:12288
    ds_read_b128 v[164:167], v184 offset:12288
    ds_read_b64_tr_b16 v[8:9], v176 offset:16384
    ds_read_b64_tr_b16 v[10:11], v176 offset:16896
    ds_read_b64_tr_b16 v[12:13], v177 offset:16384
    ds_read_b64_tr_b16 v[14:15], v177 offset:16896
    ds_read_b64_tr_b16 v[16:17], v176 offset:24576
    ds_read_b64_tr_b16 v[18:19], v176 offset:25088
    ds_read_b64_tr_b16 v[20:21], v177 offset:24576
    ds_read_b64_tr_b16 v[22:23], v177 offset:25088
    v_mfma_f32_32x32x16_bf16 v[88:103], v[24:27], v[156:159], v[88:103]
    ds_read_b64_tr_b16 v[24:25], v176 offset:18432
    ds_read_b64_tr_b16 v[26:27], v176 offset:18944
    s_add_u32 s95, s70, s8
    s_mov_b32 m0, s89
    s_nop 0
    buffer_load_dwordx4 v242, s[48:51], s95 offen offset:0 nt lds
    v_mfma_f32_32x32x16_bf16 v[104:119], v[28:31], v[156:159], v[104:119]
    ds_read_b64_tr_b16 v[28:29], v177 offset:18432
    ds_read_b64_tr_b16 v[30:31], v177 offset:18944
    v_mfma_f32_16x16x32_bf16 v[120:123], v[32:35], v[172:175], v[120:123]
    ds_read_b64_tr_b16 v[32:33], v176 offset:26624
    ds_read_b64_tr_b16 v[34:35], v176 offset:27136
    v_mfma_f32_16x16x32_bf16 v[124:127], v[36:39], v[172:175], v[124:127]
    ds_read_b64_tr_b16 v[36:37], v177 offset:26624
    ds_read_b64_tr_b16 v[38:39], v177 offset:27136
    s_waitcnt lgkmcnt(14)
    v_mfma_f32_32x32x16_bf16 v[56:71], v[8:11], v[128:131], v[56:71]
    ds_read_b64_tr_b16 v[8:9], v178 offset:16384
    ds_read_b64_tr_b16 v[10:11], v178 offset:16896
    s_add_u32 s95, s70, s8
    s_add_u32 m0, s89, 8064
    s_nop 0
    buffer_load_dwordx4 v242, s[48:51], s95 offen offset:128 nt lds
    s_waitcnt lgkmcnt(14)
    v_mfma_f32_32x32x16_bf16 v[72:87], v[12:15], v[128:131], v[72:87]
    ds_read_b64_tr_b16 v[12:13], v178 offset:16392
    ds_read_b64_tr_b16 v[14:15], v178 offset:16904
    s_waitcnt lgkmcnt(14)
    v_mfma_f32_32x32x16_bf16 v[88:103], v[16:19], v[128:131], v[88:103]
    ds_read_b64_tr_b16 v[16:17], v176 offset:20480
    ds_read_b64_tr_b16 v[18:19], v176 offset:20992
    s_add_u32 s95, s70, s8
    s_add_u32 s95, s95, 8192
    s_add_u32 m0, s89, 4096
    s_nop 0
    buffer_load_dwordx4 v242, s[48:51], s95 offen offset:0 nt lds
    s_waitcnt lgkmcnt(14)
    v_mfma_f32_32x32x16_bf16 v[104:119], v[20:23], v[128:131], v[104:119]
    ds_read_b64_tr_b16 v[20:21], v177 offset:20480
    ds_read_b64_tr_b16 v[22:23], v177 offset:20992
    s_waitcnt lgkmcnt(14)
    v_mfma_f32_32x32x16_bf16 v[56:71], v[24:27], v[132:135], v[56:71]
    ds_read_b64_tr_b16 v[24:25], v176 offset:28672
    ds_read_b64_tr_b16 v[26:27], v176 offset:29184
    s_add_u32 s95, s70, s8
    s_add_u32 s95, s95, 8192
    s_add_u32 m0, s89, 12160
    s_nop 0
    buffer_load_dwordx4 v242, s[48:51], s95 offen offset:128 nt lds
    s_waitcnt lgkmcnt(14)
    v_mfma_f32_32x32x16_bf16 v[72:87], v[28:31], v[132:135], v[72:87]
    ds_read_b64_tr_b16 v[28:29], v177 offset:28672
    ds_read_b64_tr_b16 v[30:31], v177 offset:29184
    s_waitcnt lgkmcnt(14)
    v_mfma_f32_32x32x16_bf16 v[88:103], v[32:35], v[132:135], v[88:103]
    ds_read_b64_tr_b16 v[32:33], v176 offset:22528
    ds_read_b64_tr_b16 v[34:35], v176 offset:23040
    s_waitcnt lgkmcnt(14)
    v_mfma_f32_32x32x16_bf16 v[104:119], v[36:39], v[132:135], v[104:119]
    ds_read_b64_tr_b16 v[36:37], v177 offset:22528
    ds_read_b64_tr_b16 v[38:39], v177 offset:23040
    s_waitcnt lgkmcnt(14)
    v_mfma_f32_16x16x32_bf16 v[120:123], v[8:11], v[160:163], v[120:123]
    ds_read_b64_tr_b16 v[8:9], v176 offset:30720
    ds_read_b64_tr_b16 v[10:11], v176 offset:31232
    s_waitcnt lgkmcnt(14)
    v_mfma_f32_16x16x32_bf16 v[124:127], v[12:15], v[160:163], v[124:127]
    ds_read_b64_tr_b16 v[12:13], v177 offset:30720
    ds_read_b64_tr_b16 v[14:15], v177 offset:31232
    s_waitcnt lgkmcnt(14)
    v_mfma_f32_32x32x16_bf16 v[56:71], v[16:19], v[136:139], v[56:71]
    ds_read_b64_tr_b16 v[16:17], v178 offset:20480
    ds_read_b64_tr_b16 v[18:19], v178 offset:20992
    s_waitcnt lgkmcnt(14)
    v_mfma_f32_32x32x16_bf16 v[72:87], v[20:23], v[136:139], v[72:87]
    ds_read_b64_tr_b16 v[20:21], v178 offset:20488
    ds_read_b64_tr_b16 v[22:23], v178 offset:21000
    s_waitcnt lgkmcnt(14)
    v_mfma_f32_32x32x16_bf16 v[88:103], v[24:27], v[136:139], v[88:103]
    s_waitcnt lgkmcnt(12)
    v_mfma_f32_32x32x16_bf16 v[104:119], v[28:31], v[136:139], v[104:119]
    s_waitcnt lgkmcnt(10)
    v_mfma_f32_32x32x16_bf16 v[56:71], v[32:35], v[140:143], v[56:71]
    s_waitcnt lgkmcnt(8)
    v_mfma_f32_32x32x16_bf16 v[72:87], v[36:39], v[140:143], v[72:87]
    s_waitcnt vmcnt(4)
    s_waitcnt lgkmcnt(0)
    s_barrier
    v_add_u32 v179, 0x10000, v179
    v_add_u32 v180, 0x10000, v180
    v_add_u32 v181, 0x10000, v181
    v_add_u32 v182, 0x10000, v182
    ds_read_b128 v[144:147], v179 offset:16384
    ds_read_b128 v[148:151], v180 offset:16384
    ds_read_b128 v[152:155], v181 offset:16384
    ds_read_b128 v[156:159], v182 offset:16384
    ds_read_b128 v[168:171], v183 offset:14336
    ds_read_b128 v[172:175], v184 offset:14336
    ds_read_b64_tr_b16 v[24:25], v176 offset:32768
    ds_read_b64_tr_b16 v[26:27], v176 offset:33280
    ds_read_b64_tr_b16 v[28:29], v177 offset:32768
    ds_read_b64_tr_b16 v[30:31], v177 offset:33280
    ds_read_b64_tr_b16 v[32:33], v176 offset:40960
    ds_read_b64_tr_b16 v[34:35], v176 offset:41472
    ds_read_b64_tr_b16 v[36:37], v177 offset:40960
    ds_read_b64_tr_b16 v[38:39], v177 offset:41472
    v_mfma_f32_32x32x16_bf16 v[88:103], v[8:11], v[140:143], v[88:103]
    ds_read_b64_tr_b16 v[8:9], v176 offset:34816
    ds_read_b64_tr_b16 v[10:11], v176 offset:35328
    s_add_u32 s95, s70, s8
    s_add_u32 m0, s89, 16384
    s_nop 0
    buffer_load_dwordx4 v243, s[52:55], s95 offen offset:0 nt lds
    v_mfma_f32_32x32x16_bf16 v[104:119], v[12:15], v[140:143], v[104:119]
    ds_read_b64_tr_b16 v[12:13], v177 offset:34816
    ds_read_b64_tr_b16 v[14:15], v177 offset:35328
    v_mfma_f32_16x16x32_bf16 v[120:123], v[16:19], v[164:167], v[120:123]
    ds_read_b64_tr_b16 v[16:17], v176 offset:43008
    ds_read_b64_tr_b16 v[18:19], v176 offset:43520
    v_mfma_f32_16x16x32_bf16 v[124:127], v[20:23], v[164:167], v[124:127]
    ds_read_b64_tr_b16 v[20:21], v177 offset:43008
    ds_read_b64_tr_b16 v[22:23], v177 offset:43520
    s_waitcnt lgkmcnt(14)
    v_mfma_f32_32x32x16_bf16 v[56:71], v[24:27], v[144:147], v[56:71]
    ds_read_b64_tr_b16 v[24:25], v178 offset:32768
    ds_read_b64_tr_b16 v[26:27], v178 offset:33280
    s_add_u32 s95, s70, s8
    s_add_u32 m0, s89, 24448
    s_nop 0
    buffer_load_dwordx4 v243, s[52:55], s95 offen offset:128 nt lds
    s_waitcnt lgkmcnt(14)
    v_mfma_f32_32x32x16_bf16 v[72:87], v[28:31], v[144:147], v[72:87]
    ds_read_b64_tr_b16 v[28:29], v178 offset:32776
    ds_read_b64_tr_b16 v[30:31], v178 offset:33288
    s_waitcnt lgkmcnt(14)
    v_mfma_f32_32x32x16_bf16 v[88:103], v[32:35], v[144:147], v[88:103]
    ds_read_b64_tr_b16 v[32:33], v176 offset:36864
    ds_read_b64_tr_b16 v[34:35], v176 offset:37376
    s_add_u32 s95, s70, s8
    s_add_u32 s95, s95, 8192
    s_add_u32 m0, s89, 20480
    s_nop 0
    buffer_load_dwordx4 v243, s[52:55], s95 offen offset:0 nt lds
    s_waitcnt lgkmcnt(14)
    v_mfma_f32_32x32x16_bf16 v[104:119], v[36:39], v[144:147], v[104:119]
    ds_read_b64_tr_b16 v[36:37], v177 offset:36864
    ds_read_b64_tr_b16 v[38:39], v177 offset:37376
    s_waitcnt lgkmcnt(14)
    v_mfma_f32_32x32x16_bf16 v[56:71], v[8:11], v[148:151], v[56:71]
    ds_read_b64_tr_b16 v[8:9], v176 offset:45056
    ds_read_b64_tr_b16 v[10:11], v176 offset:45568
    s_add_u32 s95, s70, s8
    s_add_u32 s95, s95, 8192
    s_add_u32 m0, s89, 28544
    s_nop 0
    buffer_load_dwordx4 v243, s[52:55], s95 offen offset:128 nt lds
    s_waitcnt lgkmcnt(14)
    v_mfma_f32_32x32x16_bf16 v[72:87], v[12:15], v[148:151], v[72:87]
    ds_read_b64_tr_b16 v[12:13], v177 offset:45056
    ds_read_b64_tr_b16 v[14:15], v177 offset:45568
    s_waitcnt lgkmcnt(14)
    v_mfma_f32_32x32x16_bf16 v[88:103], v[16:19], v[148:151], v[88:103]
    ds_read_b64_tr_b16 v[16:17], v176 offset:38912
    ds_read_b64_tr_b16 v[18:19], v176 offset:39424
    s_waitcnt lgkmcnt(14)
    v_mfma_f32_32x32x16_bf16 v[104:119], v[20:23], v[148:151], v[104:119]
    ds_read_b64_tr_b16 v[20:21], v177 offset:38912
    ds_read_b64_tr_b16 v[22:23], v177 offset:39424
    s_waitcnt lgkmcnt(14)
    v_mfma_f32_16x16x32_bf16 v[120:123], v[24:27], v[168:171], v[120:123]
    ds_read_b64_tr_b16 v[24:25], v176 offset:47104
    ds_read_b64_tr_b16 v[26:27], v176 offset:47616
    s_waitcnt lgkmcnt(14)
    v_mfma_f32_16x16x32_bf16 v[124:127], v[28:31], v[168:171], v[124:127]
    ds_read_b64_tr_b16 v[28:29], v177 offset:47104
    ds_read_b64_tr_b16 v[30:31], v177 offset:47616
    s_waitcnt lgkmcnt(14)
    v_mfma_f32_32x32x16_bf16 v[56:71], v[32:35], v[152:155], v[56:71]
    ds_read_b64_tr_b16 v[32:33], v178 offset:36864
    ds_read_b64_tr_b16 v[34:35], v178 offset:37376
    s_waitcnt lgkmcnt(14)
    v_mfma_f32_32x32x16_bf16 v[72:87], v[36:39], v[152:155], v[72:87]
    ds_read_b64_tr_b16 v[36:37], v178 offset:36872
    ds_read_b64_tr_b16 v[38:39], v178 offset:37384
    s_waitcnt lgkmcnt(14)
    v_mfma_f32_32x32x16_bf16 v[88:103], v[8:11], v[152:155], v[88:103]
    s_waitcnt lgkmcnt(12)
    v_mfma_f32_32x32x16_bf16 v[104:119], v[12:15], v[152:155], v[104:119]
    s_waitcnt lgkmcnt(10)
    v_mfma_f32_32x32x16_bf16 v[56:71], v[16:19], v[156:159], v[56:71]
    s_waitcnt lgkmcnt(8)
    v_mfma_f32_32x32x16_bf16 v[72:87], v[20:23], v[156:159], v[72:87]
    s_waitcnt lgkmcnt(6)
    v_mfma_f32_32x32x16_bf16 v[88:103], v[24:27], v[156:159], v[88:103]
    s_waitcnt lgkmcnt(4)
    v_mfma_f32_32x32x16_bf16 v[104:119], v[28:31], v[156:159], v[104:119]
    s_waitcnt lgkmcnt(2)
    v_mfma_f32_16x16x32_bf16 v[120:123], v[32:35], v[172:175], v[120:123]
    s_waitcnt lgkmcnt(0)
    v_mfma_f32_16x16x32_bf16 v[124:127], v[36:39], v[172:175], v[124:127]
    s_cmp_eq_u32 s79, 0
    s_cbranch_scc1 L_nolag0
    s_barrier
L_nolag0:
    s_nop 2
    v_mul_f32 v120, s83, v120
    v_mul_f32 v121, s83, v121
    v_mul_f32 v122, s83, v122
    v_mul_f32 v123, s83, v123
    v_mul_f32 v124, s83, v124
    v_mul_f32 v125, s83, v125
    v_mul_f32 v126, s83, v126
    v_mul_f32 v127, s83, v127
    v_cvt_pk_bf16_f32 v128, v120, v121
    v_cvt_pk_bf16_f32 v129, v122, v123
    v_cvt_pk_bf16_f32 v130, v124, v125
    v_cvt_pk_bf16_f32 v131, v126, v127
    s_mul_i32 s74, s79, 98304
    s_add_u32 s74, s74, 49152
    v_add_u32 v250, s74, v1
    v_add_u32 v247, s69, v250
    ds_write_b128 v247, v[128:131] offset:0
    v_mul_f32 v56, s83, v56
    v_mul_f32 v57, s83, v57
    v_mul_f32 v58, s83, v58
    v_mul_f32 v59, s83, v59
    v_mul_f32 v60, s83, v60
    v_mul_f32 v61, s83, v61
    v_mul_f32 v62, s83, v62
    v_mul_f32 v63, s83, v63
    v_mul_f32 v64, s83, v64
    v_mul_f32 v65, s83, v65
    v_mul_f32 v66, s83, v66
    v_mul_f32 v67, s83, v67
    v_mul_f32 v68, s83, v68
    v_mul_f32 v69, s83, v69
    v_mul_f32 v70, s83, v70
    v_mul_f32 v71, s83, v71
    v_mul_f32 v72, s83, v72
    v_mul_f32 v73, s83, v73
    v_mul_f32 v74, s83, v74
    v_mul_f32 v75, s83, v75
    v_mul_f32 v76, s83, v76
    v_mul_f32 v77, s83, v77
    v_mul_f32 v78, s83, v78
    v_mul_f32 v79, s83, v79
    v_mul_f32 v80, s83, v80
    v_mul_f32 v81, s83, v81
    v_mul_f32 v82, s83, v82
    v_mul_f32 v83, s83, v83
    v_mul_f32 v84, s83, v84
    v_mul_f32 v85, s83, v85
    v_mul_f32 v86, s83, v86
    v_mul_f32 v87, s83, v87
    v_mul_f32 v88, s83, v88
    v_mul_f32 v89, s83, v89
    v_mul_f32 v90, s83, v90
    v_mul_f32 v91, s83, v91
    v_mul_f32 v92, s83, v92
    v_mul_f32 v93, s83, v93
    v_mul_f32 v94, s83, v94
    v_mul_f32 v95, s83, v95
    v_mul_f32 v96, s83, v96
    v_mul_f32 v97, s83, v97
    v_mul_f32 v98, s83, v98
    v_mul_f32 v99, s83, v99
    v_mul_f32 v100, s83, v100
    v_mul_f32 v101, s83, v101
    v_mul_f32 v102, s83, v102
    v_mul_f32 v103, s83, v103
    v_mul_f32 v104, s83, v104
    v_mul_f32 v105, s83, v105
    v_mul_f32 v106, s83, v106
    v_mul_f32 v107, s83, v107
    v_mul_f32 v108, s83, v108
    v_mul_f32 v109, s83, v109
    v_mul_f32 v110, s83, v110
    v_mul_f32 v111, s83, v111
    v_mul_f32 v112, s83, v112
    v_mul_f32 v113, s83, v113
    v_mul_f32 v114, s83, v114
    v_mul_f32 v115, s83, v115
    v_mul_f32 v116, s83, v116
    v_mul_f32 v117, s83, v117
    v_mul_f32 v118, s83, v118
    v_mul_f32 v119, s83, v119
    v_cvt_pk_bf16_f32 v8, v56, v57
    v_cvt_pk_bf16_f32 v9, v58, v59
    v_cvt_pk_bf16_f32 v10, v60, v61
    v_cvt_pk_bf16_f32 v11, v62, v63
    v_cvt_pk_bf16_f32 v12, v64, v65
    v_cvt_pk_bf16_f32 v13, v66, v67
    v_cvt_pk_bf16_f32 v14, v68, v69
    v_cvt_pk_bf16_f32 v15, v70, v71
    v_cvt_pk_bf16_f32 v16, v72, v73
    v_cvt_pk_bf16_f32 v17, v74, v75
    v_cvt_pk_bf16_f32 v18, v76, v77
    v_cvt_pk_bf16_f32 v19, v78, v79
    v_cvt_pk_bf16_f32 v20, v80, v81
    v_cvt_pk_bf16_f32 v21, v82, v83
    v_cvt_pk_bf16_f32 v22, v84, v85
    v_cvt_pk_bf16_f32 v23, v86, v87
    v_cvt_pk_bf16_f32 v24, v88, v89
    v_cvt_pk_bf16_f32 v25, v90, v91
    v_cvt_pk_bf16_f32 v26, v92, v93
    v_cvt_pk_bf16_f32 v27, v94, v95
    v_cvt_pk_bf16_f32 v28, v96, v97
    v_cvt_pk_bf16_f32 v29, v98, v99
    v_cvt_pk_bf16_f32 v30, v100, v101
    v_cvt_pk_bf16_f32 v31, v102, v103
    v_cvt_pk_bf16_f32 v32, v104, v105
    v_cvt_pk_bf16_f32 v33, v106, v107
    v_cvt_pk_bf16_f32 v34, v108, v109
    v_cvt_pk_bf16_f32 v35, v110, v111
    v_cvt_pk_bf16_f32 v36, v112, v113
    v_cvt_pk_bf16_f32 v37, v114, v115
    v_cvt_pk_bf16_f32 v38, v116, v117
    v_cvt_pk_bf16_f32 v39, v118, v119
    s_waitcnt vmcnt(4)
    s_waitcnt lgkmcnt(0)
    s_barrier
    ds_read_b128 v[40:43], v250 offset:0
    ds_read_b128 v[44:47], v250 offset:1024
    ds_read_b128 v[48:51], v250 offset:2048
    ds_read_b128 v[52:55], v250 offset:3072
    ds_read_b128 v[208:211], v232 offset:0
    ds_read_b128 v[212:215], v233 offset:0
    ds_read_b128 v[216:219], v234 offset:0
    ds_read_b128 v[220:223], v235 offset:0
    ds_read_b128 v[224:227], v232 offset:8192
    ds_read_b128 v[228:231], v233 offset:8192
    s_waitcnt lgkmcnt(5)
    v_mfma_f32_32x32x16_bf16 v[152:167], v[208:211], v[8:11], 0
    ds_read_b128 v[208:211], v234 offset:8192
    s_add_u32 s95, s70, s9
    s_add_u32 m0, s89, 32768
    s_nop 0
    buffer_load_dwordx4 v242, s[48:51], s95 offen offset:0 nt lds
    s_waitcnt lgkmcnt(5)
    v_mfma_f32_32x32x16_bf16 v[152:167], v[212:215], v[12:15], v[152:167]
    ds_read_b128 v[212:215], v235 offset:8192
    s_add_u32 s95, s70, s9
    s_add_u32 m0, s89, 40832
    s_nop 0
    buffer_load_dwordx4 v242, s[48:51], s95 offen offset:128 nt lds
    s_waitcnt lgkmcnt(5)
    v_mfma_f32_32x32x16_bf16 v[152:167], v[216:219], v[16:19], v[152:167]
    ds_read_b128 v[216:219], v236 offset:0
    s_add_u32 s95, s70, s9
    s_add_u32 s95, s95, 8192
    s_add_u32 m0, s89, 36864
    s_nop 0
    buffer_load_dwordx4 v242, s[48:51], s95 offen offset:0 nt lds
    s_waitcnt lgkmcnt(5)
    v_mfma_f32_32x32x16_bf16 v[152:167], v[220:223], v[20:23], v[152:167]
    ds_read_b128 v[220:223], v237 offset:0
    s_add_u32 s95, s70, s9
    s_add_u32 s95, s95, 8192
    s_add_u32 m0, s89, 44928
    s_nop 0
    buffer_load_dwordx4 v242, s[48:51], s95 offen offset:128 nt lds
    s_waitcnt lgkmcnt(5)
    v_mfma_f32_32x32x16_bf16 v[152:167], v[224:227], v[24:27], v[152:167]
    ds_read_b128 v[224:227], v236 offset:8192
    s_waitcnt lgkmcnt(5)
    v_mfma_f32_32x32x16_bf16 v[152:167], v[228:231], v[28:31], v[152:167]
    ds_read_b128 v[228:231], v237 offset:8192
    s_waitcnt lgkmcnt(5)
    v_mfma_f32_32x32x16_bf16 v[152:167], v[208:211], v[32:35], v[152:167]
    ds_read_b128 v[208:211], v232 offset:4096
    s_waitcnt lgkmcnt(5)
    v_mfma_f32_32x32x16_bf16 v[152:167], v[212:215], v[36:39], v[152:167]
    ds_read_b128 v[212:215], v233 offset:4096
    s_waitcnt lgkmcnt(5)
    v_mfma_f32_16x16x32_bf16 v[184:187], v[216:219], v[40:43], 0
    ds_read_b128 v[216:219], v234 offset:4096
    s_waitcnt lgkmcnt(5)
    v_mfma_f32_16x16x32_bf16 v[184:187], v[220:223], v[44:47], v[184:187]
    ds_read_b128 v[220:223], v235 offset:4096
    s_waitcnt lgkmcnt(5)
    v_mfma_f32_16x16x32_bf16 v[184:187], v[224:227], v[48:51], v[184:187]
    ds_read_b128 v[224:227], v232 offset:12288
    s_waitcnt lgkmcnt(5)
    v_mfma_f32_16x16x32_bf16 v[184:187], v[228:231], v[52:55], v[184:187]
    ds_read_b128 v[228:231], v233 offset:12288
    s_waitcnt lgkmcnt(5)
    v_mfma_f32_32x32x16_bf16 v[168:183], v[208:211], v[8:11], 0
    ds_read_b128 v[208:211], v234 offset:12288
    s_waitcnt lgkmcnt(5)
    v_mfma_f32_32x32x16_bf16 v[168:183], v[212:215], v[12:15], v[168:183]
    ds_read_b128 v[212:215], v235 offset:12288
    s_waitcnt lgkmcnt(5)
    v_mfma_f32_32x32x16_bf16 v[168:183], v[216:219], v[16:19], v[168:183]
    s_waitcnt lgkmcnt(4)
    v_mfma_f32_32x32x16_bf16 v[168:183], v[220:223], v[20:23], v[168:183]
    s_waitcnt lgkmcnt(3)
    v_mfma_f32_32x32x16_bf16 v[168:183], v[224:227], v[24:27], v[168:183]
    s_waitcnt vmcnt(4)
    s_waitcnt lgkmcnt(0)
    s_barrier
    ds_read_b64_tr_b16 v[216:217], v238 offset:16384
    ds_read_b64_tr_b16 v[218:219], v238 offset:17408
    ds_read_b64_tr_b16 v[220:221], v239 offset:16384
    ds_read_b64_tr_b16 v[222:223], v239 offset:17408
    ds_read_b64_tr_b16 v[224:225], v238 offset:24576
    ds_read_b64_tr_b16 v[226:227], v238 offset:25600
    s_add_u32 s95, s70, s9
    s_mov_b32 m0, s89
    s_nop 0
    buffer_load_dwordx4 v243, s[52:55], s95 offen offset:0 nt lds
    v_mfma_f32_32x32x16_bf16 v[168:183], v[228:231], v[28:31], v[168:183]
    ds_read_b64_tr_b16 v[228:229], v239 offset:24576
    ds_read_b64_tr_b16 v[230:231], v239 offset:25600
    s_add_u32 s95, s70, s9
    s_add_u32 m0, s89, 8064
    s_nop 0
    buffer_load_dwordx4 v243, s[52:55], s95 offen offset:128 nt lds
    v_mfma_f32_32x32x16_bf16 v[168:183], v[208:211], v[32:35], v[168:183]
    ds_read_b64_tr_b16 v[208:209], v238 offset:18432
    ds_read_b64_tr_b16 v[210:211], v238 offset:19456
    s_add_u32 s95, s70, s9
    s_add_u32 s95, s95, 8192
    s_add_u32 m0, s89, 4096
    s_nop 0
    buffer_load_dwordx4 v243, s[52:55], s95 offen offset:0 nt lds
    v_mfma_f32_32x32x16_bf16 v[168:183], v[212:215], v[36:39], v[168:183]
    ds_read_b64_tr_b16 v[212:213], v239 offset:18432
    ds_read_b64_tr_b16 v[214:215], v239 offset:19456
    s_add_u32 s95, s70, s9
    s_add_u32 s95, s95, 8192
    s_add_u32 m0, s89, 12160
    s_nop 0
    buffer_load_dwordx4 v243, s[52:55], s95 offen offset:128 nt lds
    v_max3_f32 v246, v152, v153, v154
    v_max3_f32 v246, v246, v155, v156
    v_max3_f32 v246, v246, v157, v158
    v_max3_f32 v246, v246, v159, v160
    v_max3_f32 v246, v246, v161, v162
    v_max3_f32 v246, v246, v163, v164
    v_max3_f32 v246, v246, v165, v166
    v_max3_f32 v246, v246, v167, v168
    v_max3_f32 v246, v246, v169, v170
    v_max3_f32 v246, v246, v171, v172
    v_max3_f32 v246, v246, v173, v174
    v_max3_f32 v246, v246, v175, v176
    v_max3_f32 v246, v246, v177, v178
    v_max3_f32 v246, v246, v179, v180
    v_max3_f32 v246, v246, v181, v182
    v_max_f32 v246, v246, v183
    v_max3_f32 v247, v184, v185, v186
    v_max_f32 v247, v247, v187
    v_mov_b32 v248, v246
    s_nop 1
    v_permlane32_swap_b32 v246, v248
    v_max_f32 v246, v246, v248
    v_mov_b32 v248, v247
    s_nop 1
    v_permlane32_swap_b32 v247, v248
    v_max_f32 v247, v247, v248
    v_mov_b32 v248, v247
    s_nop 1
    v_permlane16_swap_b32 v247, v248
    v_max_f32 v247, v247, v248
    v_sub_f32 v152, v152, v246
    v_sub_f32 v153, v153, v246
    v_sub_f32 v154, v154, v246
    v_sub_f32 v155, v155, v246
    v_sub_f32 v156, v156, v246
    v_sub_f32 v157, v157, v246
    v_sub_f32 v158, v158, v246
    v_sub_f32 v159, v159, v246
    v_sub_f32 v160, v160, v246
    v_sub_f32 v161, v161, v246
    v_sub_f32 v162, v162, v246
    v_sub_f32 v163, v163, v246
    v_sub_f32 v164, v164, v246
    v_sub_f32 v165, v165, v246
    v_sub_f32 v166, v166, v246
    v_sub_f32 v167, v167, v246
    v_sub_f32 v168, v168, v246
    v_sub_f32 v169, v169, v246
    v_sub_f32 v170, v170, v246
    v_sub_f32 v171, v171, v246
    v_sub_f32 v172, v172, v246
    v_sub_f32 v173, v173, v246
    v_sub_f32 v174, v174, v246
    v_sub_f32 v175, v175, v246
    v_sub_f32 v176, v176, v246
    v_sub_f32 v177, v177, v246
    v_sub_f32 v178, v178, v246
    v_sub_f32 v179, v179, v246
    v_sub_f32 v180, v180, v246
    v_sub_f32 v181, v181, v246
    v_sub_f32 v182, v182, v246
    v_sub_f32 v183, v183, v246
    v_sub_f32 v184, v184, v247
    v_sub_f32 v185, v185, v247
    v_sub_f32 v186, v186, v247
    v_sub_f32 v187, v187, v247
    v_sub_f32 v188, 0, v246
    v_sub_f32 v189, 0, v246
    v_sub_f32 v190, 0, v246
    v_sub_f32 v191, 0, v246
    v_sub_f32 v192, 0, v246
    v_sub_f32 v193, 0, v246
    v_sub_f32 v194, 0, v246
    v_sub_f32 v195, 0, v246
    v_sub_f32 v196, 0, v246
    v_sub_f32 v197, 0, v246
    v_sub_f32 v198, 0, v246
    v_sub_f32 v199, 0, v246
    v_sub_f32 v200, 0, v246
    v_sub_f32 v201, 0, v246
    v_sub_f32 v202, 0, v246
    v_sub_f32 v203, 0, v246
    v_sub_f32 v204, 0, v247
    v_sub_f32 v205, 0, v247
    v_sub_f32 v206, 0, v247
    v_sub_f32 v207, 0, v247
    v_exp_f32 v184, v184
    v_exp_f32 v185, v185
    v_exp_f32 v186, v186
    v_exp_f32 v187, v187
    v_add_f32 v245, v184, v185
    v_cvt_pk_bf16_f32 v184, v184, v185
    v_add_f32 v245, v245, v186
    v_add_f32 v245, v245, v187
    v_cvt_pk_bf16_f32 v185, v186, v187
    v_exp_f32 v152, v152
    v_exp_f32 v153, v153
    v_exp_f32 v154, v154
    v_exp_f32 v155, v155
    v_add_f32 v244, v152, v153
    v_cvt_pk_bf16_f32 v152, v152, v153
    v_exp_f32 v156, v156
    v_exp_f32 v157, v157
    v_add_f32 v244, v244, v154
    v_add_f32 v244, v244, v155
    v_cvt_pk_bf16_f32 v153, v154, v155
    v_exp_f32 v158, v158
    v_exp_f32 v159, v159
    v_add_f32 v244, v244, v156
    v_add_f32 v244, v244, v157
    v_cvt_pk_bf16_f32 v154, v156, v157
    v_exp_f32 v160, v160
    v_exp_f32 v161, v161
    v_add_f32 v244, v244, v158
    v_add_f32 v244, v244, v159
    v_cvt_pk_bf16_f32 v155, v158, v159
    v_exp_f32 v162, v162
    v_exp_f32 v163, v163
    v_add_f32 v244, v244, v160
    v_add_f32 v244, v244, v161
    v_cvt_pk_bf16_f32 v156, v160, v161
    v_exp_f32 v164, v164
    v_exp_f32 v165, v165
    v_add_f32 v244, v244, v162
    v_add_f32 v244, v244, v163
    v_cvt_pk_bf16_f32 v157, v162, v163
    v_exp_f32 v166, v166
    v_exp_f32 v167, v167
    v_add_f32 v244, v244, v164
    v_add_f32 v244, v244, v165
    v_cvt_pk_bf16_f32 v158, v164, v165
    v_add_f32 v244, v244, v166
    v_add_f32 v244, v244, v167
    v_cvt_pk_bf16_f32 v159, v166, v167
    s_waitcnt lgkmcnt(10)
    v_mfma_f32_32x32x16_bf16 v[56:71], v[216:219], v[152:155], 0
    ds_read_b64_tr_b16 v[216:217], v238 offset:26624
    ds_read_b64_tr_b16 v[218:219], v238 offset:27648
    v_exp_f32 v168, v168
    v_exp_f32 v169, v169
    v_exp_f32 v170, v170
    s_waitcnt lgkmcnt(10)
    v_mfma_f32_32x32x16_bf16 v[72:87], v[220:223], v[152:155], 0
    ds_read_b64_tr_b16 v[220:221], v239 offset:26624
    ds_read_b64_tr_b16 v[222:223], v239 offset:27648
    v_exp_f32 v171, v171
    v_add_f32 v244, v244, v168
    v_add_f32 v244, v244, v169
    v_cvt_pk_bf16_f32 v168, v168, v169
    v_exp_f32 v172, v172
    s_waitcnt lgkmcnt(10)
    v_mfma_f32_32x32x16_bf16 v[88:103], v[224:227], v[152:155], 0
    ds_read_b64_tr_b16 v[224:225], v240 offset:16384
    ds_read_b64_tr_b16 v[226:227], v240 offset:16416
    v_exp_f32 v173, v173
    v_add_f32 v244, v244, v170
    v_add_f32 v244, v244, v171
    v_cvt_pk_bf16_f32 v169, v170, v171
    v_exp_f32 v174, v174
    s_waitcnt lgkmcnt(10)
    v_mfma_f32_32x32x16_bf16 v[104:119], v[228:231], v[152:155], 0
    ds_read_b64_tr_b16 v[228:229], v241 offset:16384
    ds_read_b64_tr_b16 v[230:231], v241 offset:16416
    v_exp_f32 v175, v175
    v_add_f32 v244, v244, v172
    v_add_f32 v244, v244, v173
    v_cvt_pk_bf16_f32 v170, v172, v173
    v_exp_f32 v176, v176
    s_waitcnt lgkmcnt(10)
    v_mfma_f32_32x32x16_bf16 v[56:71], v[208:211], v[156:159], v[56:71]
    ds_read_b64_tr_b16 v[208:209], v240 offset:24576
    ds_read_b64_tr_b16 v[210:211], v240 offset:24608
    v_exp_f32 v177, v177
    v_add_f32 v244, v244, v174
    v_add_f32 v244, v244, v175
    v_cvt_pk_bf16_f32 v171, v174, v175
    v_exp_f32 v178, v178
    s_waitcnt lgkmcnt(10)
    v_mfma_f32_32x32x16_bf16 v[72:87], v[212:215], v[156:159], v[72:87]
    ds_read_b64_tr_b16 v[212:213], v241 offset:24576
    ds_read_b64_tr_b16 v[214:215], v241 offset:24608
    v_exp_f32 v179, v179
    v_add_f32 v244, v244, v176
    v_add_f32 v244, v244, v177
    v_cvt_pk_bf16_f32 v172, v176, v177
    v_exp_f32 v180, v180
    s_waitcnt lgkmcnt(10)
    v_mfma_f32_32x32x16_bf16 v[88:103], v[216:219], v[156:159], v[88:103]
    ds_read_b64_tr_b16 v[216:217], v238 offset:20480
    ds_read_b64_tr_b16 v[218:219], v238 offset:21504
    v_exp_f32 v181, v181
    v_add_f32 v244, v244, v178
    v_add_f32 v244, v244, v179
    v_cvt_pk_bf16_f32 v173, v178, v179
    v_exp_f32 v182, v182
    s_waitcnt lgkmcnt(10)
    v_mfma_f32_32x32x16_bf16 v[104:119], v[220:223], v[156:159], v[104:119]
    ds_read_b64_tr_b16 v[220:221], v239 offset:20480
    ds_read_b64_tr_b16 v[222:223], v239 offset:21504
    v_exp_f32 v183, v183
    v_add_f32 v244, v244, v180
    v_add_f32 v244, v244, v181
    v_cvt_pk_bf16_f32 v174, v180, v181
    v_add_f32 v244, v244, v182
    s_waitcnt lgkmcnt(11)
    v_mfma_f32_16x16x16_bf16 v[120:123], v[224:225], v[184:185], 0
    s_waitcnt lgkmcnt(10)
    v_mfma_f32_16x16x16_bf16 v[124:127], v[226:227], v[184:185], 0
    ds_read_b64_tr_b16 v[224:225], v238 offset:28672
    ds_read_b64_tr_b16 v[226:227], v238 offset:29696
    v_add_f32 v244, v244, v183
    v_cvt_pk_bf16_f32 v175, v182, v183
    s_waitcnt lgkmcnt(11)
    v_mfma_f32_16x16x16_bf16 v[128:131], v[228:229], v[184:185], 0
    s_waitcnt lgkmcnt(10)
    v_mfma_f32_16x16x16_bf16 v[132:135], v[230:231], v[184:185], 0
    ds_read_b64_tr_b16 v[228:229], v239 offset:28672
    ds_read_b64_tr_b16 v[230:231], v239 offset:29696
    s_waitcnt lgkmcnt(11)
    v_mfma_f32_16x16x16_bf16 v[136:139], v[208:209], v[184:185], 0
    s_waitcnt lgkmcnt(10)
    v_mfma_f32_16x16x16_bf16 v[140:143], v[210:211], v[184:185], 0
    ds_read_b64_tr_b16 v[208:209], v238 offset:22528
    ds_read_b64_tr_b16 v[210:211], v238 offset:23552
    s_waitcnt lgkmcnt(11)
    v_mfma_f32_16x16x16_bf16 v[144:147], v[212:213], v[184:185], 0
    s_waitcnt lgkmcnt(10)
    v_mfma_f32_16x16x16_bf16 v[148:151], v[214:215], v[184:185], 0
    ds_read_b64_tr_b16 v[212:213], v239 offset:22528
    ds_read_b64_tr_b16 v[214:215], v239 offset:23552
    s_waitcnt lgkmcnt(10)
    v_mfma_f32_32x32x16_bf16 v[56:71], v[216:219], v[168:171], v[56:71]
    ds_read_b64_tr_b16 v[216:217], v238 offset:30720
    ds_read_b64_tr_b16 v[218:219], v238 offset:31744
    s_waitcnt lgkmcnt(10)
    v_mfma_f32_32x32x16_bf16 v[72:87], v[220:223], v[168:171], v[72:87]
    ds_read_b64_tr_b16 v[220:221], v239 offset:30720
    ds_read_b64_tr_b16 v[222:223], v239 offset:31744
    s_waitcnt lgkmcnt(10)
    v_mfma_f32_32x32x16_bf16 v[88:103], v[224:227], v[168:171], v[88:103]
    s_waitcnt lgkmcnt(8)
    v_mfma_f32_32x32x16_bf16 v[104:119], v[228:231], v[168:171], v[104:119]
    s_waitcnt lgkmcnt(6)
    v_mfma_f32_32x32x16_bf16 v[56:71], v[208:211], v[172:175], v[56:71]
    s_waitcnt vmcnt(4)
    s_waitcnt lgkmcnt(0)
    s_barrier
    ds_read_b128 v[224:227], v232 offset:32768
    ds_read_b128 v[228:231], v233 offset:32768
    ds_read_b128 v[208:211], v234 offset:32768
    s_add_u32 s95, s70, s10
    s_add_u32 m0, s89, 16384
    s_nop 0
    buffer_load_dwordx4 v242, s[48:51], s95 offen offset:0 nt lds
    v_mfma_f32_32x32x16_bf16 v[72:87], v[212:215], v[172:175], v[72:87]
    ds_read_b128 v[212:215], v235 offset:32768
    s_add_u32 s95, s70, s10
    s_add_u32 m0, s89, 24448
    s_nop 0
    buffer_load_dwordx4 v242, s[48:51], s95 offen offset:128 nt lds
    v_mfma_f32_32x32x16_bf16 v[88:103], v[216:219], v[172:175], v[88:103]
    ds_read_b128 v[216:219], v232 offset:40960
    s_add_u32 s95, s70, s10
    s_add_u32 s95, s95, 8192
    s_add_u32 m0, s89, 20480
    s_nop 0
    buffer_load_dwordx4 v242, s[48:51], s95 offen offset:0 nt lds
    v_mfma_f32_32x32x16_bf16 v[104:119], v[220:223], v[172:175], v[104:119]
    ds_read_b128 v[220:223], v233 offset:40960
    s_add_u32 s95, s70, s10
    s_add_u32 s95, s95, 8192
    s_add_u32 m0, s89, 28544
    s_nop 0
    buffer_load_dwordx4 v242, s[48:51], s95 offen offset:128 nt lds
    s_waitcnt lgkmcnt(5)
    v_mfma_f32_32x32x16_bf16 v[152:167], v[224:227], v[8:11], v[188:203]
    ds_read_b128 v[224:227], v234 offset:40960
    s_waitcnt lgkmcnt(5)
    v_mfma_f32_32x32x16_bf16 v[152:167], v[228:231], v[12:15], v[152:167]
    ds_read_b128 v[228:231], v235 offset:40960
    s_waitcnt lgkmcnt(5)
    v_mfma_f32_32x32x16_bf16 v[152:167], v[208:211], v[16:19], v[152:167]
    ds_read_b128 v[208:211], v236 offset:32768
    s_waitcnt lgkmcnt(5)
    v_mfma_f32_32x32x16_bf16 v[152:167], v[212:215], v[20:23], v[152:167]
    ds_read_b128 v[212:215], v237 offset:32768
    s_waitcnt lgkmcnt(5)
    v_mfma_f32_32x32x16_bf16 v[152:167], v[216:219], v[24:27], v[152:167]
    ds_read_b128 v[216:219], v236 offset:40960
    s_waitcnt lgkmcnt(5)
    v_mfma_f32_32x32x16_bf16 v[152:167], v[220:223], v[28:31], v[152:167]
    ds_read_b128 v[220:223], v237 offset:40960
    s_waitcnt lgkmcnt(5)
    v_mfma_f32_32x32x16_bf16 v[152:167], v[224:227], v[32:35], v[152:167]
    ds_read_b128 v[224:227], v232 offset:36864
    s_waitcnt lgkmcnt(5)
    v_mfma_f32_32x32x16_bf16 v[152:167], v[228:231], v[36:39], v[152:167]
    ds_read_b128 v[228:231], v233 offset:36864
    s_waitcnt lgkmcnt(5)
    v_mfma_f32_16x16x32_bf16 v[184:187], v[208:211], v[40:43], v[204:207]
    ds_read_b128 v[208:211], v234 offset:36864
    s_waitcnt lgkmcnt(5)
    v_mfma_f32_16x16x32_bf16 v[184:187], v[212:215], v[44:47], v[184:187]
    ds_read_b128 v[212:215], v235 offset:36864
    s_waitcnt lgkmcnt(5)
    v_mfma_f32_16x16x32_bf16 v[184:187], v[216:219], v[48:51], v[184:187]
    ds_read_b128 v[216:219], v232 offset:45056
    s_waitcnt lgkmcnt(5)
    v_mfma_f32_16x16x32_bf16 v[184:187], v[220:223], v[52:55], v[184:187]
    ds_read_b128 v[220:223], v233 offset:45056
    s_waitcnt lgkmcnt(5)
    v_mfma_f32_32x32x16_bf16 v[168:183], v[224:227], v[8:11], v[188:203]
    ds_read_b128 v[224:227], v234 offset:45056
    s_waitcnt lgkmcnt(5)
    v_mfma_f32_32x32x16_bf16 v[168:183], v[228:231], v[12:15], v[168:183]
    ds_read_b128 v[228:231], v235 offset:45056
    v_max3_f32 v246, v152, v153, v154
    v_max3_f32 v246, v246, v155, v156
    v_max3_f32 v246, v246, v157, v158
    v_max3_f32 v246, v246, v159, v160
    v_max3_f32 v246, v246, v161, v162
    v_max3_f32 v246, v246, v163, v164
    s_waitcnt lgkmcnt(5)
    v_mfma_f32_32x32x16_bf16 v[168:183], v[208:211], v[16:19], v[168:183]
    v_max3_f32 v246, v246, v165, v166
    v_max_f32 v246, v246, v167
    v_max3_f32 v247, v184, v185, v186
    v_max_f32 v247, v247, v187
    v_max_f32 v248, v246, v247
    v_cmp_lt_f32 vcc, 0x41000000, v248
    s_nop 1
    s_cbranch_vccnz L_slow_A01
L_back_A01:
    s_waitcnt lgkmcnt(4)
    v_mfma_f32_32x32x16_bf16 v[168:183], v[212:215], v[20:23], v[168:183]
    v_exp_f32 v184, v184
    v_exp_f32 v185, v185
    v_exp_f32 v186, v186
    s_waitcnt lgkmcnt(3)
    v_mfma_f32_32x32x16_bf16 v[168:183], v[216:219], v[24:27], v[168:183]
    s_waitcnt vmcnt(4)
    s_waitcnt lgkmcnt(0)
    s_barrier
    ds_read_b64_tr_b16 v[208:209], v238 offset:0
    ds_read_b64_tr_b16 v[210:211], v238 offset:1024
    ds_read_b64_tr_b16 v[212:213], v239 offset:0
    ds_read_b64_tr_b16 v[214:215], v239 offset:1024
    ds_read_b64_tr_b16 v[216:217], v238 offset:8192
    ds_read_b64_tr_b16 v[218:219], v238 offset:9216
    s_add_u32 s95, s70, s10
    s_add_u32 m0, s89, 32768
    s_nop 0
    buffer_load_dwordx4 v243, s[52:55], s95 offen offset:0 nt lds
    v_exp_f32 v187, v187
    v_add_f32 v245, v245, v184
    v_add_f32 v245, v245, v185
    v_cvt_pk_bf16_f32 v184, v184, v185
    v_add_f32 v245, v245, v186
    v_mfma_f32_32x32x16_bf16 v[168:183], v[220:223], v[28:31], v[168:183]
    ds_read_b64_tr_b16 v[220:221], v239 offset:8192
    ds_read_b64_tr_b16 v[222:223], v239 offset:9216
    s_add_u32 s95, s70, s10
    s_add_u32 m0, s89, 40832
    s_nop 0
    buffer_load_dwordx4 v243, s[52:55], s95 offen offset:128 nt lds
    v_add_f32 v245, v245, v187
    v_cvt_pk_bf16_f32 v185, v186, v187
    v_exp_f32 v152, v152
    v_exp_f32 v153, v153
    v_mfma_f32_32x32x16_bf16 v[168:183], v[224:227], v[32:35], v[168:183]
    ds_read_b64_tr_b16 v[224:225], v238 offset:2048
    ds_read_b64_tr_b16 v[226:227], v238 offset:3072
    s_add_u32 s95, s70, s10
    s_add_u32 s95, s95, 8192
    s_add_u32 m0, s89, 36864
    s_nop 0
    buffer_load_dwordx4 v243, s[52:55], s95 offen offset:0 nt lds
    v_exp_f32 v154, v154
    v_exp_f32 v155, v155
    v_add_f32 v244, v244, v152
    v_add_f32 v244, v244, v153
    v_mfma_f32_32x32x16_bf16 v[168:183], v[228:231], v[36:39], v[168:183]
    ds_read_b64_tr_b16 v[228:229], v239 offset:2048
    ds_read_b64_tr_b16 v[230:231], v239 offset:3072
    s_add_u32 s95, s70, s10
    s_add_u32 s95, s95, 8192
    s_add_u32 m0, s89, 44928
    s_nop 0
    buffer_load_dwordx4 v243, s[52:55], s95 offen offset:128 nt lds
    v_cvt_pk_bf16_f32 v152, v152, v153
    v_exp_f32 v156, v156
    v_exp_f32 v157, v157
    v_add_f32 v244, v244, v154
    v_add_f32 v244, v244, v155
    v_cvt_pk_bf16_f32 v153, v154, v155
    v_exp_f32 v158, v158
    v_exp_f32 v159, v159
    v_add_f32 v244, v244, v156
    v_add_f32 v244, v244, v157
    v_cvt_pk_bf16_f32 v154, v156, v157
    v_exp_f32 v160, v160
    v_exp_f32 v161, v161
    v_add_f32 v244, v244, v158
    v_add_f32 v244, v244, v159
    v_cvt_pk_bf16_f32 v155, v158, v159
    v_exp_f32 v162, v162
    v_exp_f32 v163, v163
    v_add_f32 v244, v244, v160
    v_add_f32 v244, v244, v161
    v_cvt_pk_bf16_f32 v156, v160, v161
    v_exp_f32 v164, v164
    v_exp_f32 v165, v165
    v_add_f32 v244, v244, v162
    v_add_f32 v244, v244, v163
    v_cvt_pk_bf16_f32 v157, v162, v163
    v_exp_f32 v166, v166
    v_exp_f32 v167, v167
    v_add_f32 v244, v244, v164
    v_add_f32 v244, v244, v165
    v_cvt_pk_bf16_f32 v158, v164, v165
    v_add_f32 v244, v244, v166
    v_add_f32 v244, v244, v167
    v_cvt_pk_bf16_f32 v159, v166, v167
    v_max3_f32 v246, v168, v169, v170
    v_max3_f32 v246, v246, v171, v172
    v_max3_f32 v246, v246, v173, v174
    v_max3_f32 v246, v246, v175, v176
    v_max3_f32 v246, v246, v177, v178
    v_max3_f32 v246, v246, v179, v180
    v_max3_f32 v246, v246, v181, v182
    v_max_f32 v246, v246, v183
    v_cmp_lt_f32 vcc, 0x41000000, v246
    s_nop 1
    s_cbranch_vccnz L_slow_B01
L_back_B01:
    s_waitcnt lgkmcnt(10)
    v_mfma_f32_32x32x16_bf16 v[56:71], v[208:211], v[152:155], v[56:71]
    ds_read_b64_tr_b16 v[208:209], v238 offset:10240
    ds_read_b64_tr_b16 v[210:211], v238 offset:11264
    v_exp_f32 v168, v168
    v_exp_f32 v169, v169
    v_exp_f32 v170, v170
    s_waitcnt lgkmcnt(10)
    v_mfma_f32_32x32x16_bf16 v[72:87], v[212:215], v[152:155], v[72:87]
    ds_read_b64_tr_b16 v[212:213], v239 offset:10240
    ds_read_b64_tr_b16 v[214:215], v239 offset:11264
    v_exp_f32 v171, v171
    v_add_f32 v244, v244, v168
    v_add_f32 v244, v244, v169
    v_cvt_pk_bf16_f32 v168, v168, v169
    v_exp_f32 v172, v172
    s_waitcnt lgkmcnt(10)
    v_mfma_f32_32x32x16_bf16 v[88:103], v[216:219], v[152:155], v[88:103]
    ds_read_b64_tr_b16 v[216:217], v240 offset:0
    ds_read_b64_tr_b16 v[218:219], v240 offset:32
    v_exp_f32 v173, v173
    v_add_f32 v244, v244, v170
    v_add_f32 v244, v244, v171
    v_cvt_pk_bf16_f32 v169, v170, v171
    v_exp_f32 v174, v174
    s_waitcnt lgkmcnt(10)
    v_mfma_f32_32x32x16_bf16 v[104:119], v[220:223], v[152:155], v[104:119]
    ds_read_b64_tr_b16 v[220:221], v241 offset:0
    ds_read_b64_tr_b16 v[222:223], v241 offset:32
    v_exp_f32 v175, v175
    v_add_f32 v244, v244, v172
    v_add_f32 v244, v244, v173
    v_cvt_pk_bf16_f32 v170, v172, v173
    v_exp_f32 v176, v176
    s_waitcnt lgkmcnt(10)
    v_mfma_f32_32x32x16_bf16 v[56:71], v[224:227], v[156:159], v[56:71]
    ds_read_b64_tr_b16 v[224:225], v240 offset:8192
    ds_read_b64_tr_b16 v[226:227], v240 offset:8224
    v_exp_f32 v177, v177
    v_add_f32 v244, v244, v174
    v_add_f32 v244, v244, v175
    v_cvt_pk_bf16_f32 v171, v174, v175
    v_exp_f32 v178, v178
    s_waitcnt lgkmcnt(10)
    v_mfma_f32_32x32x16_bf16 v[72:87], v[228:231], v[156:159], v[72:87]
    ds_read_b64_tr_b16 v[228:229], v241 offset:8192
    ds_read_b64_tr_b16 v[230:231], v241 offset:8224
    v_exp_f32 v179, v179
    v_add_f32 v244, v244, v176
    v_add_f32 v244, v244, v177
    v_cvt_pk_bf16_f32 v172, v176, v177
    v_exp_f32 v180, v180
    s_waitcnt lgkmcnt(10)
    v_mfma_f32_32x32x16_bf16 v[88:103], v[208:211], v[156:159], v[88:103]
    ds_read_b64_tr_b16 v[208:209], v238 offset:4096
    ds_read_b64_tr_b16 v[210:211], v238 offset:5120
    v_exp_f32 v181, v181
    v_add_f32 v244, v244, v178
    v_add_f32 v244, v244, v179
    v_cvt_pk_bf16_f32 v173, v178, v179
    v_exp_f32 v182, v182
    s_waitcnt lgkmcnt(10)
    v_mfma_f32_32x32x16_bf16 v[104:119], v[212:215], v[156:159], v[104:119]
    ds_read_b64_tr_b16 v[212:213], v239 offset:4096
    ds_read_b64_tr_b16 v[214:215], v239 offset:5120
    v_exp_f32 v183, v183
    v_add_f32 v244, v244, v180
    v_add_f32 v244, v244, v181
    v_cvt_pk_bf16_f32 v174, v180, v181
    v_add_f32 v244, v244, v182
    s_waitcnt lgkmcnt(11)
    v_mfma_f32_16x16x16_bf16 v[120:123], v[216:217], v[184:185], v[120:123]
    s_waitcnt lgkmcnt(10)
    v_mfma_f32_16x16x16_bf16 v[124:127], v[218:219], v[184:185], v[124:127]
    ds_read_b64_tr_b16 v[216:217], v238 offset:12288
    ds_read_b64_tr_b16 v[218:219], v238 offset:13312
    v_add_f32 v244, v244, v183
    v_cvt_pk_bf16_f32 v175, v182, v183
    s_waitcnt lgkmcnt(11)
    v_mfma_f32_16x16x16_bf16 v[128:131], v[220:221], v[184:185], v[128:131]
    s_waitcnt lgkmcnt(10)
    v_mfma_f32_16x16x16_bf16 v[132:135], v[222:223], v[184:185], v[132:135]
    ds_read_b64_tr_b16 v[220:221], v239 offset:12288
    ds_read_b64_tr_b16 v[222:223], v239 offset:13312
    s_waitcnt lgkmcnt(11)
    v_mfma_f32_16x16x16_bf16 v[136:139], v[224:225], v[184:185], v[136:139]
    s_waitcnt lgkmcnt(10)
    v_mfma_f32_16x16x16_bf16 v[140:143], v[226:227], v[184:185], v[140:143]
    ds_read_b64_tr_b16 v[224:225], v238 offset:6144
    ds_read_b64_tr_b16 v[226:227], v238 offset:7168
    s_waitcnt lgkmcnt(11)
    v_mfma_f32_16x16x16_bf16 v[144:147], v[228:229], v[184:185], v[144:147]
    s_waitcnt lgkmcnt(10)
    v_mfma_f32_16x16x16_bf16 v[148:151], v[230:231], v[184:185], v[148:151]
    ds_read_b64_tr_b16 v[228:229], v239 offset:6144
    ds_read_b64_tr_b16 v[230:231], v239 offset:7168
    s_waitcnt lgkmcnt(10)
    v_mfma_f32_32x32x16_bf16 v[56:71], v[208:211], v[168:171], v[56:71]
    ds_read_b64_tr_b16 v[208:209], v238 offset:14336
    ds_read_b64_tr_b16 v[210:211], v238 offset:15360
    s_waitcnt lgkmcnt(10)
    v_mfma_f32_32x32x16_bf16 v[72:87], v[212:215], v[168:171], v[72:87]
    ds_read_b64_tr_b16 v[212:213], v239 offset:14336
    ds_read_b64_tr_b16 v[214:215], v239 offset:15360
    s_waitcnt lgkmcnt(10)
    v_mfma_f32_32x32x16_bf16 v[88:103], v[216:219], v[168:171], v[88:103]
    s_waitcnt lgkmcnt(8)
    v_mfma_f32_32x32x16_bf16 v[104:119], v[220:223], v[168:171], v[104:119]
    s_waitcnt lgkmcnt(6)
    v_mfma_f32_32x32x16_bf16 v[56:71], v[224:227], v[172:175], v[56:71]
    s_waitcnt vmcnt(4)
    s_waitcnt lgkmcnt(0)
    s_barrier
    ds_read_b128 v[216:219], v232 offset:16384
    ds_read_b128 v[220:223], v233 offset:16384
    ds_read_b128 v[224:227], v234 offset:16384
    s_add_u32 s95, s70, s11
    s_mov_b32 m0, s89
    s_nop 0
    buffer_load_dwordx4 v242, s[48:51], s95 offen offset:0 nt lds
    v_mfma_f32_32x32x16_bf16 v[72:87], v[228:231], v[172:175], v[72:87]
    ds_read_b128 v[228:231], v235 offset:16384
    s_add_u32 s95, s70, s11
    s_add_u32 m0, s89, 8064
    s_nop 0
    buffer_load_dwordx4 v242, s[48:51], s95 offen offset:128 nt lds
    v_mfma_f32_32x32x16_bf16 v[88:103], v[208:211], v[172:175], v[88:103]
    ds_read_b128 v[208:211], v232 offset:24576
    s_add_u32 s95, s70, s11
    s_add_u32 s95, s95, 8192
    s_add_u32 m0, s89, 4096
    s_nop 0
    buffer_load_dwordx4 v242, s[48:51], s95 offen offset:0 nt lds
    v_mfma_f32_32x32x16_bf16 v[104:119], v[212:215], v[172:175], v[104:119]
    ds_read_b128 v[212:215], v233 offset:24576
    s_add_u32 s95, s70, s11
    s_add_u32 s95, s95, 8192
    s_add_u32 m0, s89, 12160
    s_nop 0
    buffer_load_dwordx4 v242, s[48:51], s95 offen offset:128 nt lds
    s_waitcnt lgkmcnt(5)
    v_mfma_f32_32x32x16_bf16 v[152:167], v[216:219], v[8:11], v[188:203]
    ds_read_b128 v[216:219], v234 offset:24576
    s_waitcnt lgkmcnt(5)
    v_mfma_f32_32x32x16_bf16 v[152:167], v[220:223], v[12:15], v[152:167]
    ds_read_b128 v[220:223], v235 offset:24576
    s_waitcnt lgkmcnt(5)
    v_mfma_f32_32x32x16_bf16 v[152:167], v[224:227], v[16:19], v[152:167]
    ds_read_b128 v[224:227], v236 offset:16384
    s_waitcnt lgkmcnt(5)
    v_mfma_f32_32x32x16_bf16 v[152:167], v[228:231], v[20:23], v[152:167]
    ds_read_b128 v[228:231], v237 offset:16384
    s_waitcnt lgkmcnt(5)
    v_mfma_f32_32x32x16_bf16 v[152:167], v[208:211], v[24:27], v[152:167]
    ds_read_b128 v[208:211], v236 offset:24576
    s_waitcnt lgkmcnt(5)
    v_mfma_f32_32x32x16_bf16 v[152:167], v[212:215], v[28:31], v[152:167]
    ds_read_b128 v[212:215], v237 offset:24576
    s_waitcnt lgkmcnt(5)
    v_mfma_f32_32x32x16_bf16 v[152:167], v[216:219], v[32:35], v[152:167]
    ds_read_b128 v[216:219], v232 offset:20480
    s_waitcnt lgkmcnt(5)
    v_mfma_f32_32x32x16_bf16 v[152:167], v[220:223], v[36:39], v[152:167]
    ds_read_b128 v[220:223], v233 offset:20480
    s_waitcnt lgkmcnt(5)
    v_mfma_f32_16x16x32_bf16 v[184:187], v[224:227], v[40:43], v[204:207]
    ds_read_b128 v[224:227], v234 offset:20480
    s_waitcnt lgkmcnt(5)
    v_mfma_f32_16x16x32_bf16 v[184:187], v[228:231], v[44:47], v[184:187]
    ds_read_b128 v[228:231], v235 offset:20480
    s_waitcnt lgkmcnt(5)
    v_mfma_f32_16x16x32_bf16 v[184:187], v[208:211], v[48:51], v[184:187]
    ds_read_b128 v[208:211], v232 offset:28672
    s_waitcnt lgkmcnt(5)
    v_mfma_f32_16x16x32_bf16 v[184:187], v[212:215], v[52:55], v[184:187]
    ds_read_b128 v[212:215], v233 offset:28672
    s_waitcnt lgkmcnt(5)
    v_mfma_f32_32x32x16_bf16 v[168:183], v[216:219], v[8:11], v[188:203]
    ds_read_b128 v[216:219], v234 offset:28672
    s_waitcnt lgkmcnt(5)
    v_mfma_f32_32x32x16_bf16 v[168:183], v[220:223], v[12:15], v[168:183]
    ds_read_b128 v[220:223], v235 offset:28672
    v_max3_f32 v246, v152, v153, v154
    v_max3_f32 v246, v246, v155, v156
    v_max3_f32 v246, v246, v157, v158
    v_max3_f32 v246, v246, v159, v160
    v_max3_f32 v246, v246, v161, v162
    v_max3_f32 v246, v246, v163, v164
    s_waitcnt lgkmcnt(5)
    v_mfma_f32_32x32x16_bf16 v[168:183], v[224:227], v[16:19], v[168:183]
    v_max3_f32 v246, v246, v165, v166
    v_max_f32 v246, v246, v167
    v_max3_f32 v247, v184, v185, v186
    v_max_f32 v247, v247, v187
    v_max_f32 v248, v246, v247
    v_cmp_lt_f32 vcc, 0x41000000, v248
    s_nop 1
    s_cbranch_vccnz L_slow_A02
L_back_A02:
    s_waitcnt lgkmcnt(4)
    v_mfma_f32_32x32x16_bf16 v[168:183], v[228:231], v[20:23], v[168:183]
    v_exp_f32 v184, v184
    v_exp_f32 v185, v185
    v_exp_f32 v186, v186
    s_waitcnt lgkmcnt(3)
    v_mfma_f32_32x32x16_bf16 v[168:183], v[208:211], v[24:27], v[168:183]
    s_waitcnt vmcnt(4)
    s_waitcnt lgkmcnt(0)
    s_barrier
    ds_read_b64_tr_b16 v[224:225], v238 offset:32768
    ds_read_b64_tr_b16 v[226:227], v238 offset:33792
    ds_read_b64_tr_b16 v[228:229], v239 offset:32768
    ds_read_b64_tr_b16 v[230:231], v239 offset:33792
    ds_read_b64_tr_b16 v[208:209], v238 offset:40960
    ds_read_b64_tr_b16 v[210:211], v238 offset:41984
    s_add_u32 s95, s70, s11
    s_add_u32 m0, s89, 16384
    s_nop 0
    buffer_load_dwordx4 v243, s[52:55], s95 offen offset:0 nt lds
    v_exp_f32 v187, v187
    v_add_f32 v245, v245, v184
    v_add_f32 v245, v245, v185
    v_cvt_pk_bf16_f32 v184, v184, v185
    v_add_f32 v245, v245, v186
    v_mfma_f32_32x32x16_bf16 v[168:183], v[212:215], v[28:31], v[168:183]
    ds_read_b64_tr_b16 v[212:213], v239 offset:40960
    ds_read_b64_tr_b16 v[214:215], v239 offset:41984
    s_add_u32 s95, s70, s11
    s_add_u32 m0, s89, 24448
    s_nop 0
    buffer_load_dwordx4 v243, s[52:55], s95 offen offset:128 nt lds
    v_add_f32 v245, v245, v187
    v_cvt_pk_bf16_f32 v185, v186, v187
    v_exp_f32 v152, v152
    v_exp_f32 v153, v153
    v_mfma_f32_32x32x16_bf16 v[168:183], v[216:219], v[32:35], v[168:183]
    ds_read_b64_tr_b16 v[216:217], v238 offset:34816
    ds_read_b64_tr_b16 v[218:219], v238 offset:35840
    s_add_u32 s95, s70, s11
    s_add_u32 s95, s95, 8192
    s_add_u32 m0, s89, 20480
    s_nop 0
    buffer_load_dwordx4 v243, s[52:55], s95 offen offset:0 nt lds
    v_exp_f32 v154, v154
    v_exp_f32 v155, v155
    v_add_f32 v244, v244, v152
    v_add_f32 v244, v244, v153
    v_mfma_f32_32x32x16_bf16 v[168:183], v[220:223], v[36:39], v[168:183]
    ds_read_b64_tr_b16 v[220:221], v239 offset:34816
    ds_read_b64_tr_b16 v[222:223], v239 offset:35840
    s_add_u32 s95, s70, s11
    s_add_u32 s95, s95, 8192
    s_add_u32 m0, s89, 28544
    s_nop 0
    buffer_load_dwordx4 v243, s[52:55], s95 offen offset:128 nt lds
    v_cvt_pk_bf16_f32 v152, v152, v153
    v_exp_f32 v156, v156
    v_exp_f32 v157, v157
    v_add_f32 v244, v244, v154
    v_add_f32 v244, v244, v155
    v_cvt_pk_bf16_f32 v153, v154, v155
    v_exp_f32 v158, v158
    v_exp_f32 v159, v159
    v_add_f32 v244, v244, v156
    v_add_f32 v244, v244, v157
    v_cvt_pk_bf16_f32 v154, v156, v157
    v_exp_f32 v160, v160
    v_exp_f32 v161, v161
    v_add_f32 v244, v244, v158
    v_add_f32 v244, v244, v159
    v_cvt_pk_bf16_f32 v155, v158, v159
    v_exp_f32 v162, v162
    v_exp_f32 v163, v163
    v_add_f32 v244, v244, v160
    v_add_f32 v244, v244, v161
    v_cvt_pk_bf16_f32 v156, v160, v161
    v_exp_f32 v164, v164
    v_exp_f32 v165, v165
    v_add_f32 v244, v244, v162
    v_add_f32 v244, v244, v163
    v_cvt_pk_bf16_f32 v157, v162, v163
    v_exp_f32 v166, v166
    v_exp_f32 v167, v167
    v_add_f32 v244, v244, v164
    v_add_f32 v244, v244, v165
    v_cvt_pk_bf16_f32 v158, v164, v165
    v_add_f32 v244, v244, v166
    v_add_f32 v244, v244, v167
    v_cvt_pk_bf16_f32 v159, v166, v167
    v_max3_f32 v246, v168, v169, v170
    v_max3_f32 v246, v246, v171, v172
    v_max3_f32 v246, v246, v173, v174
    v_max3_f32 v246, v246, v175, v176
    v_max3_f32 v246, v246, v177, v178
    v_max3_f32 v246, v246, v179, v180
    v_max3_f32 v246, v246, v181, v182
    v_max_f32 v246, v246, v183
    v_cmp_lt_f32 vcc, 0x41000000, v246
    s_nop 1
    s_cbranch_vccnz L_slow_B02
L_back_B02:
    s_waitcnt lgkmcnt(10)
    v_mfma_f32_32x32x16_bf16 v[56:71], v[224:227], v[152:155], v[56:71]
    ds_read_b64_tr_b16 v[224:225], v238 offset:43008
    ds_read_b64_tr_b16 v[226:227], v238 offset:44032
    v_exp_f32 v168, v168
    v_exp_f32 v169, v169
    v_exp_f32 v170, v170
    s_waitcnt lgkmcnt(10)
    v_mfma_f32_32x32x16_bf16 v[72:87], v[228:231], v[152:155], v[72:87]
    ds_read_b64_tr_b16 v[228:229], v239 offset:43008
    ds_read_b64_tr_b16 v[230:231], v239 offset:44032
    v_exp_f32 v171, v171
    v_add_f32 v244, v244, v168
    v_add_f32 v244, v244, v169
    v_cvt_pk_bf16_f32 v168, v168, v169
    v_exp_f32 v172, v172
    s_waitcnt lgkmcnt(10)
    v_mfma_f32_32x32x16_bf16 v[88:103], v[208:211], v[152:155], v[88:103]
    ds_read_b64_tr_b16 v[208:209], v240 offset:32768
    ds_read_b64_tr_b16 v[210:211], v240 offset:32800
    v_exp_f32 v173, v173
    v_add_f32 v244, v244, v170
    v_add_f32 v244, v244, v171
    v_cvt_pk_bf16_f32 v169, v170, v171
    v_exp_f32 v174, v174
    s_waitcnt lgkmcnt(10)
    v_mfma_f32_32x32x16_bf16 v[104:119], v[212:215], v[152:155], v[104:119]
    ds_read_b64_tr_b16 v[212:213], v241 offset:32768
    ds_read_b64_tr_b16 v[214:215], v241 offset:32800
    v_exp_f32 v175, v175
    v_add_f32 v244, v244, v172
    v_add_f32 v244, v244, v173
    v_cvt_pk_bf16_f32 v170, v172, v173
    v_exp_f32 v176, v176
    s_waitcnt lgkmcnt(10)
    v_mfma_f32_32x32x16_bf16 v[56:71], v[216:219], v[156:159], v[56:71]
    ds_read_b64_tr_b16 v[216:217], v240 offset:40960
    ds_read_b64_tr_b16 v[218:219], v240 offset:40992
    v_exp_f32 v177, v177
    v_add_f32 v244, v244, v174
    v_add_f32 v244, v244, v175
    v_cvt_pk_bf16_f32 v171, v174, v175
    v_exp_f32 v178, v178
    s_waitcnt lgkmcnt(10)
    v_mfma_f32_32x32x16_bf16 v[72:87], v[220:223], v[156:159], v[72:87]
    ds_read_b64_tr_b16 v[220:221], v241 offset:40960
    ds_read_b64_tr_b16 v[222:223], v241 offset:40992
    v_exp_f32 v179, v179
    v_add_f32 v244, v244, v176
    v_add_f32 v244, v244, v177
    v_cvt_pk_bf16_f32 v172, v176, v177
    v_exp_f32 v180, v180
    s_waitcnt lgkmcnt(10)
    v_mfma_f32_32x32x16_bf16 v[88:103], v[224:227], v[156:159], v[88:103]
    ds_read_b64_tr_b16 v[224:225], v238 offset:36864
    ds_read_b64_tr_b16 v[226:227], v238 offset:37888
    v_exp_f32 v181, v181
    v_add_f32 v244, v244, v178
    v_add_f32 v244, v244, v179
    v_cvt_pk_bf16_f32 v173, v178, v179
    v_exp_f32 v182, v182
    s_waitcnt lgkmcnt(10)
    v_mfma_f32_32x32x16_bf16 v[104:119], v[228:231], v[156:159], v[104:119]
    ds_read_b64_tr_b16 v[228:229], v239 offset:36864
    ds_read_b64_tr_b16 v[230:231], v239 offset:37888
    v_exp_f32 v183, v183
    v_add_f32 v244, v244, v180
    v_add_f32 v244, v244, v181
    v_cvt_pk_bf16_f32 v174, v180, v181
    v_add_f32 v244, v244, v182
    s_waitcnt lgkmcnt(11)
    v_mfma_f32_16x16x16_bf16 v[120:123], v[208:209], v[184:185], v[120:123]
    s_waitcnt lgkmcnt(10)
    v_mfma_f32_16x16x16_bf16 v[124:127], v[210:211], v[184:185], v[124:127]
    ds_read_b64_tr_b16 v[208:209], v238 offset:45056
    ds_read_b64_tr_b16 v[210:211], v238 offset:46080
    v_add_f32 v244, v244, v183
    v_cvt_pk_bf16_f32 v175, v182, v183
    s_waitcnt lgkmcnt(11)
    v_mfma_f32_16x16x16_bf16 v[128:131], v[212:213], v[184:185], v[128:131]
    s_waitcnt lgkmcnt(10)
    v_mfma_f32_16x16x16_bf16 v[132:135], v[214:215], v[184:185], v[132:135]
    ds_read_b64_tr_b16 v[212:213], v239 offset:45056
    ds_read_b64_tr_b16 v[214:215], v239 offset:46080
    s_waitcnt lgkmcnt(11)
    v_mfma_f32_16x16x16_bf16 v[136:139], v[216:217], v[184:185], v[136:139]
    s_waitcnt lgkmcnt(10)
    v_mfma_f32_16x16x16_bf16 v[140:143], v[218:219], v[184:185], v[140:143]
    ds_read_b64_tr_b16 v[216:217], v238 offset:38912
    ds_read_b64_tr_b16 v[218:219], v238 offset:39936
    s_waitcnt lgkmcnt(11)
    v_mfma_f32_16x16x16_bf16 v[144:147], v[220:221], v[184:185], v[144:147]
    s_waitcnt lgkmcnt(10)
    v_mfma_f32_16x16x16_bf16 v[148:151], v[222:223], v[184:185], v[148:151]
    ds_read_b64_tr_b16 v[220:221], v239 offset:38912
    ds_read_b64_tr_b16 v[222:223], v239 offset:39936
    s_waitcnt lgkmcnt(10)
    v_mfma_f32_32x32x16_bf16 v[56:71], v[224:227], v[168:171], v[56:71]
    ds_read_b64_tr_b16 v[224:225], v238 offset:47104
    ds_read_b64_tr_b16 v[226:227], v238 offset:48128
    s_waitcnt lgkmcnt(10)
    v_mfma_f32_32x32x16_bf16 v[72:87], v[228:231], v[168:171], v[72:87]
    ds_read_b64_tr_b16 v[228:229], v239 offset:47104
    ds_read_b64_tr_b16 v[230:231], v239 offset:48128
    s_waitcnt lgkmcnt(10)
    v_mfma_f32_32x32x16_bf16 v[88:103], v[208:211], v[168:171], v[88:103]
    s_waitcnt lgkmcnt(8)
    v_mfma_f32_32x32x16_bf16 v[104:119], v[212:215], v[168:171], v[104:119]
    s_waitcnt lgkmcnt(6)
    v_mfma_f32_32x32x16_bf16 v[56:71], v[216:219], v[172:175], v[56:71]
    s_waitcnt vmcnt(4)
    s_waitcnt lgkmcnt(0)
    s_barrier
    ds_read_b128 v[208:211], v232 offset:0
    ds_read_b128 v[212:215], v233 offset:0
    ds_read_b128 v[216:219], v234 offset:0
    s_add_u32 s95, s70, s12
    s_add_u32 m0, s89, 32768
    s_nop 0
    buffer_load_dwordx4 v242, s[48:51], s95 offen offset:0 nt lds
    v_mfma_f32_32x32x16_bf16 v[72:87], v[220:223], v[172:175], v[72:87]
    ds_read_b128 v[220:223], v235 offset:0
    s_add_u32 s95, s70, s12
    s_add_u32 m0, s89, 40832
    s_nop 0
    buffer_load_dwordx4 v242, s[48:51], s95 offen offset:128 nt lds
    v_mfma_f32_32x32x16_bf16 v[88:103], v[224:227], v[172:175], v[88:103]
    ds_read_b128 v[224:227], v232 offset:8192
    s_add_u32 s95, s70, s12
    s_add_u32 s95, s95, 8192
    s_add_u32 m0, s89, 36864
    s_nop 0
    buffer_load_dwordx4 v242, s[48:51], s95 offen offset:0 nt lds
    v_mfma_f32_32x32x16_bf16 v[104:119], v[228:231], v[172:175], v[104:119]
    ds_read_b128 v[228:231], v233 offset:8192
    s_add_u32 s95, s70, s12
    s_add_u32 s95, s95, 8192
    s_add_u32 m0, s89, 44928
    s_nop 0
    buffer_load_dwordx4 v242, s[48:51], s95 offen offset:128 nt lds
    s_waitcnt lgkmcnt(5)
    v_mfma_f32_32x32x16_bf16 v[152:167], v[208:211], v[8:11], v[188:203]
    ds_read_b128 v[208:211], v234 offset:8192
    s_waitcnt lgkmcnt(5)
    v_mfma_f32_32x32x16_bf16 v[152:167], v[212:215], v[12:15], v[152:167]
    ds_read_b128 v[212:215], v235 offset:8192
    s_waitcnt lgkmcnt(5)
    v_mfma_f32_32x32x16_bf16 v[152:167], v[216:219], v[16:19], v[152:167]
    ds_read_b128 v[216:219], v236 offset:0
    s_waitcnt lgkmcnt(5)
    v_mfma_f32_32x32x16_bf16 v[152:167], v[220:223], v[20:23], v[152:167]
    ds_read_b128 v[220:223], v237 offset:0
    s_waitcnt lgkmcnt(5)
    v_mfma_f32_32x32x16_bf16 v[152:167], v[224:227], v[24:27], v[152:167]
    ds_read_b128 v[224:227], v236 offset:8192
    s_waitcnt lgkmcnt(5)
    v_mfma_f32_32x32x16_bf16 v[152:167], v[228:231], v[28:31], v[152:167]
    ds_read_b128 v[228:231], v237 offset:8192
    s_waitcnt lgkmcnt(5)
    v_mfma_f32_32x32x16_bf16 v[152:167], v[208:211], v[32:35], v[152:167]
    ds_read_b128 v[208:211], v232 offset:4096
    s_waitcnt lgkmcnt(5)
    v_mfma_f32_32x32x16_bf16 v[152:167], v[212:215], v[36:39], v[152:167]
    ds_read_b128 v[212:215], v233 offset:4096
    s_waitcnt lgkmcnt(5)
    v_mfma_f32_16x16x32_bf16 v[184:187], v[216:219], v[40:43], v[204:207]
    ds_read_b128 v[216:219], v234 offset:4096
    s_waitcnt lgkmcnt(5)
    v_mfma_f32_16x16x32_bf16 v[184:187], v[220:223], v[44:47], v[184:187]
    ds_read_b128 v[220:223], v235 offset:4096
    s_waitcnt lgkmcnt(5)
    v_mfma_f32_16x16x32_bf16 v[184:187], v[224:227], v[48:51], v[184:187]
    ds_read_b128 v[224:227], v232 offset:12288
    s_waitcnt lgkmcnt(5)
    v_mfma_f32_16x16x32_bf16 v[184:187], v[228:231], v[52:55], v[184:187]
    ds_read_b128 v[228:231], v233 offset:12288
    s_waitcnt lgkmcnt(5)
    v_mfma_f32_32x32x16_bf16 v[168:183], v[208:211], v[8:11], v[188:203]
    ds_read_b128 v[208:211], v234 offset:12288
    s_waitcnt lgkmcnt(5)
    v_mfma_f32_32x32x16_bf16 v[168:183], v[212:215], v[12:15], v[168:183]
    ds_read_b128 v[212:215], v235 offset:12288
    v_max3_f32 v246, v152, v153, v154
    v_max3_f32 v246, v246, v155, v156
    v_max3_f32 v246, v246, v157, v158
    v_max3_f32 v246, v246, v159, v160
    v_max3_f32 v246, v246, v161, v162
    v_max3_f32 v246, v246, v163, v164
    s_waitcnt lgkmcnt(5)
    v_mfma_f32_32x32x16_bf16 v[168:183], v[216:219], v[16:19], v[168:183]
    v_max3_f32 v246, v246, v165, v166
    v_max_f32 v246, v246, v167
    v_max3_f32 v247, v184, v185, v186
    v_max_f32 v247, v247, v187
    v_max_f32 v248, v246, v247
    v_cmp_lt_f32 vcc, 0x41000000, v248
    s_nop 1
    s_cbranch_vccnz L_slow_A03
L_back_A03:
    s_waitcnt lgkmcnt(4)
    v_mfma_f32_32x32x16_bf16 v[168:183], v[220:223], v[20:23], v[168:183]
    v_exp_f32 v184, v184
    v_exp_f32 v185, v185
    v_exp_f32 v186, v186
    s_waitcnt lgkmcnt(3)
    v_mfma_f32_32x32x16_bf16 v[168:183], v[224:227], v[24:27], v[168:183]
    s_waitcnt vmcnt(4)
    s_waitcnt lgkmcnt(0)
    s_barrier
    ds_read_b64_tr_b16 v[216:217], v238 offset:16384
    ds_read_b64_tr_b16 v[218:219], v238 offset:17408
    ds_read_b64_tr_b16 v[220:221], v239 offset:16384
    ds_read_b64_tr_b16 v[222:223], v239 offset:17408
    ds_read_b64_tr_b16 v[224:225], v238 offset:24576
    ds_read_b64_tr_b16 v[226:227], v238 offset:25600
    s_add_u32 s95, s70, s12
    s_mov_b32 m0, s89
    s_nop 0
    buffer_load_dwordx4 v243, s[52:55], s95 offen offset:0 nt lds
    v_exp_f32 v187, v187
    v_add_f32 v245, v245, v184
    v_add_f32 v245, v245, v185
    v_cvt_pk_bf16_f32 v184, v184, v185
    v_add_f32 v245, v245, v186
    v_mfma_f32_32x32x16_bf16 v[168:183], v[228:231], v[28:31], v[168:183]
    ds_read_b64_tr_b16 v[228:229], v239 offset:24576
    ds_read_b64_tr_b16 v[230:231], v239 offset:25600
    s_add_u32 s95, s70, s12
    s_add_u32 m0, s89, 8064
    s_nop 0
    buffer_load_dwordx4 v243, s[52:55], s95 offen offset:128 nt lds
    v_add_f32 v245, v245, v187
    v_cvt_pk_bf16_f32 v185, v186, v187
    v_exp_f32 v152, v152
    v_exp_f32 v153, v153
    v_mfma_f32_32x32x16_bf16 v[168:183], v[208:211], v[32:35], v[168:183]
    ds_read_b64_tr_b16 v[208:209], v238 offset:18432
    ds_read_b64_tr_b16 v[210:211], v238 offset:19456
    s_add_u32 s95, s70, s12
    s_add_u32 s95, s95, 8192
    s_add_u32 m0, s89, 4096
    s_nop 0
    buffer_load_dwordx4 v243, s[52:55], s95 offen offset:0 nt lds
    v_exp_f32 v154, v154
    v_exp_f32 v155, v155
    v_add_f32 v244, v244, v152
    v_add_f32 v244, v244, v153
    v_mfma_f32_32x32x16_bf16 v[168:183], v[212:215], v[36:39], v[168:183]
    ds_read_b64_tr_b16 v[212:213], v239 offset:18432
    ds_read_b64_tr_b16 v[214:215], v239 offset:19456
    s_add_u32 s95, s70, s12
    s_add_u32 s95, s95, 8192
    s_add_u32 m0, s89, 12160
    s_nop 0
    buffer_load_dwordx4 v243, s[52:55], s95 offen offset:128 nt lds
    v_cvt_pk_bf16_f32 v152, v152, v153
    v_exp_f32 v156, v156
    v_exp_f32 v157, v157
    v_add_f32 v244, v244, v154
    v_add_f32 v244, v244, v155
    v_cvt_pk_bf16_f32 v153, v154, v155
    v_exp_f32 v158, v158
    v_exp_f32 v159, v159
    v_add_f32 v244, v244, v156
    v_add_f32 v244, v244, v157
    v_cvt_pk_bf16_f32 v154, v156, v157
    v_exp_f32 v160, v160
    v_exp_f32 v161, v161
    v_add_f32 v244, v244, v158
    v_add_f32 v244, v244, v159
    v_cvt_pk_bf16_f32 v155, v158, v159
    v_exp_f32 v162, v162
    v_exp_f32 v163, v163
    v_add_f32 v244, v244, v160
    v_add_f32 v244, v244, v161
    v_cvt_pk_bf16_f32 v156, v160, v161
    v_exp_f32 v164, v164
    v_exp_f32 v165, v165
    v_add_f32 v244, v244, v162
    v_add_f32 v244, v244, v163
    v_cvt_pk_bf16_f32 v157, v162, v163
    v_exp_f32 v166, v166
    v_exp_f32 v167, v167
    v_add_f32 v244, v244, v164
    v_add_f32 v244, v244, v165
    v_cvt_pk_bf16_f32 v158, v164, v165
    v_add_f32 v244, v244, v166
    v_add_f32 v244, v244, v167
    v_cvt_pk_bf16_f32 v159, v166, v167
    v_max3_f32 v246, v168, v169, v170
    v_max3_f32 v246, v246, v171, v172
    v_max3_f32 v246, v246, v173, v174
    v_max3_f32 v246, v246, v175, v176
    v_max3_f32 v246, v246, v177, v178
    v_max3_f32 v246, v246, v179, v180
    v_max3_f32 v246, v246, v181, v182
    v_max_f32 v246, v246, v183
    v_cmp_lt_f32 vcc, 0x41000000, v246
    s_nop 1
    s_cbranch_vccnz L_slow_B03
L_back_B03:
    s_waitcnt lgkmcnt(10)
    v_mfma_f32_32x32x16_bf16 v[56:71], v[216:219], v[152:155], v[56:71]
    ds_read_b64_tr_b16 v[216:217], v238 offset:26624
    ds_read_b64_tr_b16 v[218:219], v238 offset:27648
    v_exp_f32 v168, v168
    v_exp_f32 v169, v169
    v_exp_f32 v170, v170
    s_waitcnt lgkmcnt(10)
    v_mfma_f32_32x32x16_bf16 v[72:87], v[220:223], v[152:155], v[72:87]
    ds_read_b64_tr_b16 v[220:221], v239 offset:26624
    ds_read_b64_tr_b16 v[222:223], v239 offset:27648
    v_exp_f32 v171, v171
    v_add_f32 v244, v244, v168
    v_add_f32 v244, v244, v169
    v_cvt_pk_bf16_f32 v168, v168, v169
    v_exp_f32 v172, v172
    s_waitcnt lgkmcnt(10)
    v_mfma_f32_32x32x16_bf16 v[88:103], v[224:227], v[152:155], v[88:103]
    ds_read_b64_tr_b16 v[224:225], v240 offset:16384
    ds_read_b64_tr_b16 v[226:227], v240 offset:16416
    v_exp_f32 v173, v173
    v_add_f32 v244, v244, v170
    v_add_f32 v244, v244, v171
    v_cvt_pk_bf16_f32 v169, v170, v171
    v_exp_f32 v174, v174
    s_waitcnt lgkmcnt(10)
    v_mfma_f32_32x32x16_bf16 v[104:119], v[228:231], v[152:155], v[104:119]
    ds_read_b64_tr_b16 v[228:229], v241 offset:16384
    ds_read_b64_tr_b16 v[230:231], v241 offset:16416
    v_exp_f32 v175, v175
    v_add_f32 v244, v244, v172
    v_add_f32 v244, v244, v173
    v_cvt_pk_bf16_f32 v170, v172, v173
    v_exp_f32 v176, v176
    s_waitcnt lgkmcnt(10)
    v_mfma_f32_32x32x16_bf16 v[56:71], v[208:211], v[156:159], v[56:71]
    ds_read_b64_tr_b16 v[208:209], v240 offset:24576
    ds_read_b64_tr_b16 v[210:211], v240 offset:24608
    v_exp_f32 v177, v177
    v_add_f32 v244, v244, v174
    v_add_f32 v244, v244, v175
    v_cvt_pk_bf16_f32 v171, v174, v175
    v_exp_f32 v178, v178
    s_waitcnt lgkmcnt(10)
    v_mfma_f32_32x32x16_bf16 v[72:87], v[212:215], v[156:159], v[72:87]
    ds_read_b64_tr_b16 v[212:213], v241 offset:24576
    ds_read_b64_tr_b16 v[214:215], v241 offset:24608
    v_exp_f32 v179, v179
    v_add_f32 v244, v244, v176
    v_add_f32 v244, v244, v177
    v_cvt_pk_bf16_f32 v172, v176, v177
    v_exp_f32 v180, v180
    s_waitcnt lgkmcnt(10)
    v_mfma_f32_32x32x16_bf16 v[88:103], v[216:219], v[156:159], v[88:103]
    ds_read_b64_tr_b16 v[216:217], v238 offset:20480
    ds_read_b64_tr_b16 v[218:219], v238 offset:21504
    v_exp_f32 v181, v181
    v_add_f32 v244, v244, v178
    v_add_f32 v244, v244, v179
    v_cvt_pk_bf16_f32 v173, v178, v179
    v_exp_f32 v182, v182
    s_waitcnt lgkmcnt(10)
    v_mfma_f32_32x32x16_bf16 v[104:119], v[220:223], v[156:159], v[104:119]
    ds_read_b64_tr_b16 v[220:221], v239 offset:20480
    ds_read_b64_tr_b16 v[222:223], v239 offset:21504
    v_exp_f32 v183, v183
    v_add_f32 v244, v244, v180
    v_add_f32 v244, v244, v181
    v_cvt_pk_bf16_f32 v174, v180, v181
    v_add_f32 v244, v244, v182
    s_waitcnt lgkmcnt(11)
    v_mfma_f32_16x16x16_bf16 v[120:123], v[224:225], v[184:185], v[120:123]
    s_waitcnt lgkmcnt(10)
    v_mfma_f32_16x16x16_bf16 v[124:127], v[226:227], v[184:185], v[124:127]
    ds_read_b64_tr_b16 v[224:225], v238 offset:28672
    ds_read_b64_tr_b16 v[226:227], v238 offset:29696
    v_add_f32 v244, v244, v183
    v_cvt_pk_bf16_f32 v175, v182, v183
    s_waitcnt lgkmcnt(11)
    v_mfma_f32_16x16x16_bf16 v[128:131], v[228:229], v[184:185], v[128:131]
    s_waitcnt lgkmcnt(10)
    v_mfma_f32_16x16x16_bf16 v[132:135], v[230:231], v[184:185], v[132:135]
    ds_read_b64_tr_b16 v[228:229], v239 offset:28672
    ds_read_b64_tr_b16 v[230:231], v239 offset:29696
    s_waitcnt lgkmcnt(11)
    v_mfma_f32_16x16x16_bf16 v[136:139], v[208:209], v[184:185], v[136:139]
    s_waitcnt lgkmcnt(10)
    v_mfma_f32_16x16x16_bf16 v[140:143], v[210:211], v[184:185], v[140:143]
    ds_read_b64_tr_b16 v[208:209], v238 offset:22528
    ds_read_b64_tr_b16 v[210:211], v238 offset:23552
    s_waitcnt lgkmcnt(11)
    v_mfma_f32_16x16x16_bf16 v[144:147], v[212:213], v[184:185], v[144:147]
    s_waitcnt lgkmcnt(10)
    v_mfma_f32_16x16x16_bf16 v[148:151], v[214:215], v[184:185], v[148:151]
    ds_read_b64_tr_b16 v[212:213], v239 offset:22528
    ds_read_b64_tr_b16 v[214:215], v239 offset:23552
    s_waitcnt lgkmcnt(10)
    v_mfma_f32_32x32x16_bf16 v[56:71], v[216:219], v[168:171], v[56:71]
    ds_read_b64_tr_b16 v[216:217], v238 offset:30720
    ds_read_b64_tr_b16 v[218:219], v238 offset:31744
    s_waitcnt lgkmcnt(10)
    v_mfma_f32_32x32x16_bf16 v[72:87], v[220:223], v[168:171], v[72:87]
    ds_read_b64_tr_b16 v[220:221], v239 offset:30720
    ds_read_b64_tr_b16 v[222:223], v239 offset:31744
    s_waitcnt lgkmcnt(10)
    v_mfma_f32_32x32x16_bf16 v[88:103], v[224:227], v[168:171], v[88:103]
    s_waitcnt lgkmcnt(8)
    v_mfma_f32_32x32x16_bf16 v[104:119], v[228:231], v[168:171], v[104:119]
    s_waitcnt lgkmcnt(6)
    v_mfma_f32_32x32x16_bf16 v[56:71], v[208:211], v[172:175], v[56:71]
    s_waitcnt vmcnt(4)
    s_waitcnt lgkmcnt(0)
    s_barrier
    ds_read_b128 v[224:227], v232 offset:32768
    ds_read_b128 v[228:231], v233 offset:32768
    ds_read_b128 v[208:211], v234 offset:32768
    s_add_u32 s95, s70, s13
    s_add_u32 m0, s89, 16384
    s_nop 0
    buffer_load_dwordx4 v242, s[48:51], s95 offen offset:0 nt lds
    v_mfma_f32_32x32x16_bf16 v[72:87], v[212:215], v[172:175], v[72:87]
    ds_read_b128 v[212:215], v235 offset:32768
    s_add_u32 s95, s70, s13
    s_add_u32 m0, s89, 24448
    s_nop 0
    buffer_load_dwordx4 v242, s[48:51], s95 offen offset:128 nt lds
    v_mfma_f32_32x32x16_bf16 v[88:103], v[216:219], v[172:175], v[88:103]
    ds_read_b128 v[216:219], v232 offset:40960
    s_add_u32 s95, s70, s13
    s_add_u32 s95, s95, 8192
    s_add_u32 m0, s89, 20480
    s_nop 0
    buffer_load_dwordx4 v242, s[48:51], s95 offen offset:0 nt lds
    v_mfma_f32_32x32x16_bf16 v[104:119], v[220:223], v[172:175], v[104:119]
    ds_read_b128 v[220:223], v233 offset:40960
    s_add_u32 s95, s70, s13
    s_add_u32 s95, s95, 8192
    s_add_u32 m0, s89, 28544
    s_nop 0
    buffer_load_dwordx4 v242, s[48:51], s95 offen offset:128 nt lds
    s_waitcnt lgkmcnt(5)
    v_mfma_f32_32x32x16_bf16 v[152:167], v[224:227], v[8:11], v[188:203]
    ds_read_b128 v[224:227], v234 offset:40960
    s_waitcnt lgkmcnt(5)
    v_mfma_f32_32x32x16_bf16 v[152:167], v[228:231], v[12:15], v[152:167]
    ds_read_b128 v[228:231], v235 offset:40960
    s_waitcnt lgkmcnt(5)
    v_mfma_f32_32x32x16_bf16 v[152:167], v[208:211], v[16:19], v[152:167]
    ds_read_b128 v[208:211], v236 offset:32768
    s_waitcnt lgkmcnt(5)
    v_mfma_f32_32x32x16_bf16 v[152:167], v[212:215], v[20:23], v[152:167]
    ds_read_b128 v[212:215], v237 offset:32768
    s_waitcnt lgkmcnt(5)
    v_mfma_f32_32x32x16_bf16 v[152:167], v[216:219], v[24:27], v[152:167]
    ds_read_b128 v[216:219], v236 offset:40960
    s_waitcnt lgkmcnt(5)
    v_mfma_f32_32x32x16_bf16 v[152:167], v[220:223], v[28:31], v[152:167]
    ds_read_b128 v[220:223], v237 offset:40960
    s_waitcnt lgkmcnt(5)
    v_mfma_f32_32x32x16_bf16 v[152:167], v[224:227], v[32:35], v[152:167]
    ds_read_b128 v[224:227], v232 offset:36864
    s_waitcnt lgkmcnt(5)
    v_mfma_f32_32x32x16_bf16 v[152:167], v[228:231], v[36:39], v[152:167]
    ds_read_b128 v[228:231], v233 offset:36864
    s_waitcnt lgkmcnt(5)
    v_mfma_f32_16x16x32_bf16 v[184:187], v[208:211], v[40:43], v[204:207]
    ds_read_b128 v[208:211], v234 offset:36864
    s_waitcnt lgkmcnt(5)
    v_mfma_f32_16x16x32_bf16 v[184:187], v[212:215], v[44:47], v[184:187]
    ds_read_b128 v[212:215], v235 offset:36864
    s_waitcnt lgkmcnt(5)
    v_mfma_f32_16x16x32_bf16 v[184:187], v[216:219], v[48:51], v[184:187]
    ds_read_b128 v[216:219], v232 offset:45056
    s_waitcnt lgkmcnt(5)
    v_mfma_f32_16x16x32_bf16 v[184:187], v[220:223], v[52:55], v[184:187]
    ds_read_b128 v[220:223], v233 offset:45056
    s_waitcnt lgkmcnt(5)
    v_mfma_f32_32x32x16_bf16 v[168:183], v[224:227], v[8:11], v[188:203]
    ds_read_b128 v[224:227], v234 offset:45056
    s_waitcnt lgkmcnt(5)
    v_mfma_f32_32x32x16_bf16 v[168:183], v[228:231], v[12:15], v[168:183]
    ds_read_b128 v[228:231], v235 offset:45056
    v_max3_f32 v246, v152, v153, v154
    v_max3_f32 v246, v246, v155, v156
    v_max3_f32 v246, v246, v157, v158
    v_max3_f32 v246, v246, v159, v160
    v_max3_f32 v246, v246, v161, v162
    v_max3_f32 v246, v246, v163, v164
    s_waitcnt lgkmcnt(5)
    v_mfma_f32_32x32x16_bf16 v[168:183], v[208:211], v[16:19], v[168:183]
    v_max3_f32 v246, v246, v165, v166
    v_max_f32 v246, v246, v167
    v_max3_f32 v247, v184, v185, v186
    v_max_f32 v247, v247, v187
    v_max_f32 v248, v246, v247
    v_cmp_lt_f32 vcc, 0x41000000, v248
    s_nop 1
    s_cbranch_vccnz L_slow_A04
L_back_A04:
    s_waitcnt lgkmcnt(4)
    v_mfma_f32_32x32x16_bf16 v[168:183], v[212:215], v[20:23], v[168:183]
    v_exp_f32 v184, v184
    v_exp_f32 v185, v185
    v_exp_f32 v186, v186
    s_waitcnt lgkmcnt(3)
    v_mfma_f32_32x32x16_bf16 v[168:183], v[216:219], v[24:27], v[168:183]
    s_waitcnt vmcnt(4)
    s_waitcnt lgkmcnt(0)
    s_barrier
    ds_read_b64_tr_b16 v[208:209], v238 offset:0
    ds_read_b64_tr_b16 v[210:211], v238 offset:1024
    ds_read_b64_tr_b16 v[212:213], v239 offset:0
    ds_read_b64_tr_b16 v[214:215], v239 offset:1024
    ds_read_b64_tr_b16 v[216:217], v238 offset:8192
    ds_read_b64_tr_b16 v[218:219], v238 offset:9216
    s_add_u32 s95, s70, s13
    s_add_u32 m0, s89, 32768
    s_nop 0
    buffer_load_dwordx4 v243, s[52:55], s95 offen offset:0 nt lds
    v_exp_f32 v187, v187
    v_add_f32 v245, v245, v184
    v_add_f32 v245, v245, v185
    v_cvt_pk_bf16_f32 v184, v184, v185
    v_add_f32 v245, v245, v186
    v_mfma_f32_32x32x16_bf16 v[168:183], v[220:223], v[28:31], v[168:183]
    ds_read_b64_tr_b16 v[220:221], v239 offset:8192
    ds_read_b64_tr_b16 v[222:223], v239 offset:9216
    s_add_u32 s95, s70, s13
    s_add_u32 m0, s89, 40832
    s_nop 0
    buffer_load_dwordx4 v243, s[52:55], s95 offen offset:128 nt lds
    v_add_f32 v245, v245, v187
    v_cvt_pk_bf16_f32 v185, v186, v187
    v_exp_f32 v152, v152
    v_exp_f32 v153, v153
    v_mfma_f32_32x32x16_bf16 v[168:183], v[224:227], v[32:35], v[168:183]
    ds_read_b64_tr_b16 v[224:225], v238 offset:2048
    ds_read_b64_tr_b16 v[226:227], v238 offset:3072
    s_add_u32 s95, s70, s13
    s_add_u32 s95, s95, 8192
    s_add_u32 m0, s89, 36864
    s_nop 0
    buffer_load_dwordx4 v243, s[52:55], s95 offen offset:0 nt lds
    v_exp_f32 v154, v154
    v_exp_f32 v155, v155
    v_add_f32 v244, v244, v152
    v_add_f32 v244, v244, v153
    v_mfma_f32_32x32x16_bf16 v[168:183], v[228:231], v[36:39], v[168:183]
    ds_read_b64_tr_b16 v[228:229], v239 offset:2048
    ds_read_b64_tr_b16 v[230:231], v239 offset:3072
    s_add_u32 s95, s70, s13
    s_add_u32 s95, s95, 8192
    s_add_u32 m0, s89, 44928
    s_nop 0
    buffer_load_dwordx4 v243, s[52:55], s95 offen offset:128 nt lds
    v_cvt_pk_bf16_f32 v152, v152, v153
    v_exp_f32 v156, v156
    v_exp_f32 v157, v157
    v_add_f32 v244, v244, v154
    v_add_f32 v244, v244, v155
    v_cvt_pk_bf16_f32 v153, v154, v155
    v_exp_f32 v158, v158
    v_exp_f32 v159, v159
    v_add_f32 v244, v244, v156
    v_add_f32 v244, v244, v157
    v_cvt_pk_bf16_f32 v154, v156, v157
    v_exp_f32 v160, v160
    v_exp_f32 v161, v161
    v_add_f32 v244, v244, v158
    v_add_f32 v244, v244, v159
    v_cvt_pk_bf16_f32 v155, v158, v159
    v_exp_f32 v162, v162
    v_exp_f32 v163, v163
    v_add_f32 v244, v244, v160
    v_add_f32 v244, v244, v161
    v_cvt_pk_bf16_f32 v156, v160, v161
    v_exp_f32 v164, v164
    v_exp_f32 v165, v165
    v_add_f32 v244, v244, v162
    v_add_f32 v244, v244, v163
    v_cvt_pk_bf16_f32 v157, v162, v163
    v_exp_f32 v166, v166
    v_exp_f32 v167, v167
    v_add_f32 v244, v244, v164
    v_add_f32 v244, v244, v165
    v_cvt_pk_bf16_f32 v158, v164, v165
    v_add_f32 v244, v244, v166
    v_add_f32 v244, v244, v167
    v_cvt_pk_bf16_f32 v159, v166, v167
    v_max3_f32 v246, v168, v169, v170
    v_max3_f32 v246, v246, v171, v172
    v_max3_f32 v246, v246, v173, v174
    v_max3_f32 v246, v246, v175, v176
    v_max3_f32 v246, v246, v177, v178
    v_max3_f32 v246, v246, v179, v180
    v_max3_f32 v246, v246, v181, v182
    v_max_f32 v246, v246, v183
    v_cmp_lt_f32 vcc, 0x41000000, v246
    s_nop 1
    s_cbranch_vccnz L_slow_B04
L_back_B04:
    s_waitcnt lgkmcnt(10)
    v_mfma_f32_32x32x16_bf16 v[56:71], v[208:211], v[152:155], v[56:71]
    ds_read_b64_tr_b16 v[208:209], v238 offset:10240
    ds_read_b64_tr_b16 v[210:211], v238 offset:11264
    v_exp_f32 v168, v168
    v_exp_f32 v169, v169
    v_exp_f32 v170, v170
    s_waitcnt lgkmcnt(10)
    v_mfma_f32_32x32x16_bf16 v[72:87], v[212:215], v[152:155], v[72:87]
    ds_read_b64_tr_b16 v[212:213], v239 offset:10240
    ds_read_b64_tr_b16 v[214:215], v239 offset:11264
    v_exp_f32 v171, v171
    v_add_f32 v244, v244, v168
    v_add_f32 v244, v244, v169
    v_cvt_pk_bf16_f32 v168, v168, v169
    v_exp_f32 v172, v172
    s_waitcnt lgkmcnt(10)
    v_mfma_f32_32x32x16_bf16 v[88:103], v[216:219], v[152:155], v[88:103]
    ds_read_b64_tr_b16 v[216:217], v240 offset:0
    ds_read_b64_tr_b16 v[218:219], v240 offset:32
    v_exp_f32 v173, v173
    v_add_f32 v244, v244, v170
    v_add_f32 v244, v244, v171
    v_cvt_pk_bf16_f32 v169, v170, v171
    v_exp_f32 v174, v174
    s_waitcnt lgkmcnt(10)
    v_mfma_f32_32x32x16_bf16 v[104:119], v[220:223], v[152:155], v[104:119]
    ds_read_b64_tr_b16 v[220:221], v241 offset:0
    ds_read_b64_tr_b16 v[222:223], v241 offset:32
    v_exp_f32 v175, v175
    v_add_f32 v244, v244, v172
    v_add_f32 v244, v244, v173
    v_cvt_pk_bf16_f32 v170, v172, v173
    v_exp_f32 v176, v176
    s_waitcnt lgkmcnt(10)
    v_mfma_f32_32x32x16_bf16 v[56:71], v[224:227], v[156:159], v[56:71]
    ds_read_b64_tr_b16 v[224:225], v240 offset:8192
    ds_read_b64_tr_b16 v[226:227], v240 offset:8224
    v_exp_f32 v177, v177
    v_add_f32 v244, v244, v174
    v_add_f32 v244, v244, v175
    v_cvt_pk_bf16_f32 v171, v174, v175
    v_exp_f32 v178, v178
    s_waitcnt lgkmcnt(10)
    v_mfma_f32_32x32x16_bf16 v[72:87], v[228:231], v[156:159], v[72:87]
    ds_read_b64_tr_b16 v[228:229], v241 offset:8192
    ds_read_b64_tr_b16 v[230:231], v241 offset:8224
    v_exp_f32 v179, v179
    v_add_f32 v244, v244, v176
    v_add_f32 v244, v244, v177
    v_cvt_pk_bf16_f32 v172, v176, v177
    v_exp_f32 v180, v180
    s_waitcnt lgkmcnt(10)
    v_mfma_f32_32x32x16_bf16 v[88:103], v[208:211], v[156:159], v[88:103]
    ds_read_b64_tr_b16 v[208:209], v238 offset:4096
    ds_read_b64_tr_b16 v[210:211], v238 offset:5120
    v_exp_f32 v181, v181
    v_add_f32 v244, v244, v178
    v_add_f32 v244, v244, v179
    v_cvt_pk_bf16_f32 v173, v178, v179
    v_exp_f32 v182, v182
    s_waitcnt lgkmcnt(10)
    v_mfma_f32_32x32x16_bf16 v[104:119], v[212:215], v[156:159], v[104:119]
    ds_read_b64_tr_b16 v[212:213], v239 offset:4096
    ds_read_b64_tr_b16 v[214:215], v239 offset:5120
    v_exp_f32 v183, v183
    v_add_f32 v244, v244, v180
    v_add_f32 v244, v244, v181
    v_cvt_pk_bf16_f32 v174, v180, v181
    v_add_f32 v244, v244, v182
    s_waitcnt lgkmcnt(11)
    v_mfma_f32_16x16x16_bf16 v[120:123], v[216:217], v[184:185], v[120:123]
    s_waitcnt lgkmcnt(10)
    v_mfma_f32_16x16x16_bf16 v[124:127], v[218:219], v[184:185], v[124:127]
    ds_read_b64_tr_b16 v[216:217], v238 offset:12288
    ds_read_b64_tr_b16 v[218:219], v238 offset:13312
    v_add_f32 v244, v244, v183
    v_cvt_pk_bf16_f32 v175, v182, v183
    s_waitcnt lgkmcnt(11)
    v_mfma_f32_16x16x16_bf16 v[128:131], v[220:221], v[184:185], v[128:131]
    s_waitcnt lgkmcnt(10)
    v_mfma_f32_16x16x16_bf16 v[132:135], v[222:223], v[184:185], v[132:135]
    ds_read_b64_tr_b16 v[220:221], v239 offset:12288
    ds_read_b64_tr_b16 v[222:223], v239 offset:13312
    s_waitcnt lgkmcnt(11)
    v_mfma_f32_16x16x16_bf16 v[136:139], v[224:225], v[184:185], v[136:139]
    s_waitcnt lgkmcnt(10)
    v_mfma_f32_16x16x16_bf16 v[140:143], v[226:227], v[184:185], v[140:143]
    ds_read_b64_tr_b16 v[224:225], v238 offset:6144
    ds_read_b64_tr_b16 v[226:227], v238 offset:7168
    s_waitcnt lgkmcnt(11)
    v_mfma_f32_16x16x16_bf16 v[144:147], v[228:229], v[184:185], v[144:147]
    s_waitcnt lgkmcnt(10)
    v_mfma_f32_16x16x16_bf16 v[148:151], v[230:231], v[184:185], v[148:151]
    ds_read_b64_tr_b16 v[228:229], v239 offset:6144
    ds_read_b64_tr_b16 v[230:231], v239 offset:7168
    s_waitcnt lgkmcnt(10)
    v_mfma_f32_32x32x16_bf16 v[56:71], v[208:211], v[168:171], v[56:71]
    ds_read_b64_tr_b16 v[208:209], v238 offset:14336
    ds_read_b64_tr_b16 v[210:211], v238 offset:15360
    s_waitcnt lgkmcnt(10)
    v_mfma_f32_32x32x16_bf16 v[72:87], v[212:215], v[168:171], v[72:87]
    ds_read_b64_tr_b16 v[212:213], v239 offset:14336
    ds_read_b64_tr_b16 v[214:215], v239 offset:15360
    s_waitcnt lgkmcnt(10)
    v_mfma_f32_32x32x16_bf16 v[88:103], v[216:219], v[168:171], v[88:103]
    s_waitcnt lgkmcnt(8)
    v_mfma_f32_32x32x16_bf16 v[104:119], v[220:223], v[168:171], v[104:119]
    s_waitcnt lgkmcnt(6)
    v_mfma_f32_32x32x16_bf16 v[56:71], v[224:227], v[172:175], v[56:71]
    s_waitcnt vmcnt(4)
    s_waitcnt lgkmcnt(0)
    s_barrier
    ds_read_b128 v[216:219], v232 offset:16384
    ds_read_b128 v[220:223], v233 offset:16384
    ds_read_b128 v[224:227], v234 offset:16384
    s_add_u32 s95, s70, s14
    s_mov_b32 m0, s89
    s_nop 0
    buffer_load_dwordx4 v242, s[48:51], s95 offen offset:0 nt lds
    v_mfma_f32_32x32x16_bf16 v[72:87], v[228:231], v[172:175], v[72:87]
    ds_read_b128 v[228:231], v235 offset:16384
    s_add_u32 s95, s70, s14
    s_add_u32 m0, s89, 8064
    s_nop 0
    buffer_load_dwordx4 v242, s[48:51], s95 offen offset:128 nt lds
    v_mfma_f32_32x32x16_bf16 v[88:103], v[208:211], v[172:175], v[88:103]
    ds_read_b128 v[208:211], v232 offset:24576
    s_add_u32 s95, s70, s14
    s_add_u32 s95, s95, 8192
    s_add_u32 m0, s89, 4096
    s_nop 0
    buffer_load_dwordx4 v242, s[48:51], s95 offen offset:0 nt lds
    v_mfma_f32_32x32x16_bf16 v[104:119], v[212:215], v[172:175], v[104:119]
    ds_read_b128 v[212:215], v233 offset:24576
    s_add_u32 s95, s70, s14
    s_add_u32 s95, s95, 8192
    s_add_u32 m0, s89, 12160
    s_nop 0
    buffer_load_dwordx4 v242, s[48:51], s95 offen offset:128 nt lds
    s_waitcnt lgkmcnt(5)
    v_mfma_f32_32x32x16_bf16 v[152:167], v[216:219], v[8:11], v[188:203]
    ds_read_b128 v[216:219], v234 offset:24576
    s_waitcnt lgkmcnt(5)
    v_mfma_f32_32x32x16_bf16 v[152:167], v[220:223], v[12:15], v[152:167]
    ds_read_b128 v[220:223], v235 offset:24576
    s_waitcnt lgkmcnt(5)
    v_mfma_f32_32x32x16_bf16 v[152:167], v[224:227], v[16:19], v[152:167]
    ds_read_b128 v[224:227], v236 offset:16384
    s_waitcnt lgkmcnt(5)
    v_mfma_f32_32x32x16_bf16 v[152:167], v[228:231], v[20:23], v[152:167]
    ds_read_b128 v[228:231], v237 offset:16384
    s_waitcnt lgkmcnt(5)
    v_mfma_f32_32x32x16_bf16 v[152:167], v[208:211], v[24:27], v[152:167]
    ds_read_b128 v[208:211], v236 offset:24576
    s_waitcnt lgkmcnt(5)
    v_mfma_f32_32x32x16_bf16 v[152:167], v[212:215], v[28:31], v[152:167]
    ds_read_b128 v[212:215], v237 offset:24576
    s_waitcnt lgkmcnt(5)
    v_mfma_f32_32x32x16_bf16 v[152:167], v[216:219], v[32:35], v[152:167]
    ds_read_b128 v[216:219], v232 offset:20480
    s_waitcnt lgkmcnt(5)
    v_mfma_f32_32x32x16_bf16 v[152:167], v[220:223], v[36:39], v[152:167]
    ds_read_b128 v[220:223], v233 offset:20480
    s_waitcnt lgkmcnt(5)
    v_mfma_f32_16x16x32_bf16 v[184:187], v[224:227], v[40:43], v[204:207]
    ds_read_b128 v[224:227], v234 offset:20480
    s_waitcnt lgkmcnt(5)
    v_mfma_f32_16x16x32_bf16 v[184:187], v[228:231], v[44:47], v[184:187]
    ds_read_b128 v[228:231], v235 offset:20480
    s_waitcnt lgkmcnt(5)
    v_mfma_f32_16x16x32_bf16 v[184:187], v[208:211], v[48:51], v[184:187]
    ds_read_b128 v[208:211], v232 offset:28672
    s_waitcnt lgkmcnt(5)
    v_mfma_f32_16x16x32_bf16 v[184:187], v[212:215], v[52:55], v[184:187]
    ds_read_b128 v[212:215], v233 offset:28672
    s_waitcnt lgkmcnt(5)
    v_mfma_f32_32x32x16_bf16 v[168:183], v[216:219], v[8:11], v[188:203]
    ds_read_b128 v[216:219], v234 offset:28672
    s_waitcnt lgkmcnt(5)
    v_mfma_f32_32x32x16_bf16 v[168:183], v[220:223], v[12:15], v[168:183]
    ds_read_b128 v[220:223], v235 offset:28672
    v_max3_f32 v246, v152, v153, v154
    v_max3_f32 v246, v246, v155, v156
    v_max3_f32 v246, v246, v157, v158
    v_max3_f32 v246, v246, v159, v160
    v_max3_f32 v246, v246, v161, v162
    v_max3_f32 v246, v246, v163, v164
    s_waitcnt lgkmcnt(5)
    v_mfma_f32_32x32x16_bf16 v[168:183], v[224:227], v[16:19], v[168:183]
    v_max3_f32 v246, v246, v165, v166
    v_max_f32 v246, v246, v167
    v_max3_f32 v247, v184, v185, v186
    v_max_f32 v247, v247, v187
    v_max_f32 v248, v246, v247
    v_cmp_lt_f32 vcc, 0x41000000, v248
    s_nop 1
    s_cbranch_vccnz L_slow_A05
L_back_A05:
    s_waitcnt lgkmcnt(4)
    v_mfma_f32_32x32x16_bf16 v[168:183], v[228:231], v[20:23], v[168:183]
    v_exp_f32 v184, v184
    v_exp_f32 v185, v185
    v_exp_f32 v186, v186
    s_waitcnt lgkmcnt(3)
    v_mfma_f32_32x32x16_bf16 v[168:183], v[208:211], v[24:27], v[168:183]
    s_waitcnt vmcnt(4)
    s_waitcnt lgkmcnt(0)
    s_barrier
    ds_read_b64_tr_b16 v[224:225], v238 offset:32768
    ds_read_b64_tr_b16 v[226:227], v238 offset:33792
    ds_read_b64_tr_b16 v[228:229], v239 offset:32768
    ds_read_b64_tr_b16 v[230:231], v239 offset:33792
    ds_read_b64_tr_b16 v[208:209], v238 offset:40960
    ds_read_b64_tr_b16 v[210:211], v238 offset:41984
    s_add_u32 s95, s70, s14
    s_add_u32 m0, s89, 16384
    s_nop 0
    buffer_load_dwordx4 v243, s[52:55], s95 offen offset:0 nt lds
    v_exp_f32 v187, v187
    v_add_f32 v245, v245, v184
    v_add_f32 v245, v245, v185
    v_cvt_pk_bf16_f32 v184, v184, v185
    v_add_f32 v245, v245, v186
    v_mfma_f32_32x32x16_bf16 v[168:183], v[212:215], v[28:31], v[168:183]
    ds_read_b64_tr_b16 v[212:213], v239 offset:40960
    ds_read_b64_tr_b16 v[214:215], v239 offset:41984
    s_add_u32 s95, s70, s14
    s_add_u32 m0, s89, 24448
    s_nop 0
    buffer_load_dwordx4 v243, s[52:55], s95 offen offset:128 nt lds
    v_add_f32 v245, v245, v187
    v_cvt_pk_bf16_f32 v185, v186, v187
    v_exp_f32 v152, v152
    v_exp_f32 v153, v153
    v_mfma_f32_32x32x16_bf16 v[168:183], v[216:219], v[32:35], v[168:183]
    ds_read_b64_tr_b16 v[216:217], v238 offset:34816
    ds_read_b64_tr_b16 v[218:219], v238 offset:35840
    s_add_u32 s95, s70, s14
    s_add_u32 s95, s95, 8192
    s_add_u32 m0, s89, 20480
    s_nop 0
    buffer_load_dwordx4 v243, s[52:55], s95 offen offset:0 nt lds
    v_exp_f32 v154, v154
    v_exp_f32 v155, v155
    v_add_f32 v244, v244, v152
    v_add_f32 v244, v244, v153
    v_mfma_f32_32x32x16_bf16 v[168:183], v[220:223], v[36:39], v[168:183]
    ds_read_b64_tr_b16 v[220:221], v239 offset:34816
    ds_read_b64_tr_b16 v[222:223], v239 offset:35840
    s_add_u32 s95, s70, s14
    s_add_u32 s95, s95, 8192
    s_add_u32 m0, s89, 28544
    s_nop 0
    buffer_load_dwordx4 v243, s[52:55], s95 offen offset:128 nt lds
    v_cvt_pk_bf16_f32 v152, v152, v153
    v_exp_f32 v156, v156
    v_exp_f32 v157, v157
    v_add_f32 v244, v244, v154
    v_add_f32 v244, v244, v155
    v_cvt_pk_bf16_f32 v153, v154, v155
    v_exp_f32 v158, v158
    v_exp_f32 v159, v159
    v_add_f32 v244, v244, v156
    v_add_f32 v244, v244, v157
    v_cvt_pk_bf16_f32 v154, v156, v157
    v_exp_f32 v160, v160
    v_exp_f32 v161, v161
    v_add_f32 v244, v244, v158
    v_add_f32 v244, v244, v159
    v_cvt_pk_bf16_f32 v155, v158, v159
    v_exp_f32 v162, v162
    v_exp_f32 v163, v163
    v_add_f32 v244, v244, v160
    v_add_f32 v244, v244, v161
    v_cvt_pk_bf16_f32 v156, v160, v161
    v_exp_f32 v164, v164
    v_exp_f32 v165, v165
    v_add_f32 v244, v244, v162
    v_add_f32 v244, v244, v163
    v_cvt_pk_bf16_f32 v157, v162, v163
    v_exp_f32 v166, v166
    v_exp_f32 v167, v167
    v_add_f32 v244, v244, v164
    v_add_f32 v244, v244, v165
    v_cvt_pk_bf16_f32 v158, v164, v165
    v_add_f32 v244, v244, v166
    v_add_f32 v244, v244, v167
    v_cvt_pk_bf16_f32 v159, v166, v167
    v_max3_f32 v246, v168, v169, v170
    v_max3_f32 v246, v246, v171, v172
    v_max3_f32 v246, v246, v173, v174
    v_max3_f32 v246, v246, v175, v176
    v_max3_f32 v246, v246, v177, v178
    v_max3_f32 v246, v246, v179, v180
    v_max3_f32 v246, v246, v181, v182
    v_max_f32 v246, v246, v183
    v_cmp_lt_f32 vcc, 0x41000000, v246
    s_nop 1
    s_cbranch_vccnz L_slow_B05
L_back_B05:
    s_waitcnt lgkmcnt(10)
    v_mfma_f32_32x32x16_bf16 v[56:71], v[224:227], v[152:155], v[56:71]
    ds_read_b64_tr_b16 v[224:225], v238 offset:43008
    ds_read_b64_tr_b16 v[226:227], v238 offset:44032
    v_exp_f32 v168, v168
    v_exp_f32 v169, v169
    v_exp_f32 v170, v170
    s_waitcnt lgkmcnt(10)
    v_mfma_f32_32x32x16_bf16 v[72:87], v[228:231], v[152:155], v[72:87]
    ds_read_b64_tr_b16 v[228:229], v239 offset:43008
    ds_read_b64_tr_b16 v[230:231], v239 offset:44032
    v_exp_f32 v171, v171
    v_add_f32 v244, v244, v168
    v_add_f32 v244, v244, v169
    v_cvt_pk_bf16_f32 v168, v168, v169
    v_exp_f32 v172, v172
    s_waitcnt lgkmcnt(10)
    v_mfma_f32_32x32x16_bf16 v[88:103], v[208:211], v[152:155], v[88:103]
    ds_read_b64_tr_b16 v[208:209], v240 offset:32768
    ds_read_b64_tr_b16 v[210:211], v240 offset:32800
    v_exp_f32 v173, v173
    v_add_f32 v244, v244, v170
    v_add_f32 v244, v244, v171
    v_cvt_pk_bf16_f32 v169, v170, v171
    v_exp_f32 v174, v174
    s_waitcnt lgkmcnt(10)
    v_mfma_f32_32x32x16_bf16 v[104:119], v[212:215], v[152:155], v[104:119]
    ds_read_b64_tr_b16 v[212:213], v241 offset:32768
    ds_read_b64_tr_b16 v[214:215], v241 offset:32800
    v_exp_f32 v175, v175
    v_add_f32 v244, v244, v172
    v_add_f32 v244, v244, v173
    v_cvt_pk_bf16_f32 v170, v172, v173
    v_exp_f32 v176, v176
    s_waitcnt lgkmcnt(10)
    v_mfma_f32_32x32x16_bf16 v[56:71], v[216:219], v[156:159], v[56:71]
    ds_read_b64_tr_b16 v[216:217], v240 offset:40960
    ds_read_b64_tr_b16 v[218:219], v240 offset:40992
    v_exp_f32 v177, v177
    v_add_f32 v244, v244, v174
    v_add_f32 v244, v244, v175
    v_cvt_pk_bf16_f32 v171, v174, v175
    v_exp_f32 v178, v178
    s_waitcnt lgkmcnt(10)
    v_mfma_f32_32x32x16_bf16 v[72:87], v[220:223], v[156:159], v[72:87]
    ds_read_b64_tr_b16 v[220:221], v241 offset:40960
    ds_read_b64_tr_b16 v[222:223], v241 offset:40992
    v_exp_f32 v179, v179
    v_add_f32 v244, v244, v176
    v_add_f32 v244, v244, v177
    v_cvt_pk_bf16_f32 v172, v176, v177
    v_exp_f32 v180, v180
    s_waitcnt lgkmcnt(10)
    v_mfma_f32_32x32x16_bf16 v[88:103], v[224:227], v[156:159], v[88:103]
    ds_read_b64_tr_b16 v[224:225], v238 offset:36864
    ds_read_b64_tr_b16 v[226:227], v238 offset:37888
    v_exp_f32 v181, v181
    v_add_f32 v244, v244, v178
    v_add_f32 v244, v244, v179
    v_cvt_pk_bf16_f32 v173, v178, v179
    v_exp_f32 v182, v182
    s_waitcnt lgkmcnt(10)
    v_mfma_f32_32x32x16_bf16 v[104:119], v[228:231], v[156:159], v[104:119]
    ds_read_b64_tr_b16 v[228:229], v239 offset:36864
    ds_read_b64_tr_b16 v[230:231], v239 offset:37888
    v_exp_f32 v183, v183
    v_add_f32 v244, v244, v180
    v_add_f32 v244, v244, v181
    v_cvt_pk_bf16_f32 v174, v180, v181
    v_add_f32 v244, v244, v182
    s_waitcnt lgkmcnt(11)
    v_mfma_f32_16x16x16_bf16 v[120:123], v[208:209], v[184:185], v[120:123]
    s_waitcnt lgkmcnt(10)
    v_mfma_f32_16x16x16_bf16 v[124:127], v[210:211], v[184:185], v[124:127]
    ds_read_b64_tr_b16 v[208:209], v238 offset:45056
    ds_read_b64_tr_b16 v[210:211], v238 offset:46080
    v_add_f32 v244, v244, v183
    v_cvt_pk_bf16_f32 v175, v182, v183
    s_waitcnt lgkmcnt(11)
    v_mfma_f32_16x16x16_bf16 v[128:131], v[212:213], v[184:185], v[128:131]
    s_waitcnt lgkmcnt(10)
    v_mfma_f32_16x16x16_bf16 v[132:135], v[214:215], v[184:185], v[132:135]
    ds_read_b64_tr_b16 v[212:213], v239 offset:45056
    ds_read_b64_tr_b16 v[214:215], v239 offset:46080
    s_waitcnt lgkmcnt(11)
    v_mfma_f32_16x16x16_bf16 v[136:139], v[216:217], v[184:185], v[136:139]
    s_waitcnt lgkmcnt(10)
    v_mfma_f32_16x16x16_bf16 v[140:143], v[218:219], v[184:185], v[140:143]
    ds_read_b64_tr_b16 v[216:217], v238 offset:38912
    ds_read_b64_tr_b16 v[218:219], v238 offset:39936
    s_waitcnt lgkmcnt(11)
    v_mfma_f32_16x16x16_bf16 v[144:147], v[220:221], v[184:185], v[144:147]
    s_waitcnt lgkmcnt(10)
    v_mfma_f32_16x16x16_bf16 v[148:151], v[222:223], v[184:185], v[148:151]
    ds_read_b64_tr_b16 v[220:221], v239 offset:38912
    ds_read_b64_tr_b16 v[222:223], v239 offset:39936
    s_waitcnt lgkmcnt(10)
    v_mfma_f32_32x32x16_bf16 v[56:71], v[224:227], v[168:171], v[56:71]
    ds_read_b64_tr_b16 v[224:225], v238 offset:47104
    ds_read_b64_tr_b16 v[226:227], v238 offset:48128
    s_waitcnt lgkmcnt(10)
    v_mfma_f32_32x32x16_bf16 v[72:87], v[228:231], v[168:171], v[72:87]
    ds_read_b64_tr_b16 v[228:229], v239 offset:47104
    ds_read_b64_tr_b16 v[230:231], v239 offset:48128
    s_waitcnt lgkmcnt(10)
    v_mfma_f32_32x32x16_bf16 v[88:103], v[208:211], v[168:171], v[88:103]
    s_waitcnt lgkmcnt(8)
    v_mfma_f32_32x32x16_bf16 v[104:119], v[212:215], v[168:171], v[104:119]
    s_waitcnt lgkmcnt(6)
    v_mfma_f32_32x32x16_bf16 v[56:71], v[216:219], v[172:175], v[56:71]
    s_waitcnt vmcnt(4)
    s_waitcnt lgkmcnt(0)
    s_barrier
    ds_read_b128 v[208:211], v232 offset:0
    ds_read_b128 v[212:215], v233 offset:0
    ds_read_b128 v[216:219], v234 offset:0
    s_add_u32 s95, s70, s15
    s_add_u32 m0, s89, 32768
    s_nop 0
    buffer_load_dwordx4 v242, s[48:51], s95 offen offset:0 nt lds
    v_mfma_f32_32x32x16_bf16 v[72:87], v[220:223], v[172:175], v[72:87]
    ds_read_b128 v[220:223], v235 offset:0
    s_add_u32 s95, s70, s15
    s_add_u32 m0, s89, 40832
    s_nop 0
    buffer_load_dwordx4 v242, s[48:51], s95 offen offset:128 nt lds
    v_mfma_f32_32x32x16_bf16 v[88:103], v[224:227], v[172:175], v[88:103]
    ds_read_b128 v[224:227], v232 offset:8192
    s_add_u32 s95, s70, s15
    s_add_u32 s95, s95, 8192
    s_add_u32 m0, s89, 36864
    s_nop 0
    buffer_load_dwordx4 v242, s[48:51], s95 offen offset:0 nt lds
    v_mfma_f32_32x32x16_bf16 v[104:119], v[228:231], v[172:175], v[104:119]
    ds_read_b128 v[228:231], v233 offset:8192
    s_add_u32 s95, s70, s15
    s_add_u32 s95, s95, 8192
    s_add_u32 m0, s89, 44928
    s_nop 0
    buffer_load_dwordx4 v242, s[48:51], s95 offen offset:128 nt lds
    s_waitcnt lgkmcnt(5)
    v_mfma_f32_32x32x16_bf16 v[152:167], v[208:211], v[8:11], v[188:203]
    ds_read_b128 v[208:211], v234 offset:8192
    s_waitcnt lgkmcnt(5)
    v_mfma_f32_32x32x16_bf16 v[152:167], v[212:215], v[12:15], v[152:167]
    ds_read_b128 v[212:215], v235 offset:8192
    s_waitcnt lgkmcnt(5)
    v_mfma_f32_32x32x16_bf16 v[152:167], v[216:219], v[16:19], v[152:167]
    ds_read_b128 v[216:219], v236 offset:0
    s_waitcnt lgkmcnt(5)
    v_mfma_f32_32x32x16_bf16 v[152:167], v[220:223], v[20:23], v[152:167]
    ds_read_b128 v[220:223], v237 offset:0
    s_waitcnt lgkmcnt(5)
    v_mfma_f32_32x32x16_bf16 v[152:167], v[224:227], v[24:27], v[152:167]
    ds_read_b128 v[224:227], v236 offset:8192
    s_waitcnt lgkmcnt(5)
    v_mfma_f32_32x32x16_bf16 v[152:167], v[228:231], v[28:31], v[152:167]
    ds_read_b128 v[228:231], v237 offset:8192
    s_waitcnt lgkmcnt(5)
    v_mfma_f32_32x32x16_bf16 v[152:167], v[208:211], v[32:35], v[152:167]
    ds_read_b128 v[208:211], v232 offset:4096
    s_waitcnt lgkmcnt(5)
    v_mfma_f32_32x32x16_bf16 v[152:167], v[212:215], v[36:39], v[152:167]
    ds_read_b128 v[212:215], v233 offset:4096
    s_waitcnt lgkmcnt(5)
    v_mfma_f32_16x16x32_bf16 v[184:187], v[216:219], v[40:43], v[204:207]
    ds_read_b128 v[216:219], v234 offset:4096
    s_waitcnt lgkmcnt(5)
    v_mfma_f32_16x16x32_bf16 v[184:187], v[220:223], v[44:47], v[184:187]
    ds_read_b128 v[220:223], v235 offset:4096
    s_waitcnt lgkmcnt(5)
    v_mfma_f32_16x16x32_bf16 v[184:187], v[224:227], v[48:51], v[184:187]
    ds_read_b128 v[224:227], v232 offset:12288
    s_waitcnt lgkmcnt(5)
    v_mfma_f32_16x16x32_bf16 v[184:187], v[228:231], v[52:55], v[184:187]
    ds_read_b128 v[228:231], v233 offset:12288
    s_waitcnt lgkmcnt(5)
    v_mfma_f32_32x32x16_bf16 v[168:183], v[208:211], v[8:11], v[188:203]
    ds_read_b128 v[208:211], v234 offset:12288
    s_waitcnt lgkmcnt(5)
    v_mfma_f32_32x32x16_bf16 v[168:183], v[212:215], v[12:15], v[168:183]
    ds_read_b128 v[212:215], v235 offset:12288
    v_max3_f32 v246, v152, v153, v154
    v_max3_f32 v246, v246, v155, v156
    v_max3_f32 v246, v246, v157, v158
    v_max3_f32 v246, v246, v159, v160
    v_max3_f32 v246, v246, v161, v162
    v_max3_f32 v246, v246, v163, v164
    s_waitcnt lgkmcnt(5)
    v_mfma_f32_32x32x16_bf16 v[168:183], v[216:219], v[16:19], v[168:183]
    v_max3_f32 v246, v246, v165, v166
    v_max_f32 v246, v246, v167
    v_max3_f32 v247, v184, v185, v186
    v_max_f32 v247, v247, v187
    v_max_f32 v248, v246, v247
    v_cmp_lt_f32 vcc, 0x41000000, v248
    s_nop 1
    s_cbranch_vccnz L_slow_A06
L_back_A06:
    s_waitcnt lgkmcnt(4)
    v_mfma_f32_32x32x16_bf16 v[168:183], v[220:223], v[20:23], v[168:183]
    v_exp_f32 v184, v184
    v_exp_f32 v185, v185
    v_exp_f32 v186, v186
    s_waitcnt lgkmcnt(3)
    v_mfma_f32_32x32x16_bf16 v[168:183], v[224:227], v[24:27], v[168:183]
    s_waitcnt vmcnt(4)
    s_waitcnt lgkmcnt(0)
    s_barrier
    ds_read_b64_tr_b16 v[216:217], v238 offset:16384
    ds_read_b64_tr_b16 v[218:219], v238 offset:17408
    ds_read_b64_tr_b16 v[220:221], v239 offset:16384
    ds_read_b64_tr_b16 v[222:223], v239 offset:17408
    ds_read_b64_tr_b16 v[224:225], v238 offset:24576
    ds_read_b64_tr_b16 v[226:227], v238 offset:25600
    s_add_u32 s95, s70, s15
    s_mov_b32 m0, s89
    s_nop 0
    buffer_load_dwordx4 v243, s[52:55], s95 offen offset:0 nt lds
    v_exp_f32 v187, v187
    v_add_f32 v245, v245, v184
    v_add_f32 v245, v245, v185
    v_cvt_pk_bf16_f32 v184, v184, v185
    v_add_f32 v245, v245, v186
    v_mfma_f32_32x32x16_bf16 v[168:183], v[228:231], v[28:31], v[168:183]
    ds_read_b64_tr_b16 v[228:229], v239 offset:24576
    ds_read_b64_tr_b16 v[230:231], v239 offset:25600
    s_add_u32 s95, s70, s15
    s_add_u32 m0, s89, 8064
    s_nop 0
    buffer_load_dwordx4 v243, s[52:55], s95 offen offset:128 nt lds
    v_add_f32 v245, v245, v187
    v_cvt_pk_bf16_f32 v185, v186, v187
    v_exp_f32 v152, v152
    v_exp_f32 v153, v153
    v_mfma_f32_32x32x16_bf16 v[168:183], v[208:211], v[32:35], v[168:183]
    ds_read_b64_tr_b16 v[208:209], v238 offset:18432
    ds_read_b64_tr_b16 v[210:211], v238 offset:19456
    s_add_u32 s95, s70, s15
    s_add_u32 s95, s95, 8192
    s_add_u32 m0, s89, 4096
    s_nop 0
    buffer_load_dwordx4 v243, s[52:55], s95 offen offset:0 nt lds
    v_exp_f32 v154, v154
    v_exp_f32 v155, v155
    v_add_f32 v244, v244, v152
    v_add_f32 v244, v244, v153
    v_mfma_f32_32x32x16_bf16 v[168:183], v[212:215], v[36:39], v[168:183]
    ds_read_b64_tr_b16 v[212:213], v239 offset:18432
    ds_read_b64_tr_b16 v[214:215], v239 offset:19456
    s_add_u32 s95, s70, s15
    s_add_u32 s95, s95, 8192
    s_add_u32 m0, s89, 12160
    s_nop 0
    buffer_load_dwordx4 v243, s[52:55], s95 offen offset:128 nt lds
    v_cvt_pk_bf16_f32 v152, v152, v153
    v_exp_f32 v156, v156
    v_exp_f32 v157, v157
    v_add_f32 v244, v244, v154
    v_add_f32 v244, v244, v155
    v_cvt_pk_bf16_f32 v153, v154, v155
    v_exp_f32 v158, v158
    v_exp_f32 v159, v159
    v_add_f32 v244, v244, v156
    v_add_f32 v244, v244, v157
    v_cvt_pk_bf16_f32 v154, v156, v157
    v_exp_f32 v160, v160
    v_exp_f32 v161, v161
    v_add_f32 v244, v244, v158
    v_add_f32 v244, v244, v159
    v_cvt_pk_bf16_f32 v155, v158, v159
    v_exp_f32 v162, v162
    v_exp_f32 v163, v163
    v_add_f32 v244, v244, v160
    v_add_f32 v244, v244, v161
    v_cvt_pk_bf16_f32 v156, v160, v161
    v_exp_f32 v164, v164
    v_exp_f32 v165, v165
    v_add_f32 v244, v244, v162
    v_add_f32 v244, v244, v163
    v_cvt_pk_bf16_f32 v157, v162, v163
    v_exp_f32 v166, v166
    v_exp_f32 v167, v167
    v_add_f32 v244, v244, v164
    v_add_f32 v244, v244, v165
    v_cvt_pk_bf16_f32 v158, v164, v165
    v_add_f32 v244, v244, v166
    v_add_f32 v244, v244, v167
    v_cvt_pk_bf16_f32 v159, v166, v167
    v_max3_f32 v246, v168, v169, v170
    v_max3_f32 v246, v246, v171, v172
    v_max3_f32 v246, v246, v173, v174
    v_max3_f32 v246, v246, v175, v176
    v_max3_f32 v246, v246, v177, v178
    v_max3_f32 v246, v246, v179, v180
    v_max3_f32 v246, v246, v181, v182
    v_max_f32 v246, v246, v183
    v_cmp_lt_f32 vcc, 0x41000000, v246
    s_nop 1
    s_cbranch_vccnz L_slow_B06
L_back_B06:
    s_waitcnt lgkmcnt(10)
    v_mfma_f32_32x32x16_bf16 v[56:71], v[216:219], v[152:155], v[56:71]
    ds_read_b64_tr_b16 v[216:217], v238 offset:26624
    ds_read_b64_tr_b16 v[218:219], v238 offset:27648
    v_exp_f32 v168, v168
    v_exp_f32 v169, v169
    v_exp_f32 v170, v170
    s_waitcnt lgkmcnt(10)
    v_mfma_f32_32x32x16_bf16 v[72:87], v[220:223], v[152:155], v[72:87]
    ds_read_b64_tr_b16 v[220:221], v239 offset:26624
    ds_read_b64_tr_b16 v[222:223], v239 offset:27648
    v_exp_f32 v171, v171
    v_add_f32 v244, v244, v168
    v_add_f32 v244, v244, v169
    v_cvt_pk_bf16_f32 v168, v168, v169
    v_exp_f32 v172, v172
    s_waitcnt lgkmcnt(10)
    v_mfma_f32_32x32x16_bf16 v[88:103], v[224:227], v[152:155], v[88:103]
    ds_read_b64_tr_b16 v[224:225], v240 offset:16384
    ds_read_b64_tr_b16 v[226:227], v240 offset:16416
    v_exp_f32 v173, v173
    v_add_f32 v244, v244, v170
    v_add_f32 v244, v244, v171
    v_cvt_pk_bf16_f32 v169, v170, v171
    v_exp_f32 v174, v174
    s_waitcnt lgkmcnt(10)
    v_mfma_f32_32x32x16_bf16 v[104:119], v[228:231], v[152:155], v[104:119]
    ds_read_b64_tr_b16 v[228:229], v241 offset:16384
    ds_read_b64_tr_b16 v[230:231], v241 offset:16416
    v_exp_f32 v175, v175
    v_add_f32 v244, v244, v172
    v_add_f32 v244, v244, v173
    v_cvt_pk_bf16_f32 v170, v172, v173
    v_exp_f32 v176, v176
    s_waitcnt lgkmcnt(10)
    v_mfma_f32_32x32x16_bf16 v[56:71], v[208:211], v[156:159], v[56:71]
    ds_read_b64_tr_b16 v[208:209], v240 offset:24576
    ds_read_b64_tr_b16 v[210:211], v240 offset:24608
    v_exp_f32 v177, v177
    v_add_f32 v244, v244, v174
    v_add_f32 v244, v244, v175
    v_cvt_pk_bf16_f32 v171, v174, v175
    v_exp_f32 v178, v178
    s_waitcnt lgkmcnt(10)
    v_mfma_f32_32x32x16_bf16 v[72:87], v[212:215], v[156:159], v[72:87]
    ds_read_b64_tr_b16 v[212:213], v241 offset:24576
    ds_read_b64_tr_b16 v[214:215], v241 offset:24608
    v_exp_f32 v179, v179
    v_add_f32 v244, v244, v176
    v_add_f32 v244, v244, v177
    v_cvt_pk_bf16_f32 v172, v176, v177
    v_exp_f32 v180, v180
    s_waitcnt lgkmcnt(10)
    v_mfma_f32_32x32x16_bf16 v[88:103], v[216:219], v[156:159], v[88:103]
    ds_read_b64_tr_b16 v[216:217], v238 offset:20480
    ds_read_b64_tr_b16 v[218:219], v238 offset:21504
    v_exp_f32 v181, v181
    v_add_f32 v244, v244, v178
    v_add_f32 v244, v244, v179
    v_cvt_pk_bf16_f32 v173, v178, v179
    v_exp_f32 v182, v182
    s_waitcnt lgkmcnt(10)
    v_mfma_f32_32x32x16_bf16 v[104:119], v[220:223], v[156:159], v[104:119]
    ds_read_b64_tr_b16 v[220:221], v239 offset:20480
    ds_read_b64_tr_b16 v[222:223], v239 offset:21504
    v_exp_f32 v183, v183
    v_add_f32 v244, v244, v180
    v_add_f32 v244, v244, v181
    v_cvt_pk_bf16_f32 v174, v180, v181
    v_add_f32 v244, v244, v182
    s_waitcnt lgkmcnt(11)
    v_mfma_f32_16x16x16_bf16 v[120:123], v[224:225], v[184:185], v[120:123]
    s_waitcnt lgkmcnt(10)
    v_mfma_f32_16x16x16_bf16 v[124:127], v[226:227], v[184:185], v[124:127]
    ds_read_b64_tr_b16 v[224:225], v238 offset:28672
    ds_read_b64_tr_b16 v[226:227], v238 offset:29696
    v_add_f32 v244, v244, v183
    v_cvt_pk_bf16_f32 v175, v182, v183
    s_waitcnt lgkmcnt(11)
    v_mfma_f32_16x16x16_bf16 v[128:131], v[228:229], v[184:185], v[128:131]
    s_waitcnt lgkmcnt(10)
    v_mfma_f32_16x16x16_bf16 v[132:135], v[230:231], v[184:185], v[132:135]
    ds_read_b64_tr_b16 v[228:229], v239 offset:28672
    ds_read_b64_tr_b16 v[230:231], v239 offset:29696
    s_waitcnt lgkmcnt(11)
    v_mfma_f32_16x16x16_bf16 v[136:139], v[208:209], v[184:185], v[136:139]
    s_waitcnt lgkmcnt(10)
    v_mfma_f32_16x16x16_bf16 v[140:143], v[210:211], v[184:185], v[140:143]
    ds_read_b64_tr_b16 v[208:209], v238 offset:22528
    ds_read_b64_tr_b16 v[210:211], v238 offset:23552
    s_waitcnt lgkmcnt(11)
    v_mfma_f32_16x16x16_bf16 v[144:147], v[212:213], v[184:185], v[144:147]
    s_waitcnt lgkmcnt(10)
    v_mfma_f32_16x16x16_bf16 v[148:151], v[214:215], v[184:185], v[148:151]
    ds_read_b64_tr_b16 v[212:213], v239 offset:22528
    ds_read_b64_tr_b16 v[214:215], v239 offset:23552
    s_waitcnt lgkmcnt(10)
    v_mfma_f32_32x32x16_bf16 v[56:71], v[216:219], v[168:171], v[56:71]
    ds_read_b64_tr_b16 v[216:217], v238 offset:30720
    ds_read_b64_tr_b16 v[218:219], v238 offset:31744
    s_waitcnt lgkmcnt(10)
    v_mfma_f32_32x32x16_bf16 v[72:87], v[220:223], v[168:171], v[72:87]
    ds_read_b64_tr_b16 v[220:221], v239 offset:30720
    ds_read_b64_tr_b16 v[222:223], v239 offset:31744
    s_waitcnt lgkmcnt(10)
    v_mfma_f32_32x32x16_bf16 v[88:103], v[224:227], v[168:171], v[88:103]
    s_waitcnt lgkmcnt(8)
    v_mfma_f32_32x32x16_bf16 v[104:119], v[228:231], v[168:171], v[104:119]
    s_waitcnt lgkmcnt(6)
    v_mfma_f32_32x32x16_bf16 v[56:71], v[208:211], v[172:175], v[56:71]
    s_waitcnt vmcnt(4)
    s_waitcnt lgkmcnt(0)
    s_barrier
    ds_read_b128 v[224:227], v232 offset:32768
    ds_read_b128 v[228:231], v233 offset:32768
    ds_read_b128 v[208:211], v234 offset:32768
    v_mfma_f32_32x32x16_bf16 v[72:87], v[212:215], v[172:175], v[72:87]
    ds_read_b128 v[212:215], v235 offset:32768
    v_mfma_f32_32x32x16_bf16 v[88:103], v[216:219], v[172:175], v[88:103]
    ds_read_b128 v[216:219], v232 offset:40960
    v_mfma_f32_32x32x16_bf16 v[104:119], v[220:223], v[172:175], v[104:119]
    ds_read_b128 v[220:223], v233 offset:40960
    s_waitcnt lgkmcnt(5)
    v_mfma_f32_32x32x16_bf16 v[152:167], v[224:227], v[8:11], v[188:203]
    ds_read_b128 v[224:227], v234 offset:40960
    s_waitcnt lgkmcnt(5)
    v_mfma_f32_32x32x16_bf16 v[152:167], v[228:231], v[12:15], v[152:167]
    ds_read_b128 v[228:231], v235 offset:40960
    s_waitcnt lgkmcnt(5)
    v_mfma_f32_32x32x16_bf16 v[152:167], v[208:211], v[16:19], v[152:167]
    ds_read_b128 v[208:211], v236 offset:32768
    s_waitcnt lgkmcnt(5)
    v_mfma_f32_32x32x16_bf16 v[152:167], v[212:215], v[20:23], v[152:167]
    ds_read_b128 v[212:215], v237 offset:32768
    s_waitcnt lgkmcnt(5)
    v_mfma_f32_32x32x16_bf16 v[152:167], v[216:219], v[24:27], v[152:167]
    ds_read_b128 v[216:219], v236 offset:40960
    s_waitcnt lgkmcnt(5)
    v_mfma_f32_32x32x16_bf16 v[152:167], v[220:223], v[28:31], v[152:167]
    ds_read_b128 v[220:223], v237 offset:40960
    s_waitcnt lgkmcnt(5)
    v_mfma_f32_32x32x16_bf16 v[152:167], v[224:227], v[32:35], v[152:167]
    ds_read_b128 v[224:227], v232 offset:36864
    s_waitcnt lgkmcnt(5)
    v_mfma_f32_32x32x16_bf16 v[152:167], v[228:231], v[36:39], v[152:167]
    ds_read_b128 v[228:231], v233 offset:36864
    s_waitcnt lgkmcnt(5)
    v_mfma_f32_16x16x32_bf16 v[184:187], v[208:211], v[40:43], v[204:207]
    ds_read_b128 v[208:211], v234 offset:36864
    s_waitcnt lgkmcnt(5)
    v_mfma_f32_16x16x32_bf16 v[184:187], v[212:215], v[44:47], v[184:187]
    ds_read_b128 v[212:215], v235 offset:36864
    s_waitcnt lgkmcnt(5)
    v_mfma_f32_16x16x32_bf16 v[184:187], v[216:219], v[48:51], v[184:187]
    ds_read_b128 v[216:219], v232 offset:45056
    s_waitcnt lgkmcnt(5)
    v_mfma_f32_16x16x32_bf16 v[184:187], v[220:223], v[52:55], v[184:187]
    ds_read_b128 v[220:223], v233 offset:45056
    s_waitcnt lgkmcnt(5)
    v_mfma_f32_32x32x16_bf16 v[168:183], v[224:227], v[8:11], v[188:203]
    ds_read_b128 v[224:227], v234 offset:45056
    s_waitcnt lgkmcnt(5)
    v_mfma_f32_32x32x16_bf16 v[168:183], v[228:231], v[12:15], v[168:183]
    ds_read_b128 v[228:231], v235 offset:45056
    v_max3_f32 v246, v152, v153, v154
    v_max3_f32 v246, v246, v155, v156
    v_max3_f32 v246, v246, v157, v158
    v_max3_f32 v246, v246, v159, v160
    v_max3_f32 v246, v246, v161, v162
    v_max3_f32 v246, v246, v163, v164
    s_waitcnt lgkmcnt(5)
    v_mfma_f32_32x32x16_bf16 v[168:183], v[208:211], v[16:19], v[168:183]
    v_max3_f32 v246, v246, v165, v166
    v_max_f32 v246, v246, v167
    v_max3_f32 v247, v184, v185, v186
    v_max_f32 v247, v247, v187
    v_max_f32 v248, v246, v247
    v_cmp_lt_f32 vcc, 0x41000000, v248
    s_nop 1
    s_cbranch_vccnz L_slow_A07
L_back_A07:
    s_waitcnt lgkmcnt(4)
    v_mfma_f32_32x32x16_bf16 v[168:183], v[212:215], v[20:23], v[168:183]
    v_exp_f32 v184, v184
    v_exp_f32 v185, v185
    v_exp_f32 v186, v186
    s_waitcnt lgkmcnt(3)
    v_mfma_f32_32x32x16_bf16 v[168:183], v[216:219], v[24:27], v[168:183]
    v_exp_f32 v187, v187
    v_add_f32 v245, v245, v184
    v_add_f32 v245, v245, v185
    v_cvt_pk_bf16_f32 v184, v184, v185
    v_add_f32 v245, v245, v186
    v_add_f32 v245, v245, v187
    v_cvt_pk_bf16_f32 v185, v186, v187
    v_exp_f32 v152, v152
    v_exp_f32 v153, v153
    v_exp_f32 v154, v154
    v_exp_f32 v155, v155
    v_add_f32 v244, v244, v152
    v_add_f32 v244, v244, v153
    v_cvt_pk_bf16_f32 v152, v152, v153
    v_exp_f32 v156, v156
    v_exp_f32 v157, v157
    v_add_f32 v244, v244, v154
    v_add_f32 v244, v244, v155
    v_cvt_pk_bf16_f32 v153, v154, v155
    v_exp_f32 v158, v158
    v_exp_f32 v159, v159
    v_add_f32 v244, v244, v156
    v_add_f32 v244, v244, v157
    v_cvt_pk_bf16_f32 v154, v156, v157
    v_exp_f32 v160, v160
    v_exp_f32 v161, v161
    v_add_f32 v244, v244, v158
    v_add_f32 v244, v244, v159
    v_cvt_pk_bf16_f32 v155, v158, v159
    v_exp_f32 v162, v162
    v_exp_f32 v163, v163
    v_add_f32 v244, v244, v160
    v_add_f32 v244, v244, v161
    v_cvt_pk_bf16_f32 v156, v160, v161
    v_exp_f32 v164, v164
    v_exp_f32 v165, v165
    v_add_f32 v244, v244, v162
    v_add_f32 v244, v244, v163
    v_cvt_pk_bf16_f32 v157, v162, v163
    v_exp_f32 v166, v166
    v_exp_f32 v167, v167
    v_add_f32 v244, v244, v164
    v_add_f32 v244, v244, v165
    v_cvt_pk_bf16_f32 v158, v164, v165
    v_add_f32 v244, v244, v166
    v_add_f32 v244, v244, v167
    v_cvt_pk_bf16_f32 v159, v166, v167
    v_mov_b32 v247, v245
    v_mov_b32 v248, v247
    s_nop 1
    v_permlane32_swap_b32 v247, v248
    v_add_f32 v247, v247, v248
    v_mov_b32 v248, v247
    s_nop 1
    v_permlane16_swap_b32 v247, v248
    v_add_f32 v247, v247, v248
    v_sub_f32 v246, 0, v204
    s_lshl_b32 s74, s68, 7
    v_add_u32 v249, s74, v5
    ds_write_b64 v249, v[246:247] offset:0
    s_waitcnt vmcnt(0)
    s_waitcnt lgkmcnt(0)
    s_barrier
    ds_read_b64 v[40:41], v5 offset:0
    ds_read_b64 v[42:43], v5 offset:128
    ds_read_b64 v[44:45], v5 offset:256
    ds_read_b64 v[46:47], v5 offset:384
    s_waitcnt lgkmcnt(1)
    v_max3_f32 v48, v40, v42, v44
    s_waitcnt lgkmcnt(0)
    v_max_f32 v48, v48, v46
    v_sub_f32 v40, v40, v48
    v_sub_f32 v42, v42, v48
    v_sub_f32 v44, v44, v48
    v_sub_f32 v46, v46, v48
    v_sub_f32 v250, v246, v48
    v_exp_f32 v40, v40
    v_exp_f32 v42, v42
    v_exp_f32 v44, v44
    v_exp_f32 v46, v46
    v_exp_f32 v250, v250
    v_mul_f32 v48, v40, v41
    v_fma_f32 v48, v42, v43, v48
    v_fma_f32 v48, v44, v45, v48
    v_fma_f32 v48, v46, v47, v48
    v_rcp_f32 v48, v48
    s_nop 0
    v_mul_f32 v250, v250, v48
    ds_read_b64_tr_b16 v[208:209], v238 offset:0
    ds_read_b64_tr_b16 v[210:211], v238 offset:1024
    ds_read_b64_tr_b16 v[212:213], v239 offset:0
    ds_read_b64_tr_b16 v[214:215], v239 offset:1024
    ds_read_b64_tr_b16 v[216:217], v238 offset:8192
    ds_read_b64_tr_b16 v[218:219], v238 offset:9216
    v_mfma_f32_32x32x16_bf16 v[168:183], v[220:223], v[28:31], v[168:183]
    ds_read_b64_tr_b16 v[220:221], v239 offset:8192
    ds_read_b64_tr_b16 v[222:223], v239 offset:9216
    v_mfma_f32_32x32x16_bf16 v[168:183], v[224:227], v[32:35], v[168:183]
    ds_read_b64_tr_b16 v[224:225], v238 offset:2048
    ds_read_b64_tr_b16 v[226:227], v238 offset:3072
    v_mfma_f32_32x32x16_bf16 v[168:183], v[228:231], v[36:39], v[168:183]
    ds_read_b64_tr_b16 v[228:229], v239 offset:2048
    ds_read_b64_tr_b16 v[230:231], v239 offset:3072
    s_nop 9
    v_max3_f32 v246, v168, v169, v170
    v_max3_f32 v246, v246, v171, v172
    v_max3_f32 v246, v246, v173, v174
    v_max3_f32 v246, v246, v175, v176
    v_max3_f32 v246, v246, v177, v178
    v_max3_f32 v246, v246, v179, v180
    v_max3_f32 v246, v246, v181, v182
    v_max_f32 v246, v246, v183
    v_cmp_lt_f32 vcc, 0x41000000, v246
    s_nop 1
    s_cbranch_vccnz L_slow_B07
L_back_B07:
    s_waitcnt lgkmcnt(10)
    v_mfma_f32_32x32x16_bf16 v[56:71], v[208:211], v[152:155], v[56:71]
    ds_read_b64_tr_b16 v[208:209], v238 offset:10240
    ds_read_b64_tr_b16 v[210:211], v238 offset:11264
    v_exp_f32 v168, v168
    v_exp_f32 v169, v169
    v_exp_f32 v170, v170
    s_waitcnt lgkmcnt(10)
    v_mfma_f32_32x32x16_bf16 v[72:87], v[212:215], v[152:155], v[72:87]
    ds_read_b64_tr_b16 v[212:213], v239 offset:10240
    ds_read_b64_tr_b16 v[214:215], v239 offset:11264
    v_exp_f32 v171, v171
    v_add_f32 v244, v244, v168
    v_add_f32 v244, v244, v169
    v_cvt_pk_bf16_f32 v168, v168, v169
    v_exp_f32 v172, v172
    s_waitcnt lgkmcnt(10)
    v_mfma_f32_32x32x16_bf16 v[88:103], v[216:219], v[152:155], v[88:103]
    ds_read_b64_tr_b16 v[216:217], v240 offset:0
    ds_read_b64_tr_b16 v[218:219], v240 offset:32
    v_exp_f32 v173, v173
    v_add_f32 v244, v244, v170
    v_add_f32 v244, v244, v171
    v_cvt_pk_bf16_f32 v169, v170, v171
    v_exp_f32 v174, v174
    s_waitcnt lgkmcnt(10)
    v_mfma_f32_32x32x16_bf16 v[104:119], v[220:223], v[152:155], v[104:119]
    ds_read_b64_tr_b16 v[220:221], v241 offset:0
    ds_read_b64_tr_b16 v[222:223], v241 offset:32
    v_exp_f32 v175, v175
    v_add_f32 v244, v244, v172
    v_add_f32 v244, v244, v173
    v_cvt_pk_bf16_f32 v170, v172, v173
    v_exp_f32 v176, v176
    s_waitcnt lgkmcnt(10)
    v_mfma_f32_32x32x16_bf16 v[56:71], v[224:227], v[156:159], v[56:71]
    ds_read_b64_tr_b16 v[224:225], v240 offset:8192
    ds_read_b64_tr_b16 v[226:227], v240 offset:8224
    v_exp_f32 v177, v177
    v_add_f32 v244, v244, v174
    v_add_f32 v244, v244, v175
    v_cvt_pk_bf16_f32 v171, v174, v175
    v_exp_f32 v178, v178
    s_waitcnt lgkmcnt(10)
    v_mfma_f32_32x32x16_bf16 v[72:87], v[228:231], v[156:159], v[72:87]
    ds_read_b64_tr_b16 v[228:229], v241 offset:8192
    ds_read_b64_tr_b16 v[230:231], v241 offset:8224
    v_exp_f32 v179, v179
    v_add_f32 v244, v244, v176
    v_add_f32 v244, v244, v177
    v_cvt_pk_bf16_f32 v172, v176, v177
    v_exp_f32 v180, v180
    s_waitcnt lgkmcnt(10)
    v_mfma_f32_32x32x16_bf16 v[88:103], v[208:211], v[156:159], v[88:103]
    ds_read_b64_tr_b16 v[208:209], v238 offset:4096
    ds_read_b64_tr_b16 v[210:211], v238 offset:5120
    v_exp_f32 v181, v181
    v_add_f32 v244, v244, v178
    v_add_f32 v244, v244, v179
    v_cvt_pk_bf16_f32 v173, v178, v179
    v_exp_f32 v182, v182
    s_waitcnt lgkmcnt(10)
    v_mfma_f32_32x32x16_bf16 v[104:119], v[212:215], v[156:159], v[104:119]
    ds_read_b64_tr_b16 v[212:213], v239 offset:4096
    ds_read_b64_tr_b16 v[214:215], v239 offset:5120
    v_exp_f32 v183, v183
    v_add_f32 v244, v244, v180
    v_add_f32 v244, v244, v181
    v_cvt_pk_bf16_f32 v174, v180, v181
    v_add_f32 v244, v244, v182
    s_waitcnt lgkmcnt(11)
    v_mfma_f32_16x16x16_bf16 v[120:123], v[216:217], v[184:185], v[120:123]
    s_waitcnt lgkmcnt(10)
    v_mfma_f32_16x16x16_bf16 v[124:127], v[218:219], v[184:185], v[124:127]
    ds_read_b64_tr_b16 v[216:217], v238 offset:12288
    ds_read_b64_tr_b16 v[218:219], v238 offset:13312
    v_add_f32 v244, v244, v183
    v_cvt_pk_bf16_f32 v175, v182, v183
    s_waitcnt lgkmcnt(11)
    v_mfma_f32_16x16x16_bf16 v[128:131], v[220:221], v[184:185], v[128:131]
    s_waitcnt lgkmcnt(10)
    v_mfma_f32_16x16x16_bf16 v[132:135], v[222:223], v[184:185], v[132:135]
    ds_read_b64_tr_b16 v[220:221], v239 offset:12288
    ds_read_b64_tr_b16 v[222:223], v239 offset:13312
    s_waitcnt lgkmcnt(11)
    v_mfma_f32_16x16x16_bf16 v[136:139], v[224:225], v[184:185], v[136:139]
    s_waitcnt lgkmcnt(10)
    v_mfma_f32_16x16x16_bf16 v[140:143], v[226:227], v[184:185], v[140:143]
    ds_read_b64_tr_b16 v[224:225], v238 offset:6144
    ds_read_b64_tr_b16 v[226:227], v238 offset:7168
    s_waitcnt lgkmcnt(11)
    v_mfma_f32_16x16x16_bf16 v[144:147], v[228:229], v[184:185], v[144:147]
    s_waitcnt lgkmcnt(10)
    v_mfma_f32_16x16x16_bf16 v[148:151], v[230:231], v[184:185], v[148:151]
    ds_read_b64_tr_b16 v[228:229], v239 offset:6144
    ds_read_b64_tr_b16 v[230:231], v239 offset:7168
    s_waitcnt lgkmcnt(10)
    v_mfma_f32_32x32x16_bf16 v[56:71], v[208:211], v[168:171], v[56:71]
    ds_read_b64_tr_b16 v[208:209], v238 offset:14336
    ds_read_b64_tr_b16 v[210:211], v238 offset:15360
    s_waitcnt lgkmcnt(10)
    v_mfma_f32_32x32x16_bf16 v[72:87], v[212:215], v[168:171], v[72:87]
    ds_read_b64_tr_b16 v[212:213], v239 offset:14336
    ds_read_b64_tr_b16 v[214:215], v239 offset:15360
    s_waitcnt lgkmcnt(10)
    v_mfma_f32_32x32x16_bf16 v[88:103], v[216:219], v[168:171], v[88:103]
    s_waitcnt lgkmcnt(8)
    v_mfma_f32_32x32x16_bf16 v[104:119], v[220:223], v[168:171], v[104:119]
    s_waitcnt lgkmcnt(6)
    v_mfma_f32_32x32x16_bf16 v[56:71], v[224:227], v[172:175], v[56:71]
    s_waitcnt lgkmcnt(4)
    v_mfma_f32_32x32x16_bf16 v[72:87], v[228:231], v[172:175], v[72:87]
    s_waitcnt lgkmcnt(2)
    v_mfma_f32_32x32x16_bf16 v[88:103], v[208:211], v[172:175], v[88:103]
    s_waitcnt lgkmcnt(0)
    v_mfma_f32_32x32x16_bf16 v[104:119], v[212:215], v[172:175], v[104:119]
    v_mov_b32 v248, v244
    s_nop 1
    v_permlane32_swap_b32 v244, v248
    v_add_f32 v244, v244, v248
    v_rcp_f32 v244, v244
    v_mul_f32 v120, v120, v250
    v_mul_f32 v121, v121, v250
    v_mul_f32 v122, v122, v250
    v_mul_f32 v123, v123, v250
    v_mul_f32 v124, v124, v250
    v_mul_f32 v125, v125, v250
    v_mul_f32 v126, v126, v250
    v_mul_f32 v127, v127, v250
    v_mul_f32 v128, v128, v250
    v_mul_f32 v129, v129, v250
    v_mul_f32 v130, v130, v250
    v_mul_f32 v131, v131, v250
    v_mul_f32 v132, v132, v250
    v_mul_f32 v133, v133, v250
    v_mul_f32 v134, v134, v250
    v_mul_f32 v135, v135, v250
    v_mul_f32 v136, v136, v250
    v_mul_f32 v137, v137, v250
    v_mul_f32 v138, v138, v250
    v_mul_f32 v139, v139, v250
    v_mul_f32 v140, v140, v250
    v_mul_f32 v141, v141, v250
    v_mul_f32 v142, v142, v250
    v_mul_f32 v143, v143, v250
    v_mul_f32 v144, v144, v250
    v_mul_f32 v145, v145, v250
    v_mul_f32 v146, v146, v250
    v_mul_f32 v147, v147, v250
    v_mul_f32 v148, v148, v250
    v_mul_f32 v149, v149, v250
    v_mul_f32 v150, v150, v250
    v_mul_f32 v151, v151, v250
    s_barrier
    ds_write_b128 v251, v[120:123] offset:0
    ds_write_b128 v251, v[124:127] offset:1024
    ds_write_b128 v251, v[128:131] offset:2048
    ds_write_b128 v251, v[132:135] offset:3072
    ds_write_b128 v251, v[136:139] offset:4096
    ds_write_b128 v251, v[140:143] offset:5120
    ds_write_b128 v251, v[144:147] offset:6144
    ds_write_b128 v251, v[148:151] offset:7168
    v_mul_f32 v56, v56, v244
    v_mul_f32 v57, v57, v244
    v_mul_f32 v58, v58, v244
    v_mul_f32 v59, v59, v244
    v_mul_f32 v60, v60, v244
    v_mul_f32 v61, v61, v244
    v_mul_f32 v62, v62, v244
    v_mul_f32 v63, v63, v244
    v_mul_f32 v64, v64, v244
    v_mul_f32 v65, v65, v244
    v_mul_f32 v66, v66, v244
    v_mul_f32 v67, v67, v244
    v_mul_f32 v68, v68, v244
    v_mul_f32 v69, v69, v244
    v_mul_f32 v70, v70, v244
    v_mul_f32 v71, v71, v244
    v_cvt_pk_bf16_f32 v188, v56, v57
    v_cvt_pk_bf16_f32 v189, v58, v59
    v_cvt_pk_bf16_f32 v190, v60, v61
    v_cvt_pk_bf16_f32 v191, v62, v63
    v_cvt_pk_bf16_f32 v192, v64, v65
    v_cvt_pk_bf16_f32 v193, v66, v67
    v_cvt_pk_bf16_f32 v194, v68, v69
    v_cvt_pk_bf16_f32 v195, v70, v71
    v_mul_f32 v72, v72, v244
    v_mul_f32 v73, v73, v244
    v_mul_f32 v74, v74, v244
    v_mul_f32 v75, v75, v244
    v_mul_f32 v76, v76, v244
    v_mul_f32 v77, v77, v244
    v_mul_f32 v78, v78, v244
    v_mul_f32 v79, v79, v244
    v_mul_f32 v80, v80, v244
    v_mul_f32 v81, v81, v244
    v_mul_f32 v82, v82, v244
    v_mul_f32 v83, v83, v244
    v_mul_f32 v84, v84, v244
    v_mul_f32 v85, v85, v244
    v_mul_f32 v86, v86, v244
    v_mul_f32 v87, v87, v244
    v_cvt_pk_bf16_f32 v196, v72, v73
    v_cvt_pk_bf16_f32 v197, v74, v75
    v_cvt_pk_bf16_f32 v198, v76, v77
    v_cvt_pk_bf16_f32 v199, v78, v79
    v_cvt_pk_bf16_f32 v200, v80, v81
    v_cvt_pk_bf16_f32 v201, v82, v83
    v_cvt_pk_bf16_f32 v202, v84, v85
    v_cvt_pk_bf16_f32 v203, v86, v87
    v_mul_f32 v88, v88, v244
    v_mul_f32 v89, v89, v244
    v_mul_f32 v90, v90, v244
    v_mul_f32 v91, v91, v244
    v_mul_f32 v92, v92, v244
    v_mul_f32 v93, v93, v244
    v_mul_f32 v94, v94, v244
    v_mul_f32 v95, v95, v244
    v_mul_f32 v96, v96, v244
    v_mul_f32 v97, v97, v244
    v_mul_f32 v98, v98, v244
    v_mul_f32 v99, v99, v244
    v_mul_f32 v100, v100, v244
    v_mul_f32 v101, v101, v244
    v_mul_f32 v102, v102, v244
    v_mul_f32 v103, v103, v244
    v_cvt_pk_bf16_f32 v204, v88, v89
    v_cvt_pk_bf16_f32 v205, v90, v91
    v_cvt_pk_bf16_f32 v206, v92, v93
    v_cvt_pk_bf16_f32 v207, v94, v95
    v_cvt_pk_bf16_f32 v208, v96, v97
    v_cvt_pk_bf16_f32 v209, v98, v99
    v_cvt_pk_bf16_f32 v210, v100, v101
    v_cvt_pk_bf16_f32 v211, v102, v103
    v_mul_f32 v104, v104, v244
    v_mul_f32 v105, v105, v244
    v_mul_f32 v106, v106, v244
    v_mul_f32 v107, v107, v244
    v_mul_f32 v108, v108, v244
    v_mul_f32 v109, v109, v244
    v_mul_f32 v110, v110, v244
    v_mul_f32 v111, v111, v244
    v_mul_f32 v112, v112, v244
    v_mul_f32 v113, v113, v244
    v_mul_f32 v114, v114, v244
    v_mul_f32 v115, v115, v244
    v_mul_f32 v116, v116, v244
    v_mul_f32 v117, v117, v244
    v_mul_f32 v118, v118, v244
    v_mul_f32 v119, v119, v244
    v_cvt_pk_bf16_f32 v212, v104, v105
    v_cvt_pk_bf16_f32 v213, v106, v107
    v_cvt_pk_bf16_f32 v214, v108, v109
    v_cvt_pk_bf16_f32 v215, v110, v111
    v_cvt_pk_bf16_f32 v216, v112, v113
    v_cvt_pk_bf16_f32 v217, v114, v115
    v_cvt_pk_bf16_f32 v218, v116, v117
    v_cvt_pk_bf16_f32 v219, v118, v119
    s_lshl_b32 s86, s2, 13
    s_add_u32 s86, s86, s88
    s_add_u32 s86, s86, 67108864
    s_waitcnt lgkmcnt(0)
    s_barrier
    ds_read_b128 v[56:59], v4 offset:0
    ds_read_b128 v[60:63], v4 offset:256
    ds_read_b128 v[64:67], v4 offset:8192
    ds_read_b128 v[68:71], v4 offset:8448
    ds_read_b128 v[72:75], v4 offset:16384
    ds_read_b128 v[76:79], v4 offset:16640
    ds_read_b128 v[80:83], v4 offset:24576
    ds_read_b128 v[84:87], v4 offset:24832
    s_waitcnt lgkmcnt(5)
    v_add_f32 v56, v56, v64
    s_waitcnt lgkmcnt(1)
    v_add_f32 v72, v72, v80
    v_add_f32 v57, v57, v65
    v_add_f32 v73, v73, v81
    v_add_f32 v58, v58, v66
    v_add_f32 v74, v74, v82
    v_add_f32 v59, v59, v67
    v_add_f32 v75, v75, v83
    v_add_f32 v60, v60, v68
    s_waitcnt lgkmcnt(0)
    v_add_f32 v76, v76, v84
    v_add_f32 v61, v61, v69
    v_add_f32 v77, v77, v85
    v_add_f32 v62, v62, v70
    v_add_f32 v78, v78, v86
    v_add_f32 v63, v63, v71
    v_add_f32 v79, v79, v87
    v_add_f32 v56, v56, v72
    v_add_f32 v57, v57, v73
    v_add_f32 v58, v58, v74
    v_add_f32 v59, v59, v75
    v_add_f32 v60, v60, v76
    v_add_f32 v61, v61, v77
    v_add_f32 v62, v62, v78
    v_add_f32 v63, v63, v79
    v_cvt_pk_bf16_f32 v224, v56, v57
    v_cvt_pk_bf16_f32 v225, v58, v59
    v_cvt_pk_bf16_f32 v226, v60, v61
    v_cvt_pk_bf16_f32 v227, v62, v63
    buffer_store_dwordx4 v[224:227], v1, s[64:67], s86 offen offset:0
    s_cmp_eq_u32 s79, 1
    s_cbranch_scc1 L_nolead0
    s_barrier
L_nolead0:
    s_add_u32 s70, s70, 262144
    s_add_u32 s71, s71, 512
    s_barrier
    v_bfe_u32 v246, v252, 3, 3
    v_bfe_u32 v247, v252, 0, 3
    v_bfe_u32 v248, v252, 4, 2
    v_xor_b32 v248, v247, v248
    v_lshlrev_b32 v248, 4, v248
    v_lshl_add_u32 v185, v246, 10, v248
    s_add_u32 s74, s87, s97
    s_and_b32 s74, s74, 7
    s_lshl_b32 s74, s74, 7
    s_add_u32 s74, s74, s84
    s_add_u32 s74, s74, 131072
    s_lshl_b32 s75, s87, 11
    s_add_u32 m0, s75, 147456
    s_nop 0
    buffer_load_dwordx4 v185, s[44:47], s74 offen offset:0 lds
    v_xor_b32 v185, 64, v185
    s_add_u32 s74, s74, 8192
    s_add_u32 m0, s75, 148480
    s_nop 0
    buffer_load_dwordx4 v185, s[44:47], s74 offen offset:0 lds
    s_add_u32 s98, s97, 0
    s_and_b32 s98, s98, 7
    s_lshl_b32 s99, s98, 7
    s_add_u32 s99, s99, s84
    s_lshl_b32 s98, s98, 19
    s_add_u32 s98, s98, s71
    s_add_u32 m0, s88, 65536
    s_nop 0
    buffer_load_dwordx4 v7, s[44:47], s99 offen offset:0 lds
    s_add_u32 s99, s99, 65536
    s_add_u32 m0, s88, 73728
    s_nop 0
    buffer_load_dwordx4 v7, s[44:47], s99 offen offset:0 lds
    s_add_u32 m0, s89, 16384
    s_nop 0
    buffer_load_dwordx4 v6, s[56:59], s98 offen offset:0 lds
    s_add_u32 m0, s89, 24448
    s_nop 0
    buffer_load_dwordx4 v6, s[56:59], s98 offen offset:128 lds
    s_add_u32 s98, s98, 262144
    s_add_u32 m0, s89, 20480
    s_nop 0
    buffer_load_dwordx4 v6, s[56:59], s98 offen offset:0 lds
    s_add_u32 m0, s89, 28544
    s_nop 0
    buffer_load_dwordx4 v6, s[56:59], s98 offen offset:128 lds
    s_add_u32 s98, s97, 1
    s_and_b32 s98, s98, 7
    s_lshl_b32 s99, s98, 7
    s_add_u32 s99, s99, s84
    s_lshl_b32 s98, s98, 19
    s_add_u32 s98, s98, s71
    s_add_u32 m0, s88, 131072
    s_nop 0
    buffer_load_dwordx4 v7, s[44:47], s99 offen offset:0 lds
    s_add_u32 s99, s99, 65536
    s_add_u32 m0, s88, 139264
    s_nop 0
    buffer_load_dwordx4 v7, s[44:47], s99 offen offset:0 lds
    s_add_u32 m0, s89, 32768
    s_nop 0
    buffer_load_dwordx4 v6, s[56:59], s98 offen offset:0 lds
    s_add_u32 m0, s89, 40832
    s_nop 0
    buffer_load_dwordx4 v6, s[56:59], s98 offen offset:128 lds
    s_add_u32 s98, s98, 262144
    s_add_u32 m0, s89, 36864
    s_nop 0
    buffer_load_dwordx4 v6, s[56:59], s98 offen offset:0 lds
    s_add_u32 m0, s89, 44928
    s_nop 0
    buffer_load_dwordx4 v6, s[56:59], s98 offen offset:128 lds
    v_mov_b32 v176, v255
    v_xor_b32 v177, 64, v255
    s_lshl_b32 s74, s68, 12
    s_sub_u32 s74, s74, s85
    s_add_u32 s74, s74, 49152
    v_add_u32 v179, s74, v232
    v_add_u32 v180, s74, v233
    v_add_u32 v181, s74, v234
    v_add_u32 v182, s74, v235
    s_lshl_b32 s74, s68, 11
    s_add_u32 s74, s74, s85
    s_sub_u32 s74, 147456, s74
    v_add_u32 v183, s74, v236
    v_add_u32 v184, s74, v237
    v_bfe_u32 v246, v252, 3, 1
    v_lshlrev_b32 v246, 6, v246
    s_and_b32 s74, s68, 1
    s_lshl_b32 s74, s74, 6
    v_xor_b32 v246, s74, v246
    v_bfe_u32 v247, v252, 0, 2
    v_lshl_add_u32 v246, v247, 4, v246
    v_bfe_u32 v247, v252, 2, 2
    v_lshl_add_u32 v246, v247, 7, v246
    v_lshl_add_u32 v246, v254, 10, v246
    s_lshr_b32 s74, s68, 1
    s_lshl_b32 s74, s74, 13
    s_add_u32 s74, s74, s85
    v_add_u32 v178, s74, v246
    s_waitcnt vmcnt(6)
    s_barrier
    ds_read_b128 v[128:131], v179 offset:16384
    ds_read_b128 v[132:135], v180 offset:16384
    ds_read_b128 v[136:139], v181 offset:16384
    ds_read_b128 v[140:143], v182 offset:16384
    ds_read_b128 v[160:163], v183 offset:0
    ds_read_b128 v[164:167], v184 offset:0
    ds_read_b64_tr_b16 v[8:9], v176 offset:16384
    ds_read_b64_tr_b16 v[10:11], v176 offset:16896
    ds_read_b64_tr_b16 v[12:13], v177 offset:16384
    ds_read_b64_tr_b16 v[14:15], v177 offset:16896
    ds_read_b64_tr_b16 v[16:17], v176 offset:24576
    ds_read_b64_tr_b16 v[18:19], v176 offset:25088
    ds_read_b64_tr_b16 v[20:21], v177 offset:24576
    ds_read_b64_tr_b16 v[22:23], v177 offset:25088
    ds_read_b64_tr_b16 v[24:25], v176 offset:18432
    ds_read_b64_tr_b16 v[26:27], v176 offset:18944
    ds_read_b64_tr_b16 v[28:29], v177 offset:18432
    ds_read_b64_tr_b16 v[30:31], v177 offset:18944
    ds_read_b64_tr_b16 v[32:33], v176 offset:26624
    ds_read_b64_tr_b16 v[34:35], v176 offset:27136
    ds_read_b64_tr_b16 v[36:37], v177 offset:26624
    ds_read_b64_tr_b16 v[38:39], v177 offset:27136
    s_waitcnt lgkmcnt(14)
    v_mfma_f32_32x32x16_bf16 v[56:71], v[8:11], v[128:131], 0
    ds_read_b64_tr_b16 v[8:9], v178 offset:16384
    ds_read_b64_tr_b16 v[10:11], v178 offset:16896
    s_add_u32 s98, s97, 2
    s_and_b32 s98, s98, 7
    s_lshl_b32 s99, s98, 7
    s_add_u32 s99, s99, s84
    s_lshl_b32 s98, s98, 19
    s_add_u32 s98, s98, s71
    s_add_u32 m0, s88, 49152
    s_nop 0
    buffer_load_dwordx4 v7, s[44:47], s99 offen offset:0 lds
    s_waitcnt lgkmcnt(14)
    v_mfma_f32_32x32x16_bf16 v[72:87], v[12:15], v[128:131], 0
    ds_read_b64_tr_b16 v[12:13], v178 offset:16392
    ds_read_b64_tr_b16 v[14:15], v178 offset:16904
    s_waitcnt lgkmcnt(14)
    v_mfma_f32_32x32x16_bf16 v[88:103], v[16:19], v[128:131], 0
    ds_read_b64_tr_b16 v[16:17], v176 offset:20480
    ds_read_b64_tr_b16 v[18:19], v176 offset:20992
    s_add_u32 s99, s99, 65536
    s_add_u32 m0, s88, 57344
    s_nop 0
    buffer_load_dwordx4 v7, s[44:47], s99 offen offset:0 lds
    s_waitcnt lgkmcnt(14)
    v_mfma_f32_32x32x16_bf16 v[104:119], v[20:23], v[128:131], 0
    ds_read_b64_tr_b16 v[20:21], v177 offset:20480
    ds_read_b64_tr_b16 v[22:23], v177 offset:20992
    s_waitcnt lgkmcnt(14)
    v_mfma_f32_32x32x16_bf16 v[56:71], v[24:27], v[132:135], v[56:71]
    ds_read_b64_tr_b16 v[24:25], v176 offset:28672
    ds_read_b64_tr_b16 v[26:27], v176 offset:29184
    s_mov_b32 m0, s89
    s_nop 0
    buffer_load_dwordx4 v6, s[56:59], s98 offen offset:0 lds
    s_waitcnt lgkmcnt(14)
    v_mfma_f32_32x32x16_bf16 v[72:87], v[28:31], v[132:135], v[72:87]
    ds_read_b64_tr_b16 v[28:29], v177 offset:28672
    ds_read_b64_tr_b16 v[30:31], v177 offset:29184
    s_waitcnt lgkmcnt(14)
    v_mfma_f32_32x32x16_bf16 v[88:103], v[32:35], v[132:135], v[88:103]
    ds_read_b64_tr_b16 v[32:33], v176 offset:22528
    ds_read_b64_tr_b16 v[34:35], v176 offset:23040
    s_add_u32 m0, s89, 8064
    s_nop 0
    buffer_load_dwordx4 v6, s[56:59], s98 offen offset:128 lds
    s_waitcnt lgkmcnt(14)
    v_mfma_f32_32x32x16_bf16 v[104:119], v[36:39], v[132:135], v[104:119]
    ds_read_b64_tr_b16 v[36:37], v177 offset:22528
    ds_read_b64_tr_b16 v[38:39], v177 offset:23040
    s_waitcnt lgkmcnt(14)
    v_mfma_f32_16x16x32_bf16 v[120:123], v[8:11], v[160:163], 0
    ds_read_b64_tr_b16 v[8:9], v176 offset:30720
    ds_read_b64_tr_b16 v[10:11], v176 offset:31232
    s_waitcnt lgkmcnt(14)
    v_mfma_f32_16x16x32_bf16 v[124:127], v[12:15], v[160:163], 0
    ds_read_b64_tr_b16 v[12:13], v177 offset:30720
    ds_read_b64_tr_b16 v[14:15], v177 offset:31232
    s_waitcnt lgkmcnt(14)
    v_mfma_f32_32x32x16_bf16 v[56:71], v[16:19], v[136:139], v[56:71]
    ds_read_b64_tr_b16 v[16:17], v178 offset:20480
    ds_read_b64_tr_b16 v[18:19], v178 offset:20992
    s_add_u32 s98, s98, 262144
    s_add_u32 m0, s89, 4096
    s_nop 0
    buffer_load_dwordx4 v6, s[56:59], s98 offen offset:0 lds
    s_waitcnt lgkmcnt(14)
    v_mfma_f32_32x32x16_bf16 v[72:87], v[20:23], v[136:139], v[72:87]
    ds_read_b64_tr_b16 v[20:21], v178 offset:20488
    ds_read_b64_tr_b16 v[22:23], v178 offset:21000
    s_waitcnt lgkmcnt(14)
    v_mfma_f32_32x32x16_bf16 v[88:103], v[24:27], v[136:139], v[88:103]
    s_add_u32 m0, s89, 12160
    s_nop 0
    buffer_load_dwordx4 v6, s[56:59], s98 offen offset:128 lds
    s_waitcnt lgkmcnt(12)
    v_mfma_f32_32x32x16_bf16 v[104:119], v[28:31], v[136:139], v[104:119]
    s_waitcnt lgkmcnt(10)
    v_mfma_f32_32x32x16_bf16 v[56:71], v[32:35], v[140:143], v[56:71]
    s_waitcnt lgkmcnt(8)
    v_mfma_f32_32x32x16_bf16 v[72:87], v[36:39], v[140:143], v[72:87]
    s_waitcnt vmcnt(6)
    s_waitcnt lgkmcnt(0)
    s_barrier
    v_add_u32 v179, 0x10000, v179
    v_add_u32 v180, 0x10000, v180
    v_add_u32 v181, 0x10000, v181
    v_add_u32 v182, 0x10000, v182
    ds_read_b128 v[144:147], v179 offset:16384
    ds_read_b128 v[148:151], v180 offset:16384
    ds_read_b128 v[152:155], v181 offset:16384
    ds_read_b128 v[156:159], v182 offset:16384
    ds_read_b128 v[168:171], v183 offset:2048
    ds_read_b128 v[172:175], v184 offset:2048
    ds_read_b64_tr_b16 v[24:25], v176 offset:32768
    ds_read_b64_tr_b16 v[26:27], v176 offset:33280
    ds_read_b64_tr_b16 v[28:29], v177 offset:32768
    ds_read_b64_tr_b16 v[30:31], v177 offset:33280
    ds_read_b64_tr_b16 v[32:33], v176 offset:40960
    ds_read_b64_tr_b16 v[34:35], v176 offset:41472
    ds_read_b64_tr_b16 v[36:37], v177 offset:40960
    ds_read_b64_tr_b16 v[38:39], v177 offset:41472
    v_mfma_f32_32x32x16_bf16 v[88:103], v[8:11], v[140:143], v[88:103]
    ds_read_b64_tr_b16 v[8:9], v176 offset:34816
    ds_read_b64_tr_b16 v[10:11], v176 offset:35328
    s_add_u32 s98, s97, 3
    s_and_b32 s98, s98, 7
    s_lshl_b32 s99, s98, 7
    s_add_u32 s99, s99, s84
    s_lshl_b32 s98, s98, 19
    s_add_u32 s98, s98, s71
    s_add_u32 m0, s88, 65536
    s_nop 0
    buffer_load_dwordx4 v7, s[44:47], s99 offen offset:0 lds
    v_mfma_f32_32x32x16_bf16 v[104:119], v[12:15], v[140:143], v[104:119]
    ds_read_b64_tr_b16 v[12:13], v177 offset:34816
    ds_read_b64_tr_b16 v[14:15], v177 offset:35328
    v_mfma_f32_16x16x32_bf16 v[120:123], v[16:19], v[164:167], v[120:123]
    ds_read_b64_tr_b16 v[16:17], v176 offset:43008
    ds_read_b64_tr_b16 v[18:19], v176 offset:43520
    v_mfma_f32_16x16x32_bf16 v[124:127], v[20:23], v[164:167], v[124:127]
    ds_read_b64_tr_b16 v[20:21], v177 offset:43008
    ds_read_b64_tr_b16 v[22:23], v177 offset:43520
    s_waitcnt lgkmcnt(14)
    v_mfma_f32_32x32x16_bf16 v[56:71], v[24:27], v[144:147], v[56:71]
    ds_read_b64_tr_b16 v[24:25], v178 offset:32768
    ds_read_b64_tr_b16 v[26:27], v178 offset:33280
    s_add_u32 s99, s99, 65536
    s_add_u32 m0, s88, 73728
    s_nop 0
    buffer_load_dwordx4 v7, s[44:47], s99 offen offset:0 lds
    s_waitcnt lgkmcnt(14)
    v_mfma_f32_32x32x16_bf16 v[72:87], v[28:31], v[144:147], v[72:87]
    ds_read_b64_tr_b16 v[28:29], v178 offset:32776
    ds_read_b64_tr_b16 v[30:31], v178 offset:33288
    s_waitcnt lgkmcnt(14)
    v_mfma_f32_32x32x16_bf16 v[88:103], v[32:35], v[144:147], v[88:103]
    ds_read_b64_tr_b16 v[32:33], v176 offset:36864
    ds_read_b64_tr_b16 v[34:35], v176 offset:37376
    s_add_u32 m0, s89, 16384
    s_nop 0
    buffer_load_dwordx4 v6, s[56:59], s98 offen offset:0 lds
    s_waitcnt lgkmcnt(14)
    v_mfma_f32_32x32x16_bf16 v[104:119], v[36:39], v[144:147], v[104:119]
    ds_read_b64_tr_b16 v[36:37], v177 offset:36864
    ds_read_b64_tr_b16 v[38:39], v177 offset:37376
    s_waitcnt lgkmcnt(14)
    v_mfma_f32_32x32x16_bf16 v[56:71], v[8:11], v[148:151], v[56:71]
    ds_read_b64_tr_b16 v[8:9], v176 offset:45056
    ds_read_b64_tr_b16 v[10:11], v176 offset:45568
    s_add_u32 m0, s89, 24448
    s_nop 0
    buffer_load_dwordx4 v6, s[56:59], s98 offen offset:128 lds
    s_waitcnt lgkmcnt(14)
    v_mfma_f32_32x32x16_bf16 v[72:87], v[12:15], v[148:151], v[72:87]
    ds_read_b64_tr_b16 v[12:13], v177 offset:45056
    ds_read_b64_tr_b16 v[14:15], v177 offset:45568
    s_waitcnt lgkmcnt(14)
    v_mfma_f32_32x32x16_bf16 v[88:103], v[16:19], v[148:151], v[88:103]
    ds_read_b64_tr_b16 v[16:17], v176 offset:38912
    ds_read_b64_tr_b16 v[18:19], v176 offset:39424
    s_add_u32 s98, s98, 262144
    s_add_u32 m0, s89, 20480
    s_nop 0
    buffer_load_dwordx4 v6, s[56:59], s98 offen offset:0 lds
    s_waitcnt lgkmcnt(14)
    v_mfma_f32_32x32x16_bf16 v[104:119], v[20:23], v[148:151], v[104:119]
    ds_read_b64_tr_b16 v[20:21], v177 offset:38912
    ds_read_b64_tr_b16 v[22:23], v177 offset:39424
    s_waitcnt lgkmcnt(14)
    v_mfma_f32_16x16x32_bf16 v[120:123], v[24:27], v[168:171], v[120:123]
    ds_read_b64_tr_b16 v[24:25], v176 offset:47104
    ds_read_b64_tr_b16 v[26:27], v176 offset:47616
    s_waitcnt lgkmcnt(14)
    v_mfma_f32_16x16x32_bf16 v[124:127], v[28:31], v[168:171], v[124:127]
    ds_read_b64_tr_b16 v[28:29], v177 offset:47104
    ds_read_b64_tr_b16 v[30:31], v177 offset:47616
    s_waitcnt lgkmcnt(14)
    v_mfma_f32_32x32x16_bf16 v[56:71], v[32:35], v[152:155], v[56:71]
    ds_read_b64_tr_b16 v[32:33], v178 offset:36864
    ds_read_b64_tr_b16 v[34:35], v178 offset:37376
    s_add_u32 m0, s89, 28544
    s_nop 0
    buffer_load_dwordx4 v6, s[56:59], s98 offen offset:128 lds
    s_waitcnt lgkmcnt(14)
    v_mfma_f32_32x32x16_bf16 v[72:87], v[36:39], v[152:155], v[72:87]
    ds_read_b64_tr_b16 v[36:37], v178 offset:36872
    ds_read_b64_tr_b16 v[38:39], v178 offset:37384
    s_waitcnt lgkmcnt(14)
    v_mfma_f32_32x32x16_bf16 v[88:103], v[8:11], v[152:155], v[88:103]
    s_waitcnt lgkmcnt(12)
    v_mfma_f32_32x32x16_bf16 v[104:119], v[12:15], v[152:155], v[104:119]
    s_waitcnt lgkmcnt(10)
    v_mfma_f32_32x32x16_bf16 v[56:71], v[16:19], v[156:159], v[56:71]
    s_waitcnt lgkmcnt(8)
    v_mfma_f32_32x32x16_bf16 v[72:87], v[20:23], v[156:159], v[72:87]
    s_waitcnt vmcnt(6)
    s_waitcnt lgkmcnt(0)
    s_barrier
    v_subrev_u32 v179, 0x10000, v179
    v_subrev_u32 v180, 0x10000, v180
    v_subrev_u32 v181, 0x10000, v181
    v_subrev_u32 v182, 0x10000, v182
    ds_read_b128 v[128:131], v179 offset:0
    ds_read_b128 v[132:135], v180 offset:0
    ds_read_b128 v[136:139], v181 offset:0
    ds_read_b128 v[140:143], v182 offset:0
    ds_read_b128 v[160:163], v183 offset:4096
    ds_read_b128 v[164:167], v184 offset:4096
    ds_read_b64_tr_b16 v[8:9], v176 offset:0
    ds_read_b64_tr_b16 v[10:11], v176 offset:512
    ds_read_b64_tr_b16 v[12:13], v177 offset:0
    ds_read_b64_tr_b16 v[14:15], v177 offset:512
    ds_read_b64_tr_b16 v[16:17], v176 offset:8192
    ds_read_b64_tr_b16 v[18:19], v176 offset:8704
    ds_read_b64_tr_b16 v[20:21], v177 offset:8192
    ds_read_b64_tr_b16 v[22:23], v177 offset:8704
    v_mfma_f32_32x32x16_bf16 v[88:103], v[24:27], v[156:159], v[88:103]
    ds_read_b64_tr_b16 v[24:25], v176 offset:2048
    ds_read_b64_tr_b16 v[26:27], v176 offset:2560
    s_add_u32 s98, s97, 4
    s_and_b32 s98, s98, 7
    s_lshl_b32 s99, s98, 7
    s_add_u32 s99, s99, s84
    s_lshl_b32 s98, s98, 19
    s_add_u32 s98, s98, s71
    s_add_u32 m0, s88, 131072
    s_nop 0
    buffer_load_dwordx4 v7, s[44:47], s99 offen offset:0 lds
    v_mfma_f32_32x32x16_bf16 v[104:119], v[28:31], v[156:159], v[104:119]
    ds_read_b64_tr_b16 v[28:29], v177 offset:2048
    ds_read_b64_tr_b16 v[30:31], v177 offset:2560
    v_mfma_f32_16x16x32_bf16 v[120:123], v[32:35], v[172:175], v[120:123]
    ds_read_b64_tr_b16 v[32:33], v176 offset:10240
    ds_read_b64_tr_b16 v[34:35], v176 offset:10752
    v_mfma_f32_16x16x32_bf16 v[124:127], v[36:39], v[172:175], v[124:127]
    ds_read_b64_tr_b16 v[36:37], v177 offset:10240
    ds_read_b64_tr_b16 v[38:39], v177 offset:10752
    s_waitcnt lgkmcnt(14)
    v_mfma_f32_32x32x16_bf16 v[56:71], v[8:11], v[128:131], v[56:71]
    ds_read_b64_tr_b16 v[8:9], v178 offset:0
    ds_read_b64_tr_b16 v[10:11], v178 offset:512
    s_add_u32 s99, s99, 65536
    s_add_u32 m0, s88, 139264
    s_nop 0
    buffer_load_dwordx4 v7, s[44:47], s99 offen offset:0 lds
    s_waitcnt lgkmcnt(14)
    v_mfma_f32_32x32x16_bf16 v[72:87], v[12:15], v[128:131], v[72:87]
    ds_read_b64_tr_b16 v[12:13], v178 offset:8
    ds_read_b64_tr_b16 v[14:15], v178 offset:520
    s_waitcnt lgkmcnt(14)
    v_mfma_f32_32x32x16_bf16 v[88:103], v[16:19], v[128:131], v[88:103]
    ds_read_b64_tr_b16 v[16:17], v176 offset:4096
    ds_read_b64_tr_b16 v[18:19], v176 offset:4608
    s_add_u32 m0, s89, 32768
    s_nop 0
    buffer_load_dwordx4 v6, s[56:59], s98 offen offset:0 lds
    s_waitcnt lgkmcnt(14)
    v_mfma_f32_32x32x16_bf16 v[104:119], v[20:23], v[128:131], v[104:119]
    ds_read_b64_tr_b16 v[20:21], v177 offset:4096
    ds_read_b64_tr_b16 v[22:23], v177 offset:4608
    s_waitcnt lgkmcnt(14)
    v_mfma_f32_32x32x16_bf16 v[56:71], v[24:27], v[132:135], v[56:71]
    ds_read_b64_tr_b16 v[24:25], v176 offset:12288
    ds_read_b64_tr_b16 v[26:27], v176 offset:12800
    s_add_u32 m0, s89, 40832
    s_nop 0
    buffer_load_dwordx4 v6, s[56:59], s98 offen offset:128 lds
    s_waitcnt lgkmcnt(14)
    v_mfma_f32_32x32x16_bf16 v[72:87], v[28:31], v[132:135], v[72:87]
    ds_read_b64_tr_b16 v[28:29], v177 offset:12288
    ds_read_b64_tr_b16 v[30:31], v177 offset:12800
    s_waitcnt lgkmcnt(14)
    v_mfma_f32_32x32x16_bf16 v[88:103], v[32:35], v[132:135], v[88:103]
    ds_read_b64_tr_b16 v[32:33], v176 offset:6144
    ds_read_b64_tr_b16 v[34:35], v176 offset:6656
    s_add_u32 s98, s98, 262144
    s_add_u32 m0, s89, 36864
    s_nop 0
    buffer_load_dwordx4 v6, s[56:59], s98 offen offset:0 lds
    s_waitcnt lgkmcnt(14)
    v_mfma_f32_32x32x16_bf16 v[104:119], v[36:39], v[132:135], v[104:119]
    ds_read_b64_tr_b16 v[36:37], v177 offset:6144
    ds_read_b64_tr_b16 v[38:39], v177 offset:6656
    s_waitcnt lgkmcnt(14)
    v_mfma_f32_16x16x32_bf16 v[120:123], v[8:11], v[160:163], v[120:123]
    ds_read_b64_tr_b16 v[8:9], v176 offset:14336
    ds_read_b64_tr_b16 v[10:11], v176 offset:14848
    s_waitcnt lgkmcnt(14)
    v_mfma_f32_16x16x32_bf16 v[124:127], v[12:15], v[160:163], v[124:127]
    ds_read_b64_tr_b16 v[12:13], v177 offset:14336
    ds_read_b64_tr_b16 v[14:15], v177 offset:14848
    s_waitcnt lgkmcnt(14)
    v_mfma_f32_32x32x16_bf16 v[56:71], v[16:19], v[136:139], v[56:71]
    ds_read_b64_tr_b16 v[16:17], v178 offset:4096
    ds_read_b64_tr_b16 v[18:19], v178 offset:4608
    s_add_u32 m0, s89, 44928
    s_nop 0
    buffer_load_dwordx4 v6, s[56:59], s98 offen offset:128 lds
    s_waitcnt lgkmcnt(14)
    v_mfma_f32_32x32x16_bf16 v[72:87], v[20:23], v[136:139], v[72:87]
    ds_read_b64_tr_b16 v[20:21], v178 offset:4104
    ds_read_b64_tr_b16 v[22:23], v178 offset:4616
    s_waitcnt lgkmcnt(14)
    v_mfma_f32_32x32x16_bf16 v[88:103], v[24:27], v[136:139], v[88:103]
    s_waitcnt lgkmcnt(12)
    v_mfma_f32_32x32x16_bf16 v[104:119], v[28:31], v[136:139], v[104:119]
    s_waitcnt lgkmcnt(10)
    v_mfma_f32_32x32x16_bf16 v[56:71], v[32:35], v[140:143], v[56:71]
    s_waitcnt lgkmcnt(8)
    v_mfma_f32_32x32x16_bf16 v[72:87], v[36:39], v[140:143], v[72:87]
    s_waitcnt vmcnt(6)
    s_waitcnt lgkmcnt(0)
    s_barrier
    ds_read_b128 v[144:147], v179 offset:16384
    ds_read_b128 v[148:151], v180 offset:16384
    ds_read_b128 v[152:155], v181 offset:16384
    ds_read_b128 v[156:159], v182 offset:16384
    ds_read_b128 v[168:171], v183 offset:6144
    ds_read_b128 v[172:175], v184 offset:6144
    ds_read_b64_tr_b16 v[24:25], v176 offset:16384
    ds_read_b64_tr_b16 v[26:27], v176 offset:16896
    ds_read_b64_tr_b16 v[28:29], v177 offset:16384
    ds_read_b64_tr_b16 v[30:31], v177 offset:16896
    ds_read_b64_tr_b16 v[32:33], v176 offset:24576
    ds_read_b64_tr_b16 v[34:35], v176 offset:25088
    ds_read_b64_tr_b16 v[36:37], v177 offset:24576
    ds_read_b64_tr_b16 v[38:39], v177 offset:25088
    v_mfma_f32_32x32x16_bf16 v[88:103], v[8:11], v[140:143], v[88:103]
    ds_read_b64_tr_b16 v[8:9], v176 offset:18432
    ds_read_b64_tr_b16 v[10:11], v176 offset:18944
    s_add_u32 s98, s97, 5
    s_and_b32 s98, s98, 7
    s_lshl_b32 s99, s98, 7
    s_add_u32 s99, s99, s84
    s_lshl_b32 s98, s98, 19
    s_add_u32 s98, s98, s71
    s_add_u32 m0, s88, 49152
    s_nop 0
    buffer_load_dwordx4 v7, s[44:47], s99 offen offset:0 lds
    v_mfma_f32_32x32x16_bf16 v[104:119], v[12:15], v[140:143], v[104:119]
    ds_read_b64_tr_b16 v[12:13], v177 offset:18432
    ds_read_b64_tr_b16 v[14:15], v177 offset:18944
    v_mfma_f32_16x16x32_bf16 v[120:123], v[16:19], v[164:167], v[120:123]
    ds_read_b64_tr_b16 v[16:17], v176 offset:26624
    ds_read_b64_tr_b16 v[18:19], v176 offset:27136
    v_mfma_f32_16x16x32_bf16 v[124:127], v[20:23], v[164:167], v[124:127]
    ds_read_b64_tr_b16 v[20:21], v177 offset:26624
    ds_read_b64_tr_b16 v[22:23], v177 offset:27136
    s_waitcnt lgkmcnt(14)
    v_mfma_f32_32x32x16_bf16 v[56:71], v[24:27], v[144:147], v[56:71]
    ds_read_b64_tr_b16 v[24:25], v178 offset:16384
    ds_read_b64_tr_b16 v[26:27], v178 offset:16896
    s_add_u32 s99, s99, 65536
    s_add_u32 m0, s88, 57344
    s_nop 0
    buffer_load_dwordx4 v7, s[44:47], s99 offen offset:0 lds
    s_waitcnt lgkmcnt(14)
    v_mfma_f32_32x32x16_bf16 v[72:87], v[28:31], v[144:147], v[72:87]
    ds_read_b64_tr_b16 v[28:29], v178 offset:16392
    ds_read_b64_tr_b16 v[30:31], v178 offset:16904
    s_waitcnt lgkmcnt(14)
    v_mfma_f32_32x32x16_bf16 v[88:103], v[32:35], v[144:147], v[88:103]
    ds_read_b64_tr_b16 v[32:33], v176 offset:20480
    ds_read_b64_tr_b16 v[34:35], v176 offset:20992
    s_mov_b32 m0, s89
    s_nop 0
    buffer_load_dwordx4 v6, s[56:59], s98 offen offset:0 lds
    s_waitcnt lgkmcnt(14)
    v_mfma_f32_32x32x16_bf16 v[104:119], v[36:39], v[144:147], v[104:119]
    ds_read_b64_tr_b16 v[36:37], v177 offset:20480
    ds_read_b64_tr_b16 v[38:39], v177 offset:20992
    s_waitcnt lgkmcnt(14)
    v_mfma_f32_32x32x16_bf16 v[56:71], v[8:11], v[148:151], v[56:71]
    ds_read_b64_tr_b16 v[8:9], v176 offset:28672
    ds_read_b64_tr_b16 v[10:11], v176 offset:29184
    s_add_u32 m0, s89, 8064
    s_nop 0
    buffer_load_dwordx4 v6, s[56:59], s98 offen offset:128 lds
    s_waitcnt lgkmcnt(14)
    v_mfma_f32_32x32x16_bf16 v[72:87], v[12:15], v[148:151], v[72:87]
    ds_read_b64_tr_b16 v[12:13], v177 offset:28672
    ds_read_b64_tr_b16 v[14:15], v177 offset:29184
    s_waitcnt lgkmcnt(14)
    v_mfma_f32_32x32x16_bf16 v[88:103], v[16:19], v[148:151], v[88:103]
    ds_read_b64_tr_b16 v[16:17], v176 offset:22528
    ds_read_b64_tr_b16 v[18:19], v176 offset:23040
    s_add_u32 s98, s98, 262144
    s_add_u32 m0, s89, 4096
    s_nop 0
    buffer_load_dwordx4 v6, s[56:59], s98 offen offset:0 lds
    s_waitcnt lgkmcnt(14)
    v_mfma_f32_32x32x16_bf16 v[104:119], v[20:23], v[148:151], v[104:119]
    ds_read_b64_tr_b16 v[20:21], v177 offset:22528
    ds_read_b64_tr_b16 v[22:23], v177 offset:23040
    s_waitcnt lgkmcnt(14)
    v_mfma_f32_16x16x32_bf16 v[120:123], v[24:27], v[168:171], v[120:123]
    ds_read_b64_tr_b16 v[24:25], v176 offset:30720
    ds_read_b64_tr_b16 v[26:27], v176 offset:31232
    s_waitcnt lgkmcnt(14)
    v_mfma_f32_16x16x32_bf16 v[124:127], v[28:31], v[168:171], v[124:127]
    ds_read_b64_tr_b16 v[28:29], v177 offset:30720
    ds_read_b64_tr_b16 v[30:31], v177 offset:31232
    s_waitcnt lgkmcnt(14)
    v_mfma_f32_32x32x16_bf16 v[56:71], v[32:35], v[152:155], v[56:71]
    ds_read_b64_tr_b16 v[32:33], v178 offset:20480
    ds_read_b64_tr_b16 v[34:35], v178 offset:20992
    s_add_u32 m0, s89, 12160
    s_nop 0
    buffer_load_dwordx4 v6, s[56:59], s98 offen offset:128 lds
    s_waitcnt lgkmcnt(14)
    v_mfma_f32_32x32x16_bf16 v[72:87], v[36:39], v[152:155], v[72:87]
    ds_read_b64_tr_b16 v[36:37], v178 offset:20488
    ds_read_b64_tr_b16 v[38:39], v178 offset:21000
    s_waitcnt lgkmcnt(14)
    v_mfma_f32_32x32x16_bf16 v[88:103], v[8:11], v[152:155], v[88:103]
    s_waitcnt lgkmcnt(12)
    v_mfma_f32_32x32x16_bf16 v[104:119], v[12:15], v[152:155], v[104:119]
    s_waitcnt lgkmcnt(10)
    v_mfma_f32_32x32x16_bf16 v[56:71], v[16:19], v[156:159], v[56:71]
    s_waitcnt lgkmcnt(8)
    v_mfma_f32_32x32x16_bf16 v[72:87], v[20:23], v[156:159], v[72:87]
    s_waitcnt vmcnt(6)
    s_waitcnt lgkmcnt(0)
    s_barrier
    v_add_u32 v179, 0x10000, v179
    v_add_u32 v180, 0x10000, v180
    v_add_u32 v181, 0x10000, v181
    v_add_u32 v182, 0x10000, v182
    ds_read_b128 v[128:131], v179 offset:16384
    ds_read_b128 v[132:135], v180 offset:16384
    ds_read_b128 v[136:139], v181 offset:16384
    ds_read_b128 v[140:143], v182 offset:16384
    ds_read_b128 v[160:163], v183 offset:8192
    ds_read_b128 v[164:167], v184 offset:8192
    ds_read_b64_tr_b16 v[8:9], v176 offset:32768
    ds_read_b64_tr_b16 v[10:11], v176 offset:33280
    ds_read_b64_tr_b16 v[12:13], v177 offset:32768
    ds_read_b64_tr_b16 v[14:15], v177 offset:33280
    ds_read_b64_tr_b16 v[16:17], v176 offset:40960
    ds_read_b64_tr_b16 v[18:19], v176 offset:41472
    ds_read_b64_tr_b16 v[20:21], v177 offset:40960
    ds_read_b64_tr_b16 v[22:23], v177 offset:41472
    v_mfma_f32_32x32x16_bf16 v[88:103], v[24:27], v[156:159], v[88:103]
    ds_read_b64_tr_b16 v[24:25], v176 offset:34816
    ds_read_b64_tr_b16 v[26:27], v176 offset:35328
    s_add_u32 s98, s97, 6
    s_and_b32 s98, s98, 7
    s_lshl_b32 s99, s98, 7
    s_add_u32 s99, s99, s84
    s_lshl_b32 s98, s98, 19
    s_add_u32 s98, s98, s71
    s_add_u32 m0, s88, 65536
    s_nop 0
    buffer_load_dwordx4 v7, s[44:47], s99 offen offset:0 lds
    v_mfma_f32_32x32x16_bf16 v[104:119], v[28:31], v[156:159], v[104:119]
    ds_read_b64_tr_b16 v[28:29], v177 offset:34816
    ds_read_b64_tr_b16 v[30:31], v177 offset:35328
    v_mfma_f32_16x16x32_bf16 v[120:123], v[32:35], v[172:175], v[120:123]
    ds_read_b64_tr_b16 v[32:33], v176 offset:43008
    ds_read_b64_tr_b16 v[34:35], v176 offset:43520
    v_mfma_f32_16x16x32_bf16 v[124:127], v[36:39], v[172:175], v[124:127]
    ds_read_b64_tr_b16 v[36:37], v177 offset:43008
    ds_read_b64_tr_b16 v[38:39], v177 offset:43520
    s_waitcnt lgkmcnt(14)
    v_mfma_f32_32x32x16_bf16 v[56:71], v[8:11], v[128:131], v[56:71]
    ds_read_b64_tr_b16 v[8:9], v178 offset:32768
    ds_read_b64_tr_b16 v[10:11], v178 offset:33280
    s_add_u32 s99, s99, 65536
    s_add_u32 m0, s88, 73728
    s_nop 0
    buffer_load_dwordx4 v7, s[44:47], s99 offen offset:0 lds
    s_waitcnt lgkmcnt(14)
    v_mfma_f32_32x32x16_bf16 v[72:87], v[12:15], v[128:131], v[72:87]
    ds_read_b64_tr_b16 v[12:13], v178 offset:32776
    ds_read_b64_tr_b16 v[14:15], v178 offset:33288
    s_waitcnt lgkmcnt(14)
    v_mfma_f32_32x32x16_bf16 v[88:103], v[16:19], v[128:131], v[88:103]
    ds_read_b64_tr_b16 v[16:17], v176 offset:36864
    ds_read_b64_tr_b16 v[18:19], v176 offset:37376
    s_add_u32 m0, s89, 16384
    s_nop 0
    buffer_load_dwordx4 v6, s[56:59], s98 offen offset:0 lds
    s_waitcnt lgkmcnt(14)
    v_mfma_f32_32x32x16_bf16 v[104:119], v[20:23], v[128:131], v[104:119]
    ds_read_b64_tr_b16 v[20:21], v177 offset:36864
    ds_read_b64_tr_b16 v[22:23], v177 offset:37376
    s_waitcnt lgkmcnt(14)
    v_mfma_f32_32x32x16_bf16 v[56:71], v[24:27], v[132:135], v[56:71]
    ds_read_b64_tr_b16 v[24:25], v176 offset:45056
    ds_read_b64_tr_b16 v[26:27], v176 offset:45568
    s_add_u32 m0, s89, 24448
    s_nop 0
    buffer_load_dwordx4 v6, s[56:59], s98 offen offset:128 lds
    s_waitcnt lgkmcnt(14)
    v_mfma_f32_32x32x16_bf16 v[72:87], v[28:31], v[132:135], v[72:87]
    ds_read_b64_tr_b16 v[28:29], v177 offset:45056
    ds_read_b64_tr_b16 v[30:31], v177 offset:45568
    s_waitcnt lgkmcnt(14)
    v_mfma_f32_32x32x16_bf16 v[88:103], v[32:35], v[132:135], v[88:103]
    ds_read_b64_tr_b16 v[32:33], v176 offset:38912
    ds_read_b64_tr_b16 v[34:35], v176 offset:39424
    s_add_u32 s98, s98, 262144
    s_add_u32 m0, s89, 20480
    s_nop 0
    buffer_load_dwordx4 v6, s[56:59], s98 offen offset:0 lds
    s_waitcnt lgkmcnt(14)
    v_mfma_f32_32x32x16_bf16 v[104:119], v[36:39], v[132:135], v[104:119]
    ds_read_b64_tr_b16 v[36:37], v177 offset:38912
    ds_read_b64_tr_b16 v[38:39], v177 offset:39424
    s_waitcnt lgkmcnt(14)
    v_mfma_f32_16x16x32_bf16 v[120:123], v[8:11], v[160:163], v[120:123]
    ds_read_b64_tr_b16 v[8:9], v176 offset:47104
    ds_read_b64_tr_b16 v[10:11], v176 offset:47616
    s_waitcnt lgkmcnt(14)
    v_mfma_f32_16x16x32_bf16 v[124:127], v[12:15], v[160:163], v[124:127]
    ds_read_b64_tr_b16 v[12:13], v177 offset:47104
    ds_read_b64_tr_b16 v[14:15], v177 offset:47616
    s_waitcnt lgkmcnt(14)
    v_mfma_f32_32x32x16_bf16 v[56:71], v[16:19], v[136:139], v[56:71]
    ds_read_b64_tr_b16 v[16:17], v178 offset:36864
    ds_read_b64_tr_b16 v[18:19], v178 offset:37376
    s_add_u32 m0, s89, 28544
    s_nop 0
    buffer_load_dwordx4 v6, s[56:59], s98 offen offset:128 lds
    s_waitcnt lgkmcnt(14)
    v_mfma_f32_32x32x16_bf16 v[72:87], v[20:23], v[136:139], v[72:87]
    ds_read_b64_tr_b16 v[20:21], v178 offset:36872
    ds_read_b64_tr_b16 v[22:23], v178 offset:37384
    s_waitcnt lgkmcnt(14)
    v_mfma_f32_32x32x16_bf16 v[88:103], v[24:27], v[136:139], v[88:103]
    s_waitcnt lgkmcnt(12)
    v_mfma_f32_32x32x16_bf16 v[104:119], v[28:31], v[136:139], v[104:119]
    s_waitcnt lgkmcnt(10)
    v_mfma_f32_32x32x16_bf16 v[56:71], v[32:35], v[140:143], v[56:71]
    s_waitcnt lgkmcnt(8)
    v_mfma_f32_32x32x16_bf16 v[72:87], v[36:39], v[140:143], v[72:87]
    s_waitcnt vmcnt(6)
    s_waitcnt lgkmcnt(0)
    s_barrier
    v_subrev_u32 v179, 0x10000, v179
    v_subrev_u32 v180, 0x10000, v180
    v_subrev_u32 v181, 0x10000, v181
    v_subrev_u32 v182, 0x10000, v182
    ds_read_b128 v[144:147], v179 offset:0
    ds_read_b128 v[148:151], v180 offset:0
    ds_read_b128 v[152:155], v181 offset:0
    ds_read_b128 v[156:159], v182 offset:0
    ds_read_b128 v[168:171], v183 offset:10240
    ds_read_b128 v[172:175], v184 offset:10240
    ds_read_b64_tr_b16 v[24:25], v176 offset:0
    ds_read_b64_tr_b16 v[26:27], v176 offset:512
    ds_read_b64_tr_b16 v[28:29], v177 offset:0
    ds_read_b64_tr_b16 v[30:31], v177 offset:512
    ds_read_b64_tr_b16 v[32:33], v176 offset:8192
    ds_read_b64_tr_b16 v[34:35], v176 offset:8704
    ds_read_b64_tr_b16 v[36:37], v177 offset:8192
    ds_read_b64_tr_b16 v[38:39], v177 offset:8704
    v_mfma_f32_32x32x16_bf16 v[88:103], v[8:11], v[140:143], v[88:103]
    ds_read_b64_tr_b16 v[8:9], v176 offset:2048
    ds_read_b64_tr_b16 v[10:11], v176 offset:2560
    s_add_u32 s98, s97, 7
    s_and_b32 s98, s98, 7
    s_lshl_b32 s99, s98, 7
    s_add_u32 s99, s99, s84
    s_lshl_b32 s98, s98, 19
    s_add_u32 s98, s98, s71
    s_add_u32 m0, s88, 131072
    s_nop 0
    buffer_load_dwordx4 v7, s[44:47], s99 offen offset:0 lds
    v_mfma_f32_32x32x16_bf16 v[104:119], v[12:15], v[140:143], v[104:119]
    ds_read_b64_tr_b16 v[12:13], v177 offset:2048
    ds_read_b64_tr_b16 v[14:15], v177 offset:2560
    v_mfma_f32_16x16x32_bf16 v[120:123], v[16:19], v[164:167], v[120:123]
    ds_read_b64_tr_b16 v[16:17], v176 offset:10240
    ds_read_b64_tr_b16 v[18:19], v176 offset:10752
    v_mfma_f32_16x16x32_bf16 v[124:127], v[20:23], v[164:167], v[124:127]
    ds_read_b64_tr_b16 v[20:21], v177 offset:10240
    ds_read_b64_tr_b16 v[22:23], v177 offset:10752
    s_waitcnt lgkmcnt(14)
    v_mfma_f32_32x32x16_bf16 v[56:71], v[24:27], v[144:147], v[56:71]
    ds_read_b64_tr_b16 v[24:25], v178 offset:0
    ds_read_b64_tr_b16 v[26:27], v178 offset:512
    s_add_u32 s99, s99, 65536
    s_add_u32 m0, s88, 139264
    s_nop 0
    buffer_load_dwordx4 v7, s[44:47], s99 offen offset:0 lds
    s_waitcnt lgkmcnt(14)
    v_mfma_f32_32x32x16_bf16 v[72:87], v[28:31], v[144:147], v[72:87]
    ds_read_b64_tr_b16 v[28:29], v178 offset:8
    ds_read_b64_tr_b16 v[30:31], v178 offset:520
    s_waitcnt lgkmcnt(14)
    v_mfma_f32_32x32x16_bf16 v[88:103], v[32:35], v[144:147], v[88:103]
    ds_read_b64_tr_b16 v[32:33], v176 offset:4096
    ds_read_b64_tr_b16 v[34:35], v176 offset:4608
    s_add_u32 m0, s89, 32768
    s_nop 0
    buffer_load_dwordx4 v6, s[56:59], s98 offen offset:0 lds
    s_waitcnt lgkmcnt(14)
    v_mfma_f32_32x32x16_bf16 v[104:119], v[36:39], v[144:147], v[104:119]
    ds_read_b64_tr_b16 v[36:37], v177 offset:4096
    ds_read_b64_tr_b16 v[38:39], v177 offset:4608
    s_waitcnt lgkmcnt(14)
    v_mfma_f32_32x32x16_bf16 v[56:71], v[8:11], v[148:151], v[56:71]
    ds_read_b64_tr_b16 v[8:9], v176 offset:12288
    ds_read_b64_tr_b16 v[10:11], v176 offset:12800
    s_add_u32 m0, s89, 40832
    s_nop 0
    buffer_load_dwordx4 v6, s[56:59], s98 offen offset:128 lds
    s_waitcnt lgkmcnt(14)
    v_mfma_f32_32x32x16_bf16 v[72:87], v[12:15], v[148:151], v[72:87]
    ds_read_b64_tr_b16 v[12:13], v177 offset:12288
    ds_read_b64_tr_b16 v[14:15], v177 offset:12800
    s_waitcnt lgkmcnt(14)
    v_mfma_f32_32x32x16_bf16 v[88:103], v[16:19], v[148:151], v[88:103]
    ds_read_b64_tr_b16 v[16:17], v176 offset:6144
    ds_read_b64_tr_b16 v[18:19], v176 offset:6656
    s_add_u32 s98, s98, 262144
    s_add_u32 m0, s89, 36864
    s_nop 0
    buffer_load_dwordx4 v6, s[56:59], s98 offen offset:0 lds
    s_waitcnt lgkmcnt(14)
    v_mfma_f32_32x32x16_bf16 v[104:119], v[20:23], v[148:151], v[104:119]
    ds_read_b64_tr_b16 v[20:21], v177 offset:6144
    ds_read_b64_tr_b16 v[22:23], v177 offset:6656
    s_waitcnt lgkmcnt(14)
    v_mfma_f32_16x16x32_bf16 v[120:123], v[24:27], v[168:171], v[120:123]
    ds_read_b64_tr_b16 v[24:25], v176 offset:14336
    ds_read_b64_tr_b16 v[26:27], v176 offset:14848
    s_waitcnt lgkmcnt(14)
    v_mfma_f32_16x16x32_bf16 v[124:127], v[28:31], v[168:171], v[124:127]
    ds_read_b64_tr_b16 v[28:29], v177 offset:14336
    ds_read_b64_tr_b16 v[30:31], v177 offset:14848
    s_waitcnt lgkmcnt(14)
    v_mfma_f32_32x32x16_bf16 v[56:71], v[32:35], v[152:155], v[56:71]
    ds_read_b64_tr_b16 v[32:33], v178 offset:4096
    ds_read_b64_tr_b16 v[34:35], v178 offset:4608
    s_add_u32 m0, s89, 44928
    s_nop 0
    buffer_load_dwordx4 v6, s[56:59], s98 offen offset:128 lds
    s_waitcnt lgkmcnt(14)
    v_mfma_f32_32x32x16_bf16 v[72:87], v[36:39], v[152:155], v[72:87]
    ds_read_b64_tr_b16 v[36:37], v178 offset:4104
    ds_read_b64_tr_b16 v[38:39], v178 offset:4616
    s_waitcnt lgkmcnt(14)
    v_mfma_f32_32x32x16_bf16 v[88:103], v[8:11], v[152:155], v[88:103]
    s_waitcnt lgkmcnt(12)
    v_mfma_f32_32x32x16_bf16 v[104:119], v[12:15], v[152:155], v[104:119]
    s_waitcnt lgkmcnt(10)
    v_mfma_f32_32x32x16_bf16 v[56:71], v[16:19], v[156:159], v[56:71]
    s_waitcnt lgkmcnt(8)
    v_mfma_f32_32x32x16_bf16 v[72:87], v[20:23], v[156:159], v[72:87]
    s_waitcnt vmcnt(6)
    s_waitcnt lgkmcnt(0)
    s_barrier
    ds_read_b128 v[128:131], v179 offset:16384
    ds_read_b128 v[132:135], v180 offset:16384
    ds_read_b128 v[136:139], v181 offset:16384
    ds_read_b128 v[140:143], v182 offset:16384
    ds_read_b128 v[160:163], v183 offset:12288
    ds_read_b128 v[164:167], v184 offset:12288
    ds_read_b64_tr_b16 v[8:9], v176 offset:16384
    ds_read_b64_tr_b16 v[10:11], v176 offset:16896
    ds_read_b64_tr_b16 v[12:13], v177 offset:16384
    ds_read_b64_tr_b16 v[14:15], v177 offset:16896
    ds_read_b64_tr_b16 v[16:17], v176 offset:24576
    ds_read_b64_tr_b16 v[18:19], v176 offset:25088
    ds_read_b64_tr_b16 v[20:21], v177 offset:24576
    ds_read_b64_tr_b16 v[22:23], v177 offset:25088
    v_mfma_f32_32x32x16_bf16 v[88:103], v[24:27], v[156:159], v[88:103]
    ds_read_b64_tr_b16 v[24:25], v176 offset:18432
    ds_read_b64_tr_b16 v[26:27], v176 offset:18944
    s_add_u32 s95, s70, s8
    s_mov_b32 m0, s89
    s_nop 0
    buffer_load_dwordx4 v242, s[48:51], s95 offen offset:0 nt lds
    v_mfma_f32_32x32x16_bf16 v[104:119], v[28:31], v[156:159], v[104:119]
    ds_read_b64_tr_b16 v[28:29], v177 offset:18432
    ds_read_b64_tr_b16 v[30:31], v177 offset:18944
    v_mfma_f32_16x16x32_bf16 v[120:123], v[32:35], v[172:175], v[120:123]
    ds_read_b64_tr_b16 v[32:33], v176 offset:26624
    ds_read_b64_tr_b16 v[34:35], v176 offset:27136
    v_mfma_f32_16x16x32_bf16 v[124:127], v[36:39], v[172:175], v[124:127]
    ds_read_b64_tr_b16 v[36:37], v177 offset:26624
    ds_read_b64_tr_b16 v[38:39], v177 offset:27136
    s_waitcnt lgkmcnt(14)
    v_mfma_f32_32x32x16_bf16 v[56:71], v[8:11], v[128:131], v[56:71]
    ds_read_b64_tr_b16 v[8:9], v178 offset:16384
    ds_read_b64_tr_b16 v[10:11], v178 offset:16896
    s_add_u32 s95, s70, s8
    s_add_u32 m0, s89, 8064
    s_nop 0
    buffer_load_dwordx4 v242, s[48:51], s95 offen offset:128 nt lds
    s_waitcnt lgkmcnt(14)
    v_mfma_f32_32x32x16_bf16 v[72:87], v[12:15], v[128:131], v[72:87]
    ds_read_b64_tr_b16 v[12:13], v178 offset:16392
    ds_read_b64_tr_b16 v[14:15], v178 offset:16904
    s_waitcnt lgkmcnt(14)
    v_mfma_f32_32x32x16_bf16 v[88:103], v[16:19], v[128:131], v[88:103]
    ds_read_b64_tr_b16 v[16:17], v176 offset:20480
    ds_read_b64_tr_b16 v[18:19], v176 offset:20992
    s_add_u32 s95, s70, s8
    s_add_u32 s95, s95, 8192
    s_add_u32 m0, s89, 4096
    s_nop 0
    buffer_load_dwordx4 v242, s[48:51], s95 offen offset:0 nt lds
    s_waitcnt lgkmcnt(14)
    v_mfma_f32_32x32x16_bf16 v[104:119], v[20:23], v[128:131], v[104:119]
    ds_read_b64_tr_b16 v[20:21], v177 offset:20480
    ds_read_b64_tr_b16 v[22:23], v177 offset:20992
    s_waitcnt lgkmcnt(14)
    v_mfma_f32_32x32x16_bf16 v[56:71], v[24:27], v[132:135], v[56:71]
    ds_read_b64_tr_b16 v[24:25], v176 offset:28672
    ds_read_b64_tr_b16 v[26:27], v176 offset:29184
    s_add_u32 s95, s70, s8
    s_add_u32 s95, s95, 8192
    s_add_u32 m0, s89, 12160
    s_nop 0
    buffer_load_dwordx4 v242, s[48:51], s95 offen offset:128 nt lds
    s_waitcnt lgkmcnt(14)
    v_mfma_f32_32x32x16_bf16 v[72:87], v[28:31], v[132:135], v[72:87]
    ds_read_b64_tr_b16 v[28:29], v177 offset:28672
    ds_read_b64_tr_b16 v[30:31], v177 offset:29184
    s_waitcnt lgkmcnt(14)
    v_mfma_f32_32x32x16_bf16 v[88:103], v[32:35], v[132:135], v[88:103]
    ds_read_b64_tr_b16 v[32:33], v176 offset:22528
    ds_read_b64_tr_b16 v[34:35], v176 offset:23040
    s_waitcnt lgkmcnt(14)
    v_mfma_f32_32x32x16_bf16 v[104:119], v[36:39], v[132:135], v[104:119]
    ds_read_b64_tr_b16 v[36:37], v177 offset:22528
    ds_read_b64_tr_b16 v[38:39], v177 offset:23040
    s_waitcnt lgkmcnt(14)
    v_mfma_f32_16x16x32_bf16 v[120:123], v[8:11], v[160:163], v[120:123]
    ds_read_b64_tr_b16 v[8:9], v176 offset:30720
    ds_read_b64_tr_b16 v[10:11], v176 offset:31232
    s_waitcnt lgkmcnt(14)
    v_mfma_f32_16x16x32_bf16 v[124:127], v[12:15], v[160:163], v[124:127]
    ds_read_b64_tr_b16 v[12:13], v177 offset:30720
    ds_read_b64_tr_b16 v[14:15], v177 offset:31232
    s_waitcnt lgkmcnt(14)
    v_mfma_f32_32x32x16_bf16 v[56:71], v[16:19], v[136:139], v[56:71]
    ds_read_b64_tr_b16 v[16:17], v178 offset:20480
    ds_read_b64_tr_b16 v[18:19], v178 offset:20992
    s_waitcnt lgkmcnt(14)
    v_mfma_f32_32x32x16_bf16 v[72:87], v[20:23], v[136:139], v[72:87]
    ds_read_b64_tr_b16 v[20:21], v178 offset:20488
    ds_read_b64_tr_b16 v[22:23], v178 offset:21000
    s_waitcnt lgkmcnt(14)
    v_mfma_f32_32x32x16_bf16 v[88:103], v[24:27], v[136:139], v[88:103]
    s_waitcnt lgkmcnt(12)
    v_mfma_f32_32x32x16_bf16 v[104:119], v[28:31], v[136:139], v[104:119]
    s_waitcnt lgkmcnt(10)
    v_mfma_f32_32x32x16_bf16 v[56:71], v[32:35], v[140:143], v[56:71]
    s_waitcnt lgkmcnt(8)
    v_mfma_f32_32x32x16_bf16 v[72:87], v[36:39], v[140:143], v[72:87]
    s_waitcnt vmcnt(4)
    s_waitcnt lgkmcnt(0)
    s_barrier
    v_add_u32 v179, 0x10000, v179
    v_add_u32 v180, 0x10000, v180
    v_add_u32 v181, 0x10000, v181
    v_add_u32 v182, 0x10000, v182
    ds_read_b128 v[144:147], v179 offset:16384
    ds_read_b128 v[148:151], v180 offset:16384
    ds_read_b128 v[152:155], v181 offset:16384
    ds_read_b128 v[156:159], v182 offset:16384
    ds_read_b128 v[168:171], v183 offset:14336
    ds_read_b128 v[172:175], v184 offset:14336
    ds_read_b64_tr_b16 v[24:25], v176 offset:32768
    ds_read_b64_tr_b16 v[26:27], v176 offset:33280
    ds_read_b64_tr_b16 v[28:29], v177 offset:32768
    ds_read_b64_tr_b16 v[30:31], v177 offset:33280
    ds_read_b64_tr_b16 v[32:33], v176 offset:40960
    ds_read_b64_tr_b16 v[34:35], v176 offset:41472
    ds_read_b64_tr_b16 v[36:37], v177 offset:40960
    ds_read_b64_tr_b16 v[38:39], v177 offset:41472
    v_mfma_f32_32x32x16_bf16 v[88:103], v[8:11], v[140:143], v[88:103]
    ds_read_b64_tr_b16 v[8:9], v176 offset:34816
    ds_read_b64_tr_b16 v[10:11], v176 offset:35328
    s_add_u32 s95, s70, s8
    s_add_u32 m0, s89, 16384
    s_nop 0
    buffer_load_dwordx4 v243, s[52:55], s95 offen offset:0 nt lds
    v_mfma_f32_32x32x16_bf16 v[104:119], v[12:15], v[140:143], v[104:119]
    ds_read_b64_tr_b16 v[12:13], v177 offset:34816
    ds_read_b64_tr_b16 v[14:15], v177 offset:35328
    v_mfma_f32_16x16x32_bf16 v[120:123], v[16:19], v[164:167], v[120:123]
    ds_read_b64_tr_b16 v[16:17], v176 offset:43008
    ds_read_b64_tr_b16 v[18:19], v176 offset:43520
    v_mfma_f32_16x16x32_bf16 v[124:127], v[20:23], v[164:167], v[124:127]
    ds_read_b64_tr_b16 v[20:21], v177 offset:43008
    ds_read_b64_tr_b16 v[22:23], v177 offset:43520
    s_waitcnt lgkmcnt(14)
    v_mfma_f32_32x32x16_bf16 v[56:71], v[24:27], v[144:147], v[56:71]
    ds_read_b64_tr_b16 v[24:25], v178 offset:32768
    ds_read_b64_tr_b16 v[26:27], v178 offset:33280
    s_add_u32 s95, s70, s8
    s_add_u32 m0, s89, 24448
    s_nop 0
    buffer_load_dwordx4 v243, s[52:55], s95 offen offset:128 nt lds
    s_waitcnt lgkmcnt(14)
    v_mfma_f32_32x32x16_bf16 v[72:87], v[28:31], v[144:147], v[72:87]
    ds_read_b64_tr_b16 v[28:29], v178 offset:32776
    ds_read_b64_tr_b16 v[30:31], v178 offset:33288
    s_waitcnt lgkmcnt(14)
    v_mfma_f32_32x32x16_bf16 v[88:103], v[32:35], v[144:147], v[88:103]
    ds_read_b64_tr_b16 v[32:33], v176 offset:36864
    ds_read_b64_tr_b16 v[34:35], v176 offset:37376
    s_add_u32 s95, s70, s8
    s_add_u32 s95, s95, 8192
    s_add_u32 m0, s89, 20480
    s_nop 0
    buffer_load_dwordx4 v243, s[52:55], s95 offen offset:0 nt lds
    s_waitcnt lgkmcnt(14)
    v_mfma_f32_32x32x16_bf16 v[104:119], v[36:39], v[144:147], v[104:119]
    ds_read_b64_tr_b16 v[36:37], v177 offset:36864
    ds_read_b64_tr_b16 v[38:39], v177 offset:37376
    s_waitcnt lgkmcnt(14)
    v_mfma_f32_32x32x16_bf16 v[56:71], v[8:11], v[148:151], v[56:71]
    ds_read_b64_tr_b16 v[8:9], v176 offset:45056
    ds_read_b64_tr_b16 v[10:11], v176 offset:45568
    s_add_u32 s95, s70, s8
    s_add_u32 s95, s95, 8192
    s_add_u32 m0, s89, 28544
    s_nop 0
    buffer_load_dwordx4 v243, s[52:55], s95 offen offset:128 nt lds
    s_waitcnt lgkmcnt(14)
    v_mfma_f32_32x32x16_bf16 v[72:87], v[12:15], v[148:151], v[72:87]
    ds_read_b64_tr_b16 v[12:13], v177 offset:45056
    ds_read_b64_tr_b16 v[14:15], v177 offset:45568
    s_waitcnt lgkmcnt(14)
    v_mfma_f32_32x32x16_bf16 v[88:103], v[16:19], v[148:151], v[88:103]
    ds_read_b64_tr_b16 v[16:17], v176 offset:38912
    ds_read_b64_tr_b16 v[18:19], v176 offset:39424
    s_waitcnt lgkmcnt(14)
    v_mfma_f32_32x32x16_bf16 v[104:119], v[20:23], v[148:151], v[104:119]
    ds_read_b64_tr_b16 v[20:21], v177 offset:38912
    ds_read_b64_tr_b16 v[22:23], v177 offset:39424
    s_waitcnt lgkmcnt(14)
    v_mfma_f32_16x16x32_bf16 v[120:123], v[24:27], v[168:171], v[120:123]
    ds_read_b64_tr_b16 v[24:25], v176 offset:47104
    ds_read_b64_tr_b16 v[26:27], v176 offset:47616
    s_waitcnt lgkmcnt(14)
    v_mfma_f32_16x16x32_bf16 v[124:127], v[28:31], v[168:171], v[124:127]
    ds_read_b64_tr_b16 v[28:29], v177 offset:47104
    ds_read_b64_tr_b16 v[30:31], v177 offset:47616
    s_waitcnt lgkmcnt(14)
    v_mfma_f32_32x32x16_bf16 v[56:71], v[32:35], v[152:155], v[56:71]
    ds_read_b64_tr_b16 v[32:33], v178 offset:36864
    ds_read_b64_tr_b16 v[34:35], v178 offset:37376
    s_waitcnt lgkmcnt(14)
    v_mfma_f32_32x32x16_bf16 v[72:87], v[36:39], v[152:155], v[72:87]
    ds_read_b64_tr_b16 v[36:37], v178 offset:36872
    ds_read_b64_tr_b16 v[38:39], v178 offset:37384
    s_waitcnt lgkmcnt(14)
    v_mfma_f32_32x32x16_bf16 v[88:103], v[8:11], v[152:155], v[88:103]
    s_waitcnt lgkmcnt(12)
    v_mfma_f32_32x32x16_bf16 v[104:119], v[12:15], v[152:155], v[104:119]
    s_waitcnt lgkmcnt(10)
    v_mfma_f32_32x32x16_bf16 v[56:71], v[16:19], v[156:159], v[56:71]
    s_waitcnt lgkmcnt(8)
    v_mfma_f32_32x32x16_bf16 v[72:87], v[20:23], v[156:159], v[72:87]
    s_waitcnt lgkmcnt(6)
    v_mfma_f32_32x32x16_bf16 v[88:103], v[24:27], v[156:159], v[88:103]
    s_waitcnt lgkmcnt(4)
    v_mfma_f32_32x32x16_bf16 v[104:119], v[28:31], v[156:159], v[104:119]
    s_waitcnt lgkmcnt(2)
    v_mfma_f32_16x16x32_bf16 v[120:123], v[32:35], v[172:175], v[120:123]
    s_waitcnt lgkmcnt(0)
    v_mfma_f32_16x16x32_bf16 v[124:127], v[36:39], v[172:175], v[124:127]
    s_cmp_eq_u32 s79, 0
    s_cbranch_scc1 L_nolag1
    s_barrier
L_nolag1:
    s_nop 2
    v_mul_f32 v120, s83, v120
    v_mul_f32 v121, s83, v121
    v_mul_f32 v122, s83, v122
    v_mul_f32 v123, s83, v123
    v_mul_f32 v124, s83, v124
    v_mul_f32 v125, s83, v125
    v_mul_f32 v126, s83, v126
    v_mul_f32 v127, s83, v127
    v_cvt_pk_bf16_f32 v128, v120, v121
    v_cvt_pk_bf16_f32 v129, v122, v123
    v_cvt_pk_bf16_f32 v130, v124, v125
    v_cvt_pk_bf16_f32 v131, v126, v127
    s_mul_i32 s74, s79, 98304
    s_add_u32 s74, s74, 49152
    v_add_u32 v250, s74, v1
    v_add_u32 v247, s69, v250
    ds_write_b128 v247, v[128:131] offset:0
    v_mul_f32 v56, s83, v56
    v_mul_f32 v57, s83, v57
    v_mul_f32 v58, s83, v58
    v_mul_f32 v59, s83, v59
    v_mul_f32 v60, s83, v60
    v_mul_f32 v61, s83, v61
    v_mul_f32 v62, s83, v62
    v_mul_f32 v63, s83, v63
    v_mul_f32 v64, s83, v64
    v_mul_f32 v65, s83, v65
    v_mul_f32 v66, s83, v66
    v_mul_f32 v67, s83, v67
    v_mul_f32 v68, s83, v68
    v_mul_f32 v69, s83, v69
    v_mul_f32 v70, s83, v70
    v_mul_f32 v71, s83, v71
    v_mul_f32 v72, s83, v72
    v_mul_f32 v73, s83, v73
    v_mul_f32 v74, s83, v74
    v_mul_f32 v75, s83, v75
    v_mul_f32 v76, s83, v76
    v_mul_f32 v77, s83, v77
    v_mul_f32 v78, s83, v78
    v_mul_f32 v79, s83, v79
    v_mul_f32 v80, s83, v80
    v_mul_f32 v81, s83, v81
    v_mul_f32 v82, s83, v82
    v_mul_f32 v83, s83, v83
    v_mul_f32 v84, s83, v84
    v_mul_f32 v85, s83, v85
    v_mul_f32 v86, s83, v86
    v_mul_f32 v87, s83, v87
    v_mul_f32 v88, s83, v88
    v_mul_f32 v89, s83, v89
    v_mul_f32 v90, s83, v90
    v_mul_f32 v91, s83, v91
    v_mul_f32 v92, s83, v92
    v_mul_f32 v93, s83, v93
    v_mul_f32 v94, s83, v94
    v_mul_f32 v95, s83, v95
    v_mul_f32 v96, s83, v96
    v_mul_f32 v97, s83, v97
    v_mul_f32 v98, s83, v98
    v_mul_f32 v99, s83, v99
    v_mul_f32 v100, s83, v100
    v_mul_f32 v101, s83, v101
    v_mul_f32 v102, s83, v102
    v_mul_f32 v103, s83, v103
    v_mul_f32 v104, s83, v104
    v_mul_f32 v105, s83, v105
    v_mul_f32 v106, s83, v106
    v_mul_f32 v107, s83, v107
    v_mul_f32 v108, s83, v108
    v_mul_f32 v109, s83, v109
    v_mul_f32 v110, s83, v110
    v_mul_f32 v111, s83, v111
    v_mul_f32 v112, s83, v112
    v_mul_f32 v113, s83, v113
    v_mul_f32 v114, s83, v114
    v_mul_f32 v115, s83, v115
    v_mul_f32 v116, s83, v116
    v_mul_f32 v117, s83, v117
    v_mul_f32 v118, s83, v118
    v_mul_f32 v119, s83, v119
    v_cvt_pk_bf16_f32 v8, v56, v57
    v_cvt_pk_bf16_f32 v9, v58, v59
    v_cvt_pk_bf16_f32 v10, v60, v61
    v_cvt_pk_bf16_f32 v11, v62, v63
    v_cvt_pk_bf16_f32 v12, v64, v65
    v_cvt_pk_bf16_f32 v13, v66, v67
    v_cvt_pk_bf16_f32 v14, v68, v69
    v_cvt_pk_bf16_f32 v15, v70, v71
    v_cvt_pk_bf16_f32 v16, v72, v73
    v_cvt_pk_bf16_f32 v17, v74, v75
    v_cvt_pk_bf16_f32 v18, v76, v77
    v_cvt_pk_bf16_f32 v19, v78, v79
    v_cvt_pk_bf16_f32 v20, v80, v81
    v_cvt_pk_bf16_f32 v21, v82, v83
    v_cvt_pk_bf16_f32 v22, v84, v85
    v_cvt_pk_bf16_f32 v23, v86, v87
    v_cvt_pk_bf16_f32 v24, v88, v89
    v_cvt_pk_bf16_f32 v25, v90, v91
    v_cvt_pk_bf16_f32 v26, v92, v93
    v_cvt_pk_bf16_f32 v27, v94, v95
    v_cvt_pk_bf16_f32 v28, v96, v97
    v_cvt_pk_bf16_f32 v29, v98, v99
    v_cvt_pk_bf16_f32 v30, v100, v101
    v_cvt_pk_bf16_f32 v31, v102, v103
    v_cvt_pk_bf16_f32 v32, v104, v105
    v_cvt_pk_bf16_f32 v33, v106, v107
    v_cvt_pk_bf16_f32 v34, v108, v109
    v_cvt_pk_bf16_f32 v35, v110, v111
    v_cvt_pk_bf16_f32 v36, v112, v113
    v_cvt_pk_bf16_f32 v37, v114, v115
    v_cvt_pk_bf16_f32 v38, v116, v117
    v_cvt_pk_bf16_f32 v39, v118, v119
    v_mov_b32 v56, v188
    v_mov_b32 v57, v189
    v_mov_b32 v58, v190
    v_mov_b32 v59, v191
    v_mov_b32 v60, v192
    v_mov_b32 v61, v193
    v_mov_b32 v62, v194
    v_mov_b32 v63, v195
    v_mov_b32 v64, v196
    v_mov_b32 v65, v197
    v_mov_b32 v66, v198
    v_mov_b32 v67, v199
    v_mov_b32 v68, v200
    v_mov_b32 v69, v201
    v_mov_b32 v70, v202
    v_mov_b32 v71, v203
    v_mov_b32 v72, v204
    v_mov_b32 v73, v205
    v_mov_b32 v74, v206
    v_mov_b32 v75, v207
    v_mov_b32 v76, v208
    v_mov_b32 v77, v209
    v_mov_b32 v78, v210
    v_mov_b32 v79, v211
    v_mov_b32 v80, v212
    v_mov_b32 v81, v213
    v_mov_b32 v82, v214
    v_mov_b32 v83, v215
    v_mov_b32 v84, v216
    v_mov_b32 v85, v217
    v_mov_b32 v86, v218
    v_mov_b32 v87, v219
    s_waitcnt vmcnt(4)
    s_waitcnt lgkmcnt(0)
    s_barrier
    ds_read_b128 v[40:43], v250 offset:0
    ds_read_b128 v[44:47], v250 offset:1024
    ds_read_b128 v[48:51], v250 offset:2048
    ds_read_b128 v[52:55], v250 offset:3072
    ds_read_b128 v[208:211], v232 offset:0
    ds_read_b128 v[212:215], v233 offset:0
    ds_read_b128 v[216:219], v234 offset:0
    ds_read_b128 v[220:223], v235 offset:0
    ds_read_b128 v[224:227], v232 offset:8192
    ds_read_b128 v[228:231], v233 offset:8192
    s_waitcnt lgkmcnt(5)
    v_mfma_f32_32x32x16_bf16 v[152:167], v[208:211], v[8:11], 0
    ds_read_b128 v[208:211], v234 offset:8192
    s_add_u32 s95, s70, s9
    s_add_u32 m0, s89, 32768
    s_nop 0
    buffer_load_dwordx4 v242, s[48:51], s95 offen offset:0 nt lds
    s_waitcnt lgkmcnt(5)
    v_mfma_f32_32x32x16_bf16 v[152:167], v[212:215], v[12:15], v[152:167]
    ds_read_b128 v[212:215], v235 offset:8192
    s_add_u32 s95, s70, s9
    s_add_u32 m0, s89, 40832
    s_nop 0
    buffer_load_dwordx4 v242, s[48:51], s95 offen offset:128 nt lds
    s_waitcnt lgkmcnt(5)
    v_mfma_f32_32x32x16_bf16 v[152:167], v[216:219], v[16:19], v[152:167]
    ds_read_b128 v[216:219], v236 offset:0
    s_add_u32 s95, s70, s9
    s_add_u32 s95, s95, 8192
    s_add_u32 m0, s89, 36864
    s_nop 0
    buffer_load_dwordx4 v242, s[48:51], s95 offen offset:0 nt lds
    s_waitcnt lgkmcnt(5)
    v_mfma_f32_32x32x16_bf16 v[152:167], v[220:223], v[20:23], v[152:167]
    ds_read_b128 v[220:223], v237 offset:0
    s_add_u32 s95, s70, s9
    s_add_u32 s95, s95, 8192
    s_add_u32 m0, s89, 44928
    s_nop 0
    buffer_load_dwordx4 v242, s[48:51], s95 offen offset:128 nt lds
    s_waitcnt lgkmcnt(5)
    v_mfma_f32_32x32x16_bf16 v[152:167], v[224:227], v[24:27], v[152:167]
    ds_read_b128 v[224:227], v236 offset:8192
    s_waitcnt lgkmcnt(5)
    v_mfma_f32_32x32x16_bf16 v[152:167], v[228:231], v[28:31], v[152:167]
    ds_read_b128 v[228:231], v237 offset:8192
    s_waitcnt lgkmcnt(5)
    v_mfma_f32_32x32x16_bf16 v[152:167], v[208:211], v[32:35], v[152:167]
    ds_read_b128 v[208:211], v232 offset:4096
    s_waitcnt lgkmcnt(5)
    v_mfma_f32_32x32x16_bf16 v[152:167], v[212:215], v[36:39], v[152:167]
    ds_read_b128 v[212:215], v233 offset:4096
    s_waitcnt lgkmcnt(5)
    v_mfma_f32_16x16x32_bf16 v[184:187], v[216:219], v[40:43], 0
    ds_read_b128 v[216:219], v234 offset:4096
    s_waitcnt lgkmcnt(5)
    v_mfma_f32_16x16x32_bf16 v[184:187], v[220:223], v[44:47], v[184:187]
    ds_read_b128 v[220:223], v235 offset:4096
    s_waitcnt lgkmcnt(5)
    v_mfma_f32_16x16x32_bf16 v[184:187], v[224:227], v[48:51], v[184:187]
    ds_read_b128 v[224:227], v232 offset:12288
    s_waitcnt lgkmcnt(5)
    v_mfma_f32_16x16x32_bf16 v[184:187], v[228:231], v[52:55], v[184:187]
    ds_read_b128 v[228:231], v233 offset:12288
    s_waitcnt lgkmcnt(5)
    v_mfma_f32_32x32x16_bf16 v[168:183], v[208:211], v[8:11], 0
    ds_read_b128 v[208:211], v234 offset:12288
    s_waitcnt lgkmcnt(5)
    v_mfma_f32_32x32x16_bf16 v[168:183], v[212:215], v[12:15], v[168:183]
    ds_read_b128 v[212:215], v235 offset:12288
    s_waitcnt lgkmcnt(5)
    v_mfma_f32_32x32x16_bf16 v[168:183], v[216:219], v[16:19], v[168:183]
    s_waitcnt lgkmcnt(4)
    v_mfma_f32_32x32x16_bf16 v[168:183], v[220:223], v[20:23], v[168:183]
    s_waitcnt lgkmcnt(3)
    v_mfma_f32_32x32x16_bf16 v[168:183], v[224:227], v[24:27], v[168:183]
    s_waitcnt vmcnt(4)
    s_waitcnt lgkmcnt(0)
    s_barrier
    ds_write_b128 v3, v[56:59] offset:0
    ds_write_b128 v3, v[60:63] offset:1024
    ds_write_b128 v3, v[64:67] offset:2048
    ds_write_b128 v3, v[68:71] offset:3072
    ds_write_b128 v3, v[72:75] offset:4096
    ds_write_b128 v3, v[76:79] offset:5120
    ds_write_b128 v3, v[80:83] offset:6144
    ds_write_b128 v3, v[84:87] offset:7168
    ds_read_b64_tr_b16 v[216:217], v238 offset:16384
    ds_read_b64_tr_b16 v[218:219], v238 offset:17408
    ds_read_b64_tr_b16 v[220:221], v239 offset:16384
    ds_read_b64_tr_b16 v[222:223], v239 offset:17408
    ds_read_b64_tr_b16 v[224:225], v238 offset:24576
    ds_read_b64_tr_b16 v[226:227], v238 offset:25600
    s_add_u32 s95, s70, s9
    s_mov_b32 m0, s89
    s_nop 0
    buffer_load_dwordx4 v243, s[52:55], s95 offen offset:0 nt lds
    v_mfma_f32_32x32x16_bf16 v[168:183], v[228:231], v[28:31], v[168:183]
    ds_read_b64_tr_b16 v[228:229], v239 offset:24576
    ds_read_b64_tr_b16 v[230:231], v239 offset:25600
    s_add_u32 s95, s70, s9
    s_add_u32 m0, s89, 8064
    s_nop 0
    buffer_load_dwordx4 v243, s[52:55], s95 offen offset:128 nt lds
    v_mfma_f32_32x32x16_bf16 v[168:183], v[208:211], v[32:35], v[168:183]
    ds_read_b64_tr_b16 v[208:209], v238 offset:18432
    ds_read_b64_tr_b16 v[210:211], v238 offset:19456
    s_add_u32 s95, s70, s9
    s_add_u32 s95, s95, 8192
    s_add_u32 m0, s89, 4096
    s_nop 0
    buffer_load_dwordx4 v243, s[52:55], s95 offen offset:0 nt lds
    v_mfma_f32_32x32x16_bf16 v[168:183], v[212:215], v[36:39], v[168:183]
    ds_read_b64_tr_b16 v[212:213], v239 offset:18432
    ds_read_b64_tr_b16 v[214:215], v239 offset:19456
    s_add_u32 s95, s70, s9
    s_add_u32 s95, s95, 8192
    s_add_u32 m0, s89, 12160
    s_nop 0
    buffer_load_dwordx4 v243, s[52:55], s95 offen offset:128 nt lds
    v_max3_f32 v246, v152, v153, v154
    v_max3_f32 v246, v246, v155, v156
    v_max3_f32 v246, v246, v157, v158
    v_max3_f32 v246, v246, v159, v160
    v_max3_f32 v246, v246, v161, v162
    v_max3_f32 v246, v246, v163, v164
    v_max3_f32 v246, v246, v165, v166
    v_max3_f32 v246, v246, v167, v168
    v_max3_f32 v246, v246, v169, v170
    v_max3_f32 v246, v246, v171, v172
    v_max3_f32 v246, v246, v173, v174
    v_max3_f32 v246, v246, v175, v176
    v_max3_f32 v246, v246, v177, v178
    v_max3_f32 v246, v246, v179, v180
    v_max3_f32 v246, v246, v181, v182
    v_max_f32 v246, v246, v183
    v_max3_f32 v247, v184, v185, v186
    v_max_f32 v247, v247, v187
    v_mov_b32 v248, v246
    s_nop 1
    v_permlane32_swap_b32 v246, v248
    v_max_f32 v246, v246, v248
    v_mov_b32 v248, v247
    s_nop 1
    v_permlane32_swap_b32 v247, v248
    v_max_f32 v247, v247, v248
    v_mov_b32 v248, v247
    s_nop 1
    v_permlane16_swap_b32 v247, v248
    v_max_f32 v247, v247, v248
    v_sub_f32 v152, v152, v246
    v_sub_f32 v153, v153, v246
    v_sub_f32 v154, v154, v246
    v_sub_f32 v155, v155, v246
    v_sub_f32 v156, v156, v246
    v_sub_f32 v157, v157, v246
    v_sub_f32 v158, v158, v246
    v_sub_f32 v159, v159, v246
    v_sub_f32 v160, v160, v246
    v_sub_f32 v161, v161, v246
    v_sub_f32 v162, v162, v246
    v_sub_f32 v163, v163, v246
    v_sub_f32 v164, v164, v246
    v_sub_f32 v165, v165, v246
    v_sub_f32 v166, v166, v246
    v_sub_f32 v167, v167, v246
    v_sub_f32 v168, v168, v246
    v_sub_f32 v169, v169, v246
    v_sub_f32 v170, v170, v246
    v_sub_f32 v171, v171, v246
    v_sub_f32 v172, v172, v246
    v_sub_f32 v173, v173, v246
    v_sub_f32 v174, v174, v246
    v_sub_f32 v175, v175, v246
    v_sub_f32 v176, v176, v246
    v_sub_f32 v177, v177, v246
    v_sub_f32 v178, v178, v246
    v_sub_f32 v179, v179, v246
    v_sub_f32 v180, v180, v246
    v_sub_f32 v181, v181, v246
    v_sub_f32 v182, v182, v246
    v_sub_f32 v183, v183, v246
    v_sub_f32 v184, v184, v247
    v_sub_f32 v185, v185, v247
    v_sub_f32 v186, v186, v247
    v_sub_f32 v187, v187, v247
    v_sub_f32 v188, 0, v246
    v_sub_f32 v189, 0, v246
    v_sub_f32 v190, 0, v246
    v_sub_f32 v191, 0, v246
    v_sub_f32 v192, 0, v246
    v_sub_f32 v193, 0, v246
    v_sub_f32 v194, 0, v246
    v_sub_f32 v195, 0, v246
    v_sub_f32 v196, 0, v246
    v_sub_f32 v197, 0, v246
    v_sub_f32 v198, 0, v246
    v_sub_f32 v199, 0, v246
    v_sub_f32 v200, 0, v246
    v_sub_f32 v201, 0, v246
    v_sub_f32 v202, 0, v246
    v_sub_f32 v203, 0, v246
    v_sub_f32 v204, 0, v247
    v_sub_f32 v205, 0, v247
    v_sub_f32 v206, 0, v247
    v_sub_f32 v207, 0, v247
    v_exp_f32 v184, v184
    v_exp_f32 v185, v185
    v_exp_f32 v186, v186
    v_exp_f32 v187, v187
    v_add_f32 v245, v184, v185
    v_cvt_pk_bf16_f32 v184, v184, v185
    v_add_f32 v245, v245, v186
    v_add_f32 v245, v245, v187
    v_cvt_pk_bf16_f32 v185, v186, v187
    v_exp_f32 v152, v152
    v_exp_f32 v153, v153
    v_exp_f32 v154, v154
    v_exp_f32 v155, v155
    v_add_f32 v244, v152, v153
    v_cvt_pk_bf16_f32 v152, v152, v153
    v_exp_f32 v156, v156
    v_exp_f32 v157, v157
    v_add_f32 v244, v244, v154
    v_add_f32 v244, v244, v155
    v_cvt_pk_bf16_f32 v153, v154, v155
    v_exp_f32 v158, v158
    v_exp_f32 v159, v159
    v_add_f32 v244, v244, v156
    v_add_f32 v244, v244, v157
    v_cvt_pk_bf16_f32 v154, v156, v157
    v_exp_f32 v160, v160
    v_exp_f32 v161, v161
    v_add_f32 v244, v244, v158
    v_add_f32 v244, v244, v159
    v_cvt_pk_bf16_f32 v155, v158, v159
    v_exp_f32 v162, v162
    v_exp_f32 v163, v163
    v_add_f32 v244, v244, v160
    v_add_f32 v244, v244, v161
    v_cvt_pk_bf16_f32 v156, v160, v161
    v_exp_f32 v164, v164
    v_exp_f32 v165, v165
    v_add_f32 v244, v244, v162
    v_add_f32 v244, v244, v163
    v_cvt_pk_bf16_f32 v157, v162, v163
    v_exp_f32 v166, v166
    v_exp_f32 v167, v167
    v_add_f32 v244, v244, v164
    v_add_f32 v244, v244, v165
    v_cvt_pk_bf16_f32 v158, v164, v165
    v_add_f32 v244, v244, v166
    v_add_f32 v244, v244, v167
    v_cvt_pk_bf16_f32 v159, v166, v167
    s_waitcnt lgkmcnt(10)
    v_mfma_f32_32x32x16_bf16 v[56:71], v[216:219], v[152:155], 0
    ds_read_b64_tr_b16 v[216:217], v238 offset:26624
    ds_read_b64_tr_b16 v[218:219], v238 offset:27648
    v_exp_f32 v168, v168
    v_exp_f32 v169, v169
    v_exp_f32 v170, v170
    s_waitcnt lgkmcnt(10)
    v_mfma_f32_32x32x16_bf16 v[72:87], v[220:223], v[152:155], 0
    ds_read_b64_tr_b16 v[220:221], v239 offset:26624
    ds_read_b64_tr_b16 v[222:223], v239 offset:27648
    v_exp_f32 v171, v171
    v_add_f32 v244, v244, v168
    v_add_f32 v244, v244, v169
    v_cvt_pk_bf16_f32 v168, v168, v169
    v_exp_f32 v172, v172
    s_waitcnt lgkmcnt(10)
    v_mfma_f32_32x32x16_bf16 v[88:103], v[224:227], v[152:155], 0
    ds_read_b64_tr_b16 v[224:225], v240 offset:16384
    ds_read_b64_tr_b16 v[226:227], v240 offset:16416
    v_exp_f32 v173, v173
    v_add_f32 v244, v244, v170
    v_add_f32 v244, v244, v171
    v_cvt_pk_bf16_f32 v169, v170, v171
    v_exp_f32 v174, v174
    s_waitcnt lgkmcnt(10)
    v_mfma_f32_32x32x16_bf16 v[104:119], v[228:231], v[152:155], 0
    ds_read_b64_tr_b16 v[228:229], v241 offset:16384
    ds_read_b64_tr_b16 v[230:231], v241 offset:16416
    v_exp_f32 v175, v175
    v_add_f32 v244, v244, v172
    v_add_f32 v244, v244, v173
    v_cvt_pk_bf16_f32 v170, v172, v173
    v_exp_f32 v176, v176
    s_waitcnt lgkmcnt(10)
    v_mfma_f32_32x32x16_bf16 v[56:71], v[208:211], v[156:159], v[56:71]
    ds_read_b64_tr_b16 v[208:209], v240 offset:24576
    ds_read_b64_tr_b16 v[210:211], v240 offset:24608
    v_exp_f32 v177, v177
    v_add_f32 v244, v244, v174
    v_add_f32 v244, v244, v175
    v_cvt_pk_bf16_f32 v171, v174, v175
    v_exp_f32 v178, v178
    s_waitcnt lgkmcnt(10)
    v_mfma_f32_32x32x16_bf16 v[72:87], v[212:215], v[156:159], v[72:87]
    ds_read_b64_tr_b16 v[212:213], v241 offset:24576
    ds_read_b64_tr_b16 v[214:215], v241 offset:24608
    v_exp_f32 v179, v179
    v_add_f32 v244, v244, v176
    v_add_f32 v244, v244, v177
    v_cvt_pk_bf16_f32 v172, v176, v177
    v_exp_f32 v180, v180
    s_waitcnt lgkmcnt(10)
    v_mfma_f32_32x32x16_bf16 v[88:103], v[216:219], v[156:159], v[88:103]
    ds_read_b64_tr_b16 v[216:217], v238 offset:20480
    ds_read_b64_tr_b16 v[218:219], v238 offset:21504
    v_exp_f32 v181, v181
    v_add_f32 v244, v244, v178
    v_add_f32 v244, v244, v179
    v_cvt_pk_bf16_f32 v173, v178, v179
    v_exp_f32 v182, v182
    s_waitcnt lgkmcnt(10)
    v_mfma_f32_32x32x16_bf16 v[104:119], v[220:223], v[156:159], v[104:119]
    ds_read_b64_tr_b16 v[220:221], v239 offset:20480
    ds_read_b64_tr_b16 v[222:223], v239 offset:21504
    v_exp_f32 v183, v183
    v_add_f32 v244, v244, v180
    v_add_f32 v244, v244, v181
    v_cvt_pk_bf16_f32 v174, v180, v181
    v_add_f32 v244, v244, v182
    s_waitcnt lgkmcnt(11)
    v_mfma_f32_16x16x16_bf16 v[120:123], v[224:225], v[184:185], 0
    s_waitcnt lgkmcnt(10)
    v_mfma_f32_16x16x16_bf16 v[124:127], v[226:227], v[184:185], 0
    ds_read_b64_tr_b16 v[224:225], v238 offset:28672
    ds_read_b64_tr_b16 v[226:227], v238 offset:29696
    v_add_f32 v244, v244, v183
    v_cvt_pk_bf16_f32 v175, v182, v183
    s_waitcnt lgkmcnt(11)
    v_mfma_f32_16x16x16_bf16 v[128:131], v[228:229], v[184:185], 0
    s_waitcnt lgkmcnt(10)
    v_mfma_f32_16x16x16_bf16 v[132:135], v[230:231], v[184:185], 0
    ds_read_b64_tr_b16 v[228:229], v239 offset:28672
    ds_read_b64_tr_b16 v[230:231], v239 offset:29696
    s_waitcnt lgkmcnt(11)
    v_mfma_f32_16x16x16_bf16 v[136:139], v[208:209], v[184:185], 0
    s_waitcnt lgkmcnt(10)
    v_mfma_f32_16x16x16_bf16 v[140:143], v[210:211], v[184:185], 0
    ds_read_b64_tr_b16 v[208:209], v238 offset:22528
    ds_read_b64_tr_b16 v[210:211], v238 offset:23552
    s_waitcnt lgkmcnt(11)
    v_mfma_f32_16x16x16_bf16 v[144:147], v[212:213], v[184:185], 0
    s_waitcnt lgkmcnt(10)
    v_mfma_f32_16x16x16_bf16 v[148:151], v[214:215], v[184:185], 0
    ds_read_b64_tr_b16 v[212:213], v239 offset:22528
    ds_read_b64_tr_b16 v[214:215], v239 offset:23552
    s_waitcnt lgkmcnt(10)
    v_mfma_f32_32x32x16_bf16 v[56:71], v[216:219], v[168:171], v[56:71]
    ds_read_b64_tr_b16 v[216:217], v238 offset:30720
    ds_read_b64_tr_b16 v[218:219], v238 offset:31744
    s_waitcnt lgkmcnt(10)
    v_mfma_f32_32x32x16_bf16 v[72:87], v[220:223], v[168:171], v[72:87]
    ds_read_b64_tr_b16 v[220:221], v239 offset:30720
    ds_read_b64_tr_b16 v[222:223], v239 offset:31744
    s_waitcnt lgkmcnt(10)
    v_mfma_f32_32x32x16_bf16 v[88:103], v[224:227], v[168:171], v[88:103]
    s_waitcnt lgkmcnt(8)
    v_mfma_f32_32x32x16_bf16 v[104:119], v[228:231], v[168:171], v[104:119]
    s_waitcnt lgkmcnt(6)
    v_mfma_f32_32x32x16_bf16 v[56:71], v[208:211], v[172:175], v[56:71]
    s_waitcnt vmcnt(4)
    s_waitcnt lgkmcnt(0)
    s_barrier
    ds_read_b128 v[224:227], v232 offset:32768
    ds_read_b128 v[228:231], v233 offset:32768
    ds_read_b128 v[208:211], v234 offset:32768
    s_add_u32 s95, s70, s10
    s_add_u32 m0, s89, 16384
    s_nop 0
    buffer_load_dwordx4 v242, s[48:51], s95 offen offset:0 nt lds
    v_mfma_f32_32x32x16_bf16 v[72:87], v[212:215], v[172:175], v[72:87]
    ds_read_b128 v[212:215], v235 offset:32768
    s_add_u32 s95, s70, s10
    s_add_u32 m0, s89, 24448
    s_nop 0
    buffer_load_dwordx4 v242, s[48:51], s95 offen offset:128 nt lds
    v_mfma_f32_32x32x16_bf16 v[88:103], v[216:219], v[172:175], v[88:103]
    ds_read_b128 v[216:219], v232 offset:40960
    s_add_u32 s95, s70, s10
    s_add_u32 s95, s95, 8192
    s_add_u32 m0, s89, 20480
    s_nop 0
    buffer_load_dwordx4 v242, s[48:51], s95 offen offset:0 nt lds
    v_mfma_f32_32x32x16_bf16 v[104:119], v[220:223], v[172:175], v[104:119]
    ds_read_b128 v[220:223], v233 offset:40960
    s_add_u32 s95, s70, s10
    s_add_u32 s95, s95, 8192
    s_add_u32 m0, s89, 28544
    s_nop 0
    buffer_load_dwordx4 v242, s[48:51], s95 offen offset:128 nt lds
    s_waitcnt lgkmcnt(5)
    v_mfma_f32_32x32x16_bf16 v[152:167], v[224:227], v[8:11], v[188:203]
    ds_read_b128 v[224:227], v234 offset:40960
    s_waitcnt lgkmcnt(5)
    v_mfma_f32_32x32x16_bf16 v[152:167], v[228:231], v[12:15], v[152:167]
    ds_read_b128 v[228:231], v235 offset:40960
    s_waitcnt lgkmcnt(5)
    v_mfma_f32_32x32x16_bf16 v[152:167], v[208:211], v[16:19], v[152:167]
    ds_read_b128 v[208:211], v236 offset:32768
    s_waitcnt lgkmcnt(5)
    v_mfma_f32_32x32x16_bf16 v[152:167], v[212:215], v[20:23], v[152:167]
    ds_read_b128 v[212:215], v237 offset:32768
    s_waitcnt lgkmcnt(5)
    v_mfma_f32_32x32x16_bf16 v[152:167], v[216:219], v[24:27], v[152:167]
    ds_read_b128 v[216:219], v236 offset:40960
    s_waitcnt lgkmcnt(5)
    v_mfma_f32_32x32x16_bf16 v[152:167], v[220:223], v[28:31], v[152:167]
    ds_read_b128 v[220:223], v237 offset:40960
    s_waitcnt lgkmcnt(5)
    v_mfma_f32_32x32x16_bf16 v[152:167], v[224:227], v[32:35], v[152:167]
    ds_read_b128 v[224:227], v232 offset:36864
    s_waitcnt lgkmcnt(5)
    v_mfma_f32_32x32x16_bf16 v[152:167], v[228:231], v[36:39], v[152:167]
    ds_read_b128 v[228:231], v233 offset:36864
    s_waitcnt lgkmcnt(5)
    v_mfma_f32_16x16x32_bf16 v[184:187], v[208:211], v[40:43], v[204:207]
    ds_read_b128 v[208:211], v234 offset:36864
    s_waitcnt lgkmcnt(5)
    v_mfma_f32_16x16x32_bf16 v[184:187], v[212:215], v[44:47], v[184:187]
    ds_read_b128 v[212:215], v235 offset:36864
    s_waitcnt lgkmcnt(5)
    v_mfma_f32_16x16x32_bf16 v[184:187], v[216:219], v[48:51], v[184:187]
    ds_read_b128 v[216:219], v232 offset:45056
    s_waitcnt lgkmcnt(5)
    v_mfma_f32_16x16x32_bf16 v[184:187], v[220:223], v[52:55], v[184:187]
    ds_read_b128 v[220:223], v233 offset:45056
    s_waitcnt lgkmcnt(5)
    v_mfma_f32_32x32x16_bf16 v[168:183], v[224:227], v[8:11], v[188:203]
    ds_read_b128 v[224:227], v234 offset:45056
    s_waitcnt lgkmcnt(5)
    v_mfma_f32_32x32x16_bf16 v[168:183], v[228:231], v[12:15], v[168:183]
    ds_read_b128 v[228:231], v235 offset:45056
    v_max3_f32 v246, v152, v153, v154
    v_max3_f32 v246, v246, v155, v156
    v_max3_f32 v246, v246, v157, v158
    v_max3_f32 v246, v246, v159, v160
    v_max3_f32 v246, v246, v161, v162
    v_max3_f32 v246, v246, v163, v164
    s_waitcnt lgkmcnt(5)
    v_mfma_f32_32x32x16_bf16 v[168:183], v[208:211], v[16:19], v[168:183]
    v_max3_f32 v246, v246, v165, v166
    v_max_f32 v246, v246, v167
    v_max3_f32 v247, v184, v185, v186
    v_max_f32 v247, v247, v187
    v_max_f32 v248, v246, v247
    v_cmp_lt_f32 vcc, 0x41000000, v248
    s_nop 1
    s_cbranch_vccnz L_slow_A11
L_back_A11:
    s_waitcnt lgkmcnt(4)
    v_mfma_f32_32x32x16_bf16 v[168:183], v[212:215], v[20:23], v[168:183]
    v_exp_f32 v184, v184
    v_exp_f32 v185, v185
    v_exp_f32 v186, v186
    s_waitcnt lgkmcnt(3)
    v_mfma_f32_32x32x16_bf16 v[168:183], v[216:219], v[24:27], v[168:183]
    s_waitcnt vmcnt(4)
    s_waitcnt lgkmcnt(0)
    s_barrier
    ds_read_b64_tr_b16 v[208:209], v238 offset:0
    ds_read_b64_tr_b16 v[210:211], v238 offset:1024
    ds_read_b64_tr_b16 v[212:213], v239 offset:0
    ds_read_b64_tr_b16 v[214:215], v239 offset:1024
    ds_read_b64_tr_b16 v[216:217], v238 offset:8192
    ds_read_b64_tr_b16 v[218:219], v238 offset:9216
    s_add_u32 s95, s70, s10
    s_add_u32 m0, s89, 32768
    s_nop 0
    buffer_load_dwordx4 v243, s[52:55], s95 offen offset:0 nt lds
    v_exp_f32 v187, v187
    v_add_f32 v245, v245, v184
    v_add_f32 v245, v245, v185
    v_cvt_pk_bf16_f32 v184, v184, v185
    v_add_f32 v245, v245, v186
    v_mfma_f32_32x32x16_bf16 v[168:183], v[220:223], v[28:31], v[168:183]
    ds_read_b64_tr_b16 v[220:221], v239 offset:8192
    ds_read_b64_tr_b16 v[222:223], v239 offset:9216
    s_add_u32 s95, s70, s10
    s_add_u32 m0, s89, 40832
    s_nop 0
    buffer_load_dwordx4 v243, s[52:55], s95 offen offset:128 nt lds
    v_add_f32 v245, v245, v187
    v_cvt_pk_bf16_f32 v185, v186, v187
    v_exp_f32 v152, v152
    v_exp_f32 v153, v153
    v_mfma_f32_32x32x16_bf16 v[168:183], v[224:227], v[32:35], v[168:183]
    ds_read_b64_tr_b16 v[224:225], v238 offset:2048
    ds_read_b64_tr_b16 v[226:227], v238 offset:3072
    s_add_u32 s95, s70, s10
    s_add_u32 s95, s95, 8192
    s_add_u32 m0, s89, 36864
    s_nop 0
    buffer_load_dwordx4 v243, s[52:55], s95 offen offset:0 nt lds
    v_exp_f32 v154, v154
    v_exp_f32 v155, v155
    v_add_f32 v244, v244, v152
    v_add_f32 v244, v244, v153
    v_mfma_f32_32x32x16_bf16 v[168:183], v[228:231], v[36:39], v[168:183]
    ds_read_b64_tr_b16 v[228:229], v239 offset:2048
    ds_read_b64_tr_b16 v[230:231], v239 offset:3072
    s_add_u32 s95, s70, s10
    s_add_u32 s95, s95, 8192
    s_add_u32 m0, s89, 44928
    s_nop 0
    buffer_load_dwordx4 v243, s[52:55], s95 offen offset:128 nt lds
    v_cvt_pk_bf16_f32 v152, v152, v153
    v_exp_f32 v156, v156
    v_exp_f32 v157, v157
    v_add_f32 v244, v244, v154
    v_add_f32 v244, v244, v155
    v_cvt_pk_bf16_f32 v153, v154, v155
    v_exp_f32 v158, v158
    v_exp_f32 v159, v159
    v_add_f32 v244, v244, v156
    v_add_f32 v244, v244, v157
    v_cvt_pk_bf16_f32 v154, v156, v157
    v_exp_f32 v160, v160
    v_exp_f32 v161, v161
    v_add_f32 v244, v244, v158
    v_add_f32 v244, v244, v159
    v_cvt_pk_bf16_f32 v155, v158, v159
    v_exp_f32 v162, v162
    v_exp_f32 v163, v163
    v_add_f32 v244, v244, v160
    v_add_f32 v244, v244, v161
    v_cvt_pk_bf16_f32 v156, v160, v161
    v_exp_f32 v164, v164
    v_exp_f32 v165, v165
    v_add_f32 v244, v244, v162
    v_add_f32 v244, v244, v163
    v_cvt_pk_bf16_f32 v157, v162, v163
    v_exp_f32 v166, v166
    v_exp_f32 v167, v167
    v_add_f32 v244, v244, v164
    v_add_f32 v244, v244, v165
    v_cvt_pk_bf16_f32 v158, v164, v165
    v_add_f32 v244, v244, v166
    v_add_f32 v244, v244, v167
    v_cvt_pk_bf16_f32 v159, v166, v167
    v_max3_f32 v246, v168, v169, v170
    v_max3_f32 v246, v246, v171, v172
    v_max3_f32 v246, v246, v173, v174
    v_max3_f32 v246, v246, v175, v176
    v_max3_f32 v246, v246, v177, v178
    v_max3_f32 v246, v246, v179, v180
    v_max3_f32 v246, v246, v181, v182
    v_max_f32 v246, v246, v183
    v_cmp_lt_f32 vcc, 0x41000000, v246
    s_nop 1
    s_cbranch_vccnz L_slow_B11
L_back_B11:
    s_waitcnt lgkmcnt(10)
    v_mfma_f32_32x32x16_bf16 v[56:71], v[208:211], v[152:155], v[56:71]
    ds_read_b64_tr_b16 v[208:209], v238 offset:10240
    ds_read_b64_tr_b16 v[210:211], v238 offset:11264
    v_exp_f32 v168, v168
    v_exp_f32 v169, v169
    v_exp_f32 v170, v170
    s_waitcnt lgkmcnt(10)
    v_mfma_f32_32x32x16_bf16 v[72:87], v[212:215], v[152:155], v[72:87]
    ds_read_b64_tr_b16 v[212:213], v239 offset:10240
    ds_read_b64_tr_b16 v[214:215], v239 offset:11264
    v_exp_f32 v171, v171
    v_add_f32 v244, v244, v168
    v_add_f32 v244, v244, v169
    v_cvt_pk_bf16_f32 v168, v168, v169
    v_exp_f32 v172, v172
    s_waitcnt lgkmcnt(10)
    v_mfma_f32_32x32x16_bf16 v[88:103], v[216:219], v[152:155], v[88:103]
    ds_read_b64_tr_b16 v[216:217], v240 offset:0
    ds_read_b64_tr_b16 v[218:219], v240 offset:32
    v_exp_f32 v173, v173
    v_add_f32 v244, v244, v170
    v_add_f32 v244, v244, v171
    v_cvt_pk_bf16_f32 v169, v170, v171
    v_exp_f32 v174, v174
    s_waitcnt lgkmcnt(10)
    v_mfma_f32_32x32x16_bf16 v[104:119], v[220:223], v[152:155], v[104:119]
    ds_read_b64_tr_b16 v[220:221], v241 offset:0
    ds_read_b64_tr_b16 v[222:223], v241 offset:32
    v_exp_f32 v175, v175
    v_add_f32 v244, v244, v172
    v_add_f32 v244, v244, v173
    v_cvt_pk_bf16_f32 v170, v172, v173
    v_exp_f32 v176, v176
    s_waitcnt lgkmcnt(10)
    v_mfma_f32_32x32x16_bf16 v[56:71], v[224:227], v[156:159], v[56:71]
    ds_read_b64_tr_b16 v[224:225], v240 offset:8192
    ds_read_b64_tr_b16 v[226:227], v240 offset:8224
    v_exp_f32 v177, v177
    v_add_f32 v244, v244, v174
    v_add_f32 v244, v244, v175
    v_cvt_pk_bf16_f32 v171, v174, v175
    v_exp_f32 v178, v178
    s_waitcnt lgkmcnt(10)
    v_mfma_f32_32x32x16_bf16 v[72:87], v[228:231], v[156:159], v[72:87]
    ds_read_b64_tr_b16 v[228:229], v241 offset:8192
    ds_read_b64_tr_b16 v[230:231], v241 offset:8224
    v_exp_f32 v179, v179
    v_add_f32 v244, v244, v176
    v_add_f32 v244, v244, v177
    v_cvt_pk_bf16_f32 v172, v176, v177
    v_exp_f32 v180, v180
    s_waitcnt lgkmcnt(10)
    v_mfma_f32_32x32x16_bf16 v[88:103], v[208:211], v[156:159], v[88:103]
    ds_read_b64_tr_b16 v[208:209], v238 offset:4096
    ds_read_b64_tr_b16 v[210:211], v238 offset:5120
    v_exp_f32 v181, v181
    v_add_f32 v244, v244, v178
    v_add_f32 v244, v244, v179
    v_cvt_pk_bf16_f32 v173, v178, v179
    v_exp_f32 v182, v182
    s_waitcnt lgkmcnt(10)
    v_mfma_f32_32x32x16_bf16 v[104:119], v[212:215], v[156:159], v[104:119]
    ds_read_b64_tr_b16 v[212:213], v239 offset:4096
    ds_read_b64_tr_b16 v[214:215], v239 offset:5120
    v_exp_f32 v183, v183
    v_add_f32 v244, v244, v180
    v_add_f32 v244, v244, v181
    v_cvt_pk_bf16_f32 v174, v180, v181
    v_add_f32 v244, v244, v182
    s_waitcnt lgkmcnt(11)
    v_mfma_f32_16x16x16_bf16 v[120:123], v[216:217], v[184:185], v[120:123]
    s_waitcnt lgkmcnt(10)
    v_mfma_f32_16x16x16_bf16 v[124:127], v[218:219], v[184:185], v[124:127]
    ds_read_b64_tr_b16 v[216:217], v238 offset:12288
    ds_read_b64_tr_b16 v[218:219], v238 offset:13312
    v_add_f32 v244, v244, v183
    v_cvt_pk_bf16_f32 v175, v182, v183
    s_waitcnt lgkmcnt(11)
    v_mfma_f32_16x16x16_bf16 v[128:131], v[220:221], v[184:185], v[128:131]
    s_waitcnt lgkmcnt(10)
    v_mfma_f32_16x16x16_bf16 v[132:135], v[222:223], v[184:185], v[132:135]
    ds_read_b64_tr_b16 v[220:221], v239 offset:12288
    ds_read_b64_tr_b16 v[222:223], v239 offset:13312
    s_waitcnt lgkmcnt(11)
    v_mfma_f32_16x16x16_bf16 v[136:139], v[224:225], v[184:185], v[136:139]
    s_waitcnt lgkmcnt(10)
    v_mfma_f32_16x16x16_bf16 v[140:143], v[226:227], v[184:185], v[140:143]
    ds_read_b64_tr_b16 v[224:225], v238 offset:6144
    ds_read_b64_tr_b16 v[226:227], v238 offset:7168
    s_waitcnt lgkmcnt(11)
    v_mfma_f32_16x16x16_bf16 v[144:147], v[228:229], v[184:185], v[144:147]
    s_waitcnt lgkmcnt(10)
    v_mfma_f32_16x16x16_bf16 v[148:151], v[230:231], v[184:185], v[148:151]
    ds_read_b64_tr_b16 v[228:229], v239 offset:6144
    ds_read_b64_tr_b16 v[230:231], v239 offset:7168
    s_waitcnt lgkmcnt(10)
    v_mfma_f32_32x32x16_bf16 v[56:71], v[208:211], v[168:171], v[56:71]
    ds_read_b64_tr_b16 v[208:209], v238 offset:14336
    ds_read_b64_tr_b16 v[210:211], v238 offset:15360
    s_waitcnt lgkmcnt(10)
    v_mfma_f32_32x32x16_bf16 v[72:87], v[212:215], v[168:171], v[72:87]
    ds_read_b64_tr_b16 v[212:213], v239 offset:14336
    ds_read_b64_tr_b16 v[214:215], v239 offset:15360
    s_waitcnt lgkmcnt(10)
    v_mfma_f32_32x32x16_bf16 v[88:103], v[216:219], v[168:171], v[88:103]
    s_waitcnt lgkmcnt(8)
    v_mfma_f32_32x32x16_bf16 v[104:119], v[220:223], v[168:171], v[104:119]
    s_waitcnt lgkmcnt(6)
    v_mfma_f32_32x32x16_bf16 v[56:71], v[224:227], v[172:175], v[56:71]
    s_waitcnt vmcnt(4)
    s_waitcnt lgkmcnt(0)
    s_barrier
    ds_read_b128 v[216:219], v232 offset:16384
    ds_read_b128 v[220:223], v233 offset:16384
    ds_read_b128 v[224:227], v234 offset:16384
    s_add_u32 s95, s70, s11
    s_mov_b32 m0, s89
    s_nop 0
    buffer_load_dwordx4 v242, s[48:51], s95 offen offset:0 nt lds
    v_mfma_f32_32x32x16_bf16 v[72:87], v[228:231], v[172:175], v[72:87]
    ds_read_b128 v[228:231], v235 offset:16384
    s_add_u32 s95, s70, s11
    s_add_u32 m0, s89, 8064
    s_nop 0
    buffer_load_dwordx4 v242, s[48:51], s95 offen offset:128 nt lds
    v_mfma_f32_32x32x16_bf16 v[88:103], v[208:211], v[172:175], v[88:103]
    ds_read_b128 v[208:211], v232 offset:24576
    s_add_u32 s95, s70, s11
    s_add_u32 s95, s95, 8192
    s_add_u32 m0, s89, 4096
    s_nop 0
    buffer_load_dwordx4 v242, s[48:51], s95 offen offset:0 nt lds
    v_mfma_f32_32x32x16_bf16 v[104:119], v[212:215], v[172:175], v[104:119]
    ds_read_b128 v[212:215], v233 offset:24576
    s_add_u32 s95, s70, s11
    s_add_u32 s95, s95, 8192
    s_add_u32 m0, s89, 12160
    s_nop 0
    buffer_load_dwordx4 v242, s[48:51], s95 offen offset:128 nt lds
    s_waitcnt lgkmcnt(5)
    v_mfma_f32_32x32x16_bf16 v[152:167], v[216:219], v[8:11], v[188:203]
    ds_read_b128 v[216:219], v234 offset:24576
    s_waitcnt lgkmcnt(5)
    v_mfma_f32_32x32x16_bf16 v[152:167], v[220:223], v[12:15], v[152:167]
    ds_read_b128 v[220:223], v235 offset:24576
    s_waitcnt lgkmcnt(5)
    v_mfma_f32_32x32x16_bf16 v[152:167], v[224:227], v[16:19], v[152:167]
    ds_read_b128 v[224:227], v236 offset:16384
    s_waitcnt lgkmcnt(5)
    v_mfma_f32_32x32x16_bf16 v[152:167], v[228:231], v[20:23], v[152:167]
    ds_read_b128 v[228:231], v237 offset:16384
    s_waitcnt lgkmcnt(5)
    v_mfma_f32_32x32x16_bf16 v[152:167], v[208:211], v[24:27], v[152:167]
    ds_read_b128 v[208:211], v236 offset:24576
    s_waitcnt lgkmcnt(5)
    v_mfma_f32_32x32x16_bf16 v[152:167], v[212:215], v[28:31], v[152:167]
    ds_read_b128 v[212:215], v237 offset:24576
    s_waitcnt lgkmcnt(5)
    v_mfma_f32_32x32x16_bf16 v[152:167], v[216:219], v[32:35], v[152:167]
    ds_read_b128 v[216:219], v232 offset:20480
    s_waitcnt lgkmcnt(5)
    v_mfma_f32_32x32x16_bf16 v[152:167], v[220:223], v[36:39], v[152:167]
    ds_read_b128 v[220:223], v233 offset:20480
    s_waitcnt lgkmcnt(5)
    v_mfma_f32_16x16x32_bf16 v[184:187], v[224:227], v[40:43], v[204:207]
    ds_read_b128 v[224:227], v234 offset:20480
    s_waitcnt lgkmcnt(5)
    v_mfma_f32_16x16x32_bf16 v[184:187], v[228:231], v[44:47], v[184:187]
    ds_read_b128 v[228:231], v235 offset:20480
    s_waitcnt lgkmcnt(5)
    v_mfma_f32_16x16x32_bf16 v[184:187], v[208:211], v[48:51], v[184:187]
    ds_read_b128 v[208:211], v232 offset:28672
    s_waitcnt lgkmcnt(5)
    v_mfma_f32_16x16x32_bf16 v[184:187], v[212:215], v[52:55], v[184:187]
    ds_read_b128 v[212:215], v233 offset:28672
    s_waitcnt lgkmcnt(5)
    v_mfma_f32_32x32x16_bf16 v[168:183], v[216:219], v[8:11], v[188:203]
    ds_read_b128 v[216:219], v234 offset:28672
    s_waitcnt lgkmcnt(5)
    v_mfma_f32_32x32x16_bf16 v[168:183], v[220:223], v[12:15], v[168:183]
    ds_read_b128 v[220:223], v235 offset:28672
    v_max3_f32 v246, v152, v153, v154
    v_max3_f32 v246, v246, v155, v156
    v_max3_f32 v246, v246, v157, v158
    v_max3_f32 v246, v246, v159, v160
    v_max3_f32 v246, v246, v161, v162
    v_max3_f32 v246, v246, v163, v164
    s_waitcnt lgkmcnt(5)
    v_mfma_f32_32x32x16_bf16 v[168:183], v[224:227], v[16:19], v[168:183]
    v_max3_f32 v246, v246, v165, v166
    v_max_f32 v246, v246, v167
    v_max3_f32 v247, v184, v185, v186
    v_max_f32 v247, v247, v187
    v_max_f32 v248, v246, v247
    v_cmp_lt_f32 vcc, 0x41000000, v248
    s_nop 1
    s_cbranch_vccnz L_slow_A12
L_back_A12:
    s_waitcnt lgkmcnt(4)
    v_mfma_f32_32x32x16_bf16 v[168:183], v[228:231], v[20:23], v[168:183]
    v_exp_f32 v184, v184
    v_exp_f32 v185, v185
    v_exp_f32 v186, v186
    s_waitcnt lgkmcnt(3)
    v_mfma_f32_32x32x16_bf16 v[168:183], v[208:211], v[24:27], v[168:183]
    s_waitcnt vmcnt(4)
    s_waitcnt lgkmcnt(0)
    s_barrier
    ds_read_b64_tr_b16 v[224:225], v238 offset:32768
    ds_read_b64_tr_b16 v[226:227], v238 offset:33792
    ds_read_b64_tr_b16 v[228:229], v239 offset:32768
    ds_read_b64_tr_b16 v[230:231], v239 offset:33792
    ds_read_b64_tr_b16 v[208:209], v238 offset:40960
    ds_read_b64_tr_b16 v[210:211], v238 offset:41984
    s_add_u32 s95, s70, s11
    s_add_u32 m0, s89, 16384
    s_nop 0
    buffer_load_dwordx4 v243, s[52:55], s95 offen offset:0 nt lds
    v_exp_f32 v187, v187
    v_add_f32 v245, v245, v184
    v_add_f32 v245, v245, v185
    v_cvt_pk_bf16_f32 v184, v184, v185
    v_add_f32 v245, v245, v186
    v_mfma_f32_32x32x16_bf16 v[168:183], v[212:215], v[28:31], v[168:183]
    ds_read_b64_tr_b16 v[212:213], v239 offset:40960
    ds_read_b64_tr_b16 v[214:215], v239 offset:41984
    s_add_u32 s95, s70, s11
    s_add_u32 m0, s89, 24448
    s_nop 0
    buffer_load_dwordx4 v243, s[52:55], s95 offen offset:128 nt lds
    v_add_f32 v245, v245, v187
    v_cvt_pk_bf16_f32 v185, v186, v187
    v_exp_f32 v152, v152
    v_exp_f32 v153, v153
    v_mfma_f32_32x32x16_bf16 v[168:183], v[216:219], v[32:35], v[168:183]
    ds_read_b64_tr_b16 v[216:217], v238 offset:34816
    ds_read_b64_tr_b16 v[218:219], v238 offset:35840
    s_add_u32 s95, s70, s11
    s_add_u32 s95, s95, 8192
    s_add_u32 m0, s89, 20480
    s_nop 0
    buffer_load_dwordx4 v243, s[52:55], s95 offen offset:0 nt lds
    v_exp_f32 v154, v154
    v_exp_f32 v155, v155
    v_add_f32 v244, v244, v152
    v_add_f32 v244, v244, v153
    v_mfma_f32_32x32x16_bf16 v[168:183], v[220:223], v[36:39], v[168:183]
    ds_read_b64_tr_b16 v[220:221], v239 offset:34816
    ds_read_b64_tr_b16 v[222:223], v239 offset:35840
    s_add_u32 s95, s70, s11
    s_add_u32 s95, s95, 8192
    s_add_u32 m0, s89, 28544
    s_nop 0
    buffer_load_dwordx4 v243, s[52:55], s95 offen offset:128 nt lds
    v_cvt_pk_bf16_f32 v152, v152, v153
    v_exp_f32 v156, v156
    v_exp_f32 v157, v157
    v_add_f32 v244, v244, v154
    v_add_f32 v244, v244, v155
    v_cvt_pk_bf16_f32 v153, v154, v155
    v_exp_f32 v158, v158
    v_exp_f32 v159, v159
    v_add_f32 v244, v244, v156
    v_add_f32 v244, v244, v157
    v_cvt_pk_bf16_f32 v154, v156, v157
    v_exp_f32 v160, v160
    v_exp_f32 v161, v161
    v_add_f32 v244, v244, v158
    v_add_f32 v244, v244, v159
    v_cvt_pk_bf16_f32 v155, v158, v159
    v_exp_f32 v162, v162
    v_exp_f32 v163, v163
    v_add_f32 v244, v244, v160
    v_add_f32 v244, v244, v161
    v_cvt_pk_bf16_f32 v156, v160, v161
    v_exp_f32 v164, v164
    v_exp_f32 v165, v165
    v_add_f32 v244, v244, v162
    v_add_f32 v244, v244, v163
    v_cvt_pk_bf16_f32 v157, v162, v163
    v_exp_f32 v166, v166
    v_exp_f32 v167, v167
    v_add_f32 v244, v244, v164
    v_add_f32 v244, v244, v165
    v_cvt_pk_bf16_f32 v158, v164, v165
    v_add_f32 v244, v244, v166
    v_add_f32 v244, v244, v167
    v_cvt_pk_bf16_f32 v159, v166, v167
    v_max3_f32 v246, v168, v169, v170
    v_max3_f32 v246, v246, v171, v172
    v_max3_f32 v246, v246, v173, v174
    v_max3_f32 v246, v246, v175, v176
    v_max3_f32 v246, v246, v177, v178
    v_max3_f32 v246, v246, v179, v180
    v_max3_f32 v246, v246, v181, v182
    v_max_f32 v246, v246, v183
    v_cmp_lt_f32 vcc, 0x41000000, v246
    s_nop 1
    s_cbranch_vccnz L_slow_B12
L_back_B12:
    s_waitcnt lgkmcnt(10)
    v_mfma_f32_32x32x16_bf16 v[56:71], v[224:227], v[152:155], v[56:71]
    ds_read_b64_tr_b16 v[224:225], v238 offset:43008
    ds_read_b64_tr_b16 v[226:227], v238 offset:44032
    v_exp_f32 v168, v168
    v_exp_f32 v169, v169
    v_exp_f32 v170, v170
    s_waitcnt lgkmcnt(10)
    v_mfma_f32_32x32x16_bf16 v[72:87], v[228:231], v[152:155], v[72:87]
    ds_read_b64_tr_b16 v[228:229], v239 offset:43008
    ds_read_b64_tr_b16 v[230:231], v239 offset:44032
    v_exp_f32 v171, v171
    v_add_f32 v244, v244, v168
    v_add_f32 v244, v244, v169
    v_cvt_pk_bf16_f32 v168, v168, v169
    v_exp_f32 v172, v172
    s_waitcnt lgkmcnt(10)
    v_mfma_f32_32x32x16_bf16 v[88:103], v[208:211], v[152:155], v[88:103]
    ds_read_b64_tr_b16 v[208:209], v240 offset:32768
    ds_read_b64_tr_b16 v[210:211], v240 offset:32800
    v_exp_f32 v173, v173
    v_add_f32 v244, v244, v170
    v_add_f32 v244, v244, v171
    v_cvt_pk_bf16_f32 v169, v170, v171
    v_exp_f32 v174, v174
    s_waitcnt lgkmcnt(10)
    v_mfma_f32_32x32x16_bf16 v[104:119], v[212:215], v[152:155], v[104:119]
    ds_read_b64_tr_b16 v[212:213], v241 offset:32768
    ds_read_b64_tr_b16 v[214:215], v241 offset:32800
    v_exp_f32 v175, v175
    v_add_f32 v244, v244, v172
    v_add_f32 v244, v244, v173
    v_cvt_pk_bf16_f32 v170, v172, v173
    v_exp_f32 v176, v176
    s_waitcnt lgkmcnt(10)
    v_mfma_f32_32x32x16_bf16 v[56:71], v[216:219], v[156:159], v[56:71]
    ds_read_b64_tr_b16 v[216:217], v240 offset:40960
    ds_read_b64_tr_b16 v[218:219], v240 offset:40992
    v_exp_f32 v177, v177
    v_add_f32 v244, v244, v174
    v_add_f32 v244, v244, v175
    v_cvt_pk_bf16_f32 v171, v174, v175
    v_exp_f32 v178, v178
    s_waitcnt lgkmcnt(10)
    v_mfma_f32_32x32x16_bf16 v[72:87], v[220:223], v[156:159], v[72:87]
    ds_read_b64_tr_b16 v[220:221], v241 offset:40960
    ds_read_b64_tr_b16 v[222:223], v241 offset:40992
    v_exp_f32 v179, v179
    v_add_f32 v244, v244, v176
    v_add_f32 v244, v244, v177
    v_cvt_pk_bf16_f32 v172, v176, v177
    v_exp_f32 v180, v180
    s_waitcnt lgkmcnt(10)
    v_mfma_f32_32x32x16_bf16 v[88:103], v[224:227], v[156:159], v[88:103]
    ds_read_b64_tr_b16 v[224:225], v238 offset:36864
    ds_read_b64_tr_b16 v[226:227], v238 offset:37888
    v_exp_f32 v181, v181
    v_add_f32 v244, v244, v178
    v_add_f32 v244, v244, v179
    v_cvt_pk_bf16_f32 v173, v178, v179
    v_exp_f32 v182, v182
    s_waitcnt lgkmcnt(10)
    v_mfma_f32_32x32x16_bf16 v[104:119], v[228:231], v[156:159], v[104:119]
    ds_read_b64_tr_b16 v[228:229], v239 offset:36864
    ds_read_b64_tr_b16 v[230:231], v239 offset:37888
    v_exp_f32 v183, v183
    v_add_f32 v244, v244, v180
    v_add_f32 v244, v244, v181
    v_cvt_pk_bf16_f32 v174, v180, v181
    v_add_f32 v244, v244, v182
    s_waitcnt lgkmcnt(11)
    v_mfma_f32_16x16x16_bf16 v[120:123], v[208:209], v[184:185], v[120:123]
    s_waitcnt lgkmcnt(10)
    v_mfma_f32_16x16x16_bf16 v[124:127], v[210:211], v[184:185], v[124:127]
    ds_read_b64_tr_b16 v[208:209], v238 offset:45056
    ds_read_b64_tr_b16 v[210:211], v238 offset:46080
    v_add_f32 v244, v244, v183
    v_cvt_pk_bf16_f32 v175, v182, v183
    s_waitcnt lgkmcnt(11)
    v_mfma_f32_16x16x16_bf16 v[128:131], v[212:213], v[184:185], v[128:131]
    s_waitcnt lgkmcnt(10)
    v_mfma_f32_16x16x16_bf16 v[132:135], v[214:215], v[184:185], v[132:135]
    ds_read_b64_tr_b16 v[212:213], v239 offset:45056
    ds_read_b64_tr_b16 v[214:215], v239 offset:46080
    s_waitcnt lgkmcnt(11)
    v_mfma_f32_16x16x16_bf16 v[136:139], v[216:217], v[184:185], v[136:139]
    s_waitcnt lgkmcnt(10)
    v_mfma_f32_16x16x16_bf16 v[140:143], v[218:219], v[184:185], v[140:143]
    ds_read_b64_tr_b16 v[216:217], v238 offset:38912
    ds_read_b64_tr_b16 v[218:219], v238 offset:39936
    s_waitcnt lgkmcnt(11)
    v_mfma_f32_16x16x16_bf16 v[144:147], v[220:221], v[184:185], v[144:147]
    s_waitcnt lgkmcnt(10)
    v_mfma_f32_16x16x16_bf16 v[148:151], v[222:223], v[184:185], v[148:151]
    ds_read_b64_tr_b16 v[220:221], v239 offset:38912
    ds_read_b64_tr_b16 v[222:223], v239 offset:39936
    s_waitcnt lgkmcnt(10)
    v_mfma_f32_32x32x16_bf16 v[56:71], v[224:227], v[168:171], v[56:71]
    ds_read_b64_tr_b16 v[224:225], v238 offset:47104
    ds_read_b64_tr_b16 v[226:227], v238 offset:48128
    s_waitcnt lgkmcnt(10)
    v_mfma_f32_32x32x16_bf16 v[72:87], v[228:231], v[168:171], v[72:87]
    ds_read_b64_tr_b16 v[228:229], v239 offset:47104
    ds_read_b64_tr_b16 v[230:231], v239 offset:48128
    s_waitcnt lgkmcnt(10)
    v_mfma_f32_32x32x16_bf16 v[88:103], v[208:211], v[168:171], v[88:103]
    s_waitcnt lgkmcnt(8)
    v_mfma_f32_32x32x16_bf16 v[104:119], v[212:215], v[168:171], v[104:119]
    s_waitcnt lgkmcnt(6)
    v_mfma_f32_32x32x16_bf16 v[56:71], v[216:219], v[172:175], v[56:71]
    s_waitcnt vmcnt(4)
    s_waitcnt lgkmcnt(0)
    s_barrier
    ds_read_b128 v[208:211], v232 offset:0
    ds_read_b128 v[212:215], v233 offset:0
    ds_read_b128 v[216:219], v234 offset:0
    s_add_u32 s95, s70, s12
    s_add_u32 m0, s89, 32768
    s_nop 0
    buffer_load_dwordx4 v242, s[48:51], s95 offen offset:0 nt lds
    v_mfma_f32_32x32x16_bf16 v[72:87], v[220:223], v[172:175], v[72:87]
    ds_read_b128 v[220:223], v235 offset:0
    s_add_u32 s95, s70, s12
    s_add_u32 m0, s89, 40832
    s_nop 0
    buffer_load_dwordx4 v242, s[48:51], s95 offen offset:128 nt lds
    v_mfma_f32_32x32x16_bf16 v[88:103], v[224:227], v[172:175], v[88:103]
    ds_read_b128 v[224:227], v232 offset:8192
    s_add_u32 s95, s70, s12
    s_add_u32 s95, s95, 8192
    s_add_u32 m0, s89, 36864
    s_nop 0
    buffer_load_dwordx4 v242, s[48:51], s95 offen offset:0 nt lds
    v_mfma_f32_32x32x16_bf16 v[104:119], v[228:231], v[172:175], v[104:119]
    ds_read_b128 v[228:231], v233 offset:8192
    s_add_u32 s95, s70, s12
    s_add_u32 s95, s95, 8192
    s_add_u32 m0, s89, 44928
    s_nop 0
    buffer_load_dwordx4 v242, s[48:51], s95 offen offset:128 nt lds
    s_waitcnt lgkmcnt(5)
    v_mfma_f32_32x32x16_bf16 v[152:167], v[208:211], v[8:11], v[188:203]
    ds_read_b128 v[208:211], v234 offset:8192
    s_waitcnt lgkmcnt(5)
    v_mfma_f32_32x32x16_bf16 v[152:167], v[212:215], v[12:15], v[152:167]
    ds_read_b128 v[212:215], v235 offset:8192
    s_waitcnt lgkmcnt(5)
    v_mfma_f32_32x32x16_bf16 v[152:167], v[216:219], v[16:19], v[152:167]
    ds_read_b128 v[216:219], v236 offset:0
    s_waitcnt lgkmcnt(5)
    v_mfma_f32_32x32x16_bf16 v[152:167], v[220:223], v[20:23], v[152:167]
    ds_read_b128 v[220:223], v237 offset:0
    s_waitcnt lgkmcnt(5)
    v_mfma_f32_32x32x16_bf16 v[152:167], v[224:227], v[24:27], v[152:167]
    ds_read_b128 v[224:227], v236 offset:8192
    s_waitcnt lgkmcnt(5)
    v_mfma_f32_32x32x16_bf16 v[152:167], v[228:231], v[28:31], v[152:167]
    ds_read_b128 v[228:231], v237 offset:8192
    s_waitcnt lgkmcnt(5)
    v_mfma_f32_32x32x16_bf16 v[152:167], v[208:211], v[32:35], v[152:167]
    ds_read_b128 v[208:211], v232 offset:4096
    s_waitcnt lgkmcnt(5)
    v_mfma_f32_32x32x16_bf16 v[152:167], v[212:215], v[36:39], v[152:167]
    ds_read_b128 v[212:215], v233 offset:4096
    s_waitcnt lgkmcnt(5)
    v_mfma_f32_16x16x32_bf16 v[184:187], v[216:219], v[40:43], v[204:207]
    ds_read_b128 v[216:219], v234 offset:4096
    s_waitcnt lgkmcnt(5)
    v_mfma_f32_16x16x32_bf16 v[184:187], v[220:223], v[44:47], v[184:187]
    ds_read_b128 v[220:223], v235 offset:4096
    s_waitcnt lgkmcnt(5)
    v_mfma_f32_16x16x32_bf16 v[184:187], v[224:227], v[48:51], v[184:187]
    ds_read_b128 v[224:227], v232 offset:12288
    s_waitcnt lgkmcnt(5)
    v_mfma_f32_16x16x32_bf16 v[184:187], v[228:231], v[52:55], v[184:187]
    ds_read_b128 v[228:231], v233 offset:12288
    s_waitcnt lgkmcnt(5)
    v_mfma_f32_32x32x16_bf16 v[168:183], v[208:211], v[8:11], v[188:203]
    ds_read_b128 v[208:211], v234 offset:12288
    s_waitcnt lgkmcnt(5)
    v_mfma_f32_32x32x16_bf16 v[168:183], v[212:215], v[12:15], v[168:183]
    ds_read_b128 v[212:215], v235 offset:12288
    v_max3_f32 v246, v152, v153, v154
    v_max3_f32 v246, v246, v155, v156
    v_max3_f32 v246, v246, v157, v158
    v_max3_f32 v246, v246, v159, v160
    v_max3_f32 v246, v246, v161, v162
    v_max3_f32 v246, v246, v163, v164
    s_waitcnt lgkmcnt(5)
    v_mfma_f32_32x32x16_bf16 v[168:183], v[216:219], v[16:19], v[168:183]
    v_max3_f32 v246, v246, v165, v166
    v_max_f32 v246, v246, v167
    v_max3_f32 v247, v184, v185, v186
    v_max_f32 v247, v247, v187
    v_max_f32 v248, v246, v247
    v_cmp_lt_f32 vcc, 0x41000000, v248
    s_nop 1
    s_cbranch_vccnz L_slow_A13
L_back_A13:
    s_waitcnt lgkmcnt(4)
    v_mfma_f32_32x32x16_bf16 v[168:183], v[220:223], v[20:23], v[168:183]
    v_exp_f32 v184, v184
    v_exp_f32 v185, v185
    v_exp_f32 v186, v186
    s_waitcnt lgkmcnt(3)
    v_mfma_f32_32x32x16_bf16 v[168:183], v[224:227], v[24:27], v[168:183]
    s_waitcnt vmcnt(4)
    s_waitcnt lgkmcnt(0)
    s_barrier
    ds_read_b64_tr_b16 v[216:217], v238 offset:16384
    ds_read_b64_tr_b16 v[218:219], v238 offset:17408
    ds_read_b64_tr_b16 v[220:221], v239 offset:16384
    ds_read_b64_tr_b16 v[222:223], v239 offset:17408
    ds_read_b64_tr_b16 v[224:225], v238 offset:24576
    ds_read_b64_tr_b16 v[226:227], v238 offset:25600
    s_add_u32 s95, s70, s12
    s_mov_b32 m0, s89
    s_nop 0
    buffer_load_dwordx4 v243, s[52:55], s95 offen offset:0 nt lds
    v_exp_f32 v187, v187
    v_add_f32 v245, v245, v184
    v_add_f32 v245, v245, v185
    v_cvt_pk_bf16_f32 v184, v184, v185
    v_add_f32 v245, v245, v186
    v_mfma_f32_32x32x16_bf16 v[168:183], v[228:231], v[28:31], v[168:183]
    ds_read_b64_tr_b16 v[228:229], v239 offset:24576
    ds_read_b64_tr_b16 v[230:231], v239 offset:25600
    s_add_u32 s95, s70, s12
    s_add_u32 m0, s89, 8064
    s_nop 0
    buffer_load_dwordx4 v243, s[52:55], s95 offen offset:128 nt lds
    v_add_f32 v245, v245, v187
    v_cvt_pk_bf16_f32 v185, v186, v187
    v_exp_f32 v152, v152
    v_exp_f32 v153, v153
    v_mfma_f32_32x32x16_bf16 v[168:183], v[208:211], v[32:35], v[168:183]
    ds_read_b64_tr_b16 v[208:209], v238 offset:18432
    ds_read_b64_tr_b16 v[210:211], v238 offset:19456
    s_add_u32 s95, s70, s12
    s_add_u32 s95, s95, 8192
    s_add_u32 m0, s89, 4096
    s_nop 0
    buffer_load_dwordx4 v243, s[52:55], s95 offen offset:0 nt lds
    v_exp_f32 v154, v154
    v_exp_f32 v155, v155
    v_add_f32 v244, v244, v152
    v_add_f32 v244, v244, v153
    v_mfma_f32_32x32x16_bf16 v[168:183], v[212:215], v[36:39], v[168:183]
    ds_read_b64_tr_b16 v[212:213], v239 offset:18432
    ds_read_b64_tr_b16 v[214:215], v239 offset:19456
    s_add_u32 s95, s70, s12
    s_add_u32 s95, s95, 8192
    s_add_u32 m0, s89, 12160
    s_nop 0
    buffer_load_dwordx4 v243, s[52:55], s95 offen offset:128 nt lds
    v_cvt_pk_bf16_f32 v152, v152, v153
    v_exp_f32 v156, v156
    v_exp_f32 v157, v157
    v_add_f32 v244, v244, v154
    v_add_f32 v244, v244, v155
    v_cvt_pk_bf16_f32 v153, v154, v155
    v_exp_f32 v158, v158
    v_exp_f32 v159, v159
    v_add_f32 v244, v244, v156
    v_add_f32 v244, v244, v157
    v_cvt_pk_bf16_f32 v154, v156, v157
    v_exp_f32 v160, v160
    v_exp_f32 v161, v161
    v_add_f32 v244, v244, v158
    v_add_f32 v244, v244, v159
    v_cvt_pk_bf16_f32 v155, v158, v159
    v_exp_f32 v162, v162
    v_exp_f32 v163, v163
    v_add_f32 v244, v244, v160
    v_add_f32 v244, v244, v161
    v_cvt_pk_bf16_f32 v156, v160, v161
    v_exp_f32 v164, v164
    v_exp_f32 v165, v165
    v_add_f32 v244, v244, v162
    v_add_f32 v244, v244, v163
    v_cvt_pk_bf16_f32 v157, v162, v163
    v_exp_f32 v166, v166
    v_exp_f32 v167, v167
    v_add_f32 v244, v244, v164
    v_add_f32 v244, v244, v165
    v_cvt_pk_bf16_f32 v158, v164, v165
    v_add_f32 v244, v244, v166
    v_add_f32 v244, v244, v167
    v_cvt_pk_bf16_f32 v159, v166, v167
    v_max3_f32 v246, v168, v169, v170
    v_max3_f32 v246, v246, v171, v172
    v_max3_f32 v246, v246, v173, v174
    v_max3_f32 v246, v246, v175, v176
    v_max3_f32 v246, v246, v177, v178
    v_max3_f32 v246, v246, v179, v180
    v_max3_f32 v246, v246, v181, v182
    v_max_f32 v246, v246, v183
    v_cmp_lt_f32 vcc, 0x41000000, v246
    s_nop 1
    s_cbranch_vccnz L_slow_B13
L_back_B13:
    s_waitcnt lgkmcnt(10)
    v_mfma_f32_32x32x16_bf16 v[56:71], v[216:219], v[152:155], v[56:71]
    ds_read_b64_tr_b16 v[216:217], v238 offset:26624
    ds_read_b64_tr_b16 v[218:219], v238 offset:27648
    v_exp_f32 v168, v168
    v_exp_f32 v169, v169
    v_exp_f32 v170, v170
    s_waitcnt lgkmcnt(10)
    v_mfma_f32_32x32x16_bf16 v[72:87], v[220:223], v[152:155], v[72:87]
    ds_read_b64_tr_b16 v[220:221], v239 offset:26624
    ds_read_b64_tr_b16 v[222:223], v239 offset:27648
    v_exp_f32 v171, v171
    v_add_f32 v244, v244, v168
    v_add_f32 v244, v244, v169
    v_cvt_pk_bf16_f32 v168, v168, v169
    v_exp_f32 v172, v172
    s_waitcnt lgkmcnt(10)
    v_mfma_f32_32x32x16_bf16 v[88:103], v[224:227], v[152:155], v[88:103]
    ds_read_b64_tr_b16 v[224:225], v240 offset:16384
    ds_read_b64_tr_b16 v[226:227], v240 offset:16416
    v_exp_f32 v173, v173
    v_add_f32 v244, v244, v170
    v_add_f32 v244, v244, v171
    v_cvt_pk_bf16_f32 v169, v170, v171
    v_exp_f32 v174, v174
    s_waitcnt lgkmcnt(10)
    v_mfma_f32_32x32x16_bf16 v[104:119], v[228:231], v[152:155], v[104:119]
    ds_read_b64_tr_b16 v[228:229], v241 offset:16384
    ds_read_b64_tr_b16 v[230:231], v241 offset:16416
    v_exp_f32 v175, v175
    v_add_f32 v244, v244, v172
    v_add_f32 v244, v244, v173
    v_cvt_pk_bf16_f32 v170, v172, v173
    v_exp_f32 v176, v176
    s_waitcnt lgkmcnt(10)
    v_mfma_f32_32x32x16_bf16 v[56:71], v[208:211], v[156:159], v[56:71]
    ds_read_b64_tr_b16 v[208:209], v240 offset:24576
    ds_read_b64_tr_b16 v[210:211], v240 offset:24608
    v_exp_f32 v177, v177
    v_add_f32 v244, v244, v174
    v_add_f32 v244, v244, v175
    v_cvt_pk_bf16_f32 v171, v174, v175
    v_exp_f32 v178, v178
    s_waitcnt lgkmcnt(10)
    v_mfma_f32_32x32x16_bf16 v[72:87], v[212:215], v[156:159], v[72:87]
    ds_read_b64_tr_b16 v[212:213], v241 offset:24576
    ds_read_b64_tr_b16 v[214:215], v241 offset:24608
    v_exp_f32 v179, v179
    v_add_f32 v244, v244, v176
    v_add_f32 v244, v244, v177
    v_cvt_pk_bf16_f32 v172, v176, v177
    v_exp_f32 v180, v180
    s_waitcnt lgkmcnt(10)
    v_mfma_f32_32x32x16_bf16 v[88:103], v[216:219], v[156:159], v[88:103]
    ds_read_b64_tr_b16 v[216:217], v238 offset:20480
    ds_read_b64_tr_b16 v[218:219], v238 offset:21504
    v_exp_f32 v181, v181
    v_add_f32 v244, v244, v178
    v_add_f32 v244, v244, v179
    v_cvt_pk_bf16_f32 v173, v178, v179
    v_exp_f32 v182, v182
    s_waitcnt lgkmcnt(10)
    v_mfma_f32_32x32x16_bf16 v[104:119], v[220:223], v[156:159], v[104:119]
    ds_read_b64_tr_b16 v[220:221], v239 offset:20480
    ds_read_b64_tr_b16 v[222:223], v239 offset:21504
    v_exp_f32 v183, v183
    v_add_f32 v244, v244, v180
    v_add_f32 v244, v244, v181
    v_cvt_pk_bf16_f32 v174, v180, v181
    v_add_f32 v244, v244, v182
    s_waitcnt lgkmcnt(11)
    v_mfma_f32_16x16x16_bf16 v[120:123], v[224:225], v[184:185], v[120:123]
    s_waitcnt lgkmcnt(10)
    v_mfma_f32_16x16x16_bf16 v[124:127], v[226:227], v[184:185], v[124:127]
    ds_read_b64_tr_b16 v[224:225], v238 offset:28672
    ds_read_b64_tr_b16 v[226:227], v238 offset:29696
    v_add_f32 v244, v244, v183
    v_cvt_pk_bf16_f32 v175, v182, v183
    s_waitcnt lgkmcnt(11)
    v_mfma_f32_16x16x16_bf16 v[128:131], v[228:229], v[184:185], v[128:131]
    s_waitcnt lgkmcnt(10)
    v_mfma_f32_16x16x16_bf16 v[132:135], v[230:231], v[184:185], v[132:135]
    ds_read_b64_tr_b16 v[228:229], v239 offset:28672
    ds_read_b64_tr_b16 v[230:231], v239 offset:29696
    s_waitcnt lgkmcnt(11)
    v_mfma_f32_16x16x16_bf16 v[136:139], v[208:209], v[184:185], v[136:139]
    s_waitcnt lgkmcnt(10)
    v_mfma_f32_16x16x16_bf16 v[140:143], v[210:211], v[184:185], v[140:143]
    ds_read_b64_tr_b16 v[208:209], v238 offset:22528
    ds_read_b64_tr_b16 v[210:211], v238 offset:23552
    s_waitcnt lgkmcnt(11)
    v_mfma_f32_16x16x16_bf16 v[144:147], v[212:213], v[184:185], v[144:147]
    s_waitcnt lgkmcnt(10)
    v_mfma_f32_16x16x16_bf16 v[148:151], v[214:215], v[184:185], v[148:151]
    ds_read_b64_tr_b16 v[212:213], v239 offset:22528
    ds_read_b64_tr_b16 v[214:215], v239 offset:23552
    s_waitcnt lgkmcnt(10)
    v_mfma_f32_32x32x16_bf16 v[56:71], v[216:219], v[168:171], v[56:71]
    ds_read_b64_tr_b16 v[216:217], v238 offset:30720
    ds_read_b64_tr_b16 v[218:219], v238 offset:31744
    s_waitcnt lgkmcnt(10)
    v_mfma_f32_32x32x16_bf16 v[72:87], v[220:223], v[168:171], v[72:87]
    ds_read_b64_tr_b16 v[220:221], v239 offset:30720
    ds_read_b64_tr_b16 v[222:223], v239 offset:31744
    s_waitcnt lgkmcnt(10)
    v_mfma_f32_32x32x16_bf16 v[88:103], v[224:227], v[168:171], v[88:103]
    s_waitcnt lgkmcnt(8)
    v_mfma_f32_32x32x16_bf16 v[104:119], v[228:231], v[168:171], v[104:119]
    s_waitcnt lgkmcnt(6)
    v_mfma_f32_32x32x16_bf16 v[56:71], v[208:211], v[172:175], v[56:71]
    s_waitcnt vmcnt(4)
    s_waitcnt lgkmcnt(0)
    s_barrier
    ds_read_b128 v[224:227], v232 offset:32768
    ds_read_b128 v[228:231], v233 offset:32768
    ds_read_b128 v[208:211], v234 offset:32768
    s_add_u32 s95, s70, s13
    s_add_u32 m0, s89, 16384
    s_nop 0
    buffer_load_dwordx4 v242, s[48:51], s95 offen offset:0 nt lds
    v_mfma_f32_32x32x16_bf16 v[72:87], v[212:215], v[172:175], v[72:87]
    ds_read_b128 v[212:215], v235 offset:32768
    s_add_u32 s95, s70, s13
    s_add_u32 m0, s89, 24448
    s_nop 0
    buffer_load_dwordx4 v242, s[48:51], s95 offen offset:128 nt lds
    v_mfma_f32_32x32x16_bf16 v[88:103], v[216:219], v[172:175], v[88:103]
    ds_read_b128 v[216:219], v232 offset:40960
    s_add_u32 s95, s70, s13
    s_add_u32 s95, s95, 8192
    s_add_u32 m0, s89, 20480
    s_nop 0
    buffer_load_dwordx4 v242, s[48:51], s95 offen offset:0 nt lds
    v_mfma_f32_32x32x16_bf16 v[104:119], v[220:223], v[172:175], v[104:119]
    ds_read_b128 v[220:223], v233 offset:40960
    s_add_u32 s95, s70, s13
    s_add_u32 s95, s95, 8192
    s_add_u32 m0, s89, 28544
    s_nop 0
    buffer_load_dwordx4 v242, s[48:51], s95 offen offset:128 nt lds
    s_waitcnt lgkmcnt(5)
    v_mfma_f32_32x32x16_bf16 v[152:167], v[224:227], v[8:11], v[188:203]
    ds_read_b128 v[224:227], v234 offset:40960
    s_waitcnt lgkmcnt(5)
    v_mfma_f32_32x32x16_bf16 v[152:167], v[228:231], v[12:15], v[152:167]
    ds_read_b128 v[228:231], v235 offset:40960
    s_waitcnt lgkmcnt(5)
    v_mfma_f32_32x32x16_bf16 v[152:167], v[208:211], v[16:19], v[152:167]
    ds_read_b128 v[208:211], v236 offset:32768
    s_waitcnt lgkmcnt(5)
    v_mfma_f32_32x32x16_bf16 v[152:167], v[212:215], v[20:23], v[152:167]
    ds_read_b128 v[212:215], v237 offset:32768
    s_waitcnt lgkmcnt(5)
    v_mfma_f32_32x32x16_bf16 v[152:167], v[216:219], v[24:27], v[152:167]
    ds_read_b128 v[216:219], v236 offset:40960
    s_waitcnt lgkmcnt(5)
    v_mfma_f32_32x32x16_bf16 v[152:167], v[220:223], v[28:31], v[152:167]
    ds_read_b128 v[220:223], v237 offset:40960
    s_waitcnt lgkmcnt(5)
    v_mfma_f32_32x32x16_bf16 v[152:167], v[224:227], v[32:35], v[152:167]
    ds_read_b128 v[224:227], v232 offset:36864
    s_waitcnt lgkmcnt(5)
    v_mfma_f32_32x32x16_bf16 v[152:167], v[228:231], v[36:39], v[152:167]
    ds_read_b128 v[228:231], v233 offset:36864
    s_waitcnt lgkmcnt(5)
    v_mfma_f32_16x16x32_bf16 v[184:187], v[208:211], v[40:43], v[204:207]
    ds_read_b128 v[208:211], v234 offset:36864
    s_waitcnt lgkmcnt(5)
    v_mfma_f32_16x16x32_bf16 v[184:187], v[212:215], v[44:47], v[184:187]
    ds_read_b128 v[212:215], v235 offset:36864
    s_waitcnt lgkmcnt(5)
    v_mfma_f32_16x16x32_bf16 v[184:187], v[216:219], v[48:51], v[184:187]
    ds_read_b128 v[216:219], v232 offset:45056
    s_waitcnt lgkmcnt(5)
    v_mfma_f32_16x16x32_bf16 v[184:187], v[220:223], v[52:55], v[184:187]
    ds_read_b128 v[220:223], v233 offset:45056
    s_waitcnt lgkmcnt(5)
    v_mfma_f32_32x32x16_bf16 v[168:183], v[224:227], v[8:11], v[188:203]
    ds_read_b128 v[224:227], v234 offset:45056
    s_waitcnt lgkmcnt(5)
    v_mfma_f32_32x32x16_bf16 v[168:183], v[228:231], v[12:15], v[168:183]
    ds_read_b128 v[228:231], v235 offset:45056
    v_max3_f32 v246, v152, v153, v154
    v_max3_f32 v246, v246, v155, v156
    v_max3_f32 v246, v246, v157, v158
    v_max3_f32 v246, v246, v159, v160
    v_max3_f32 v246, v246, v161, v162
    v_max3_f32 v246, v246, v163, v164
    s_waitcnt lgkmcnt(5)
    v_mfma_f32_32x32x16_bf16 v[168:183], v[208:211], v[16:19], v[168:183]
    v_max3_f32 v246, v246, v165, v166
    v_max_f32 v246, v246, v167
    v_max3_f32 v247, v184, v185, v186
    v_max_f32 v247, v247, v187
    v_max_f32 v248, v246, v247
    v_cmp_lt_f32 vcc, 0x41000000, v248
    s_nop 1
    s_cbranch_vccnz L_slow_A14
L_back_A14:
    s_waitcnt lgkmcnt(4)
    v_mfma_f32_32x32x16_bf16 v[168:183], v[212:215], v[20:23], v[168:183]
    v_exp_f32 v184, v184
    v_exp_f32 v185, v185
    v_exp_f32 v186, v186
    s_waitcnt lgkmcnt(3)
    v_mfma_f32_32x32x16_bf16 v[168:183], v[216:219], v[24:27], v[168:183]
    s_waitcnt vmcnt(4)
    s_waitcnt lgkmcnt(0)
    s_barrier
    ds_read_b64_tr_b16 v[208:209], v238 offset:0
    ds_read_b64_tr_b16 v[210:211], v238 offset:1024
    ds_read_b64_tr_b16 v[212:213], v239 offset:0
    ds_read_b64_tr_b16 v[214:215], v239 offset:1024
    ds_read_b64_tr_b16 v[216:217], v238 offset:8192
    ds_read_b64_tr_b16 v[218:219], v238 offset:9216
    s_add_u32 s95, s70, s13
    s_add_u32 m0, s89, 32768
    s_nop 0
    buffer_load_dwordx4 v243, s[52:55], s95 offen offset:0 nt lds
    v_exp_f32 v187, v187
    v_add_f32 v245, v245, v184
    v_add_f32 v245, v245, v185
    v_cvt_pk_bf16_f32 v184, v184, v185
    v_add_f32 v245, v245, v186
    v_mfma_f32_32x32x16_bf16 v[168:183], v[220:223], v[28:31], v[168:183]
    ds_read_b64_tr_b16 v[220:221], v239 offset:8192
    ds_read_b64_tr_b16 v[222:223], v239 offset:9216
    s_add_u32 s95, s70, s13
    s_add_u32 m0, s89, 40832
    s_nop 0
    buffer_load_dwordx4 v243, s[52:55], s95 offen offset:128 nt lds
    v_add_f32 v245, v245, v187
    v_cvt_pk_bf16_f32 v185, v186, v187
    v_exp_f32 v152, v152
    v_exp_f32 v153, v153
    v_mfma_f32_32x32x16_bf16 v[168:183], v[224:227], v[32:35], v[168:183]
    ds_read_b64_tr_b16 v[224:225], v238 offset:2048
    ds_read_b64_tr_b16 v[226:227], v238 offset:3072
    s_add_u32 s95, s70, s13
    s_add_u32 s95, s95, 8192
    s_add_u32 m0, s89, 36864
    s_nop 0
    buffer_load_dwordx4 v243, s[52:55], s95 offen offset:0 nt lds
    v_exp_f32 v154, v154
    v_exp_f32 v155, v155
    v_add_f32 v244, v244, v152
    v_add_f32 v244, v244, v153
    v_mfma_f32_32x32x16_bf16 v[168:183], v[228:231], v[36:39], v[168:183]
    ds_read_b64_tr_b16 v[228:229], v239 offset:2048
    ds_read_b64_tr_b16 v[230:231], v239 offset:3072
    s_add_u32 s95, s70, s13
    s_add_u32 s95, s95, 8192
    s_add_u32 m0, s89, 44928
    s_nop 0
    buffer_load_dwordx4 v243, s[52:55], s95 offen offset:128 nt lds
    v_cvt_pk_bf16_f32 v152, v152, v153
    v_exp_f32 v156, v156
    v_exp_f32 v157, v157
    v_add_f32 v244, v244, v154
    v_add_f32 v244, v244, v155
    v_cvt_pk_bf16_f32 v153, v154, v155
    v_exp_f32 v158, v158
    v_exp_f32 v159, v159
    v_add_f32 v244, v244, v156
    v_add_f32 v244, v244, v157
    v_cvt_pk_bf16_f32 v154, v156, v157
    v_exp_f32 v160, v160
    v_exp_f32 v161, v161
    v_add_f32 v244, v244, v158
    v_add_f32 v244, v244, v159
    v_cvt_pk_bf16_f32 v155, v158, v159
    v_exp_f32 v162, v162
    v_exp_f32 v163, v163
    v_add_f32 v244, v244, v160
    v_add_f32 v244, v244, v161
    v_cvt_pk_bf16_f32 v156, v160, v161
    v_exp_f32 v164, v164
    v_exp_f32 v165, v165
    v_add_f32 v244, v244, v162
    v_add_f32 v244, v244, v163
    v_cvt_pk_bf16_f32 v157, v162, v163
    v_exp_f32 v166, v166
    v_exp_f32 v167, v167
    v_add_f32 v244, v244, v164
    v_add_f32 v244, v244, v165
    v_cvt_pk_bf16_f32 v158, v164, v165
    v_add_f32 v244, v244, v166
    v_add_f32 v244, v244, v167
    v_cvt_pk_bf16_f32 v159, v166, v167
    v_max3_f32 v246, v168, v169, v170
    v_max3_f32 v246, v246, v171, v172
    v_max3_f32 v246, v246, v173, v174
    v_max3_f32 v246, v246, v175, v176
    v_max3_f32 v246, v246, v177, v178
    v_max3_f32 v246, v246, v179, v180
    v_max3_f32 v246, v246, v181, v182
    v_max_f32 v246, v246, v183
    v_cmp_lt_f32 vcc, 0x41000000, v246
    s_nop 1
    s_cbranch_vccnz L_slow_B14
L_back_B14:
    s_waitcnt lgkmcnt(10)
    v_mfma_f32_32x32x16_bf16 v[56:71], v[208:211], v[152:155], v[56:71]
    ds_read_b64_tr_b16 v[208:209], v238 offset:10240
    ds_read_b64_tr_b16 v[210:211], v238 offset:11264
    v_exp_f32 v168, v168
    v_exp_f32 v169, v169
    v_exp_f32 v170, v170
    s_waitcnt lgkmcnt(10)
    v_mfma_f32_32x32x16_bf16 v[72:87], v[212:215], v[152:155], v[72:87]
    ds_read_b64_tr_b16 v[212:213], v239 offset:10240
    ds_read_b64_tr_b16 v[214:215], v239 offset:11264
    v_exp_f32 v171, v171
    v_add_f32 v244, v244, v168
    v_add_f32 v244, v244, v169
    v_cvt_pk_bf16_f32 v168, v168, v169
    v_exp_f32 v172, v172
    s_waitcnt lgkmcnt(10)
    v_mfma_f32_32x32x16_bf16 v[88:103], v[216:219], v[152:155], v[88:103]
    ds_read_b64_tr_b16 v[216:217], v240 offset:0
    ds_read_b64_tr_b16 v[218:219], v240 offset:32
    v_exp_f32 v173, v173
    v_add_f32 v244, v244, v170
    v_add_f32 v244, v244, v171
    v_cvt_pk_bf16_f32 v169, v170, v171
    v_exp_f32 v174, v174
    s_waitcnt lgkmcnt(10)
    v_mfma_f32_32x32x16_bf16 v[104:119], v[220:223], v[152:155], v[104:119]
    ds_read_b64_tr_b16 v[220:221], v241 offset:0
    ds_read_b64_tr_b16 v[222:223], v241 offset:32
    v_exp_f32 v175, v175
    v_add_f32 v244, v244, v172
    v_add_f32 v244, v244, v173
    v_cvt_pk_bf16_f32 v170, v172, v173
    v_exp_f32 v176, v176
    s_waitcnt lgkmcnt(10)
    v_mfma_f32_32x32x16_bf16 v[56:71], v[224:227], v[156:159], v[56:71]
    ds_read_b64_tr_b16 v[224:225], v240 offset:8192
    ds_read_b64_tr_b16 v[226:227], v240 offset:8224
    v_exp_f32 v177, v177
    v_add_f32 v244, v244, v174
    v_add_f32 v244, v244, v175
    v_cvt_pk_bf16_f32 v171, v174, v175
    v_exp_f32 v178, v178
    s_waitcnt lgkmcnt(10)
    v_mfma_f32_32x32x16_bf16 v[72:87], v[228:231], v[156:159], v[72:87]
    ds_read_b64_tr_b16 v[228:229], v241 offset:8192
    ds_read_b64_tr_b16 v[230:231], v241 offset:8224
    v_exp_f32 v179, v179
    v_add_f32 v244, v244, v176
    v_add_f32 v244, v244, v177
    v_cvt_pk_bf16_f32 v172, v176, v177
    v_exp_f32 v180, v180
    s_waitcnt lgkmcnt(10)
    v_mfma_f32_32x32x16_bf16 v[88:103], v[208:211], v[156:159], v[88:103]
    ds_read_b64_tr_b16 v[208:209], v238 offset:4096
    ds_read_b64_tr_b16 v[210:211], v238 offset:5120
    v_exp_f32 v181, v181
    v_add_f32 v244, v244, v178
    v_add_f32 v244, v244, v179
    v_cvt_pk_bf16_f32 v173, v178, v179
    v_exp_f32 v182, v182
    s_waitcnt lgkmcnt(10)
    v_mfma_f32_32x32x16_bf16 v[104:119], v[212:215], v[156:159], v[104:119]
    ds_read_b64_tr_b16 v[212:213], v239 offset:4096
    ds_read_b64_tr_b16 v[214:215], v239 offset:5120
    v_exp_f32 v183, v183
    v_add_f32 v244, v244, v180
    v_add_f32 v244, v244, v181
    v_cvt_pk_bf16_f32 v174, v180, v181
    v_add_f32 v244, v244, v182
    s_waitcnt lgkmcnt(11)
    v_mfma_f32_16x16x16_bf16 v[120:123], v[216:217], v[184:185], v[120:123]
    s_waitcnt lgkmcnt(10)
    v_mfma_f32_16x16x16_bf16 v[124:127], v[218:219], v[184:185], v[124:127]
    ds_read_b64_tr_b16 v[216:217], v238 offset:12288
    ds_read_b64_tr_b16 v[218:219], v238 offset:13312
    v_add_f32 v244, v244, v183
    v_cvt_pk_bf16_f32 v175, v182, v183
    s_waitcnt lgkmcnt(11)
    v_mfma_f32_16x16x16_bf16 v[128:131], v[220:221], v[184:185], v[128:131]
    s_waitcnt lgkmcnt(10)
    v_mfma_f32_16x16x16_bf16 v[132:135], v[222:223], v[184:185], v[132:135]
    ds_read_b64_tr_b16 v[220:221], v239 offset:12288
    ds_read_b64_tr_b16 v[222:223], v239 offset:13312
    s_waitcnt lgkmcnt(11)
    v_mfma_f32_16x16x16_bf16 v[136:139], v[224:225], v[184:185], v[136:139]
    s_waitcnt lgkmcnt(10)
    v_mfma_f32_16x16x16_bf16 v[140:143], v[226:227], v[184:185], v[140:143]
    ds_read_b64_tr_b16 v[224:225], v238 offset:6144
    ds_read_b64_tr_b16 v[226:227], v238 offset:7168
    s_waitcnt lgkmcnt(11)
    v_mfma_f32_16x16x16_bf16 v[144:147], v[228:229], v[184:185], v[144:147]
    s_waitcnt lgkmcnt(10)
    v_mfma_f32_16x16x16_bf16 v[148:151], v[230:231], v[184:185], v[148:151]
    ds_read_b64_tr_b16 v[228:229], v239 offset:6144
    ds_read_b64_tr_b16 v[230:231], v239 offset:7168
    s_waitcnt lgkmcnt(10)
    v_mfma_f32_32x32x16_bf16 v[56:71], v[208:211], v[168:171], v[56:71]
    ds_read_b64_tr_b16 v[208:209], v238 offset:14336
    ds_read_b64_tr_b16 v[210:211], v238 offset:15360
    s_waitcnt lgkmcnt(10)
    v_mfma_f32_32x32x16_bf16 v[72:87], v[212:215], v[168:171], v[72:87]
    ds_read_b64_tr_b16 v[212:213], v239 offset:14336
    ds_read_b64_tr_b16 v[214:215], v239 offset:15360
    s_waitcnt lgkmcnt(10)
    v_mfma_f32_32x32x16_bf16 v[88:103], v[216:219], v[168:171], v[88:103]
    s_waitcnt lgkmcnt(8)
    v_mfma_f32_32x32x16_bf16 v[104:119], v[220:223], v[168:171], v[104:119]
    s_waitcnt lgkmcnt(6)
    v_mfma_f32_32x32x16_bf16 v[56:71], v[224:227], v[172:175], v[56:71]
    s_waitcnt vmcnt(4)
    s_waitcnt lgkmcnt(0)
    s_barrier
    ds_read_b128 v[216:219], v232 offset:16384
    ds_read_b128 v[220:223], v233 offset:16384
    ds_read_b128 v[224:227], v234 offset:16384
    s_add_u32 s95, s70, s14
    s_mov_b32 m0, s89
    s_nop 0
    buffer_load_dwordx4 v242, s[48:51], s95 offen offset:0 nt lds
    v_mfma_f32_32x32x16_bf16 v[72:87], v[228:231], v[172:175], v[72:87]
    ds_read_b128 v[228:231], v235 offset:16384
    s_add_u32 s95, s70, s14
    s_add_u32 m0, s89, 8064
    s_nop 0
    buffer_load_dwordx4 v242, s[48:51], s95 offen offset:128 nt lds
    v_mfma_f32_32x32x16_bf16 v[88:103], v[208:211], v[172:175], v[88:103]
    ds_read_b128 v[208:211], v232 offset:24576
    s_add_u32 s95, s70, s14
    s_add_u32 s95, s95, 8192
    s_add_u32 m0, s89, 4096
    s_nop 0
    buffer_load_dwordx4 v242, s[48:51], s95 offen offset:0 nt lds
    v_mfma_f32_32x32x16_bf16 v[104:119], v[212:215], v[172:175], v[104:119]
    ds_read_b128 v[212:215], v233 offset:24576
    s_add_u32 s95, s70, s14
    s_add_u32 s95, s95, 8192
    s_add_u32 m0, s89, 12160
    s_nop 0
    buffer_load_dwordx4 v242, s[48:51], s95 offen offset:128 nt lds
    s_waitcnt lgkmcnt(5)
    v_mfma_f32_32x32x16_bf16 v[152:167], v[216:219], v[8:11], v[188:203]
    ds_read_b128 v[216:219], v234 offset:24576
    s_waitcnt lgkmcnt(5)
    v_mfma_f32_32x32x16_bf16 v[152:167], v[220:223], v[12:15], v[152:167]
    ds_read_b128 v[220:223], v235 offset:24576
    s_waitcnt lgkmcnt(5)
    v_mfma_f32_32x32x16_bf16 v[152:167], v[224:227], v[16:19], v[152:167]
    ds_read_b128 v[224:227], v236 offset:16384
    s_waitcnt lgkmcnt(5)
    v_mfma_f32_32x32x16_bf16 v[152:167], v[228:231], v[20:23], v[152:167]
    ds_read_b128 v[228:231], v237 offset:16384
    s_waitcnt lgkmcnt(5)
    v_mfma_f32_32x32x16_bf16 v[152:167], v[208:211], v[24:27], v[152:167]
    ds_read_b128 v[208:211], v236 offset:24576
    s_waitcnt lgkmcnt(5)
    v_mfma_f32_32x32x16_bf16 v[152:167], v[212:215], v[28:31], v[152:167]
    ds_read_b128 v[212:215], v237 offset:24576
    s_waitcnt lgkmcnt(5)
    v_mfma_f32_32x32x16_bf16 v[152:167], v[216:219], v[32:35], v[152:167]
    ds_read_b128 v[216:219], v232 offset:20480
    s_waitcnt lgkmcnt(5)
    v_mfma_f32_32x32x16_bf16 v[152:167], v[220:223], v[36:39], v[152:167]
    ds_read_b128 v[220:223], v233 offset:20480
    s_waitcnt lgkmcnt(5)
    v_mfma_f32_16x16x32_bf16 v[184:187], v[224:227], v[40:43], v[204:207]
    ds_read_b128 v[224:227], v234 offset:20480
    s_waitcnt lgkmcnt(5)
    v_mfma_f32_16x16x32_bf16 v[184:187], v[228:231], v[44:47], v[184:187]
    ds_read_b128 v[228:231], v235 offset:20480
    s_waitcnt lgkmcnt(5)
    v_mfma_f32_16x16x32_bf16 v[184:187], v[208:211], v[48:51], v[184:187]
    ds_read_b128 v[208:211], v232 offset:28672
    s_waitcnt lgkmcnt(5)
    v_mfma_f32_16x16x32_bf16 v[184:187], v[212:215], v[52:55], v[184:187]
    ds_read_b128 v[212:215], v233 offset:28672
    s_waitcnt lgkmcnt(5)
    v_mfma_f32_32x32x16_bf16 v[168:183], v[216:219], v[8:11], v[188:203]
    ds_read_b128 v[216:219], v234 offset:28672
    s_waitcnt lgkmcnt(5)
    v_mfma_f32_32x32x16_bf16 v[168:183], v[220:223], v[12:15], v[168:183]
    ds_read_b128 v[220:223], v235 offset:28672
    v_max3_f32 v246, v152, v153, v154
    v_max3_f32 v246, v246, v155, v156
    v_max3_f32 v246, v246, v157, v158
    v_max3_f32 v246, v246, v159, v160
    v_max3_f32 v246, v246, v161, v162
    v_max3_f32 v246, v246, v163, v164
    s_waitcnt lgkmcnt(5)
    v_mfma_f32_32x32x16_bf16 v[168:183], v[224:227], v[16:19], v[168:183]
    v_max3_f32 v246, v246, v165, v166
    v_max_f32 v246, v246, v167
    v_max3_f32 v247, v184, v185, v186
    v_max_f32 v247, v247, v187
    v_max_f32 v248, v246, v247
    v_cmp_lt_f32 vcc, 0x41000000, v248
    s_nop 1
    s_cbranch_vccnz L_slow_A15
L_back_A15:
    s_waitcnt lgkmcnt(4)
    v_mfma_f32_32x32x16_bf16 v[168:183], v[228:231], v[20:23], v[168:183]
    v_exp_f32 v184, v184
    v_exp_f32 v185, v185
    v_exp_f32 v186, v186
    s_waitcnt lgkmcnt(3)
    v_mfma_f32_32x32x16_bf16 v[168:183], v[208:211], v[24:27], v[168:183]
    s_waitcnt vmcnt(4)
    s_waitcnt lgkmcnt(0)
    s_barrier
    ds_read_b64_tr_b16 v[224:225], v238 offset:32768
    ds_read_b64_tr_b16 v[226:227], v238 offset:33792
    ds_read_b64_tr_b16 v[228:229], v239 offset:32768
    ds_read_b64_tr_b16 v[230:231], v239 offset:33792
    ds_read_b64_tr_b16 v[208:209], v238 offset:40960
    ds_read_b64_tr_b16 v[210:211], v238 offset:41984
    s_add_u32 s95, s70, s14
    s_add_u32 m0, s89, 16384
    s_nop 0
    buffer_load_dwordx4 v243, s[52:55], s95 offen offset:0 nt lds
    v_exp_f32 v187, v187
    v_add_f32 v245, v245, v184
    v_add_f32 v245, v245, v185
    v_cvt_pk_bf16_f32 v184, v184, v185
    v_add_f32 v245, v245, v186
    v_mfma_f32_32x32x16_bf16 v[168:183], v[212:215], v[28:31], v[168:183]
    ds_read_b64_tr_b16 v[212:213], v239 offset:40960
    ds_read_b64_tr_b16 v[214:215], v239 offset:41984
    s_add_u32 s95, s70, s14
    s_add_u32 m0, s89, 24448
    s_nop 0
    buffer_load_dwordx4 v243, s[52:55], s95 offen offset:128 nt lds
    v_add_f32 v245, v245, v187
    v_cvt_pk_bf16_f32 v185, v186, v187
    v_exp_f32 v152, v152
    v_exp_f32 v153, v153
    v_mfma_f32_32x32x16_bf16 v[168:183], v[216:219], v[32:35], v[168:183]
    ds_read_b64_tr_b16 v[216:217], v238 offset:34816
    ds_read_b64_tr_b16 v[218:219], v238 offset:35840
    s_add_u32 s95, s70, s14
    s_add_u32 s95, s95, 8192
    s_add_u32 m0, s89, 20480
    s_nop 0
    buffer_load_dwordx4 v243, s[52:55], s95 offen offset:0 nt lds
    v_exp_f32 v154, v154
    v_exp_f32 v155, v155
    v_add_f32 v244, v244, v152
    v_add_f32 v244, v244, v153
    v_mfma_f32_32x32x16_bf16 v[168:183], v[220:223], v[36:39], v[168:183]
    ds_read_b64_tr_b16 v[220:221], v239 offset:34816
    ds_read_b64_tr_b16 v[222:223], v239 offset:35840
    s_add_u32 s95, s70, s14
    s_add_u32 s95, s95, 8192
    s_add_u32 m0, s89, 28544
    s_nop 0
    buffer_load_dwordx4 v243, s[52:55], s95 offen offset:128 nt lds
    v_cvt_pk_bf16_f32 v152, v152, v153
    v_exp_f32 v156, v156
    v_exp_f32 v157, v157
    v_add_f32 v244, v244, v154
    v_add_f32 v244, v244, v155
    v_cvt_pk_bf16_f32 v153, v154, v155
    v_exp_f32 v158, v158
    v_exp_f32 v159, v159
    v_add_f32 v244, v244, v156
    v_add_f32 v244, v244, v157
    v_cvt_pk_bf16_f32 v154, v156, v157
    v_exp_f32 v160, v160
    v_exp_f32 v161, v161
    v_add_f32 v244, v244, v158
    v_add_f32 v244, v244, v159
    v_cvt_pk_bf16_f32 v155, v158, v159
    v_exp_f32 v162, v162
    v_exp_f32 v163, v163
    v_add_f32 v244, v244, v160
    v_add_f32 v244, v244, v161
    v_cvt_pk_bf16_f32 v156, v160, v161
    v_exp_f32 v164, v164
    v_exp_f32 v165, v165
    v_add_f32 v244, v244, v162
    v_add_f32 v244, v244, v163
    v_cvt_pk_bf16_f32 v157, v162, v163
    v_exp_f32 v166, v166
    v_exp_f32 v167, v167
    v_add_f32 v244, v244, v164
    v_add_f32 v244, v244, v165
    v_cvt_pk_bf16_f32 v158, v164, v165
    v_add_f32 v244, v244, v166
    v_add_f32 v244, v244, v167
    v_cvt_pk_bf16_f32 v159, v166, v167
    v_max3_f32 v246, v168, v169, v170
    v_max3_f32 v246, v246, v171, v172
    v_max3_f32 v246, v246, v173, v174
    v_max3_f32 v246, v246, v175, v176
    v_max3_f32 v246, v246, v177, v178
    v_max3_f32 v246, v246, v179, v180
    v_max3_f32 v246, v246, v181, v182
    v_max_f32 v246, v246, v183
    v_cmp_lt_f32 vcc, 0x41000000, v246
    s_nop 1
    s_cbranch_vccnz L_slow_B15
L_back_B15:
    s_waitcnt lgkmcnt(10)
    v_mfma_f32_32x32x16_bf16 v[56:71], v[224:227], v[152:155], v[56:71]
    ds_read_b64_tr_b16 v[224:225], v238 offset:43008
    ds_read_b64_tr_b16 v[226:227], v238 offset:44032
    v_exp_f32 v168, v168
    v_exp_f32 v169, v169
    v_exp_f32 v170, v170
    s_waitcnt lgkmcnt(10)
    v_mfma_f32_32x32x16_bf16 v[72:87], v[228:231], v[152:155], v[72:87]
    ds_read_b64_tr_b16 v[228:229], v239 offset:43008
    ds_read_b64_tr_b16 v[230:231], v239 offset:44032
    v_exp_f32 v171, v171
    v_add_f32 v244, v244, v168
    v_add_f32 v244, v244, v169
    v_cvt_pk_bf16_f32 v168, v168, v169
    v_exp_f32 v172, v172
    s_waitcnt lgkmcnt(10)
    v_mfma_f32_32x32x16_bf16 v[88:103], v[208:211], v[152:155], v[88:103]
    ds_read_b64_tr_b16 v[208:209], v240 offset:32768
    ds_read_b64_tr_b16 v[210:211], v240 offset:32800
    v_exp_f32 v173, v173
    v_add_f32 v244, v244, v170
    v_add_f32 v244, v244, v171
    v_cvt_pk_bf16_f32 v169, v170, v171
    v_exp_f32 v174, v174
    s_waitcnt lgkmcnt(10)
    v_mfma_f32_32x32x16_bf16 v[104:119], v[212:215], v[152:155], v[104:119]
    ds_read_b64_tr_b16 v[212:213], v241 offset:32768
    ds_read_b64_tr_b16 v[214:215], v241 offset:32800
    v_exp_f32 v175, v175
    v_add_f32 v244, v244, v172
    v_add_f32 v244, v244, v173
    v_cvt_pk_bf16_f32 v170, v172, v173
    v_exp_f32 v176, v176
    s_waitcnt lgkmcnt(10)
    v_mfma_f32_32x32x16_bf16 v[56:71], v[216:219], v[156:159], v[56:71]
    ds_read_b64_tr_b16 v[216:217], v240 offset:40960
    ds_read_b64_tr_b16 v[218:219], v240 offset:40992
    v_exp_f32 v177, v177
    v_add_f32 v244, v244, v174
    v_add_f32 v244, v244, v175
    v_cvt_pk_bf16_f32 v171, v174, v175
    v_exp_f32 v178, v178
    s_waitcnt lgkmcnt(10)
    v_mfma_f32_32x32x16_bf16 v[72:87], v[220:223], v[156:159], v[72:87]
    ds_read_b64_tr_b16 v[220:221], v241 offset:40960
    ds_read_b64_tr_b16 v[222:223], v241 offset:40992
    v_exp_f32 v179, v179
    v_add_f32 v244, v244, v176
    v_add_f32 v244, v244, v177
    v_cvt_pk_bf16_f32 v172, v176, v177
    v_exp_f32 v180, v180
    s_waitcnt lgkmcnt(10)
    v_mfma_f32_32x32x16_bf16 v[88:103], v[224:227], v[156:159], v[88:103]
    ds_read_b64_tr_b16 v[224:225], v238 offset:36864
    ds_read_b64_tr_b16 v[226:227], v238 offset:37888
    v_exp_f32 v181, v181
    v_add_f32 v244, v244, v178
    v_add_f32 v244, v244, v179
    v_cvt_pk_bf16_f32 v173, v178, v179
    v_exp_f32 v182, v182
    s_waitcnt lgkmcnt(10)
    v_mfma_f32_32x32x16_bf16 v[104:119], v[228:231], v[156:159], v[104:119]
    ds_read_b64_tr_b16 v[228:229], v239 offset:36864
    ds_read_b64_tr_b16 v[230:231], v239 offset:37888
    v_exp_f32 v183, v183
    v_add_f32 v244, v244, v180
    v_add_f32 v244, v244, v181
    v_cvt_pk_bf16_f32 v174, v180, v181
    v_add_f32 v244, v244, v182
    s_waitcnt lgkmcnt(11)
    v_mfma_f32_16x16x16_bf16 v[120:123], v[208:209], v[184:185], v[120:123]
    s_waitcnt lgkmcnt(10)
    v_mfma_f32_16x16x16_bf16 v[124:127], v[210:211], v[184:185], v[124:127]
    ds_read_b64_tr_b16 v[208:209], v238 offset:45056
    ds_read_b64_tr_b16 v[210:211], v238 offset:46080
    v_add_f32 v244, v244, v183
    v_cvt_pk_bf16_f32 v175, v182, v183
    s_waitcnt lgkmcnt(11)
    v_mfma_f32_16x16x16_bf16 v[128:131], v[212:213], v[184:185], v[128:131]
    s_waitcnt lgkmcnt(10)
    v_mfma_f32_16x16x16_bf16 v[132:135], v[214:215], v[184:185], v[132:135]
    ds_read_b64_tr_b16 v[212:213], v239 offset:45056
    ds_read_b64_tr_b16 v[214:215], v239 offset:46080
    s_waitcnt lgkmcnt(11)
    v_mfma_f32_16x16x16_bf16 v[136:139], v[216:217], v[184:185], v[136:139]
    s_waitcnt lgkmcnt(10)
    v_mfma_f32_16x16x16_bf16 v[140:143], v[218:219], v[184:185], v[140:143]
    ds_read_b64_tr_b16 v[216:217], v238 offset:38912
    ds_read_b64_tr_b16 v[218:219], v238 offset:39936
    s_waitcnt lgkmcnt(11)
    v_mfma_f32_16x16x16_bf16 v[144:147], v[220:221], v[184:185], v[144:147]
    s_waitcnt lgkmcnt(10)
    v_mfma_f32_16x16x16_bf16 v[148:151], v[222:223], v[184:185], v[148:151]
    ds_read_b64_tr_b16 v[220:221], v239 offset:38912
    ds_read_b64_tr_b16 v[222:223], v239 offset:39936
    s_waitcnt lgkmcnt(10)
    v_mfma_f32_32x32x16_bf16 v[56:71], v[224:227], v[168:171], v[56:71]
    ds_read_b64_tr_b16 v[224:225], v238 offset:47104
    ds_read_b64_tr_b16 v[226:227], v238 offset:48128
    s_waitcnt lgkmcnt(10)
    v_mfma_f32_32x32x16_bf16 v[72:87], v[228:231], v[168:171], v[72:87]
    ds_read_b64_tr_b16 v[228:229], v239 offset:47104
    ds_read_b64_tr_b16 v[230:231], v239 offset:48128
    s_waitcnt lgkmcnt(10)
    v_mfma_f32_32x32x16_bf16 v[88:103], v[208:211], v[168:171], v[88:103]
    s_waitcnt lgkmcnt(8)
    v_mfma_f32_32x32x16_bf16 v[104:119], v[212:215], v[168:171], v[104:119]
    s_waitcnt lgkmcnt(6)
    v_mfma_f32_32x32x16_bf16 v[56:71], v[216:219], v[172:175], v[56:71]
    s_waitcnt vmcnt(4)
    s_waitcnt lgkmcnt(0)
    s_barrier
    ds_read_b128 v[208:211], v232 offset:0
    ds_read_b128 v[212:215], v233 offset:0
    ds_read_b128 v[216:219], v234 offset:0
    s_add_u32 s95, s70, s15
    s_add_u32 m0, s89, 32768
    s_nop 0
    buffer_load_dwordx4 v242, s[48:51], s95 offen offset:0 nt lds
    v_mfma_f32_32x32x16_bf16 v[72:87], v[220:223], v[172:175], v[72:87]
    ds_read_b128 v[220:223], v235 offset:0
    s_add_u32 s95, s70, s15
    s_add_u32 m0, s89, 40832
    s_nop 0
    buffer_load_dwordx4 v242, s[48:51], s95 offen offset:128 nt lds
    v_mfma_f32_32x32x16_bf16 v[88:103], v[224:227], v[172:175], v[88:103]
    ds_read_b128 v[224:227], v232 offset:8192
    s_add_u32 s95, s70, s15
    s_add_u32 s95, s95, 8192
    s_add_u32 m0, s89, 36864
    s_nop 0
    buffer_load_dwordx4 v242, s[48:51], s95 offen offset:0 nt lds
    v_mfma_f32_32x32x16_bf16 v[104:119], v[228:231], v[172:175], v[104:119]
    ds_read_b128 v[228:231], v233 offset:8192
    s_add_u32 s95, s70, s15
    s_add_u32 s95, s95, 8192
    s_add_u32 m0, s89, 44928
    s_nop 0
    buffer_load_dwordx4 v242, s[48:51], s95 offen offset:128 nt lds
    s_waitcnt lgkmcnt(5)
    v_mfma_f32_32x32x16_bf16 v[152:167], v[208:211], v[8:11], v[188:203]
    ds_read_b128 v[208:211], v234 offset:8192
    s_waitcnt lgkmcnt(5)
    v_mfma_f32_32x32x16_bf16 v[152:167], v[212:215], v[12:15], v[152:167]
    ds_read_b128 v[212:215], v235 offset:8192
    s_waitcnt lgkmcnt(5)
    v_mfma_f32_32x32x16_bf16 v[152:167], v[216:219], v[16:19], v[152:167]
    ds_read_b128 v[216:219], v236 offset:0
    s_waitcnt lgkmcnt(5)
    v_mfma_f32_32x32x16_bf16 v[152:167], v[220:223], v[20:23], v[152:167]
    ds_read_b128 v[220:223], v237 offset:0
    s_waitcnt lgkmcnt(5)
    v_mfma_f32_32x32x16_bf16 v[152:167], v[224:227], v[24:27], v[152:167]
    ds_read_b128 v[224:227], v236 offset:8192
    s_waitcnt lgkmcnt(5)
    v_mfma_f32_32x32x16_bf16 v[152:167], v[228:231], v[28:31], v[152:167]
    ds_read_b128 v[228:231], v237 offset:8192
    s_waitcnt lgkmcnt(5)
    v_mfma_f32_32x32x16_bf16 v[152:167], v[208:211], v[32:35], v[152:167]
    ds_read_b128 v[208:211], v232 offset:4096
    s_waitcnt lgkmcnt(5)
    v_mfma_f32_32x32x16_bf16 v[152:167], v[212:215], v[36:39], v[152:167]
    ds_read_b128 v[212:215], v233 offset:4096
    s_waitcnt lgkmcnt(5)
    v_mfma_f32_16x16x32_bf16 v[184:187], v[216:219], v[40:43], v[204:207]
    ds_read_b128 v[216:219], v234 offset:4096
    s_waitcnt lgkmcnt(5)
    v_mfma_f32_16x16x32_bf16 v[184:187], v[220:223], v[44:47], v[184:187]
    ds_read_b128 v[220:223], v235 offset:4096
    s_waitcnt lgkmcnt(5)
    v_mfma_f32_16x16x32_bf16 v[184:187], v[224:227], v[48:51], v[184:187]
    ds_read_b128 v[224:227], v232 offset:12288
    s_waitcnt lgkmcnt(5)
    v_mfma_f32_16x16x32_bf16 v[184:187], v[228:231], v[52:55], v[184:187]
    ds_read_b128 v[228:231], v233 offset:12288
    s_waitcnt lgkmcnt(5)
    v_mfma_f32_32x32x16_bf16 v[168:183], v[208:211], v[8:11], v[188:203]
    ds_read_b128 v[208:211], v234 offset:12288
    s_waitcnt lgkmcnt(5)
    v_mfma_f32_32x32x16_bf16 v[168:183], v[212:215], v[12:15], v[168:183]
    ds_read_b128 v[212:215], v235 offset:12288
    v_max3_f32 v246, v152, v153, v154
    v_max3_f32 v246, v246, v155, v156
    v_max3_f32 v246, v246, v157, v158
    v_max3_f32 v246, v246, v159, v160
    v_max3_f32 v246, v246, v161, v162
    v_max3_f32 v246, v246, v163, v164
    s_waitcnt lgkmcnt(5)
    v_mfma_f32_32x32x16_bf16 v[168:183], v[216:219], v[16:19], v[168:183]
    v_max3_f32 v246, v246, v165, v166
    v_max_f32 v246, v246, v167
    v_max3_f32 v247, v184, v185, v186
    v_max_f32 v247, v247, v187
    v_max_f32 v248, v246, v247
    v_cmp_lt_f32 vcc, 0x41000000, v248
    s_nop 1
    s_cbranch_vccnz L_slow_A16
L_back_A16:
    s_waitcnt lgkmcnt(4)
    v_mfma_f32_32x32x16_bf16 v[168:183], v[220:223], v[20:23], v[168:183]
    v_exp_f32 v184, v184
    v_exp_f32 v185, v185
    v_exp_f32 v186, v186
    s_waitcnt lgkmcnt(3)
    v_mfma_f32_32x32x16_bf16 v[168:183], v[224:227], v[24:27], v[168:183]
    s_waitcnt vmcnt(4)
    s_waitcnt lgkmcnt(0)
    s_barrier
    ds_read_b64_tr_b16 v[216:217], v238 offset:16384
    ds_read_b64_tr_b16 v[218:219], v238 offset:17408
    ds_read_b64_tr_b16 v[220:221], v239 offset:16384
    ds_read_b64_tr_b16 v[222:223], v239 offset:17408
    ds_read_b64_tr_b16 v[224:225], v238 offset:24576
    ds_read_b64_tr_b16 v[226:227], v238 offset:25600
    s_add_u32 s95, s70, s15
    s_mov_b32 m0, s89
    s_nop 0
    buffer_load_dwordx4 v243, s[52:55], s95 offen offset:0 nt lds
    v_exp_f32 v187, v187
    v_add_f32 v245, v245, v184
    v_add_f32 v245, v245, v185
    v_cvt_pk_bf16_f32 v184, v184, v185
    v_add_f32 v245, v245, v186
    v_mfma_f32_32x32x16_bf16 v[168:183], v[228:231], v[28:31], v[168:183]
    ds_read_b64_tr_b16 v[228:229], v239 offset:24576
    ds_read_b64_tr_b16 v[230:231], v239 offset:25600
    s_add_u32 s95, s70, s15
    s_add_u32 m0, s89, 8064
    s_nop 0
    buffer_load_dwordx4 v243, s[52:55], s95 offen offset:128 nt lds
    v_add_f32 v245, v245, v187
    v_cvt_pk_bf16_f32 v185, v186, v187
    v_exp_f32 v152, v152
    v_exp_f32 v153, v153
    v_mfma_f32_32x32x16_bf16 v[168:183], v[208:211], v[32:35], v[168:183]
    ds_read_b64_tr_b16 v[208:209], v238 offset:18432
    ds_read_b64_tr_b16 v[210:211], v238 offset:19456
    s_add_u32 s95, s70, s15
    s_add_u32 s95, s95, 8192
    s_add_u32 m0, s89, 4096
    s_nop 0
    buffer_load_dwordx4 v243, s[52:55], s95 offen offset:0 nt lds
    v_exp_f32 v154, v154
    v_exp_f32 v155, v155
    v_add_f32 v244, v244, v152
    v_add_f32 v244, v244, v153
    v_mfma_f32_32x32x16_bf16 v[168:183], v[212:215], v[36:39], v[168:183]
    ds_read_b64_tr_b16 v[212:213], v239 offset:18432
    ds_read_b64_tr_b16 v[214:215], v239 offset:19456
    s_add_u32 s95, s70, s15
    s_add_u32 s95, s95, 8192
    s_add_u32 m0, s89, 12160
    s_nop 0
    buffer_load_dwordx4 v243, s[52:55], s95 offen offset:128 nt lds
    v_cvt_pk_bf16_f32 v152, v152, v153
    v_exp_f32 v156, v156
    v_exp_f32 v157, v157
    v_add_f32 v244, v244, v154
    v_add_f32 v244, v244, v155
    v_cvt_pk_bf16_f32 v153, v154, v155
    v_exp_f32 v158, v158
    v_exp_f32 v159, v159
    v_add_f32 v244, v244, v156
    v_add_f32 v244, v244, v157
    v_cvt_pk_bf16_f32 v154, v156, v157
    v_exp_f32 v160, v160
    v_exp_f32 v161, v161
    v_add_f32 v244, v244, v158
    v_add_f32 v244, v244, v159
    v_cvt_pk_bf16_f32 v155, v158, v159
    v_exp_f32 v162, v162
    v_exp_f32 v163, v163
    v_add_f32 v244, v244, v160
    v_add_f32 v244, v244, v161
    v_cvt_pk_bf16_f32 v156, v160, v161
    v_exp_f32 v164, v164
    v_exp_f32 v165, v165
    v_add_f32 v244, v244, v162
    v_add_f32 v244, v244, v163
    v_cvt_pk_bf16_f32 v157, v162, v163
    v_exp_f32 v166, v166
    v_exp_f32 v167, v167
    v_add_f32 v244, v244, v164
    v_add_f32 v244, v244, v165
    v_cvt_pk_bf16_f32 v158, v164, v165
    v_add_f32 v244, v244, v166
    v_add_f32 v244, v244, v167
    v_cvt_pk_bf16_f32 v159, v166, v167
    v_max3_f32 v246, v168, v169, v170
    v_max3_f32 v246, v246, v171, v172
    v_max3_f32 v246, v246, v173, v174
    v_max3_f32 v246, v246, v175, v176
    v_max3_f32 v246, v246, v177, v178
    v_max3_f32 v246, v246, v179, v180
    v_max3_f32 v246, v246, v181, v182
    v_max_f32 v246, v246, v183
    v_cmp_lt_f32 vcc, 0x41000000, v246
    s_nop 1
    s_cbranch_vccnz L_slow_B16
L_back_B16:
    s_waitcnt lgkmcnt(10)
    v_mfma_f32_32x32x16_bf16 v[56:71], v[216:219], v[152:155], v[56:71]
    ds_read_b64_tr_b16 v[216:217], v238 offset:26624
    ds_read_b64_tr_b16 v[218:219], v238 offset:27648
    v_exp_f32 v168, v168
    v_exp_f32 v169, v169
    v_exp_f32 v170, v170
    s_waitcnt lgkmcnt(10)
    v_mfma_f32_32x32x16_bf16 v[72:87], v[220:223], v[152:155], v[72:87]
    ds_read_b64_tr_b16 v[220:221], v239 offset:26624
    ds_read_b64_tr_b16 v[222:223], v239 offset:27648
    v_exp_f32 v171, v171
    v_add_f32 v244, v244, v168
    v_add_f32 v244, v244, v169
    v_cvt_pk_bf16_f32 v168, v168, v169
    v_exp_f32 v172, v172
    s_waitcnt lgkmcnt(10)
    v_mfma_f32_32x32x16_bf16 v[88:103], v[224:227], v[152:155], v[88:103]
    ds_read_b64_tr_b16 v[224:225], v240 offset:16384
    ds_read_b64_tr_b16 v[226:227], v240 offset:16416
    v_exp_f32 v173, v173
    v_add_f32 v244, v244, v170
    v_add_f32 v244, v244, v171
    v_cvt_pk_bf16_f32 v169, v170, v171
    v_exp_f32 v174, v174
    s_waitcnt lgkmcnt(10)
    v_mfma_f32_32x32x16_bf16 v[104:119], v[228:231], v[152:155], v[104:119]
    ds_read_b64_tr_b16 v[228:229], v241 offset:16384
    ds_read_b64_tr_b16 v[230:231], v241 offset:16416
    v_exp_f32 v175, v175
    v_add_f32 v244, v244, v172
    v_add_f32 v244, v244, v173
    v_cvt_pk_bf16_f32 v170, v172, v173
    v_exp_f32 v176, v176
    s_waitcnt lgkmcnt(10)
    v_mfma_f32_32x32x16_bf16 v[56:71], v[208:211], v[156:159], v[56:71]
    ds_read_b64_tr_b16 v[208:209], v240 offset:24576
    ds_read_b64_tr_b16 v[210:211], v240 offset:24608
    v_exp_f32 v177, v177
    v_add_f32 v244, v244, v174
    v_add_f32 v244, v244, v175
    v_cvt_pk_bf16_f32 v171, v174, v175
    v_exp_f32 v178, v178
    s_waitcnt lgkmcnt(10)
    v_mfma_f32_32x32x16_bf16 v[72:87], v[212:215], v[156:159], v[72:87]
    ds_read_b64_tr_b16 v[212:213], v241 offset:24576
    ds_read_b64_tr_b16 v[214:215], v241 offset:24608
    v_exp_f32 v179, v179
    v_add_f32 v244, v244, v176
    v_add_f32 v244, v244, v177
    v_cvt_pk_bf16_f32 v172, v176, v177
    v_exp_f32 v180, v180
    s_waitcnt lgkmcnt(10)
    v_mfma_f32_32x32x16_bf16 v[88:103], v[216:219], v[156:159], v[88:103]
    ds_read_b64_tr_b16 v[216:217], v238 offset:20480
    ds_read_b64_tr_b16 v[218:219], v238 offset:21504
    v_exp_f32 v181, v181
    v_add_f32 v244, v244, v178
    v_add_f32 v244, v244, v179
    v_cvt_pk_bf16_f32 v173, v178, v179
    v_exp_f32 v182, v182
    s_waitcnt lgkmcnt(10)
    v_mfma_f32_32x32x16_bf16 v[104:119], v[220:223], v[156:159], v[104:119]
    ds_read_b64_tr_b16 v[220:221], v239 offset:20480
    ds_read_b64_tr_b16 v[222:223], v239 offset:21504
    v_exp_f32 v183, v183
    v_add_f32 v244, v244, v180
    v_add_f32 v244, v244, v181
    v_cvt_pk_bf16_f32 v174, v180, v181
    v_add_f32 v244, v244, v182
    s_waitcnt lgkmcnt(11)
    v_mfma_f32_16x16x16_bf16 v[120:123], v[224:225], v[184:185], v[120:123]
    s_waitcnt lgkmcnt(10)
    v_mfma_f32_16x16x16_bf16 v[124:127], v[226:227], v[184:185], v[124:127]
    ds_read_b64_tr_b16 v[224:225], v238 offset:28672
    ds_read_b64_tr_b16 v[226:227], v238 offset:29696
    v_add_f32 v244, v244, v183
    v_cvt_pk_bf16_f32 v175, v182, v183
    s_waitcnt lgkmcnt(11)
    v_mfma_f32_16x16x16_bf16 v[128:131], v[228:229], v[184:185], v[128:131]
    s_waitcnt lgkmcnt(10)
    v_mfma_f32_16x16x16_bf16 v[132:135], v[230:231], v[184:185], v[132:135]
    ds_read_b64_tr_b16 v[228:229], v239 offset:28672
    ds_read_b64_tr_b16 v[230:231], v239 offset:29696
    s_waitcnt lgkmcnt(11)
    v_mfma_f32_16x16x16_bf16 v[136:139], v[208:209], v[184:185], v[136:139]
    s_waitcnt lgkmcnt(10)
    v_mfma_f32_16x16x16_bf16 v[140:143], v[210:211], v[184:185], v[140:143]
    ds_read_b64_tr_b16 v[208:209], v238 offset:22528
    ds_read_b64_tr_b16 v[210:211], v238 offset:23552
    s_waitcnt lgkmcnt(11)
    v_mfma_f32_16x16x16_bf16 v[144:147], v[212:213], v[184:185], v[144:147]
    s_waitcnt lgkmcnt(10)
    v_mfma_f32_16x16x16_bf16 v[148:151], v[214:215], v[184:185], v[148:151]
    ds_read_b64_tr_b16 v[212:213], v239 offset:22528
    ds_read_b64_tr_b16 v[214:215], v239 offset:23552
    s_waitcnt lgkmcnt(10)
    v_mfma_f32_32x32x16_bf16 v[56:71], v[216:219], v[168:171], v[56:71]
    ds_read_b64_tr_b16 v[216:217], v238 offset:30720
    ds_read_b64_tr_b16 v[218:219], v238 offset:31744
    s_waitcnt lgkmcnt(10)
    v_mfma_f32_32x32x16_bf16 v[72:87], v[220:223], v[168:171], v[72:87]
    ds_read_b64_tr_b16 v[220:221], v239 offset:30720
    ds_read_b64_tr_b16 v[222:223], v239 offset:31744
    s_waitcnt lgkmcnt(10)
    v_mfma_f32_32x32x16_bf16 v[88:103], v[224:227], v[168:171], v[88:103]
    s_waitcnt lgkmcnt(8)
    v_mfma_f32_32x32x16_bf16 v[104:119], v[228:231], v[168:171], v[104:119]
    s_waitcnt lgkmcnt(6)
    v_mfma_f32_32x32x16_bf16 v[56:71], v[208:211], v[172:175], v[56:71]
    s_waitcnt vmcnt(4)
    s_waitcnt lgkmcnt(0)
    s_barrier
    ds_read_b128 v[224:227], v232 offset:32768
    ds_read_b128 v[228:231], v233 offset:32768
    ds_read_b128 v[208:211], v234 offset:32768
    v_mfma_f32_32x32x16_bf16 v[72:87], v[212:215], v[172:175], v[72:87]
    ds_read_b128 v[212:215], v235 offset:32768
    v_mfma_f32_32x32x16_bf16 v[88:103], v[216:219], v[172:175], v[88:103]
    ds_read_b128 v[216:219], v232 offset:40960
    v_mfma_f32_32x32x16_bf16 v[104:119], v[220:223], v[172:175], v[104:119]
    ds_read_b128 v[220:223], v233 offset:40960
    s_waitcnt lgkmcnt(5)
    v_mfma_f32_32x32x16_bf16 v[152:167], v[224:227], v[8:11], v[188:203]
    ds_read_b128 v[224:227], v234 offset:40960
    s_waitcnt lgkmcnt(5)
    v_mfma_f32_32x32x16_bf16 v[152:167], v[228:231], v[12:15], v[152:167]
    ds_read_b128 v[228:231], v235 offset:40960
    s_waitcnt lgkmcnt(5)
    v_mfma_f32_32x32x16_bf16 v[152:167], v[208:211], v[16:19], v[152:167]
    ds_read_b128 v[208:211], v236 offset:32768
    s_waitcnt lgkmcnt(5)
    v_mfma_f32_32x32x16_bf16 v[152:167], v[212:215], v[20:23], v[152:167]
    ds_read_b128 v[212:215], v237 offset:32768
    s_waitcnt lgkmcnt(5)
    v_mfma_f32_32x32x16_bf16 v[152:167], v[216:219], v[24:27], v[152:167]
    ds_read_b128 v[216:219], v236 offset:40960
    s_waitcnt lgkmcnt(5)
    v_mfma_f32_32x32x16_bf16 v[152:167], v[220:223], v[28:31], v[152:167]
    ds_read_b128 v[220:223], v237 offset:40960
    s_waitcnt lgkmcnt(5)
    v_mfma_f32_32x32x16_bf16 v[152:167], v[224:227], v[32:35], v[152:167]
    ds_read_b128 v[224:227], v232 offset:36864
    s_waitcnt lgkmcnt(5)
    v_mfma_f32_32x32x16_bf16 v[152:167], v[228:231], v[36:39], v[152:167]
    ds_read_b128 v[228:231], v233 offset:36864
    s_waitcnt lgkmcnt(5)
    v_mfma_f32_16x16x32_bf16 v[184:187], v[208:211], v[40:43], v[204:207]
    ds_read_b128 v[208:211], v234 offset:36864
    s_waitcnt lgkmcnt(5)
    v_mfma_f32_16x16x32_bf16 v[184:187], v[212:215], v[44:47], v[184:187]
    ds_read_b128 v[212:215], v235 offset:36864
    s_waitcnt lgkmcnt(5)
    v_mfma_f32_16x16x32_bf16 v[184:187], v[216:219], v[48:51], v[184:187]
    ds_read_b128 v[216:219], v232 offset:45056
    s_waitcnt lgkmcnt(5)
    v_mfma_f32_16x16x32_bf16 v[184:187], v[220:223], v[52:55], v[184:187]
    ds_read_b128 v[220:223], v233 offset:45056
    s_waitcnt lgkmcnt(5)
    v_mfma_f32_32x32x16_bf16 v[168:183], v[224:227], v[8:11], v[188:203]
    ds_read_b128 v[224:227], v234 offset:45056
    s_waitcnt lgkmcnt(5)
    v_mfma_f32_32x32x16_bf16 v[168:183], v[228:231], v[12:15], v[168:183]
    ds_read_b128 v[228:231], v235 offset:45056
    v_max3_f32 v246, v152, v153, v154
    v_max3_f32 v246, v246, v155, v156
    v_max3_f32 v246, v246, v157, v158
    v_max3_f32 v246, v246, v159, v160
    v_max3_f32 v246, v246, v161, v162
    v_max3_f32 v246, v246, v163, v164
    s_waitcnt lgkmcnt(5)
    v_mfma_f32_32x32x16_bf16 v[168:183], v[208:211], v[16:19], v[168:183]
    v_max3_f32 v246, v246, v165, v166
    v_max_f32 v246, v246, v167
    v_max3_f32 v247, v184, v185, v186
    v_max_f32 v247, v247, v187
    v_max_f32 v248, v246, v247
    v_cmp_lt_f32 vcc, 0x41000000, v248
    s_nop 1
    s_cbranch_vccnz L_slow_A17
L_back_A17:
    s_waitcnt lgkmcnt(4)
    v_mfma_f32_32x32x16_bf16 v[168:183], v[212:215], v[20:23], v[168:183]
    v_exp_f32 v184, v184
    v_exp_f32 v185, v185
    v_exp_f32 v186, v186
    s_waitcnt lgkmcnt(3)
    v_mfma_f32_32x32x16_bf16 v[168:183], v[216:219], v[24:27], v[168:183]
    v_exp_f32 v187, v187
    v_add_f32 v245, v245, v184
    v_add_f32 v245, v245, v185
    v_cvt_pk_bf16_f32 v184, v184, v185
    v_add_f32 v245, v245, v186
    v_add_f32 v245, v245, v187
    v_cvt_pk_bf16_f32 v185, v186, v187
    v_exp_f32 v152, v152
    v_exp_f32 v153, v153
    v_exp_f32 v154, v154
    v_exp_f32 v155, v155
    v_add_f32 v244, v244, v152
    v_add_f32 v244, v244, v153
    v_cvt_pk_bf16_f32 v152, v152, v153
    v_exp_f32 v156, v156
    v_exp_f32 v157, v157
    v_add_f32 v244, v244, v154
    v_add_f32 v244, v244, v155
    v_cvt_pk_bf16_f32 v153, v154, v155
    v_exp_f32 v158, v158
    v_exp_f32 v159, v159
    v_add_f32 v244, v244, v156
    v_add_f32 v244, v244, v157
    v_cvt_pk_bf16_f32 v154, v156, v157
    v_exp_f32 v160, v160
    v_exp_f32 v161, v161
    v_add_f32 v244, v244, v158
    v_add_f32 v244, v244, v159
    v_cvt_pk_bf16_f32 v155, v158, v159
    v_exp_f32 v162, v162
    v_exp_f32 v163, v163
    v_add_f32 v244, v244, v160
    v_add_f32 v244, v244, v161
    v_cvt_pk_bf16_f32 v156, v160, v161
    v_exp_f32 v164, v164
    v_exp_f32 v165, v165
    v_add_f32 v244, v244, v162
    v_add_f32 v244, v244, v163
    v_cvt_pk_bf16_f32 v157, v162, v163
    v_exp_f32 v166, v166
    v_exp_f32 v167, v167
    v_add_f32 v244, v244, v164
    v_add_f32 v244, v244, v165
    v_cvt_pk_bf16_f32 v158, v164, v165
    v_add_f32 v244, v244, v166
    v_add_f32 v244, v244, v167
    v_cvt_pk_bf16_f32 v159, v166, v167
    v_mov_b32 v247, v245
    v_mov_b32 v248, v247
    s_nop 1
    v_permlane32_swap_b32 v247, v248
    v_add_f32 v247, v247, v248
    v_mov_b32 v248, v247
    s_nop 1
    v_permlane16_swap_b32 v247, v248
    v_add_f32 v247, v247, v248
    v_sub_f32 v246, 0, v204
    s_lshl_b32 s74, s68, 7
    v_add_u32 v249, s74, v5
    ds_write_b64 v249, v[246:247] offset:0
    s_waitcnt vmcnt(0)
    s_waitcnt lgkmcnt(0)
    s_barrier
    ds_read_b64 v[40:41], v5 offset:0
    ds_read_b64 v[42:43], v5 offset:128
    ds_read_b64 v[44:45], v5 offset:256
    ds_read_b64 v[46:47], v5 offset:384
    s_waitcnt lgkmcnt(1)
    v_max3_f32 v48, v40, v42, v44
    s_waitcnt lgkmcnt(0)
    v_max_f32 v48, v48, v46
    v_sub_f32 v40, v40, v48
    v_sub_f32 v42, v42, v48
    v_sub_f32 v44, v44, v48
    v_sub_f32 v46, v46, v48
    v_sub_f32 v250, v246, v48
    v_exp_f32 v40, v40
    v_exp_f32 v42, v42
    v_exp_f32 v44, v44
    v_exp_f32 v46, v46
    v_exp_f32 v250, v250
    v_mul_f32 v48, v40, v41
    v_fma_f32 v48, v42, v43, v48
    v_fma_f32 v48, v44, v45, v48
    v_fma_f32 v48, v46, v47, v48
    v_rcp_f32 v48, v48
    s_nop 0
    v_mul_f32 v250, v250, v48
    ds_read_b64_tr_b16 v[208:209], v238 offset:0
    ds_read_b64_tr_b16 v[210:211], v238 offset:1024
    ds_read_b64_tr_b16 v[212:213], v239 offset:0
    ds_read_b64_tr_b16 v[214:215], v239 offset:1024
    ds_read_b64_tr_b16 v[216:217], v238 offset:8192
    ds_read_b64_tr_b16 v[218:219], v238 offset:9216
    v_mfma_f32_32x32x16_bf16 v[168:183], v[220:223], v[28:31], v[168:183]
    ds_read_b64_tr_b16 v[220:221], v239 offset:8192
    ds_read_b64_tr_b16 v[222:223], v239 offset:9216
    v_mfma_f32_32x32x16_bf16 v[168:183], v[224:227], v[32:35], v[168:183]
    ds_read_b64_tr_b16 v[224:225], v238 offset:2048
    ds_read_b64_tr_b16 v[226:227], v238 offset:3072
    v_mfma_f32_32x32x16_bf16 v[168:183], v[228:231], v[36:39], v[168:183]
    ds_read_b64_tr_b16 v[228:229], v239 offset:2048
    ds_read_b64_tr_b16 v[230:231], v239 offset:3072
    s_nop 9
    v_max3_f32 v246, v168, v169, v170
    v_max3_f32 v246, v246, v171, v172
    v_max3_f32 v246, v246, v173, v174
    v_max3_f32 v246, v246, v175, v176
    v_max3_f32 v246, v246, v177, v178
    v_max3_f32 v246, v246, v179, v180
    v_max3_f32 v246, v246, v181, v182
    v_max_f32 v246, v246, v183
    v_cmp_lt_f32 vcc, 0x41000000, v246
    s_nop 1
    s_cbranch_vccnz L_slow_B17
L_back_B17:
    s_waitcnt lgkmcnt(10)
    v_mfma_f32_32x32x16_bf16 v[56:71], v[208:211], v[152:155], v[56:71]
    ds_read_b64_tr_b16 v[208:209], v238 offset:10240
    ds_read_b64_tr_b16 v[210:211], v238 offset:11264
    v_exp_f32 v168, v168
    v_exp_f32 v169, v169
    v_exp_f32 v170, v170
    s_waitcnt lgkmcnt(10)
    v_mfma_f32_32x32x16_bf16 v[72:87], v[212:215], v[152:155], v[72:87]
    ds_read_b64_tr_b16 v[212:213], v239 offset:10240
    ds_read_b64_tr_b16 v[214:215], v239 offset:11264
    v_exp_f32 v171, v171
    v_add_f32 v244, v244, v168
    v_add_f32 v244, v244, v169
    v_cvt_pk_bf16_f32 v168, v168, v169
    v_exp_f32 v172, v172
    s_waitcnt lgkmcnt(10)
    v_mfma_f32_32x32x16_bf16 v[88:103], v[216:219], v[152:155], v[88:103]
    ds_read_b64_tr_b16 v[216:217], v240 offset:0
    ds_read_b64_tr_b16 v[218:219], v240 offset:32
    v_exp_f32 v173, v173
    v_add_f32 v244, v244, v170
    v_add_f32 v244, v244, v171
    v_cvt_pk_bf16_f32 v169, v170, v171
    v_exp_f32 v174, v174
    s_waitcnt lgkmcnt(10)
    v_mfma_f32_32x32x16_bf16 v[104:119], v[220:223], v[152:155], v[104:119]
    ds_read_b64_tr_b16 v[220:221], v241 offset:0
    ds_read_b64_tr_b16 v[222:223], v241 offset:32
    v_exp_f32 v175, v175
    v_add_f32 v244, v244, v172
    v_add_f32 v244, v244, v173
    v_cvt_pk_bf16_f32 v170, v172, v173
    v_exp_f32 v176, v176
    s_waitcnt lgkmcnt(10)
    v_mfma_f32_32x32x16_bf16 v[56:71], v[224:227], v[156:159], v[56:71]
    ds_read_b64_tr_b16 v[224:225], v240 offset:8192
    ds_read_b64_tr_b16 v[226:227], v240 offset:8224
    v_exp_f32 v177, v177
    v_add_f32 v244, v244, v174
    v_add_f32 v244, v244, v175
    v_cvt_pk_bf16_f32 v171, v174, v175
    v_exp_f32 v178, v178
    s_waitcnt lgkmcnt(10)
    v_mfma_f32_32x32x16_bf16 v[72:87], v[228:231], v[156:159], v[72:87]
    ds_read_b64_tr_b16 v[228:229], v241 offset:8192
    ds_read_b64_tr_b16 v[230:231], v241 offset:8224
    v_exp_f32 v179, v179
    v_add_f32 v244, v244, v176
    v_add_f32 v244, v244, v177
    v_cvt_pk_bf16_f32 v172, v176, v177
    v_exp_f32 v180, v180
    s_waitcnt lgkmcnt(10)
    v_mfma_f32_32x32x16_bf16 v[88:103], v[208:211], v[156:159], v[88:103]
    ds_read_b64_tr_b16 v[208:209], v238 offset:4096
    ds_read_b64_tr_b16 v[210:211], v238 offset:5120
    v_exp_f32 v181, v181
    v_add_f32 v244, v244, v178
    v_add_f32 v244, v244, v179
    v_cvt_pk_bf16_f32 v173, v178, v179
    v_exp_f32 v182, v182
    s_waitcnt lgkmcnt(10)
    v_mfma_f32_32x32x16_bf16 v[104:119], v[212:215], v[156:159], v[104:119]
    ds_read_b64_tr_b16 v[212:213], v239 offset:4096
    ds_read_b64_tr_b16 v[214:215], v239 offset:5120
    v_exp_f32 v183, v183
    v_add_f32 v244, v244, v180
    v_add_f32 v244, v244, v181
    v_cvt_pk_bf16_f32 v174, v180, v181
    v_add_f32 v244, v244, v182
    s_waitcnt lgkmcnt(11)
    v_mfma_f32_16x16x16_bf16 v[120:123], v[216:217], v[184:185], v[120:123]
    s_waitcnt lgkmcnt(10)
    v_mfma_f32_16x16x16_bf16 v[124:127], v[218:219], v[184:185], v[124:127]
    ds_read_b64_tr_b16 v[216:217], v238 offset:12288
    ds_read_b64_tr_b16 v[218:219], v238 offset:13312
    v_add_f32 v244, v244, v183
    v_cvt_pk_bf16_f32 v175, v182, v183
    s_waitcnt lgkmcnt(11)
    v_mfma_f32_16x16x16_bf16 v[128:131], v[220:221], v[184:185], v[128:131]
    s_waitcnt lgkmcnt(10)
    v_mfma_f32_16x16x16_bf16 v[132:135], v[222:223], v[184:185], v[132:135]
    ds_read_b64_tr_b16 v[220:221], v239 offset:12288
    ds_read_b64_tr_b16 v[222:223], v239 offset:13312
    s_waitcnt lgkmcnt(11)
    v_mfma_f32_16x16x16_bf16 v[136:139], v[224:225], v[184:185], v[136:139]
    s_waitcnt lgkmcnt(10)
    v_mfma_f32_16x16x16_bf16 v[140:143], v[226:227], v[184:185], v[140:143]
    ds_read_b64_tr_b16 v[224:225], v238 offset:6144
    ds_read_b64_tr_b16 v[226:227], v238 offset:7168
    s_waitcnt lgkmcnt(11)
    v_mfma_f32_16x16x16_bf16 v[144:147], v[228:229], v[184:185], v[144:147]
    s_waitcnt lgkmcnt(10)
    v_mfma_f32_16x16x16_bf16 v[148:151], v[230:231], v[184:185], v[148:151]
    ds_read_b64_tr_b16 v[228:229], v239 offset:6144
    ds_read_b64_tr_b16 v[230:231], v239 offset:7168
    s_waitcnt lgkmcnt(10)
    v_mfma_f32_32x32x16_bf16 v[56:71], v[208:211], v[168:171], v[56:71]
    ds_read_b64_tr_b16 v[208:209], v238 offset:14336
    ds_read_b64_tr_b16 v[210:211], v238 offset:15360
    s_waitcnt lgkmcnt(10)
    v_mfma_f32_32x32x16_bf16 v[72:87], v[212:215], v[168:171], v[72:87]
    ds_read_b64_tr_b16 v[212:213], v239 offset:14336
    ds_read_b64_tr_b16 v[214:215], v239 offset:15360
    s_waitcnt lgkmcnt(10)
    v_mfma_f32_32x32x16_bf16 v[88:103], v[216:219], v[168:171], v[88:103]
    s_waitcnt lgkmcnt(8)
    v_mfma_f32_32x32x16_bf16 v[104:119], v[220:223], v[168:171], v[104:119]
    s_waitcnt lgkmcnt(6)
    v_mfma_f32_32x32x16_bf16 v[56:71], v[224:227], v[172:175], v[56:71]
    s_waitcnt lgkmcnt(4)
    v_mfma_f32_32x32x16_bf16 v[72:87], v[228:231], v[172:175], v[72:87]
    s_waitcnt lgkmcnt(2)
    v_mfma_f32_32x32x16_bf16 v[88:103], v[208:211], v[172:175], v[88:103]
    s_waitcnt lgkmcnt(0)
    v_mfma_f32_32x32x16_bf16 v[104:119], v[212:215], v[172:175], v[104:119]
    v_mov_b32 v248, v244
    s_nop 1
    v_permlane32_swap_b32 v244, v248
    v_add_f32 v244, v244, v248
    v_rcp_f32 v244, v244
    v_mul_f32 v120, v120, v250
    v_mul_f32 v121, v121, v250
    v_mul_f32 v122, v122, v250
    v_mul_f32 v123, v123, v250
    v_mul_f32 v124, v124, v250
    v_mul_f32 v125, v125, v250
    v_mul_f32 v126, v126, v250
    v_mul_f32 v127, v127, v250
    v_mul_f32 v128, v128, v250
    v_mul_f32 v129, v129, v250
    v_mul_f32 v130, v130, v250
    v_mul_f32 v131, v131, v250
    v_mul_f32 v132, v132, v250
    v_mul_f32 v133, v133, v250
    v_mul_f32 v134, v134, v250
    v_mul_f32 v135, v135, v250
    v_mul_f32 v136, v136, v250
    v_mul_f32 v137, v137, v250
    v_mul_f32 v138, v138, v250
    v_mul_f32 v139, v139, v250
    v_mul_f32 v140, v140, v250
    v_mul_f32 v141, v141, v250
    v_mul_f32 v142, v142, v250
    v_mul_f32 v143, v143, v250
    v_mul_f32 v144, v144, v250
    v_mul_f32 v145, v145, v250
    v_mul_f32 v146, v146, v250
    v_mul_f32 v147, v147, v250
    v_mul_f32 v148, v148, v250
    v_mul_f32 v149, v149, v250
    v_mul_f32 v150, v150, v250
    v_mul_f32 v151, v151, v250
    s_cmp_lt_u32 s77, 16
    s_cselect_b32 s60, s24, s34
    s_cselect_b32 s61, s25, s35
    s_mov_b32 s62, 4194304
    s_mov_b32 s63, 0x00020000
    s_lshr_b32 s74, s76, 2
    s_lshl_b32 s74, s74, 19
    s_and_b32 s75, s77, 15
    s_lshl_b32 s75, s75, 15
    s_add_u32 s74, s74, s75
    s_lshl_b32 s75, s87, 12
    s_add_u32 s74, s74, s75
    buffer_load_dwordx4 v[8:11], v1, s[60:63], s74 offen offset:0
    buffer_load_dwordx4 v[12:15], v1, s[60:63], s74 offen offset:1024
    buffer_load_dwordx4 v[16:19], v1, s[60:63], s74 offen offset:2048
    buffer_load_dwordx4 v[20:23], v1, s[60:63], s74 offen offset:3072
    s_barrier
    ds_write_b128 v251, v[120:123] offset:0
    ds_write_b128 v251, v[124:127] offset:1024
    ds_write_b128 v251, v[128:131] offset:2048
    ds_write_b128 v251, v[132:135] offset:3072
    ds_write_b128 v251, v[136:139] offset:4096
    ds_write_b128 v251, v[140:143] offset:5120
    ds_write_b128 v251, v[144:147] offset:6144
    ds_write_b128 v251, v[148:151] offset:7168
    v_mul_f32 v56, v56, v244
    v_mul_f32 v57, v57, v244
    v_mul_f32 v58, v58, v244
    v_mul_f32 v59, v59, v244
    v_mul_f32 v60, v60, v244
    v_mul_f32 v61, v61, v244
    v_mul_f32 v62, v62, v244
    v_mul_f32 v63, v63, v244
    v_mul_f32 v64, v64, v244
    v_mul_f32 v65, v65, v244
    v_mul_f32 v66, v66, v244
    v_mul_f32 v67, v67, v244
    v_mul_f32 v68, v68, v244
    v_mul_f32 v69, v69, v244
    v_mul_f32 v70, v70, v244
    v_mul_f32 v71, v71, v244
    v_cvt_pk_bf16_f32 v152, v56, v57
    v_cvt_pk_bf16_f32 v153, v58, v59
    v_cvt_pk_bf16_f32 v154, v60, v61
    v_cvt_pk_bf16_f32 v155, v62, v63
    v_cvt_pk_bf16_f32 v156, v64, v65
    v_cvt_pk_bf16_f32 v157, v66, v67
    v_cvt_pk_bf16_f32 v158, v68, v69
    v_cvt_pk_bf16_f32 v159, v70, v71
    v_mul_f32 v72, v72, v244
    v_mul_f32 v73, v73, v244
    v_mul_f32 v74, v74, v244
    v_mul_f32 v75, v75, v244
    v_mul_f32 v76, v76, v244
    v_mul_f32 v77, v77, v244
    v_mul_f32 v78, v78, v244
    v_mul_f32 v79, v79, v244
    v_mul_f32 v80, v80, v244
    v_mul_f32 v81, v81, v244
    v_mul_f32 v82, v82, v244
    v_mul_f32 v83, v83, v244
    v_mul_f32 v84, v84, v244
    v_mul_f32 v85, v85, v244
    v_mul_f32 v86, v86, v244
    v_mul_f32 v87, v87, v244
    v_cvt_pk_bf16_f32 v160, v72, v73
    v_cvt_pk_bf16_f32 v161, v74, v75
    v_cvt_pk_bf16_f32 v162, v76, v77
    v_cvt_pk_bf16_f32 v163, v78, v79
    v_cvt_pk_bf16_f32 v164, v80, v81
    v_cvt_pk_bf16_f32 v165, v82, v83
    v_cvt_pk_bf16_f32 v166, v84, v85
    v_cvt_pk_bf16_f32 v167, v86, v87
    v_mul_f32 v88, v88, v244
    v_mul_f32 v89, v89, v244
    v_mul_f32 v90, v90, v244
    v_mul_f32 v91, v91, v244
    v_mul_f32 v92, v92, v244
    v_mul_f32 v93, v93, v244
    v_mul_f32 v94, v94, v244
    v_mul_f32 v95, v95, v244
    v_mul_f32 v96, v96, v244
    v_mul_f32 v97, v97, v244
    v_mul_f32 v98, v98, v244
    v_mul_f32 v99, v99, v244
    v_mul_f32 v100, v100, v244
    v_mul_f32 v101, v101, v244
    v_mul_f32 v102, v102, v244
    v_mul_f32 v103, v103, v244
    v_cvt_pk_bf16_f32 v168, v88, v89
    v_cvt_pk_bf16_f32 v169, v90, v91
    v_cvt_pk_bf16_f32 v170, v92, v93
    v_cvt_pk_bf16_f32 v171, v94, v95
    v_cvt_pk_bf16_f32 v172, v96, v97
    v_cvt_pk_bf16_f32 v173, v98, v99
    v_cvt_pk_bf16_f32 v174, v100, v101
    v_cvt_pk_bf16_f32 v175, v102, v103
    v_mul_f32 v104, v104, v244
    v_mul_f32 v105, v105, v244
    v_mul_f32 v106, v106, v244
    v_mul_f32 v107, v107, v244
    v_mul_f32 v108, v108, v244
    v_mul_f32 v109, v109, v244
    v_mul_f32 v110, v110, v244
    v_mul_f32 v111, v111, v244
    v_mul_f32 v112, v112, v244
    v_mul_f32 v113, v113, v244
    v_mul_f32 v114, v114, v244
    v_mul_f32 v115, v115, v244
    v_mul_f32 v116, v116, v244
    v_mul_f32 v117, v117, v244
    v_mul_f32 v118, v118, v244
    v_mul_f32 v119, v119, v244
    v_cvt_pk_bf16_f32 v176, v104, v105
    v_cvt_pk_bf16_f32 v177, v106, v107
    v_cvt_pk_bf16_f32 v178, v108, v109
    v_cvt_pk_bf16_f32 v179, v110, v111
    v_cvt_pk_bf16_f32 v180, v112, v113
    v_cvt_pk_bf16_f32 v181, v114, v115
    v_cvt_pk_bf16_f32 v182, v116, v117
    v_cvt_pk_bf16_f32 v183, v118, v119
    s_lshl_b32 s86, s2, 13
    s_add_u32 s86, s86, s88
    s_add_u32 s86, s86, 67108864
    buffer_load_dwordx4 v[40:43], v1, s[64:67], s86 offen offset:0
    s_waitcnt lgkmcnt(0)
    s_barrier
    ds_read_b128 v[56:59], v4 offset:0
    ds_read_b128 v[60:63], v4 offset:256
    ds_read_b128 v[64:67], v4 offset:8192
    ds_read_b128 v[68:71], v4 offset:8448
    ds_read_b128 v[72:75], v4 offset:16384
    ds_read_b128 v[76:79], v4 offset:16640
    ds_read_b128 v[80:83], v4 offset:24576
    ds_read_b128 v[84:87], v4 offset:24832
    s_waitcnt lgkmcnt(5)
    v_add_f32 v56, v56, v64
    s_waitcnt lgkmcnt(1)
    v_add_f32 v72, v72, v80
    v_add_f32 v57, v57, v65
    v_add_f32 v73, v73, v81
    v_add_f32 v58, v58, v66
    v_add_f32 v74, v74, v82
    v_add_f32 v59, v59, v67
    v_add_f32 v75, v75, v83
    v_add_f32 v60, v60, v68
    s_waitcnt lgkmcnt(0)
    v_add_f32 v76, v76, v84
    v_add_f32 v61, v61, v69
    v_add_f32 v77, v77, v85
    v_add_f32 v62, v62, v70
    v_add_f32 v78, v78, v86
    v_add_f32 v63, v63, v71
    v_add_f32 v79, v79, v87
    v_add_f32 v56, v56, v72
    v_add_f32 v57, v57, v73
    v_add_f32 v58, v58, v74
    v_add_f32 v59, v59, v75
    v_add_f32 v60, v60, v76
    v_add_f32 v61, v61, v77
    v_add_f32 v62, v62, v78
    v_add_f32 v63, v63, v79
    v_cvt_pk_bf16_f32 v208, v56, v57
    v_cvt_pk_bf16_f32 v209, v58, v59
    v_cvt_pk_bf16_f32 v210, v60, v61
    v_cvt_pk_bf16_f32 v211, v62, v63
    s_cmp_eq_u32 s79, 1
    s_cbranch_scc1 L_nolead1
    s_barrier
L_nolead1:
    s_cmp_lt_u32 s77, 16
    s_cselect_b32 s60, s24, s34
    s_cselect_b32 s61, s25, s35
    s_mov_b32 s62, 4194304
    s_mov_b32 s63, 0x00020000
    s_sub_u32 s12, 81920, s85
    s_lshl_b32 s74, s79, 9
    s_lshl_b32 s8, s76, 17
    s_add_u32 s8, s8, s74
    s_add_u32 s9, s8, 262144
    s_xor_b32 s10, s76, 1
    s_lshl_b32 s10, s10, 17
    s_add_u32 s10, s10, s74
    s_add_u32 s11, s10, 262144
    s_lshr_b32 s75, s76, 2
    s_lshl_b32 s74, s77, 3
    s_add_u32 s75, s75, s74
    s_mul_i32 s75, s75, 160
    s_mul_i32 s74, s79, 20
    s_add_u32 s75, s75, s74
    s_lshl_b32 s75, s75, 10
    s_lshl_b32 s74, s68, 12
    s_add_u32 s13, s75, s74
    s_add_u32 s14, s75, s69
    s_add_u32 s14, s14, 16384
    s_barrier
    v_subrev_u32 v249, 49152, v3
    ds_write_b128 v249, v[152:155] offset:0
    ds_write_b128 v249, v[156:159] offset:1024
    ds_write_b128 v249, v[160:163] offset:2048
    ds_write_b128 v249, v[164:167] offset:3072
    ds_write_b128 v249, v[168:171] offset:4096
    ds_write_b128 v249, v[172:175] offset:5120
    ds_write_b128 v249, v[176:179] offset:6144
    ds_write_b128 v249, v[180:183] offset:7168
    v_add_u32 v248, s89, v1
    s_waitcnt vmcnt(0)
    ds_write_b128 v248, v[40:43] offset:32768
    ds_write_b128 v248, v[208:211] offset:36864
    ds_read_b128 v[8:11], v3 offset:0
    ds_read_b128 v[12:15], v3 offset:1024
    ds_read_b128 v[16:19], v3 offset:2048
    ds_read_b128 v[20:23], v3 offset:3072
    ds_read_b128 v[24:27], v3 offset:4096
    ds_read_b128 v[28:31], v3 offset:5120
    ds_read_b128 v[32:35], v3 offset:6144
    ds_read_b128 v[36:39], v3 offset:7168
    s_sub_u32 s96, s12, s85
    v_add_u32 v247, s96, v3
    v_add_u32 v246, s96, v249
    ds_read_b128 v[56:59], v247 offset:0
    ds_read_b128 v[60:63], v247 offset:1024
    ds_read_b128 v[64:67], v247 offset:2048
    ds_read_b128 v[68:71], v247 offset:3072
    ds_read_b128 v[72:75], v247 offset:4096
    ds_read_b128 v[76:79], v247 offset:5120
    ds_read_b128 v[80:83], v247 offset:6144
    ds_read_b128 v[84:87], v247 offset:7168
    v_bfe_u32 v120, v252, 3, 3
    v_bfe_u32 v121, v252, 0, 3
    v_bfe_u32 v122, v252, 4, 1
    v_lshlrev_b32 v122, 2, v122
    v_xor_b32 v121, v121, v122
    v_lshlrev_b32 v121, 4, v121
    v_lshl_add_u32 v121, v120, 10, v121
    s_lshl_b32 s74, s68, 13
    v_add_u32 v242, s74, v121
    v_bfe_u32 v120, v252, 5, 1
    v_lshlrev_b32 v120, 9, v120
    v_add_u32 v244, v120, v238
    v_xor_b32 v245, 64, v244
    v_bfe_u32 v120, v252, 3, 1
    v_lshlrev_b32 v120, 6, v120
    s_lshl_b32 s74, s68, 5
    v_xor_b32 v120, s74, v120
    v_bfe_u32 v121, v252, 1, 1
    v_lshl_add_u32 v120, v121, 4, v120
    v_bfe_u32 v121, v252, 0, 1
    v_lshl_add_u32 v120, v121, 3, v120
    v_bfe_u32 v121, v252, 2, 2
    v_lshl_add_u32 v120, v121, 7, v120
    v_lshl_add_u32 v120, v254, 10, v120
    v_add_u32 v250, s85, v120
    v_bfe_u32 v120, v252, 5, 1
    v_lshlrev_b32 v120, 9, v120
    v_lshl_add_u32 v120, v253, 4, v120
    v_bfe_u32 v121, v252, 4, 1
    v_lshl_add_u32 v2, v121, 3, v120
    v_add_u32 v240, s85, v1
    v_add_u32 v241, s12, v1
    s_waitcnt lgkmcnt(0)
    s_barrier
    s_mov_b32 s95, s8
    s_add_u32 m0, s89, 49152
    s_nop 0
    buffer_load_dwordx4 v242, s[60:63], s95 offen offset:0 lds
    s_add_u32 s95, s8, 32768
    s_add_u32 m0, s89, 53248
    s_nop 0
    buffer_load_dwordx4 v242, s[60:63], s95 offen offset:0 lds
    s_add_u32 s95, s8, 65536
    s_add_u32 m0, s89, 57344
    s_nop 0
    buffer_load_dwordx4 v242, s[60:63], s95 offen offset:0 lds
    s_add_u32 s95, s8, 98304
    s_add_u32 m0, s89, 61440
    s_nop 0
    buffer_load_dwordx4 v242, s[60:63], s95 offen offset:0 lds
    s_mov_b32 s95, s9
    s_add_u32 m0, s89, 65536
    s_nop 0
    buffer_load_dwordx4 v242, s[60:63], s95 offen offset:0 lds
    s_add_u32 s95, s9, 32768
    s_add_u32 m0, s89, 69632
    s_nop 0
    buffer_load_dwordx4 v242, s[60:63], s95 offen offset:0 lds
    s_add_u32 s95, s9, 65536
    s_add_u32 m0, s89, 73728
    s_nop 0
    buffer_load_dwordx4 v242, s[60:63], s95 offen offset:0 lds
    s_add_u32 s95, s9, 98304
    s_add_u32 m0, s89, 77824
    s_nop 0
    buffer_load_dwordx4 v242, s[60:63], s95 offen offset:0 lds
    ds_read_b128 v[88:91], v246 offset:0
    ds_read_b128 v[92:95], v246 offset:1024
    ds_read_b128 v[96:99], v246 offset:2048
    ds_read_b128 v[100:103], v246 offset:3072
    ds_read_b128 v[104:107], v246 offset:4096
    ds_read_b128 v[108:111], v246 offset:5120
    ds_read_b128 v[112:115], v246 offset:6144
    ds_read_b128 v[116:119], v246 offset:7168
    v_add_u32 v246, 0x8000, v244
    v_add_u32 v247, 0x8000, v245
    v_add_u32 v248, 0x8000, v250
    s_waitcnt vmcnt(4)
    s_waitcnt lgkmcnt(0)
    s_barrier
    ds_read_b64_tr_b16 v[40:41], v244 offset:49152
    ds_read_b64_tr_b16 v[42:43], v244 offset:49664
    ds_read_b64_tr_b16 v[44:45], v245 offset:49152
    ds_read_b64_tr_b16 v[46:47], v245 offset:49664
    ds_read_b64_tr_b16 v[48:49], v244 offset:51200
    ds_read_b64_tr_b16 v[50:51], v244 offset:51712
    ds_read_b64_tr_b16 v[224:225], v245 offset:51200
    ds_read_b64_tr_b16 v[226:227], v245 offset:51712
    ds_read_b64_tr_b16 v[228:229], v250 offset:49152
    ds_read_b64_tr_b16 v[230:231], v250 offset:49664
    ds_read_b64_tr_b16 v[232:233], v244 offset:53248
    ds_read_b64_tr_b16 v[234:235], v244 offset:53760
    s_waitcnt lgkmcnt(10)
    v_mfma_f32_32x32x16_bf16 v[120:135], v[40:43], v[8:11], 0
    ds_read_b64_tr_b16 v[40:41], v245 offset:53248
    ds_read_b64_tr_b16 v[42:43], v245 offset:53760
    s_mov_b32 s95, s10
    s_mov_b32 m0, s89
    s_nop 0
    buffer_load_dwordx4 v242, s[60:63], s95 offen offset:0 lds
    ds_read_b128 v[52:55], v240 offset:32768
    s_waitcnt lgkmcnt(11)
    v_mfma_f32_32x32x16_bf16 v[136:151], v[44:47], v[8:11], 0
    ds_read_b64_tr_b16 v[44:45], v244 offset:55296
    ds_read_b64_tr_b16 v[46:47], v244 offset:55808
    s_waitcnt lgkmcnt(11)
    v_mfma_f32_32x32x16_bf16 v[120:135], v[48:51], v[12:15], v[120:135]
    ds_read_b64_tr_b16 v[48:49], v245 offset:55296
    ds_read_b64_tr_b16 v[50:51], v245 offset:55808
    s_add_u32 s95, s10, 32768
    s_add_u32 m0, s89, 4096
    s_nop 0
    buffer_load_dwordx4 v242, s[60:63], s95 offen offset:0 lds
    s_waitcnt lgkmcnt(11)
    v_mfma_f32_32x32x16_bf16 v[136:151], v[224:227], v[12:15], v[136:151]
    ds_read_b64_tr_b16 v[224:225], v250 offset:53248
    ds_read_b64_tr_b16 v[226:227], v250 offset:53760
    s_waitcnt lgkmcnt(6)
    v_mfma_f32_16x16x32_bf16 v[216:219], v[228:231], v[52:55], 0
    ds_read_b64_tr_b16 v[228:229], v244 offset:57344
    ds_read_b64_tr_b16 v[230:231], v244 offset:57856
    v_mfma_f32_32x32x16_bf16 v[120:135], v[232:235], v[16:19], v[120:135]
    ds_read_b64_tr_b16 v[232:233], v245 offset:57344
    ds_read_b64_tr_b16 v[234:235], v245 offset:57856
    s_add_u32 s95, s10, 65536
    s_add_u32 m0, s89, 8192
    s_nop 0
    buffer_load_dwordx4 v242, s[60:63], s95 offen offset:0 lds
    ds_read_b128 v[236:239], v240 offset:33792
    v_mfma_f32_32x32x16_bf16 v[136:151], v[40:43], v[16:19], v[136:151]
    ds_read_b64_tr_b16 v[40:41], v244 offset:59392
    ds_read_b64_tr_b16 v[42:43], v244 offset:59904
    s_waitcnt lgkmcnt(11)
    v_mfma_f32_32x32x16_bf16 v[120:135], v[44:47], v[20:23], v[120:135]
    ds_read_b64_tr_b16 v[44:45], v245 offset:59392
    ds_read_b64_tr_b16 v[46:47], v245 offset:59904
    s_add_u32 s95, s10, 98304
    s_add_u32 m0, s89, 12288
    s_nop 0
    buffer_load_dwordx4 v242, s[60:63], s95 offen offset:0 lds
    s_waitcnt lgkmcnt(11)
    v_mfma_f32_32x32x16_bf16 v[136:151], v[48:51], v[20:23], v[136:151]
    ds_read_b64_tr_b16 v[48:49], v250 offset:57344
    ds_read_b64_tr_b16 v[50:51], v250 offset:57856
    s_waitcnt lgkmcnt(6)
    v_mfma_f32_16x16x32_bf16 v[216:219], v[224:227], v[236:239], v[216:219]
    ds_read_b64_tr_b16 v[224:225], v244 offset:61440
    ds_read_b64_tr_b16 v[226:227], v244 offset:61952
    v_mfma_f32_32x32x16_bf16 v[120:135], v[228:231], v[24:27], v[120:135]
    ds_read_b64_tr_b16 v[228:229], v245 offset:61440
    ds_read_b64_tr_b16 v[230:231], v245 offset:61952
    s_mov_b32 s95, s11
    s_add_u32 m0, s89, 16384
    s_nop 0
    buffer_load_dwordx4 v242, s[60:63], s95 offen offset:0 lds
    ds_read_b128 v[52:55], v240 offset:34816
    v_mfma_f32_32x32x16_bf16 v[136:151], v[232:235], v[24:27], v[136:151]
    ds_read_b64_tr_b16 v[232:233], v244 offset:63488
    ds_read_b64_tr_b16 v[234:235], v244 offset:64000
    s_waitcnt lgkmcnt(11)
    v_mfma_f32_32x32x16_bf16 v[120:135], v[40:43], v[28:31], v[120:135]
    ds_read_b64_tr_b16 v[40:41], v245 offset:63488
    ds_read_b64_tr_b16 v[42:43], v245 offset:64000
    s_add_u32 s95, s11, 32768
    s_add_u32 m0, s89, 20480
    s_nop 0
    buffer_load_dwordx4 v242, s[60:63], s95 offen offset:0 lds
    s_waitcnt lgkmcnt(11)
    v_mfma_f32_32x32x16_bf16 v[136:151], v[44:47], v[28:31], v[136:151]
    ds_read_b64_tr_b16 v[44:45], v250 offset:61440
    ds_read_b64_tr_b16 v[46:47], v250 offset:61952
    s_waitcnt lgkmcnt(6)
    v_mfma_f32_16x16x32_bf16 v[216:219], v[48:51], v[52:55], v[216:219]
    v_mfma_f32_32x32x16_bf16 v[120:135], v[224:227], v[32:35], v[120:135]
    s_add_u32 s95, s11, 65536
    s_add_u32 m0, s89, 24576
    s_nop 0
    buffer_load_dwordx4 v242, s[60:63], s95 offen offset:0 lds
    ds_read_b128 v[236:239], v240 offset:35840
    v_mfma_f32_32x32x16_bf16 v[136:151], v[228:231], v[32:35], v[136:151]
    s_waitcnt lgkmcnt(5)
    v_mfma_f32_32x32x16_bf16 v[120:135], v[232:235], v[36:39], v[120:135]
    s_add_u32 s95, s11, 98304
    s_add_u32 m0, s89, 28672
    s_nop 0
    buffer_load_dwordx4 v242, s[60:63], s95 offen offset:0 lds
    s_waitcnt vmcnt(8)
    s_waitcnt lgkmcnt(0)
    s_barrier
    ds_read_b64_tr_b16 v[48:49], v246 offset:32768
    ds_read_b64_tr_b16 v[50:51], v246 offset:33280
    ds_read_b64_tr_b16 v[224:225], v247 offset:32768
    ds_read_b64_tr_b16 v[226:227], v247 offset:33280
    ds_read_b64_tr_b16 v[228:229], v246 offset:34816
    ds_read_b64_tr_b16 v[230:231], v246 offset:35328
    ds_read_b64_tr_b16 v[232:233], v247 offset:34816
    ds_read_b64_tr_b16 v[234:235], v247 offset:35328
    s_add_u32 s95, s8, 128
    s_add_u32 m0, s89, 49152
    s_nop 0
    buffer_load_dwordx4 v242, s[60:63], s95 offen offset:0 lds
    v_mfma_f32_32x32x16_bf16 v[136:151], v[40:43], v[36:39], v[136:151]
    ds_read_b64_tr_b16 v[40:41], v248 offset:32768
    ds_read_b64_tr_b16 v[42:43], v248 offset:33280
    v_mfma_f32_16x16x32_bf16 v[216:219], v[44:47], v[236:239], v[216:219]
    ds_read_b64_tr_b16 v[44:45], v246 offset:36864
    ds_read_b64_tr_b16 v[46:47], v246 offset:37376
    s_waitcnt lgkmcnt(10)
    v_mfma_f32_32x32x16_bf16 v[120:135], v[48:51], v[152:155], v[120:135]
    ds_read_b64_tr_b16 v[48:49], v247 offset:36864
    ds_read_b64_tr_b16 v[50:51], v247 offset:37376
    s_add_u32 s95, s8, 32896
    s_add_u32 m0, s89, 53248
    s_nop 0
    buffer_load_dwordx4 v242, s[60:63], s95 offen offset:0 lds
    ds_read_b128 v[52:55], v240 offset:36864
    s_waitcnt lgkmcnt(11)
    v_mfma_f32_32x32x16_bf16 v[136:151], v[224:227], v[152:155], v[136:151]
    ds_read_b64_tr_b16 v[224:225], v246 offset:38912
    ds_read_b64_tr_b16 v[226:227], v246 offset:39424
    s_waitcnt lgkmcnt(11)
    v_mfma_f32_32x32x16_bf16 v[120:135], v[228:231], v[156:159], v[120:135]
    ds_read_b64_tr_b16 v[228:229], v247 offset:38912
    ds_read_b64_tr_b16 v[230:231], v247 offset:39424
    s_add_u32 s95, s8, 65664
    s_add_u32 m0, s89, 57344
    s_nop 0
    buffer_load_dwordx4 v242, s[60:63], s95 offen offset:0 lds
    s_waitcnt lgkmcnt(11)
    v_mfma_f32_32x32x16_bf16 v[136:151], v[232:235], v[156:159], v[136:151]
    ds_read_b64_tr_b16 v[232:233], v248 offset:36864
    ds_read_b64_tr_b16 v[234:235], v248 offset:37376
    s_waitcnt lgkmcnt(6)
    v_mfma_f32_16x16x32_bf16 v[216:219], v[40:43], v[52:55], v[216:219]
    ds_read_b64_tr_b16 v[40:41], v246 offset:40960
    ds_read_b64_tr_b16 v[42:43], v246 offset:41472
    v_mfma_f32_32x32x16_bf16 v[120:135], v[44:47], v[160:163], v[120:135]
    ds_read_b64_tr_b16 v[44:45], v247 offset:40960
    ds_read_b64_tr_b16 v[46:47], v247 offset:41472
    s_add_u32 s95, s8, 98432
    s_add_u32 m0, s89, 61440
    s_nop 0
    buffer_load_dwordx4 v242, s[60:63], s95 offen offset:0 lds
    ds_read_b128 v[236:239], v240 offset:37888
    v_mfma_f32_32x32x16_bf16 v[136:151], v[48:51], v[160:163], v[136:151]
    ds_read_b64_tr_b16 v[48:49], v246 offset:43008
    ds_read_b64_tr_b16 v[50:51], v246 offset:43520
    s_waitcnt lgkmcnt(11)
    v_mfma_f32_32x32x16_bf16 v[120:135], v[224:227], v[164:167], v[120:135]
    ds_read_b64_tr_b16 v[224:225], v247 offset:43008
    ds_read_b64_tr_b16 v[226:227], v247 offset:43520
    s_waitcnt lgkmcnt(11)
    v_mfma_f32_32x32x16_bf16 v[136:151], v[228:231], v[164:167], v[136:151]
    ds_read_b64_tr_b16 v[228:229], v248 offset:40960
    ds_read_b64_tr_b16 v[230:231], v248 offset:41472
    s_waitcnt lgkmcnt(6)
    v_mfma_f32_16x16x32_bf16 v[216:219], v[232:235], v[236:239], v[216:219]
    ds_read_b64_tr_b16 v[232:233], v246 offset:45056
    ds_read_b64_tr_b16 v[234:235], v246 offset:45568
    v_mfma_f32_32x32x16_bf16 v[120:135], v[40:43], v[168:171], v[120:135]
    ds_read_b64_tr_b16 v[40:41], v247 offset:45056
    ds_read_b64_tr_b16 v[42:43], v247 offset:45568
    ds_read_b128 v[52:55], v240 offset:38912
    v_mfma_f32_32x32x16_bf16 v[136:151], v[44:47], v[168:171], v[136:151]
    ds_read_b64_tr_b16 v[44:45], v246 offset:47104
    ds_read_b64_tr_b16 v[46:47], v246 offset:47616
    s_waitcnt lgkmcnt(11)
    v_mfma_f32_32x32x16_bf16 v[120:135], v[48:51], v[172:175], v[120:135]
    ds_read_b64_tr_b16 v[48:49], v247 offset:47104
    ds_read_b64_tr_b16 v[50:51], v247 offset:47616
    s_waitcnt lgkmcnt(11)
    v_mfma_f32_32x32x16_bf16 v[136:151], v[224:227], v[172:175], v[136:151]
    ds_read_b64_tr_b16 v[224:225], v248 offset:45056
    ds_read_b64_tr_b16 v[226:227], v248 offset:45568
    s_waitcnt lgkmcnt(6)
    v_mfma_f32_16x16x32_bf16 v[216:219], v[228:231], v[52:55], v[216:219]
    v_mfma_f32_32x32x16_bf16 v[120:135], v[232:235], v[176:179], v[120:135]
    ds_read_b128 v[236:239], v240 offset:39936
    v_mfma_f32_32x32x16_bf16 v[136:151], v[40:43], v[176:179], v[136:151]
    s_waitcnt lgkmcnt(5)
    v_mfma_f32_32x32x16_bf16 v[120:135], v[44:47], v[180:183], v[120:135]
    s_waitcnt vmcnt(8)
    s_waitcnt lgkmcnt(0)
    s_barrier
    ds_read_b64_tr_b16 v[228:229], v244 offset:0
    ds_read_b64_tr_b16 v[230:231], v244 offset:512
    ds_read_b64_tr_b16 v[232:233], v245 offset:0
    ds_read_b64_tr_b16 v[234:235], v245 offset:512
    ds_read_b64_tr_b16 v[40:41], v244 offset:2048
    ds_read_b64_tr_b16 v[42:43], v244 offset:2560
    ds_read_b64_tr_b16 v[44:45], v245 offset:2048
    ds_read_b64_tr_b16 v[46:47], v245 offset:2560
    s_add_u32 s95, s9, 128
    s_add_u32 m0, s89, 65536
    s_nop 0
    buffer_load_dwordx4 v242, s[60:63], s95 offen offset:0 lds
    v_mfma_f32_32x32x16_bf16 v[136:151], v[48:51], v[180:183], v[136:151]
    ds_read_b64_tr_b16 v[48:49], v250 offset:0
    ds_read_b64_tr_b16 v[50:51], v250 offset:512
    v_mfma_f32_16x16x32_bf16 v[216:219], v[224:227], v[236:239], v[216:219]
    ds_read_b64_tr_b16 v[224:225], v244 offset:4096
    ds_read_b64_tr_b16 v[226:227], v244 offset:4608
    s_waitcnt lgkmcnt(10)
    v_mfma_f32_32x32x16_bf16 v[120:135], v[228:231], v[56:59], v[120:135]
    ds_read_b64_tr_b16 v[228:229], v245 offset:4096
    ds_read_b64_tr_b16 v[230:231], v245 offset:4608
    s_add_u32 s95, s9, 32896
    s_add_u32 m0, s89, 69632
    s_nop 0
    buffer_load_dwordx4 v242, s[60:63], s95 offen offset:0 lds
    ds_read_b128 v[52:55], v241 offset:32768
    s_waitcnt lgkmcnt(11)
    v_mfma_f32_32x32x16_bf16 v[136:151], v[232:235], v[56:59], v[136:151]
    ds_read_b64_tr_b16 v[232:233], v244 offset:6144
    ds_read_b64_tr_b16 v[234:235], v244 offset:6656
    s_waitcnt lgkmcnt(11)
    v_mfma_f32_32x32x16_bf16 v[120:135], v[40:43], v[60:63], v[120:135]
    ds_read_b64_tr_b16 v[40:41], v245 offset:6144
    ds_read_b64_tr_b16 v[42:43], v245 offset:6656
    s_add_u32 s95, s9, 65664
    s_add_u32 m0, s89, 73728
    s_nop 0
    buffer_load_dwordx4 v242, s[60:63], s95 offen offset:0 lds
    s_waitcnt lgkmcnt(11)
    v_mfma_f32_32x32x16_bf16 v[136:151], v[44:47], v[60:63], v[136:151]
    ds_read_b64_tr_b16 v[44:45], v250 offset:4096
    ds_read_b64_tr_b16 v[46:47], v250 offset:4608
    s_waitcnt lgkmcnt(6)
    v_mfma_f32_16x16x32_bf16 v[216:219], v[48:51], v[52:55], v[216:219]
    ds_read_b64_tr_b16 v[48:49], v244 offset:8192
    ds_read_b64_tr_b16 v[50:51], v244 offset:8704
    v_mfma_f32_32x32x16_bf16 v[120:135], v[224:227], v[64:67], v[120:135]
    ds_read_b64_tr_b16 v[224:225], v245 offset:8192
    ds_read_b64_tr_b16 v[226:227], v245 offset:8704
    s_add_u32 s95, s9, 98432
    s_add_u32 m0, s89, 77824
    s_nop 0
    buffer_load_dwordx4 v242, s[60:63], s95 offen offset:0 lds
    ds_read_b128 v[236:239], v241 offset:33792
    v_mfma_f32_32x32x16_bf16 v[136:151], v[228:231], v[64:67], v[136:151]
    ds_read_b64_tr_b16 v[228:229], v244 offset:10240
    ds_read_b64_tr_b16 v[230:231], v244 offset:10752
    s_waitcnt lgkmcnt(11)
    v_mfma_f32_32x32x16_bf16 v[120:135], v[232:235], v[68:71], v[120:135]
    ds_read_b64_tr_b16 v[232:233], v245 offset:10240
    ds_read_b64_tr_b16 v[234:235], v245 offset:10752
    s_waitcnt lgkmcnt(11)
    v_mfma_f32_32x32x16_bf16 v[136:151], v[40:43], v[68:71], v[136:151]
    ds_read_b64_tr_b16 v[40:41], v250 offset:8192
    ds_read_b64_tr_b16 v[42:43], v250 offset:8704
    s_waitcnt lgkmcnt(6)
    v_mfma_f32_16x16x32_bf16 v[216:219], v[44:47], v[236:239], v[216:219]
    ds_read_b64_tr_b16 v[44:45], v244 offset:12288
    ds_read_b64_tr_b16 v[46:47], v244 offset:12800
    v_mfma_f32_32x32x16_bf16 v[120:135], v[48:51], v[72:75], v[120:135]
    ds_read_b64_tr_b16 v[48:49], v245 offset:12288
    ds_read_b64_tr_b16 v[50:51], v245 offset:12800
    ds_read_b128 v[52:55], v241 offset:34816
    v_mfma_f32_32x32x16_bf16 v[136:151], v[224:227], v[72:75], v[136:151]
    ds_read_b64_tr_b16 v[224:225], v244 offset:14336
    ds_read_b64_tr_b16 v[226:227], v244 offset:14848
    s_waitcnt lgkmcnt(11)
    v_mfma_f32_32x32x16_bf16 v[120:135], v[228:231], v[76:79], v[120:135]
    ds_read_b64_tr_b16 v[228:229], v245 offset:14336
    ds_read_b64_tr_b16 v[230:231], v245 offset:14848
    s_waitcnt lgkmcnt(11)
    v_mfma_f32_32x32x16_bf16 v[136:151], v[232:235], v[76:79], v[136:151]
    ds_read_b64_tr_b16 v[232:233], v250 offset:12288
    ds_read_b64_tr_b16 v[234:235], v250 offset:12800
    s_waitcnt lgkmcnt(6)
    v_mfma_f32_16x16x32_bf16 v[216:219], v[40:43], v[52:55], v[216:219]
    v_mfma_f32_32x32x16_bf16 v[120:135], v[44:47], v[80:83], v[120:135]
    ds_read_b128 v[236:239], v241 offset:35840
    v_mfma_f32_32x32x16_bf16 v[136:151], v[48:51], v[80:83], v[136:151]
    s_waitcnt lgkmcnt(5)
    v_mfma_f32_32x32x16_bf16 v[120:135], v[224:227], v[84:87], v[120:135]
    s_waitcnt vmcnt(8)
    s_waitcnt lgkmcnt(0)
    s_barrier
    ds_read_b64_tr_b16 v[40:41], v244 offset:16384
    ds_read_b64_tr_b16 v[42:43], v244 offset:16896
    ds_read_b64_tr_b16 v[44:45], v245 offset:16384
    ds_read_b64_tr_b16 v[46:47], v245 offset:16896
    ds_read_b64_tr_b16 v[48:49], v244 offset:18432
    ds_read_b64_tr_b16 v[50:51], v244 offset:18944
    ds_read_b64_tr_b16 v[224:225], v245 offset:18432
    ds_read_b64_tr_b16 v[226:227], v245 offset:18944
    s_add_u32 s95, s10, 128
    s_mov_b32 m0, s89
    s_nop 0
    buffer_load_dwordx4 v242, s[60:63], s95 offen offset:0 lds
    v_mfma_f32_32x32x16_bf16 v[136:151], v[228:231], v[84:87], v[136:151]
    ds_read_b64_tr_b16 v[228:229], v250 offset:16384
    ds_read_b64_tr_b16 v[230:231], v250 offset:16896
    v_mfma_f32_16x16x32_bf16 v[216:219], v[232:235], v[236:239], v[216:219]
    ds_read_b64_tr_b16 v[232:233], v244 offset:20480
    ds_read_b64_tr_b16 v[234:235], v244 offset:20992
    s_waitcnt lgkmcnt(10)
    v_mfma_f32_32x32x16_bf16 v[120:135], v[40:43], v[88:91], v[120:135]
    ds_read_b64_tr_b16 v[40:41], v245 offset:20480
    ds_read_b64_tr_b16 v[42:43], v245 offset:20992
    s_add_u32 s95, s10, 32896
    s_add_u32 m0, s89, 4096
    s_nop 0
    buffer_load_dwordx4 v242, s[60:63], s95 offen offset:0 lds
    ds_read_b128 v[52:55], v241 offset:36864
    s_waitcnt lgkmcnt(11)
    v_mfma_f32_32x32x16_bf16 v[136:151], v[44:47], v[88:91], v[136:151]
    ds_read_b64_tr_b16 v[44:45], v244 offset:22528
    ds_read_b64_tr_b16 v[46:47], v244 offset:23040
    s_waitcnt lgkmcnt(11)
    v_mfma_f32_32x32x16_bf16 v[120:135], v[48:51], v[92:95], v[120:135]
    ds_read_b64_tr_b16 v[48:49], v245 offset:22528
    ds_read_b64_tr_b16 v[50:51], v245 offset:23040
    s_add_u32 s95, s10, 65664
    s_add_u32 m0, s89, 8192
    s_nop 0
    buffer_load_dwordx4 v242, s[60:63], s95 offen offset:0 lds
    s_waitcnt lgkmcnt(11)
    v_mfma_f32_32x32x16_bf16 v[136:151], v[224:227], v[92:95], v[136:151]
    ds_read_b64_tr_b16 v[224:225], v250 offset:20480
    ds_read_b64_tr_b16 v[226:227], v250 offset:20992
    s_waitcnt lgkmcnt(6)
    v_mfma_f32_16x16x32_bf16 v[216:219], v[228:231], v[52:55], v[216:219]
    ds_read_b64_tr_b16 v[228:229], v244 offset:24576
    ds_read_b64_tr_b16 v[230:231], v244 offset:25088
    v_mfma_f32_32x32x16_bf16 v[120:135], v[232:235], v[96:99], v[120:135]
    ds_read_b64_tr_b16 v[232:233], v245 offset:24576
    ds_read_b64_tr_b16 v[234:235], v245 offset:25088
    s_add_u32 s95, s10, 98432
    s_add_u32 m0, s89, 12288
    s_nop 0
    buffer_load_dwordx4 v242, s[60:63], s95 offen offset:0 lds
    ds_read_b128 v[236:239], v241 offset:37888
    v_mfma_f32_32x32x16_bf16 v[136:151], v[40:43], v[96:99], v[136:151]
    ds_read_b64_tr_b16 v[40:41], v244 offset:26624
    ds_read_b64_tr_b16 v[42:43], v244 offset:27136
    s_waitcnt lgkmcnt(11)
    v_mfma_f32_32x32x16_bf16 v[120:135], v[44:47], v[100:103], v[120:135]
    ds_read_b64_tr_b16 v[44:45], v245 offset:26624
    ds_read_b64_tr_b16 v[46:47], v245 offset:27136
    s_waitcnt lgkmcnt(11)
    v_mfma_f32_32x32x16_bf16 v[136:151], v[48:51], v[100:103], v[136:151]
    ds_read_b64_tr_b16 v[48:49], v250 offset:24576
    ds_read_b64_tr_b16 v[50:51], v250 offset:25088
    s_waitcnt lgkmcnt(6)
    v_mfma_f32_16x16x32_bf16 v[216:219], v[224:227], v[236:239], v[216:219]
    ds_read_b64_tr_b16 v[224:225], v244 offset:28672
    ds_read_b64_tr_b16 v[226:227], v244 offset:29184
    v_mfma_f32_32x32x16_bf16 v[120:135], v[228:231], v[104:107], v[120:135]
    ds_read_b64_tr_b16 v[228:229], v245 offset:28672
    ds_read_b64_tr_b16 v[230:231], v245 offset:29184
    ds_read_b128 v[52:55], v241 offset:38912
    v_mfma_f32_32x32x16_bf16 v[136:151], v[232:235], v[104:107], v[136:151]
    ds_read_b64_tr_b16 v[232:233], v244 offset:30720
    ds_read_b64_tr_b16 v[234:235], v244 offset:31232
    s_waitcnt lgkmcnt(11)
    v_mfma_f32_32x32x16_bf16 v[120:135], v[40:43], v[108:111], v[120:135]
    ds_read_b64_tr_b16 v[40:41], v245 offset:30720
    ds_read_b64_tr_b16 v[42:43], v245 offset:31232
    s_waitcnt lgkmcnt(11)
    v_mfma_f32_32x32x16_bf16 v[136:151], v[44:47], v[108:111], v[136:151]
    ds_read_b64_tr_b16 v[44:45], v250 offset:28672
    ds_read_b64_tr_b16 v[46:47], v250 offset:29184
    s_waitcnt lgkmcnt(6)
    v_mfma_f32_16x16x32_bf16 v[216:219], v[48:51], v[52:55], v[216:219]
    v_mfma_f32_32x32x16_bf16 v[120:135], v[224:227], v[112:115], v[120:135]
    ds_read_b128 v[236:239], v241 offset:39936
    v_mfma_f32_32x32x16_bf16 v[136:151], v[228:231], v[112:115], v[136:151]
    s_waitcnt lgkmcnt(5)
    v_mfma_f32_32x32x16_bf16 v[120:135], v[232:235], v[116:119], v[120:135]
    s_waitcnt vmcnt(8)
    s_waitcnt lgkmcnt(0)
    s_barrier
    ds_read_b64_tr_b16 v[48:49], v244 offset:49152
    ds_read_b64_tr_b16 v[50:51], v244 offset:49664
    ds_read_b64_tr_b16 v[224:225], v245 offset:49152
    ds_read_b64_tr_b16 v[226:227], v245 offset:49664
    ds_read_b64_tr_b16 v[228:229], v244 offset:51200
    ds_read_b64_tr_b16 v[230:231], v244 offset:51712
    ds_read_b64_tr_b16 v[232:233], v245 offset:51200
    ds_read_b64_tr_b16 v[234:235], v245 offset:51712
    s_add_u32 s95, s11, 128
    s_add_u32 m0, s89, 16384
    s_nop 0
    buffer_load_dwordx4 v242, s[60:63], s95 offen offset:0 lds
    v_mfma_f32_32x32x16_bf16 v[136:151], v[40:43], v[116:119], v[136:151]
    ds_read_b64_tr_b16 v[40:41], v250 offset:49152
    ds_read_b64_tr_b16 v[42:43], v250 offset:49664
    v_mfma_f32_16x16x32_bf16 v[216:219], v[44:47], v[236:239], v[216:219]
    ds_read_b64_tr_b16 v[44:45], v244 offset:53248
    ds_read_b64_tr_b16 v[46:47], v244 offset:53760
    s_waitcnt lgkmcnt(10)
    v_mfma_f32_32x32x16_bf16 v[184:199], v[48:51], v[8:11], 0
    ds_read_b64_tr_b16 v[48:49], v245 offset:53248
    ds_read_b64_tr_b16 v[50:51], v245 offset:53760
    s_add_u32 s95, s11, 32896
    s_add_u32 m0, s89, 20480
    s_nop 0
    buffer_load_dwordx4 v242, s[60:63], s95 offen offset:0 lds
    ds_read_b128 v[52:55], v240 offset:32768
    s_waitcnt lgkmcnt(11)
    v_mfma_f32_32x32x16_bf16 v[200:215], v[224:227], v[8:11], 0
    ds_read_b64_tr_b16 v[224:225], v244 offset:55296
    ds_read_b64_tr_b16 v[226:227], v244 offset:55808
    s_waitcnt lgkmcnt(11)
    v_mfma_f32_32x32x16_bf16 v[184:199], v[228:231], v[12:15], v[184:199]
    ds_read_b64_tr_b16 v[228:229], v245 offset:55296
    ds_read_b64_tr_b16 v[230:231], v245 offset:55808
    s_add_u32 s95, s11, 65664
    s_add_u32 m0, s89, 24576
    s_nop 0
    buffer_load_dwordx4 v242, s[60:63], s95 offen offset:0 lds
    s_waitcnt lgkmcnt(11)
    v_mfma_f32_32x32x16_bf16 v[200:215], v[232:235], v[12:15], v[200:215]
    ds_read_b64_tr_b16 v[232:233], v250 offset:53248
    ds_read_b64_tr_b16 v[234:235], v250 offset:53760
    s_waitcnt lgkmcnt(6)
    v_mfma_f32_16x16x32_bf16 v[220:223], v[40:43], v[52:55], 0
    ds_read_b64_tr_b16 v[40:41], v244 offset:57344
    ds_read_b64_tr_b16 v[42:43], v244 offset:57856
    v_mfma_f32_32x32x16_bf16 v[184:199], v[44:47], v[16:19], v[184:199]
    ds_read_b64_tr_b16 v[44:45], v245 offset:57344
    ds_read_b64_tr_b16 v[46:47], v245 offset:57856
    s_add_u32 s95, s11, 98432
    s_add_u32 m0, s89, 28672
    s_nop 0
    buffer_load_dwordx4 v242, s[60:63], s95 offen offset:0 lds
    v_cvt_pk_bf16_f32 v120, v120, v121
    v_cvt_pk_bf16_f32 v121, v122, v123
    v_cvt_pk_bf16_f32 v122, v124, v125
    v_cvt_pk_bf16_f32 v123, v126, v127
    ds_read_b128 v[236:239], v240 offset:33792
    v_mfma_f32_32x32x16_bf16 v[200:215], v[48:51], v[16:19], v[200:215]
    ds_read_b64_tr_b16 v[48:49], v244 offset:59392
    ds_read_b64_tr_b16 v[50:51], v244 offset:59904
    v_cvt_pk_bf16_f32 v124, v128, v129
    v_cvt_pk_bf16_f32 v125, v130, v131
    v_cvt_pk_bf16_f32 v126, v132, v133
    v_cvt_pk_bf16_f32 v127, v134, v135
    s_waitcnt lgkmcnt(11)
    v_mfma_f32_32x32x16_bf16 v[184:199], v[224:227], v[20:23], v[184:199]
    ds_read_b64_tr_b16 v[224:225], v245 offset:59392
    ds_read_b64_tr_b16 v[226:227], v245 offset:59904
    s_add_u32 s96, s13, 0
    buffer_store_dwordx4 v[120:123], v1, s[64:67], s96 offen offset:0 sc1
    s_waitcnt lgkmcnt(11)
    v_mfma_f32_32x32x16_bf16 v[200:215], v[228:231], v[20:23], v[200:215]
    ds_read_b64_tr_b16 v[228:229], v250 offset:57344
    ds_read_b64_tr_b16 v[230:231], v250 offset:57856
    buffer_store_dwordx4 v[124:127], v1, s[64:67], s96 offen offset:1024 sc1
    s_waitcnt lgkmcnt(6)
    v_mfma_f32_16x16x32_bf16 v[220:223], v[232:235], v[236:239], v[220:223]
    ds_read_b64_tr_b16 v[232:233], v244 offset:61440
    ds_read_b64_tr_b16 v[234:235], v244 offset:61952
    v_cvt_pk_bf16_f32 v136, v136, v137
    v_mfma_f32_32x32x16_bf16 v[184:199], v[40:43], v[24:27], v[184:199]
    ds_read_b64_tr_b16 v[40:41], v245 offset:61440
    ds_read_b64_tr_b16 v[42:43], v245 offset:61952
    v_cvt_pk_bf16_f32 v137, v138, v139
    v_cvt_pk_bf16_f32 v138, v140, v141
    v_cvt_pk_bf16_f32 v139, v142, v143
    v_cvt_pk_bf16_f32 v140, v144, v145
    ds_read_b128 v[52:55], v240 offset:34816
    v_mfma_f32_32x32x16_bf16 v[200:215], v[44:47], v[24:27], v[200:215]
    ds_read_b64_tr_b16 v[44:45], v244 offset:63488
    ds_read_b64_tr_b16 v[46:47], v244 offset:64000
    v_cvt_pk_bf16_f32 v141, v146, v147
    v_cvt_pk_bf16_f32 v142, v148, v149
    v_cvt_pk_bf16_f32 v143, v150, v151
    buffer_store_dwordx4 v[136:139], v1, s[64:67], s96 offen offset:2048 sc1
    s_waitcnt lgkmcnt(11)
    v_mfma_f32_32x32x16_bf16 v[184:199], v[48:51], v[28:31], v[184:199]
    ds_read_b64_tr_b16 v[48:49], v245 offset:63488
    ds_read_b64_tr_b16 v[50:51], v245 offset:64000
    buffer_store_dwordx4 v[140:143], v1, s[64:67], s96 offen offset:3072 sc1
    s_waitcnt lgkmcnt(11)
    v_mfma_f32_32x32x16_bf16 v[200:215], v[224:227], v[28:31], v[200:215]
    ds_read_b64_tr_b16 v[224:225], v250 offset:61440
    ds_read_b64_tr_b16 v[226:227], v250 offset:61952
    v_cvt_pk_bf16_f32 v216, v216, v217
    v_cvt_pk_bf16_f32 v217, v218, v219
    s_add_u32 s75, s14, 0
    buffer_store_dwordx2 v[216:217], v2, s[64:67], s75 offen offset:0 sc1
    s_waitcnt lgkmcnt(6)
    v_mfma_f32_16x16x32_bf16 v[220:223], v[228:231], v[52:55], v[220:223]
    v_mfma_f32_32x32x16_bf16 v[184:199], v[232:235], v[32:35], v[184:199]
    ds_read_b128 v[236:239], v240 offset:35840
    v_mfma_f32_32x32x16_bf16 v[200:215], v[40:43], v[32:35], v[200:215]
    s_waitcnt lgkmcnt(5)
    v_mfma_f32_32x32x16_bf16 v[184:199], v[44:47], v[36:39], v[184:199]
    s_waitcnt vmcnt(13)
    s_waitcnt lgkmcnt(0)
    s_barrier
    ds_read_b64_tr_b16 v[228:229], v246 offset:32768
    ds_read_b64_tr_b16 v[230:231], v246 offset:33280
    ds_read_b64_tr_b16 v[232:233], v247 offset:32768
    ds_read_b64_tr_b16 v[234:235], v247 offset:33280
    ds_read_b64_tr_b16 v[40:41], v246 offset:34816
    ds_read_b64_tr_b16 v[42:43], v246 offset:35328
    ds_read_b64_tr_b16 v[44:45], v247 offset:34816
    ds_read_b64_tr_b16 v[46:47], v247 offset:35328
    s_add_u32 s95, s8, 256
    s_add_u32 m0, s89, 49152
    s_nop 0
    buffer_load_dwordx4 v242, s[60:63], s95 offen offset:0 lds
    v_mfma_f32_32x32x16_bf16 v[200:215], v[48:51], v[36:39], v[200:215]
    ds_read_b64_tr_b16 v[48:49], v248 offset:32768
    ds_read_b64_tr_b16 v[50:51], v248 offset:33280
    v_mfma_f32_16x16x32_bf16 v[220:223], v[224:227], v[236:239], v[220:223]
    ds_read_b64_tr_b16 v[224:225], v246 offset:36864
    ds_read_b64_tr_b16 v[226:227], v246 offset:37376
    s_waitcnt lgkmcnt(10)
    v_mfma_f32_32x32x16_bf16 v[184:199], v[228:231], v[152:155], v[184:199]
    ds_read_b64_tr_b16 v[228:229], v247 offset:36864
    ds_read_b64_tr_b16 v[230:231], v247 offset:37376
    s_add_u32 s95, s8, 33024
    s_add_u32 m0, s89, 53248
    s_nop 0
    buffer_load_dwordx4 v242, s[60:63], s95 offen offset:0 lds
    ds_read_b128 v[52:55], v240 offset:36864
    s_waitcnt lgkmcnt(11)
    v_mfma_f32_32x32x16_bf16 v[200:215], v[232:235], v[152:155], v[200:215]
    ds_read_b64_tr_b16 v[232:233], v246 offset:38912
    ds_read_b64_tr_b16 v[234:235], v246 offset:39424
    s_waitcnt lgkmcnt(11)
    v_mfma_f32_32x32x16_bf16 v[184:199], v[40:43], v[156:159], v[184:199]
    ds_read_b64_tr_b16 v[40:41], v247 offset:38912
    ds_read_b64_tr_b16 v[42:43], v247 offset:39424
    s_add_u32 s95, s8, 65792
    s_add_u32 m0, s89, 57344
    s_nop 0
    buffer_load_dwordx4 v242, s[60:63], s95 offen offset:0 lds
    s_waitcnt lgkmcnt(11)
    v_mfma_f32_32x32x16_bf16 v[200:215], v[44:47], v[156:159], v[200:215]
    ds_read_b64_tr_b16 v[44:45], v248 offset:36864
    ds_read_b64_tr_b16 v[46:47], v248 offset:37376
    s_waitcnt lgkmcnt(6)
    v_mfma_f32_16x16x32_bf16 v[220:223], v[48:51], v[52:55], v[220:223]
    ds_read_b64_tr_b16 v[48:49], v246 offset:40960
    ds_read_b64_tr_b16 v[50:51], v246 offset:41472
    v_mfma_f32_32x32x16_bf16 v[184:199], v[224:227], v[160:163], v[184:199]
    ds_read_b64_tr_b16 v[224:225], v247 offset:40960
    ds_read_b64_tr_b16 v[226:227], v247 offset:41472
    s_add_u32 s95, s8, 98560
    s_add_u32 m0, s89, 61440
    s_nop 0
    buffer_load_dwordx4 v242, s[60:63], s95 offen offset:0 lds
    ds_read_b128 v[236:239], v240 offset:37888
    v_mfma_f32_32x32x16_bf16 v[200:215], v[228:231], v[160:163], v[200:215]
    ds_read_b64_tr_b16 v[228:229], v246 offset:43008
    ds_read_b64_tr_b16 v[230:231], v246 offset:43520
    s_waitcnt lgkmcnt(11)
    v_mfma_f32_32x32x16_bf16 v[184:199], v[232:235], v[164:167], v[184:199]
    ds_read_b64_tr_b16 v[232:233], v247 offset:43008
    ds_read_b64_tr_b16 v[234:235], v247 offset:43520
    s_waitcnt lgkmcnt(11)
    v_mfma_f32_32x32x16_bf16 v[200:215], v[40:43], v[164:167], v[200:215]
    ds_read_b64_tr_b16 v[40:41], v248 offset:40960
    ds_read_b64_tr_b16 v[42:43], v248 offset:41472
    s_waitcnt lgkmcnt(6)
    v_mfma_f32_16x16x32_bf16 v[220:223], v[44:47], v[236:239], v[220:223]
    ds_read_b64_tr_b16 v[44:45], v246 offset:45056
    ds_read_b64_tr_b16 v[46:47], v246 offset:45568
    v_mfma_f32_32x32x16_bf16 v[184:199], v[48:51], v[168:171], v[184:199]
    ds_read_b64_tr_b16 v[48:49], v247 offset:45056
    ds_read_b64_tr_b16 v[50:51], v247 offset:45568
    ds_read_b128 v[52:55], v240 offset:38912
    v_mfma_f32_32x32x16_bf16 v[200:215], v[224:227], v[168:171], v[200:215]
    ds_read_b64_tr_b16 v[224:225], v246 offset:47104
    ds_read_b64_tr_b16 v[226:227], v246 offset:47616
    s_waitcnt lgkmcnt(11)
    v_mfma_f32_32x32x16_bf16 v[184:199], v[228:231], v[172:175], v[184:199]
    ds_read_b64_tr_b16 v[228:229], v247 offset:47104
    ds_read_b64_tr_b16 v[230:231], v247 offset:47616
    s_waitcnt lgkmcnt(11)
    v_mfma_f32_32x32x16_bf16 v[200:215], v[232:235], v[172:175], v[200:215]
    ds_read_b64_tr_b16 v[232:233], v248 offset:45056
    ds_read_b64_tr_b16 v[234:235], v248 offset:45568
    s_waitcnt lgkmcnt(6)
    v_mfma_f32_16x16x32_bf16 v[220:223], v[40:43], v[52:55], v[220:223]
    v_mfma_f32_32x32x16_bf16 v[184:199], v[44:47], v[176:179], v[184:199]
    ds_read_b128 v[236:239], v240 offset:39936
    v_mfma_f32_32x32x16_bf16 v[200:215], v[48:51], v[176:179], v[200:215]
    s_waitcnt lgkmcnt(5)
    v_mfma_f32_32x32x16_bf16 v[184:199], v[224:227], v[180:183], v[184:199]
    s_waitcnt vmcnt(13)
    s_waitcnt lgkmcnt(0)
    s_barrier
    ds_read_b64_tr_b16 v[40:41], v244 offset:0
    ds_read_b64_tr_b16 v[42:43], v244 offset:512
    ds_read_b64_tr_b16 v[44:45], v245 offset:0
    ds_read_b64_tr_b16 v[46:47], v245 offset:512
    ds_read_b64_tr_b16 v[48:49], v244 offset:2048
    ds_read_b64_tr_b16 v[50:51], v244 offset:2560
    ds_read_b64_tr_b16 v[224:225], v245 offset:2048
    ds_read_b64_tr_b16 v[226:227], v245 offset:2560
    s_add_u32 s95, s9, 256
    s_add_u32 m0, s89, 65536
    s_nop 0
    buffer_load_dwordx4 v242, s[60:63], s95 offen offset:0 lds
    v_mfma_f32_32x32x16_bf16 v[200:215], v[228:231], v[180:183], v[200:215]
    ds_read_b64_tr_b16 v[228:229], v250 offset:0
    ds_read_b64_tr_b16 v[230:231], v250 offset:512
    v_mfma_f32_16x16x32_bf16 v[220:223], v[232:235], v[236:239], v[220:223]
    ds_read_b64_tr_b16 v[232:233], v244 offset:4096
    ds_read_b64_tr_b16 v[234:235], v244 offset:4608
    s_waitcnt lgkmcnt(10)
    v_mfma_f32_32x32x16_bf16 v[184:199], v[40:43], v[56:59], v[184:199]
    ds_read_b64_tr_b16 v[40:41], v245 offset:4096
    ds_read_b64_tr_b16 v[42:43], v245 offset:4608
    s_add_u32 s95, s9, 33024
    s_add_u32 m0, s89, 69632
    s_nop 0
    buffer_load_dwordx4 v242, s[60:63], s95 offen offset:0 lds
    ds_read_b128 v[52:55], v241 offset:32768
    s_waitcnt lgkmcnt(11)
    v_mfma_f32_32x32x16_bf16 v[200:215], v[44:47], v[56:59], v[200:215]
    ds_read_b64_tr_b16 v[44:45], v244 offset:6144
    ds_read_b64_tr_b16 v[46:47], v244 offset:6656
    s_waitcnt lgkmcnt(11)
    v_mfma_f32_32x32x16_bf16 v[184:199], v[48:51], v[60:63], v[184:199]
    ds_read_b64_tr_b16 v[48:49], v245 offset:6144
    ds_read_b64_tr_b16 v[50:51], v245 offset:6656
    s_add_u32 s95, s9, 65792
    s_add_u32 m0, s89, 73728
    s_nop 0
    buffer_load_dwordx4 v242, s[60:63], s95 offen offset:0 lds
    s_waitcnt lgkmcnt(11)
    v_mfma_f32_32x32x16_bf16 v[200:215], v[224:227], v[60:63], v[200:215]
    ds_read_b64_tr_b16 v[224:225], v250 offset:4096
    ds_read_b64_tr_b16 v[226:227], v250 offset:4608
    s_waitcnt lgkmcnt(6)
    v_mfma_f32_16x16x32_bf16 v[220:223], v[228:231], v[52:55], v[220:223]
    ds_read_b64_tr_b16 v[228:229], v244 offset:8192
    ds_read_b64_tr_b16 v[230:231], v244 offset:8704
    v_mfma_f32_32x32x16_bf16 v[184:199], v[232:235], v[64:67], v[184:199]
    ds_read_b64_tr_b16 v[232:233], v245 offset:8192
    ds_read_b64_tr_b16 v[234:235], v245 offset:8704
    s_add_u32 s95, s9, 98560
    s_add_u32 m0, s89, 77824
    s_nop 0
    buffer_load_dwordx4 v242, s[60:63], s95 offen offset:0 lds
    ds_read_b128 v[236:239], v241 offset:33792
    v_mfma_f32_32x32x16_bf16 v[200:215], v[40:43], v[64:67], v[200:215]
    ds_read_b64_tr_b16 v[40:41], v244 offset:10240
    ds_read_b64_tr_b16 v[42:43], v244 offset:10752
    s_waitcnt lgkmcnt(11)
    v_mfma_f32_32x32x16_bf16 v[184:199], v[44:47], v[68:71], v[184:199]
    ds_read_b64_tr_b16 v[44:45], v245 offset:10240
    ds_read_b64_tr_b16 v[46:47], v245 offset:10752
    s_waitcnt lgkmcnt(11)
    v_mfma_f32_32x32x16_bf16 v[200:215], v[48:51], v[68:71], v[200:215]
    ds_read_b64_tr_b16 v[48:49], v250 offset:8192
    ds_read_b64_tr_b16 v[50:51], v250 offset:8704
    s_waitcnt lgkmcnt(6)
    v_mfma_f32_16x16x32_bf16 v[220:223], v[224:227], v[236:239], v[220:223]
    ds_read_b64_tr_b16 v[224:225], v244 offset:12288
    ds_read_b64_tr_b16 v[226:227], v244 offset:12800
    v_mfma_f32_32x32x16_bf16 v[184:199], v[228:231], v[72:75], v[184:199]
    ds_read_b64_tr_b16 v[228:229], v245 offset:12288
    ds_read_b64_tr_b16 v[230:231], v245 offset:12800
    ds_read_b128 v[52:55], v241 offset:34816
    v_mfma_f32_32x32x16_bf16 v[200:215], v[232:235], v[72:75], v[200:215]
    ds_read_b64_tr_b16 v[232:233], v244 offset:14336
    ds_read_b64_tr_b16 v[234:235], v244 offset:14848
    s_waitcnt lgkmcnt(11)
    v_mfma_f32_32x32x16_bf16 v[184:199], v[40:43], v[76:79], v[184:199]
    ds_read_b64_tr_b16 v[40:41], v245 offset:14336
    ds_read_b64_tr_b16 v[42:43], v245 offset:14848
    s_waitcnt lgkmcnt(11)
    v_mfma_f32_32x32x16_bf16 v[200:215], v[44:47], v[76:79], v[200:215]
    ds_read_b64_tr_b16 v[44:45], v250 offset:12288
    ds_read_b64_tr_b16 v[46:47], v250 offset:12800
    s_waitcnt lgkmcnt(6)
    v_mfma_f32_16x16x32_bf16 v[220:223], v[48:51], v[52:55], v[220:223]
    v_mfma_f32_32x32x16_bf16 v[184:199], v[224:227], v[80:83], v[184:199]
    ds_read_b128 v[236:239], v241 offset:35840
    v_mfma_f32_32x32x16_bf16 v[200:215], v[228:231], v[80:83], v[200:215]
    s_waitcnt lgkmcnt(5)
    v_mfma_f32_32x32x16_bf16 v[184:199], v[232:235], v[84:87], v[184:199]
    s_waitcnt vmcnt(13)
    s_waitcnt lgkmcnt(0)
    s_barrier
    ds_read_b64_tr_b16 v[48:49], v244 offset:16384
    ds_read_b64_tr_b16 v[50:51], v244 offset:16896
    ds_read_b64_tr_b16 v[224:225], v245 offset:16384
    ds_read_b64_tr_b16 v[226:227], v245 offset:16896
    ds_read_b64_tr_b16 v[228:229], v244 offset:18432
    ds_read_b64_tr_b16 v[230:231], v244 offset:18944
    ds_read_b64_tr_b16 v[232:233], v245 offset:18432
    ds_read_b64_tr_b16 v[234:235], v245 offset:18944
    s_add_u32 s95, s10, 256
    s_mov_b32 m0, s89
    s_nop 0
    buffer_load_dwordx4 v242, s[60:63], s95 offen offset:0 lds
    v_mfma_f32_32x32x16_bf16 v[200:215], v[40:43], v[84:87], v[200:215]
    ds_read_b64_tr_b16 v[40:41], v250 offset:16384
    ds_read_b64_tr_b16 v[42:43], v250 offset:16896
    v_mfma_f32_16x16x32_bf16 v[220:223], v[44:47], v[236:239], v[220:223]
    ds_read_b64_tr_b16 v[44:45], v244 offset:20480
    ds_read_b64_tr_b16 v[46:47], v244 offset:20992
    s_waitcnt lgkmcnt(10)
    v_mfma_f32_32x32x16_bf16 v[184:199], v[48:51], v[88:91], v[184:199]
    ds_read_b64_tr_b16 v[48:49], v245 offset:20480
    ds_read_b64_tr_b16 v[50:51], v245 offset:20992
    s_add_u32 s95, s10, 33024
    s_add_u32 m0, s89, 4096
    s_nop 0
    buffer_load_dwordx4 v242, s[60:63], s95 offen offset:0 lds
    ds_read_b128 v[52:55], v241 offset:36864
    s_waitcnt lgkmcnt(11)
    v_mfma_f32_32x32x16_bf16 v[200:215], v[224:227], v[88:91], v[200:215]
    ds_read_b64_tr_b16 v[224:225], v244 offset:22528
    ds_read_b64_tr_b16 v[226:227], v244 offset:23040
    s_waitcnt lgkmcnt(11)
    v_mfma_f32_32x32x16_bf16 v[184:199], v[228:231], v[92:95], v[184:199]
    ds_read_b64_tr_b16 v[228:229], v245 offset:22528
    ds_read_b64_tr_b16 v[230:231], v245 offset:23040
    s_add_u32 s95, s10, 65792
    s_add_u32 m0, s89, 8192
    s_nop 0
    buffer_load_dwordx4 v242, s[60:63], s95 offen offset:0 lds
    s_waitcnt lgkmcnt(11)
    v_mfma_f32_32x32x16_bf16 v[200:215], v[232:235], v[92:95], v[200:215]
    ds_read_b64_tr_b16 v[232:233], v250 offset:20480
    ds_read_b64_tr_b16 v[234:235], v250 offset:20992
    s_waitcnt lgkmcnt(6)
    v_mfma_f32_16x16x32_bf16 v[220:223], v[40:43], v[52:55], v[220:223]
    ds_read_b64_tr_b16 v[40:41], v244 offset:24576
    ds_read_b64_tr_b16 v[42:43], v244 offset:25088
    v_mfma_f32_32x32x16_bf16 v[184:199], v[44:47], v[96:99], v[184:199]
    ds_read_b64_tr_b16 v[44:45], v245 offset:24576
    ds_read_b64_tr_b16 v[46:47], v245 offset:25088
    s_add_u32 s95, s10, 98560
    s_add_u32 m0, s89, 12288
    s_nop 0
    buffer_load_dwordx4 v242, s[60:63], s95 offen offset:0 lds
    ds_read_b128 v[236:239], v241 offset:37888
    v_mfma_f32_32x32x16_bf16 v[200:215], v[48:51], v[96:99], v[200:215]
    ds_read_b64_tr_b16 v[48:49], v244 offset:26624
    ds_read_b64_tr_b16 v[50:51], v244 offset:27136
    s_waitcnt lgkmcnt(11)
    v_mfma_f32_32x32x16_bf16 v[184:199], v[224:227], v[100:103], v[184:199]
    ds_read_b64_tr_b16 v[224:225], v245 offset:26624
    ds_read_b64_tr_b16 v[226:227], v245 offset:27136
    s_waitcnt lgkmcnt(11)
    v_mfma_f32_32x32x16_bf16 v[200:215], v[228:231], v[100:103], v[200:215]
    ds_read_b64_tr_b16 v[228:229], v250 offset:24576
    ds_read_b64_tr_b16 v[230:231], v250 offset:25088
    s_waitcnt lgkmcnt(6)
    v_mfma_f32_16x16x32_bf16 v[220:223], v[232:235], v[236:239], v[220:223]
    ds_read_b64_tr_b16 v[232:233], v244 offset:28672
    ds_read_b64_tr_b16 v[234:235], v244 offset:29184
    v_mfma_f32_32x32x16_bf16 v[184:199], v[40:43], v[104:107], v[184:199]
    ds_read_b64_tr_b16 v[40:41], v245 offset:28672
    ds_read_b64_tr_b16 v[42:43], v245 offset:29184
    ds_read_b128 v[52:55], v241 offset:38912
    v_mfma_f32_32x32x16_bf16 v[200:215], v[44:47], v[104:107], v[200:215]
    ds_read_b64_tr_b16 v[44:45], v244 offset:30720
    ds_read_b64_tr_b16 v[46:47], v244 offset:31232
    s_waitcnt lgkmcnt(11)
    v_mfma_f32_32x32x16_bf16 v[184:199], v[48:51], v[108:111], v[184:199]
    ds_read_b64_tr_b16 v[48:49], v245 offset:30720
    ds_read_b64_tr_b16 v[50:51], v245 offset:31232
    s_waitcnt lgkmcnt(11)
    v_mfma_f32_32x32x16_bf16 v[200:215], v[224:227], v[108:111], v[200:215]
    ds_read_b64_tr_b16 v[224:225], v250 offset:28672
    ds_read_b64_tr_b16 v[226:227], v250 offset:29184
    s_waitcnt lgkmcnt(6)
    v_mfma_f32_16x16x32_bf16 v[220:223], v[228:231], v[52:55], v[220:223]
    v_mfma_f32_32x32x16_bf16 v[184:199], v[232:235], v[112:115], v[184:199]
    ds_read_b128 v[236:239], v241 offset:39936
    v_mfma_f32_32x32x16_bf16 v[200:215], v[40:43], v[112:115], v[200:215]
    s_waitcnt lgkmcnt(5)
    v_mfma_f32_32x32x16_bf16 v[184:199], v[44:47], v[116:119], v[184:199]
    s_waitcnt vmcnt(8)
    s_waitcnt lgkmcnt(0)
    s_barrier
    ds_read_b64_tr_b16 v[228:229], v244 offset:49152
    ds_read_b64_tr_b16 v[230:231], v244 offset:49664
    ds_read_b64_tr_b16 v[232:233], v245 offset:49152
    ds_read_b64_tr_b16 v[234:235], v245 offset:49664
    ds_read_b64_tr_b16 v[40:41], v244 offset:51200
    ds_read_b64_tr_b16 v[42:43], v244 offset:51712
    ds_read_b64_tr_b16 v[44:45], v245 offset:51200
    ds_read_b64_tr_b16 v[46:47], v245 offset:51712
    s_add_u32 s95, s11, 256
    s_add_u32 m0, s89, 16384
    s_nop 0
    buffer_load_dwordx4 v242, s[60:63], s95 offen offset:0 lds
    v_mfma_f32_32x32x16_bf16 v[200:215], v[48:51], v[116:119], v[200:215]
    ds_read_b64_tr_b16 v[48:49], v250 offset:49152
    ds_read_b64_tr_b16 v[50:51], v250 offset:49664
    v_mfma_f32_16x16x32_bf16 v[220:223], v[224:227], v[236:239], v[220:223]
    ds_read_b64_tr_b16 v[224:225], v244 offset:53248
    ds_read_b64_tr_b16 v[226:227], v244 offset:53760
    s_waitcnt lgkmcnt(10)
    v_mfma_f32_32x32x16_bf16 v[120:135], v[228:231], v[8:11], 0
    ds_read_b64_tr_b16 v[228:229], v245 offset:53248
    ds_read_b64_tr_b16 v[230:231], v245 offset:53760
    s_add_u32 s95, s11, 33024
    s_add_u32 m0, s89, 20480
    s_nop 0
    buffer_load_dwordx4 v242, s[60:63], s95 offen offset:0 lds
    ds_read_b128 v[52:55], v240 offset:32768
    s_waitcnt lgkmcnt(11)
    v_mfma_f32_32x32x16_bf16 v[136:151], v[232:235], v[8:11], 0
    ds_read_b64_tr_b16 v[232:233], v244 offset:55296
    ds_read_b64_tr_b16 v[234:235], v244 offset:55808
    s_waitcnt lgkmcnt(11)
    v_mfma_f32_32x32x16_bf16 v[120:135], v[40:43], v[12:15], v[120:135]
    ds_read_b64_tr_b16 v[40:41], v245 offset:55296
    ds_read_b64_tr_b16 v[42:43], v245 offset:55808
    s_add_u32 s95, s11, 65792
    s_add_u32 m0, s89, 24576
    s_nop 0
    buffer_load_dwordx4 v242, s[60:63], s95 offen offset:0 lds
    s_waitcnt lgkmcnt(11)
    v_mfma_f32_32x32x16_bf16 v[136:151], v[44:47], v[12:15], v[136:151]
    ds_read_b64_tr_b16 v[44:45], v250 offset:53248
    ds_read_b64_tr_b16 v[46:47], v250 offset:53760
    s_waitcnt lgkmcnt(6)
    v_mfma_f32_16x16x32_bf16 v[216:219], v[48:51], v[52:55], 0
    ds_read_b64_tr_b16 v[48:49], v244 offset:57344
    ds_read_b64_tr_b16 v[50:51], v244 offset:57856
    v_mfma_f32_32x32x16_bf16 v[120:135], v[224:227], v[16:19], v[120:135]
    ds_read_b64_tr_b16 v[224:225], v245 offset:57344
    ds_read_b64_tr_b16 v[226:227], v245 offset:57856
    s_add_u32 s95, s11, 98560
    s_add_u32 m0, s89, 28672
    s_nop 0
    buffer_load_dwordx4 v242, s[60:63], s95 offen offset:0 lds
    v_cvt_pk_bf16_f32 v184, v184, v185
    v_cvt_pk_bf16_f32 v185, v186, v187
    v_cvt_pk_bf16_f32 v186, v188, v189
    v_cvt_pk_bf16_f32 v187, v190, v191
    ds_read_b128 v[236:239], v240 offset:33792
    v_mfma_f32_32x32x16_bf16 v[136:151], v[228:231], v[16:19], v[136:151]
    ds_read_b64_tr_b16 v[228:229], v244 offset:59392
    ds_read_b64_tr_b16 v[230:231], v244 offset:59904
    v_cvt_pk_bf16_f32 v188, v192, v193
    v_cvt_pk_bf16_f32 v189, v194, v195
    v_cvt_pk_bf16_f32 v190, v196, v197
    v_cvt_pk_bf16_f32 v191, v198, v199
    s_waitcnt lgkmcnt(11)
    v_mfma_f32_32x32x16_bf16 v[120:135], v[232:235], v[20:23], v[120:135]
    ds_read_b64_tr_b16 v[232:233], v245 offset:59392
    ds_read_b64_tr_b16 v[234:235], v245 offset:59904
    s_add_u32 s96, s13, 40960
    buffer_store_dwordx4 v[184:187], v1, s[64:67], s96 offen offset:0 sc1
    s_waitcnt lgkmcnt(11)
    v_mfma_f32_32x32x16_bf16 v[136:151], v[40:43], v[20:23], v[136:151]
    ds_read_b64_tr_b16 v[40:41], v250 offset:57344
    ds_read_b64_tr_b16 v[42:43], v250 offset:57856
    buffer_store_dwordx4 v[188:191], v1, s[64:67], s96 offen offset:1024 sc1
    s_waitcnt lgkmcnt(6)
    v_mfma_f32_16x16x32_bf16 v[216:219], v[44:47], v[236:239], v[216:219]
    ds_read_b64_tr_b16 v[44:45], v244 offset:61440
    ds_read_b64_tr_b16 v[46:47], v244 offset:61952
    v_cvt_pk_bf16_f32 v200, v200, v201
    v_mfma_f32_32x32x16_bf16 v[120:135], v[48:51], v[24:27], v[120:135]
    ds_read_b64_tr_b16 v[48:49], v245 offset:61440
    ds_read_b64_tr_b16 v[50:51], v245 offset:61952
    v_cvt_pk_bf16_f32 v201, v202, v203
    v_cvt_pk_bf16_f32 v202, v204, v205
    v_cvt_pk_bf16_f32 v203, v206, v207
    v_cvt_pk_bf16_f32 v204, v208, v209
    ds_read_b128 v[52:55], v240 offset:34816
    v_mfma_f32_32x32x16_bf16 v[136:151], v[224:227], v[24:27], v[136:151]
    ds_read_b64_tr_b16 v[224:225], v244 offset:63488
    ds_read_b64_tr_b16 v[226:227], v244 offset:64000
    v_cvt_pk_bf16_f32 v205, v210, v211
    v_cvt_pk_bf16_f32 v206, v212, v213
    v_cvt_pk_bf16_f32 v207, v214, v215
    buffer_store_dwordx4 v[200:203], v1, s[64:67], s96 offen offset:2048 sc1
    s_waitcnt lgkmcnt(11)
    v_mfma_f32_32x32x16_bf16 v[120:135], v[228:231], v[28:31], v[120:135]
    ds_read_b64_tr_b16 v[228:229], v245 offset:63488
    ds_read_b64_tr_b16 v[230:231], v245 offset:64000
    buffer_store_dwordx4 v[204:207], v1, s[64:67], s96 offen offset:3072 sc1
    s_waitcnt lgkmcnt(11)
    v_mfma_f32_32x32x16_bf16 v[136:151], v[232:235], v[28:31], v[136:151]
    ds_read_b64_tr_b16 v[232:233], v250 offset:61440
    ds_read_b64_tr_b16 v[234:235], v250 offset:61952
    v_cvt_pk_bf16_f32 v220, v220, v221
    v_cvt_pk_bf16_f32 v221, v222, v223
    s_add_u32 s75, s14, 40960
    buffer_store_dwordx2 v[220:221], v2, s[64:67], s75 offen offset:0 sc1
    s_waitcnt lgkmcnt(6)
    v_mfma_f32_16x16x32_bf16 v[216:219], v[40:43], v[52:55], v[216:219]
    v_mfma_f32_32x32x16_bf16 v[120:135], v[44:47], v[32:35], v[120:135]
    ds_read_b128 v[236:239], v240 offset:35840
    v_mfma_f32_32x32x16_bf16 v[136:151], v[48:51], v[32:35], v[136:151]
    s_waitcnt lgkmcnt(5)
    v_mfma_f32_32x32x16_bf16 v[120:135], v[224:227], v[36:39], v[120:135]
    s_waitcnt vmcnt(13)
    s_waitcnt lgkmcnt(0)
    s_barrier
    ds_read_b64_tr_b16 v[40:41], v246 offset:32768
    ds_read_b64_tr_b16 v[42:43], v246 offset:33280
    ds_read_b64_tr_b16 v[44:45], v247 offset:32768
    ds_read_b64_tr_b16 v[46:47], v247 offset:33280
    ds_read_b64_tr_b16 v[48:49], v246 offset:34816
    ds_read_b64_tr_b16 v[50:51], v246 offset:35328
    ds_read_b64_tr_b16 v[224:225], v247 offset:34816
    ds_read_b64_tr_b16 v[226:227], v247 offset:35328
    s_add_u32 s95, s8, 384
    s_add_u32 m0, s89, 49152
    s_nop 0
    buffer_load_dwordx4 v242, s[60:63], s95 offen offset:0 lds
    v_mfma_f32_32x32x16_bf16 v[136:151], v[228:231], v[36:39], v[136:151]
    ds_read_b64_tr_b16 v[228:229], v248 offset:32768
    ds_read_b64_tr_b16 v[230:231], v248 offset:33280
    v_mfma_f32_16x16x32_bf16 v[216:219], v[232:235], v[236:239], v[216:219]
    ds_read_b64_tr_b16 v[232:233], v246 offset:36864
    ds_read_b64_tr_b16 v[234:235], v246 offset:37376
    s_waitcnt lgkmcnt(10)
    v_mfma_f32_32x32x16_bf16 v[120:135], v[40:43], v[152:155], v[120:135]
    ds_read_b64_tr_b16 v[40:41], v247 offset:36864
    ds_read_b64_tr_b16 v[42:43], v247 offset:37376
    s_add_u32 s95, s8, 33152
    s_add_u32 m0, s89, 53248
    s_nop 0
    buffer_load_dwordx4 v242, s[60:63], s95 offen offset:0 lds
    ds_read_b128 v[52:55], v240 offset:36864
    s_waitcnt lgkmcnt(11)
    v_mfma_f32_32x32x16_bf16 v[136:151], v[44:47], v[152:155], v[136:151]
    ds_read_b64_tr_b16 v[44:45], v246 offset:38912
    ds_read_b64_tr_b16 v[46:47], v246 offset:39424
    s_waitcnt lgkmcnt(11)
    v_mfma_f32_32x32x16_bf16 v[120:135], v[48:51], v[156:159], v[120:135]
    ds_read_b64_tr_b16 v[48:49], v247 offset:38912
    ds_read_b64_tr_b16 v[50:51], v247 offset:39424
    s_add_u32 s95, s8, 65920
    s_add_u32 m0, s89, 57344
    s_nop 0
    buffer_load_dwordx4 v242, s[60:63], s95 offen offset:0 lds
    s_waitcnt lgkmcnt(11)
    v_mfma_f32_32x32x16_bf16 v[136:151], v[224:227], v[156:159], v[136:151]
    ds_read_b64_tr_b16 v[224:225], v248 offset:36864
    ds_read_b64_tr_b16 v[226:227], v248 offset:37376
    s_waitcnt lgkmcnt(6)
    v_mfma_f32_16x16x32_bf16 v[216:219], v[228:231], v[52:55], v[216:219]
    ds_read_b64_tr_b16 v[228:229], v246 offset:40960
    ds_read_b64_tr_b16 v[230:231], v246 offset:41472
    v_mfma_f32_32x32x16_bf16 v[120:135], v[232:235], v[160:163], v[120:135]
    ds_read_b64_tr_b16 v[232:233], v247 offset:40960
    ds_read_b64_tr_b16 v[234:235], v247 offset:41472
    s_add_u32 s95, s8, 98688
    s_add_u32 m0, s89, 61440
    s_nop 0
    buffer_load_dwordx4 v242, s[60:63], s95 offen offset:0 lds
    ds_read_b128 v[236:239], v240 offset:37888
    v_mfma_f32_32x32x16_bf16 v[136:151], v[40:43], v[160:163], v[136:151]
    ds_read_b64_tr_b16 v[40:41], v246 offset:43008
    ds_read_b64_tr_b16 v[42:43], v246 offset:43520
    s_waitcnt lgkmcnt(11)
    v_mfma_f32_32x32x16_bf16 v[120:135], v[44:47], v[164:167], v[120:135]
    ds_read_b64_tr_b16 v[44:45], v247 offset:43008
    ds_read_b64_tr_b16 v[46:47], v247 offset:43520
    s_waitcnt lgkmcnt(11)
    v_mfma_f32_32x32x16_bf16 v[136:151], v[48:51], v[164:167], v[136:151]
    ds_read_b64_tr_b16 v[48:49], v248 offset:40960
    ds_read_b64_tr_b16 v[50:51], v248 offset:41472
    s_waitcnt lgkmcnt(6)
    v_mfma_f32_16x16x32_bf16 v[216:219], v[224:227], v[236:239], v[216:219]
    ds_read_b64_tr_b16 v[224:225], v246 offset:45056
    ds_read_b64_tr_b16 v[226:227], v246 offset:45568
    v_mfma_f32_32x32x16_bf16 v[120:135], v[228:231], v[168:171], v[120:135]
    ds_read_b64_tr_b16 v[228:229], v247 offset:45056
    ds_read_b64_tr_b16 v[230:231], v247 offset:45568
    ds_read_b128 v[52:55], v240 offset:38912
    v_mfma_f32_32x32x16_bf16 v[136:151], v[232:235], v[168:171], v[136:151]
    ds_read_b64_tr_b16 v[232:233], v246 offset:47104
    ds_read_b64_tr_b16 v[234:235], v246 offset:47616
    s_waitcnt lgkmcnt(11)
    v_mfma_f32_32x32x16_bf16 v[120:135], v[40:43], v[172:175], v[120:135]
    ds_read_b64_tr_b16 v[40:41], v247 offset:47104
    ds_read_b64_tr_b16 v[42:43], v247 offset:47616
    s_waitcnt lgkmcnt(11)
    v_mfma_f32_32x32x16_bf16 v[136:151], v[44:47], v[172:175], v[136:151]
    ds_read_b64_tr_b16 v[44:45], v248 offset:45056
    ds_read_b64_tr_b16 v[46:47], v248 offset:45568
    s_waitcnt lgkmcnt(6)
    v_mfma_f32_16x16x32_bf16 v[216:219], v[48:51], v[52:55], v[216:219]
    v_mfma_f32_32x32x16_bf16 v[120:135], v[224:227], v[176:179], v[120:135]
    ds_read_b128 v[236:239], v240 offset:39936
    v_mfma_f32_32x32x16_bf16 v[136:151], v[228:231], v[176:179], v[136:151]
    s_waitcnt lgkmcnt(5)
    v_mfma_f32_32x32x16_bf16 v[120:135], v[232:235], v[180:183], v[120:135]
    s_waitcnt vmcnt(13)
    s_waitcnt lgkmcnt(0)
    s_barrier
    ds_read_b64_tr_b16 v[48:49], v244 offset:0
    ds_read_b64_tr_b16 v[50:51], v244 offset:512
    ds_read_b64_tr_b16 v[224:225], v245 offset:0
    ds_read_b64_tr_b16 v[226:227], v245 offset:512
    ds_read_b64_tr_b16 v[228:229], v244 offset:2048
    ds_read_b64_tr_b16 v[230:231], v244 offset:2560
    ds_read_b64_tr_b16 v[232:233], v245 offset:2048
    ds_read_b64_tr_b16 v[234:235], v245 offset:2560
    s_add_u32 s95, s9, 384
    s_add_u32 m0, s89, 65536
    s_nop 0
    buffer_load_dwordx4 v242, s[60:63], s95 offen offset:0 lds
    v_mfma_f32_32x32x16_bf16 v[136:151], v[40:43], v[180:183], v[136:151]
    ds_read_b64_tr_b16 v[40:41], v250 offset:0
    ds_read_b64_tr_b16 v[42:43], v250 offset:512
    v_mfma_f32_16x16x32_bf16 v[216:219], v[44:47], v[236:239], v[216:219]
    ds_read_b64_tr_b16 v[44:45], v244 offset:4096
    ds_read_b64_tr_b16 v[46:47], v244 offset:4608
    s_waitcnt lgkmcnt(10)
    v_mfma_f32_32x32x16_bf16 v[120:135], v[48:51], v[56:59], v[120:135]
    ds_read_b64_tr_b16 v[48:49], v245 offset:4096
    ds_read_b64_tr_b16 v[50:51], v245 offset:4608
    s_add_u32 s95, s9, 33152
    s_add_u32 m0, s89, 69632
    s_nop 0
    buffer_load_dwordx4 v242, s[60:63], s95 offen offset:0 lds
    ds_read_b128 v[52:55], v241 offset:32768
    s_waitcnt lgkmcnt(11)
    v_mfma_f32_32x32x16_bf16 v[136:151], v[224:227], v[56:59], v[136:151]
    ds_read_b64_tr_b16 v[224:225], v244 offset:6144
    ds_read_b64_tr_b16 v[226:227], v244 offset:6656
    s_waitcnt lgkmcnt(11)
    v_mfma_f32_32x32x16_bf16 v[120:135], v[228:231], v[60:63], v[120:135]
    ds_read_b64_tr_b16 v[228:229], v245 offset:6144
    ds_read_b64_tr_b16 v[230:231], v245 offset:6656
    s_add_u32 s95, s9, 65920
    s_add_u32 m0, s89, 73728
    s_nop 0
    buffer_load_dwordx4 v242, s[60:63], s95 offen offset:0 lds
    s_waitcnt lgkmcnt(11)
    v_mfma_f32_32x32x16_bf16 v[136:151], v[232:235], v[60:63], v[136:151]
    ds_read_b64_tr_b16 v[232:233], v250 offset:4096
    ds_read_b64_tr_b16 v[234:235], v250 offset:4608
    s_waitcnt lgkmcnt(6)
    v_mfma_f32_16x16x32_bf16 v[216:219], v[40:43], v[52:55], v[216:219]
    ds_read_b64_tr_b16 v[40:41], v244 offset:8192
    ds_read_b64_tr_b16 v[42:43], v244 offset:8704
    v_mfma_f32_32x32x16_bf16 v[120:135], v[44:47], v[64:67], v[120:135]
    ds_read_b64_tr_b16 v[44:45], v245 offset:8192
    ds_read_b64_tr_b16 v[46:47], v245 offset:8704
    s_add_u32 s95, s9, 98688
    s_add_u32 m0, s89, 77824
    s_nop 0
    buffer_load_dwordx4 v242, s[60:63], s95 offen offset:0 lds
    ds_read_b128 v[236:239], v241 offset:33792
    v_mfma_f32_32x32x16_bf16 v[136:151], v[48:51], v[64:67], v[136:151]
    ds_read_b64_tr_b16 v[48:49], v244 offset:10240
    ds_read_b64_tr_b16 v[50:51], v244 offset:10752
    s_waitcnt lgkmcnt(11)
    v_mfma_f32_32x32x16_bf16 v[120:135], v[224:227], v[68:71], v[120:135]
    ds_read_b64_tr_b16 v[224:225], v245 offset:10240
    ds_read_b64_tr_b16 v[226:227], v245 offset:10752
    s_waitcnt lgkmcnt(11)
    v_mfma_f32_32x32x16_bf16 v[136:151], v[228:231], v[68:71], v[136:151]
    ds_read_b64_tr_b16 v[228:229], v250 offset:8192
    ds_read_b64_tr_b16 v[230:231], v250 offset:8704
    s_waitcnt lgkmcnt(6)
    v_mfma_f32_16x16x32_bf16 v[216:219], v[232:235], v[236:239], v[216:219]
    ds_read_b64_tr_b16 v[232:233], v244 offset:12288
    ds_read_b64_tr_b16 v[234:235], v244 offset:12800
    v_mfma_f32_32x32x16_bf16 v[120:135], v[40:43], v[72:75], v[120:135]
    ds_read_b64_tr_b16 v[40:41], v245 offset:12288
    ds_read_b64_tr_b16 v[42:43], v245 offset:12800
    ds_read_b128 v[52:55], v241 offset:34816
    v_mfma_f32_32x32x16_bf16 v[136:151], v[44:47], v[72:75], v[136:151]
    ds_read_b64_tr_b16 v[44:45], v244 offset:14336
    ds_read_b64_tr_b16 v[46:47], v244 offset:14848
    s_waitcnt lgkmcnt(11)
    v_mfma_f32_32x32x16_bf16 v[120:135], v[48:51], v[76:79], v[120:135]
    ds_read_b64_tr_b16 v[48:49], v245 offset:14336
    ds_read_b64_tr_b16 v[50:51], v245 offset:14848
    s_waitcnt lgkmcnt(11)
    v_mfma_f32_32x32x16_bf16 v[136:151], v[224:227], v[76:79], v[136:151]
    ds_read_b64_tr_b16 v[224:225], v250 offset:12288
    ds_read_b64_tr_b16 v[226:227], v250 offset:12800
    s_waitcnt lgkmcnt(6)
    v_mfma_f32_16x16x32_bf16 v[216:219], v[228:231], v[52:55], v[216:219]
    v_mfma_f32_32x32x16_bf16 v[120:135], v[232:235], v[80:83], v[120:135]
    ds_read_b128 v[236:239], v241 offset:35840
    v_mfma_f32_32x32x16_bf16 v[136:151], v[40:43], v[80:83], v[136:151]
    s_waitcnt lgkmcnt(5)
    v_mfma_f32_32x32x16_bf16 v[120:135], v[44:47], v[84:87], v[120:135]
    s_waitcnt vmcnt(13)
    s_waitcnt lgkmcnt(0)
    s_barrier
    ds_read_b64_tr_b16 v[228:229], v244 offset:16384
    ds_read_b64_tr_b16 v[230:231], v244 offset:16896
    ds_read_b64_tr_b16 v[232:233], v245 offset:16384
    ds_read_b64_tr_b16 v[234:235], v245 offset:16896
    ds_read_b64_tr_b16 v[40:41], v244 offset:18432
    ds_read_b64_tr_b16 v[42:43], v244 offset:18944
    ds_read_b64_tr_b16 v[44:45], v245 offset:18432
    ds_read_b64_tr_b16 v[46:47], v245 offset:18944
    s_add_u32 s95, s10, 384
    s_mov_b32 m0, s89
    s_nop 0
    buffer_load_dwordx4 v242, s[60:63], s95 offen offset:0 lds
    v_mfma_f32_32x32x16_bf16 v[136:151], v[48:51], v[84:87], v[136:151]
    ds_read_b64_tr_b16 v[48:49], v250 offset:16384
    ds_read_b64_tr_b16 v[50:51], v250 offset:16896
    v_mfma_f32_16x16x32_bf16 v[216:219], v[224:227], v[236:239], v[216:219]
    ds_read_b64_tr_b16 v[224:225], v244 offset:20480
    ds_read_b64_tr_b16 v[226:227], v244 offset:20992
    s_waitcnt lgkmcnt(10)
    v_mfma_f32_32x32x16_bf16 v[120:135], v[228:231], v[88:91], v[120:135]
    ds_read_b64_tr_b16 v[228:229], v245 offset:20480
    ds_read_b64_tr_b16 v[230:231], v245 offset:20992
    s_add_u32 s95, s10, 33152
    s_add_u32 m0, s89, 4096
    s_nop 0
    buffer_load_dwordx4 v242, s[60:63], s95 offen offset:0 lds
    ds_read_b128 v[52:55], v241 offset:36864
    s_waitcnt lgkmcnt(11)
    v_mfma_f32_32x32x16_bf16 v[136:151], v[232:235], v[88:91], v[136:151]
    ds_read_b64_tr_b16 v[232:233], v244 offset:22528
    ds_read_b64_tr_b16 v[234:235], v244 offset:23040
    s_waitcnt lgkmcnt(11)
    v_mfma_f32_32x32x16_bf16 v[120:135], v[40:43], v[92:95], v[120:135]
    ds_read_b64_tr_b16 v[40:41], v245 offset:22528
    ds_read_b64_tr_b16 v[42:43], v245 offset:23040
    s_add_u32 s95, s10, 65920
    s_add_u32 m0, s89, 8192
    s_nop 0
    buffer_load_dwordx4 v242, s[60:63], s95 offen offset:0 lds
    s_waitcnt lgkmcnt(11)
    v_mfma_f32_32x32x16_bf16 v[136:151], v[44:47], v[92:95], v[136:151]
    ds_read_b64_tr_b16 v[44:45], v250 offset:20480
    ds_read_b64_tr_b16 v[46:47], v250 offset:20992
    s_waitcnt lgkmcnt(6)
    v_mfma_f32_16x16x32_bf16 v[216:219], v[48:51], v[52:55], v[216:219]
    ds_read_b64_tr_b16 v[48:49], v244 offset:24576
    ds_read_b64_tr_b16 v[50:51], v244 offset:25088
    v_mfma_f32_32x32x16_bf16 v[120:135], v[224:227], v[96:99], v[120:135]
    ds_read_b64_tr_b16 v[224:225], v245 offset:24576
    ds_read_b64_tr_b16 v[226:227], v245 offset:25088
    s_add_u32 s95, s10, 98688
    s_add_u32 m0, s89, 12288
    s_nop 0
    buffer_load_dwordx4 v242, s[60:63], s95 offen offset:0 lds
    ds_read_b128 v[236:239], v241 offset:37888
    v_mfma_f32_32x32x16_bf16 v[136:151], v[228:231], v[96:99], v[136:151]
    ds_read_b64_tr_b16 v[228:229], v244 offset:26624
    ds_read_b64_tr_b16 v[230:231], v244 offset:27136
    s_waitcnt lgkmcnt(11)
    v_mfma_f32_32x32x16_bf16 v[120:135], v[232:235], v[100:103], v[120:135]
    ds_read_b64_tr_b16 v[232:233], v245 offset:26624
    ds_read_b64_tr_b16 v[234:235], v245 offset:27136
    s_waitcnt lgkmcnt(11)
    v_mfma_f32_32x32x16_bf16 v[136:151], v[40:43], v[100:103], v[136:151]
    ds_read_b64_tr_b16 v[40:41], v250 offset:24576
    ds_read_b64_tr_b16 v[42:43], v250 offset:25088
    s_waitcnt lgkmcnt(6)
    v_mfma_f32_16x16x32_bf16 v[216:219], v[44:47], v[236:239], v[216:219]
    ds_read_b64_tr_b16 v[44:45], v244 offset:28672
    ds_read_b64_tr_b16 v[46:47], v244 offset:29184
    v_mfma_f32_32x32x16_bf16 v[120:135], v[48:51], v[104:107], v[120:135]
    ds_read_b64_tr_b16 v[48:49], v245 offset:28672
    ds_read_b64_tr_b16 v[50:51], v245 offset:29184
    ds_read_b128 v[52:55], v241 offset:38912
    v_mfma_f32_32x32x16_bf16 v[136:151], v[224:227], v[104:107], v[136:151]
    ds_read_b64_tr_b16 v[224:225], v244 offset:30720
    ds_read_b64_tr_b16 v[226:227], v244 offset:31232
    s_waitcnt lgkmcnt(11)
    v_mfma_f32_32x32x16_bf16 v[120:135], v[228:231], v[108:111], v[120:135]
    ds_read_b64_tr_b16 v[228:229], v245 offset:30720
    ds_read_b64_tr_b16 v[230:231], v245 offset:31232
    s_waitcnt lgkmcnt(11)
    v_mfma_f32_32x32x16_bf16 v[136:151], v[232:235], v[108:111], v[136:151]
    ds_read_b64_tr_b16 v[232:233], v250 offset:28672
    ds_read_b64_tr_b16 v[234:235], v250 offset:29184
    s_waitcnt lgkmcnt(6)
    v_mfma_f32_16x16x32_bf16 v[216:219], v[40:43], v[52:55], v[216:219]
    v_mfma_f32_32x32x16_bf16 v[120:135], v[44:47], v[112:115], v[120:135]
    ds_read_b128 v[236:239], v241 offset:39936
    v_mfma_f32_32x32x16_bf16 v[136:151], v[48:51], v[112:115], v[136:151]
    s_waitcnt lgkmcnt(5)
    v_mfma_f32_32x32x16_bf16 v[120:135], v[224:227], v[116:119], v[120:135]
    s_waitcnt vmcnt(8)
    s_waitcnt lgkmcnt(0)
    s_barrier
    ds_read_b64_tr_b16 v[40:41], v244 offset:49152
    ds_read_b64_tr_b16 v[42:43], v244 offset:49664
    ds_read_b64_tr_b16 v[44:45], v245 offset:49152
    ds_read_b64_tr_b16 v[46:47], v245 offset:49664
    ds_read_b64_tr_b16 v[48:49], v244 offset:51200
    ds_read_b64_tr_b16 v[50:51], v244 offset:51712
    ds_read_b64_tr_b16 v[224:225], v245 offset:51200
    ds_read_b64_tr_b16 v[226:227], v245 offset:51712
    s_add_u32 s95, s11, 384
    s_add_u32 m0, s89, 16384
    s_nop 0
    buffer_load_dwordx4 v242, s[60:63], s95 offen offset:0 lds
    v_mfma_f32_32x32x16_bf16 v[136:151], v[228:231], v[116:119], v[136:151]
    ds_read_b64_tr_b16 v[228:229], v250 offset:49152
    ds_read_b64_tr_b16 v[230:231], v250 offset:49664
    v_mfma_f32_16x16x32_bf16 v[216:219], v[232:235], v[236:239], v[216:219]
    ds_read_b64_tr_b16 v[232:233], v244 offset:53248
    ds_read_b64_tr_b16 v[234:235], v244 offset:53760
    s_waitcnt lgkmcnt(10)
    v_mfma_f32_32x32x16_bf16 v[184:199], v[40:43], v[8:11], 0
    ds_read_b64_tr_b16 v[40:41], v245 offset:53248
    ds_read_b64_tr_b16 v[42:43], v245 offset:53760
    s_add_u32 s95, s11, 33152
    s_add_u32 m0, s89, 20480
    s_nop 0
    buffer_load_dwordx4 v242, s[60:63], s95 offen offset:0 lds
    ds_read_b128 v[52:55], v240 offset:32768
    s_waitcnt lgkmcnt(11)
    v_mfma_f32_32x32x16_bf16 v[200:215], v[44:47], v[8:11], 0
    ds_read_b64_tr_b16 v[44:45], v244 offset:55296
    ds_read_b64_tr_b16 v[46:47], v244 offset:55808
    s_waitcnt lgkmcnt(11)
    v_mfma_f32_32x32x16_bf16 v[184:199], v[48:51], v[12:15], v[184:199]
    ds_read_b64_tr_b16 v[48:49], v245 offset:55296
    ds_read_b64_tr_b16 v[50:51], v245 offset:55808
    s_add_u32 s95, s11, 65920
    s_add_u32 m0, s89, 24576
    s_nop 0
    buffer_load_dwordx4 v242, s[60:63], s95 offen offset:0 lds
    s_waitcnt lgkmcnt(11)
    v_mfma_f32_32x32x16_bf16 v[200:215], v[224:227], v[12:15], v[200:215]
    ds_read_b64_tr_b16 v[224:225], v250 offset:53248
    ds_read_b64_tr_b16 v[226:227], v250 offset:53760
    s_waitcnt lgkmcnt(6)
    v_mfma_f32_16x16x32_bf16 v[220:223], v[228:231], v[52:55], 0
    ds_read_b64_tr_b16 v[228:229], v244 offset:57344
    ds_read_b64_tr_b16 v[230:231], v244 offset:57856
    v_mfma_f32_32x32x16_bf16 v[184:199], v[232:235], v[16:19], v[184:199]
    ds_read_b64_tr_b16 v[232:233], v245 offset:57344
    ds_read_b64_tr_b16 v[234:235], v245 offset:57856
    s_add_u32 s95, s11, 98688
    s_add_u32 m0, s89, 28672
    s_nop 0
    buffer_load_dwordx4 v242, s[60:63], s95 offen offset:0 lds
    v_cvt_pk_bf16_f32 v120, v120, v121
    v_cvt_pk_bf16_f32 v121, v122, v123
    v_cvt_pk_bf16_f32 v122, v124, v125
    v_cvt_pk_bf16_f32 v123, v126, v127
    ds_read_b128 v[236:239], v240 offset:33792
    v_mfma_f32_32x32x16_bf16 v[200:215], v[40:43], v[16:19], v[200:215]
    ds_read_b64_tr_b16 v[40:41], v244 offset:59392
    ds_read_b64_tr_b16 v[42:43], v244 offset:59904
    v_cvt_pk_bf16_f32 v124, v128, v129
    v_cvt_pk_bf16_f32 v125, v130, v131
    v_cvt_pk_bf16_f32 v126, v132, v133
    v_cvt_pk_bf16_f32 v127, v134, v135
    s_waitcnt lgkmcnt(11)
    v_mfma_f32_32x32x16_bf16 v[184:199], v[44:47], v[20:23], v[184:199]
    ds_read_b64_tr_b16 v[44:45], v245 offset:59392
    ds_read_b64_tr_b16 v[46:47], v245 offset:59904
    s_add_u32 s96, s13, 81920
    buffer_store_dwordx4 v[120:123], v1, s[64:67], s96 offen offset:0 sc1
    s_waitcnt lgkmcnt(11)
    v_mfma_f32_32x32x16_bf16 v[200:215], v[48:51], v[20:23], v[200:215]
    ds_read_b64_tr_b16 v[48:49], v250 offset:57344
    ds_read_b64_tr_b16 v[50:51], v250 offset:57856
    buffer_store_dwordx4 v[124:127], v1, s[64:67], s96 offen offset:1024 sc1
    s_waitcnt lgkmcnt(6)
    v_mfma_f32_16x16x32_bf16 v[220:223], v[224:227], v[236:239], v[220:223]
    ds_read_b64_tr_b16 v[224:225], v244 offset:61440
    ds_read_b64_tr_b16 v[226:227], v244 offset:61952
    v_cvt_pk_bf16_f32 v136, v136, v137
    v_mfma_f32_32x32x16_bf16 v[184:199], v[228:231], v[24:27], v[184:199]
    ds_read_b64_tr_b16 v[228:229], v245 offset:61440
    ds_read_b64_tr_b16 v[230:231], v245 offset:61952
    v_cvt_pk_bf16_f32 v137, v138, v139
    v_cvt_pk_bf16_f32 v138, v140, v141
    v_cvt_pk_bf16_f32 v139, v142, v143
    v_cvt_pk_bf16_f32 v140, v144, v145
    ds_read_b128 v[52:55], v240 offset:34816
    v_mfma_f32_32x32x16_bf16 v[200:215], v[232:235], v[24:27], v[200:215]
    ds_read_b64_tr_b16 v[232:233], v244 offset:63488
    ds_read_b64_tr_b16 v[234:235], v244 offset:64000
    v_cvt_pk_bf16_f32 v141, v146, v147
    v_cvt_pk_bf16_f32 v142, v148, v149
    v_cvt_pk_bf16_f32 v143, v150, v151
    buffer_store_dwordx4 v[136:139], v1, s[64:67], s96 offen offset:2048 sc1
    s_waitcnt lgkmcnt(11)
    v_mfma_f32_32x32x16_bf16 v[184:199], v[40:43], v[28:31], v[184:199]
    ds_read_b64_tr_b16 v[40:41], v245 offset:63488
    ds_read_b64_tr_b16 v[42:43], v245 offset:64000
    buffer_store_dwordx4 v[140:143], v1, s[64:67], s96 offen offset:3072 sc1
    s_waitcnt lgkmcnt(11)
    v_mfma_f32_32x32x16_bf16 v[200:215], v[44:47], v[28:31], v[200:215]
    ds_read_b64_tr_b16 v[44:45], v250 offset:61440
    ds_read_b64_tr_b16 v[46:47], v250 offset:61952
    v_cvt_pk_bf16_f32 v216, v216, v217
    v_cvt_pk_bf16_f32 v217, v218, v219
    s_add_u32 s75, s14, 81920
    buffer_store_dwordx2 v[216:217], v2, s[64:67], s75 offen offset:0 sc1
    s_waitcnt lgkmcnt(6)
    v_mfma_f32_16x16x32_bf16 v[220:223], v[48:51], v[52:55], v[220:223]
    v_mfma_f32_32x32x16_bf16 v[184:199], v[224:227], v[32:35], v[184:199]
    ds_read_b128 v[236:239], v240 offset:35840
    v_mfma_f32_32x32x16_bf16 v[200:215], v[228:231], v[32:35], v[200:215]
    s_waitcnt lgkmcnt(5)
    v_mfma_f32_32x32x16_bf16 v[184:199], v[232:235], v[36:39], v[184:199]
    s_waitcnt vmcnt(13)
    s_waitcnt lgkmcnt(0)
    s_barrier
    ds_read_b64_tr_b16 v[48:49], v246 offset:32768
    ds_read_b64_tr_b16 v[50:51], v246 offset:33280
    ds_read_b64_tr_b16 v[224:225], v247 offset:32768
    ds_read_b64_tr_b16 v[226:227], v247 offset:33280
    ds_read_b64_tr_b16 v[228:229], v246 offset:34816
    ds_read_b64_tr_b16 v[230:231], v246 offset:35328
    ds_read_b64_tr_b16 v[232:233], v247 offset:34816
    ds_read_b64_tr_b16 v[234:235], v247 offset:35328
    v_mfma_f32_32x32x16_bf16 v[200:215], v[40:43], v[36:39], v[200:215]
    ds_read_b64_tr_b16 v[40:41], v248 offset:32768
    ds_read_b64_tr_b16 v[42:43], v248 offset:33280
    v_mfma_f32_16x16x32_bf16 v[220:223], v[44:47], v[236:239], v[220:223]
    ds_read_b64_tr_b16 v[44:45], v246 offset:36864
    ds_read_b64_tr_b16 v[46:47], v246 offset:37376
    s_waitcnt lgkmcnt(10)
    v_mfma_f32_32x32x16_bf16 v[184:199], v[48:51], v[152:155], v[184:199]
    ds_read_b64_tr_b16 v[48:49], v247 offset:36864
    ds_read_b64_tr_b16 v[50:51], v247 offset:37376
    ds_read_b128 v[52:55], v240 offset:36864
    s_waitcnt lgkmcnt(11)
    v_mfma_f32_32x32x16_bf16 v[200:215], v[224:227], v[152:155], v[200:215]
    ds_read_b64_tr_b16 v[224:225], v246 offset:38912
    ds_read_b64_tr_b16 v[226:227], v246 offset:39424
    s_waitcnt lgkmcnt(11)
    v_mfma_f32_32x32x16_bf16 v[184:199], v[228:231], v[156:159], v[184:199]
    ds_read_b64_tr_b16 v[228:229], v247 offset:38912
    ds_read_b64_tr_b16 v[230:231], v247 offset:39424
    s_waitcnt lgkmcnt(11)
    v_mfma_f32_32x32x16_bf16 v[200:215], v[232:235], v[156:159], v[200:215]
    ds_read_b64_tr_b16 v[232:233], v248 offset:36864
    ds_read_b64_tr_b16 v[234:235], v248 offset:37376
    s_waitcnt lgkmcnt(6)
    v_mfma_f32_16x16x32_bf16 v[220:223], v[40:43], v[52:55], v[220:223]
    ds_read_b64_tr_b16 v[40:41], v246 offset:40960
    ds_read_b64_tr_b16 v[42:43], v246 offset:41472
    v_mfma_f32_32x32x16_bf16 v[184:199], v[44:47], v[160:163], v[184:199]
    ds_read_b64_tr_b16 v[44:45], v247 offset:40960
    ds_read_b64_tr_b16 v[46:47], v247 offset:41472
    ds_read_b128 v[236:239], v240 offset:37888
    v_mfma_f32_32x32x16_bf16 v[200:215], v[48:51], v[160:163], v[200:215]
    ds_read_b64_tr_b16 v[48:49], v246 offset:43008
    ds_read_b64_tr_b16 v[50:51], v246 offset:43520
    s_waitcnt lgkmcnt(11)
    v_mfma_f32_32x32x16_bf16 v[184:199], v[224:227], v[164:167], v[184:199]
    ds_read_b64_tr_b16 v[224:225], v247 offset:43008
    ds_read_b64_tr_b16 v[226:227], v247 offset:43520
    s_waitcnt lgkmcnt(11)
    v_mfma_f32_32x32x16_bf16 v[200:215], v[228:231], v[164:167], v[200:215]
    ds_read_b64_tr_b16 v[228:229], v248 offset:40960
    ds_read_b64_tr_b16 v[230:231], v248 offset:41472
    s_waitcnt lgkmcnt(6)
    v_mfma_f32_16x16x32_bf16 v[220:223], v[232:235], v[236:239], v[220:223]
    ds_read_b64_tr_b16 v[232:233], v246 offset:45056
    ds_read_b64_tr_b16 v[234:235], v246 offset:45568
    v_mfma_f32_32x32x16_bf16 v[184:199], v[40:43], v[168:171], v[184:199]
    ds_read_b64_tr_b16 v[40:41], v247 offset:45056
    ds_read_b64_tr_b16 v[42:43], v247 offset:45568
    ds_read_b128 v[52:55], v240 offset:38912
    v_mfma_f32_32x32x16_bf16 v[200:215], v[44:47], v[168:171], v[200:215]
    ds_read_b64_tr_b16 v[44:45], v246 offset:47104
    ds_read_b64_tr_b16 v[46:47], v246 offset:47616
    s_waitcnt lgkmcnt(11)
    v_mfma_f32_32x32x16_bf16 v[184:199], v[48:51], v[172:175], v[184:199]
    ds_read_b64_tr_b16 v[48:49], v247 offset:47104
    ds_read_b64_tr_b16 v[50:51], v247 offset:47616
    s_waitcnt lgkmcnt(11)
    v_mfma_f32_32x32x16_bf16 v[200:215], v[224:227], v[172:175], v[200:215]
    ds_read_b64_tr_b16 v[224:225], v248 offset:45056
    ds_read_b64_tr_b16 v[226:227], v248 offset:45568
    s_waitcnt lgkmcnt(6)
    v_mfma_f32_16x16x32_bf16 v[220:223], v[228:231], v[52:55], v[220:223]
    v_mfma_f32_32x32x16_bf16 v[184:199], v[232:235], v[176:179], v[184:199]
    ds_read_b128 v[236:239], v240 offset:39936
    v_mfma_f32_32x32x16_bf16 v[200:215], v[40:43], v[176:179], v[200:215]
    s_waitcnt lgkmcnt(5)
    v_mfma_f32_32x32x16_bf16 v[184:199], v[44:47], v[180:183], v[184:199]
    s_waitcnt vmcnt(9)
    s_waitcnt lgkmcnt(0)
    s_barrier
    ds_read_b64_tr_b16 v[228:229], v244 offset:0
    ds_read_b64_tr_b16 v[230:231], v244 offset:512
    ds_read_b64_tr_b16 v[232:233], v245 offset:0
    ds_read_b64_tr_b16 v[234:235], v245 offset:512
    ds_read_b64_tr_b16 v[40:41], v244 offset:2048
    ds_read_b64_tr_b16 v[42:43], v244 offset:2560
    ds_read_b64_tr_b16 v[44:45], v245 offset:2048
    ds_read_b64_tr_b16 v[46:47], v245 offset:2560
    v_mfma_f32_32x32x16_bf16 v[200:215], v[48:51], v[180:183], v[200:215]
    ds_read_b64_tr_b16 v[48:49], v250 offset:0
    ds_read_b64_tr_b16 v[50:51], v250 offset:512
    v_mfma_f32_16x16x32_bf16 v[220:223], v[224:227], v[236:239], v[220:223]
    ds_read_b64_tr_b16 v[224:225], v244 offset:4096
    ds_read_b64_tr_b16 v[226:227], v244 offset:4608
    s_waitcnt lgkmcnt(10)
    v_mfma_f32_32x32x16_bf16 v[184:199], v[228:231], v[56:59], v[184:199]
    ds_read_b64_tr_b16 v[228:229], v245 offset:4096
    ds_read_b64_tr_b16 v[230:231], v245 offset:4608
    ds_read_b128 v[52:55], v241 offset:32768
    s_waitcnt lgkmcnt(11)
    v_mfma_f32_32x32x16_bf16 v[200:215], v[232:235], v[56:59], v[200:215]
    ds_read_b64_tr_b16 v[232:233], v244 offset:6144
    ds_read_b64_tr_b16 v[234:235], v244 offset:6656
    s_waitcnt lgkmcnt(11)
    v_mfma_f32_32x32x16_bf16 v[184:199], v[40:43], v[60:63], v[184:199]
    ds_read_b64_tr_b16 v[40:41], v245 offset:6144
    ds_read_b64_tr_b16 v[42:43], v245 offset:6656
    s_waitcnt lgkmcnt(11)
    v_mfma_f32_32x32x16_bf16 v[200:215], v[44:47], v[60:63], v[200:215]
    ds_read_b64_tr_b16 v[44:45], v250 offset:4096
    ds_read_b64_tr_b16 v[46:47], v250 offset:4608
    s_waitcnt lgkmcnt(6)
    v_mfma_f32_16x16x32_bf16 v[220:223], v[48:51], v[52:55], v[220:223]
    ds_read_b64_tr_b16 v[48:49], v244 offset:8192
    ds_read_b64_tr_b16 v[50:51], v244 offset:8704
    v_mfma_f32_32x32x16_bf16 v[184:199], v[224:227], v[64:67], v[184:199]
    ds_read_b64_tr_b16 v[224:225], v245 offset:8192
    ds_read_b64_tr_b16 v[226:227], v245 offset:8704
    ds_read_b128 v[236:239], v241 offset:33792
    v_mfma_f32_32x32x16_bf16 v[200:215], v[228:231], v[64:67], v[200:215]
    ds_read_b64_tr_b16 v[228:229], v244 offset:10240
    ds_read_b64_tr_b16 v[230:231], v244 offset:10752
    s_waitcnt lgkmcnt(11)
    v_mfma_f32_32x32x16_bf16 v[184:199], v[232:235], v[68:71], v[184:199]
    ds_read_b64_tr_b16 v[232:233], v245 offset:10240
    ds_read_b64_tr_b16 v[234:235], v245 offset:10752
    s_waitcnt lgkmcnt(11)
    v_mfma_f32_32x32x16_bf16 v[200:215], v[40:43], v[68:71], v[200:215]
    ds_read_b64_tr_b16 v[40:41], v250 offset:8192
    ds_read_b64_tr_b16 v[42:43], v250 offset:8704
    s_waitcnt lgkmcnt(6)
    v_mfma_f32_16x16x32_bf16 v[220:223], v[44:47], v[236:239], v[220:223]
    ds_read_b64_tr_b16 v[44:45], v244 offset:12288
    ds_read_b64_tr_b16 v[46:47], v244 offset:12800
    v_mfma_f32_32x32x16_bf16 v[184:199], v[48:51], v[72:75], v[184:199]
    ds_read_b64_tr_b16 v[48:49], v245 offset:12288
    ds_read_b64_tr_b16 v[50:51], v245 offset:12800
    ds_read_b128 v[52:55], v241 offset:34816
    v_mfma_f32_32x32x16_bf16 v[200:215], v[224:227], v[72:75], v[200:215]
    ds_read_b64_tr_b16 v[224:225], v244 offset:14336
    ds_read_b64_tr_b16 v[226:227], v244 offset:14848
    s_waitcnt lgkmcnt(11)
    v_mfma_f32_32x32x16_bf16 v[184:199], v[228:231], v[76:79], v[184:199]
    ds_read_b64_tr_b16 v[228:229], v245 offset:14336
    ds_read_b64_tr_b16 v[230:231], v245 offset:14848
    s_waitcnt lgkmcnt(11)
    v_mfma_f32_32x32x16_bf16 v[200:215], v[232:235], v[76:79], v[200:215]
    ds_read_b64_tr_b16 v[232:233], v250 offset:12288
    ds_read_b64_tr_b16 v[234:235], v250 offset:12800
    s_waitcnt lgkmcnt(6)
    v_mfma_f32_16x16x32_bf16 v[220:223], v[40:43], v[52:55], v[220:223]
    v_mfma_f32_32x32x16_bf16 v[184:199], v[44:47], v[80:83], v[184:199]
    ds_read_b128 v[236:239], v241 offset:35840
    v_mfma_f32_32x32x16_bf16 v[200:215], v[48:51], v[80:83], v[200:215]
    s_waitcnt lgkmcnt(5)
    v_mfma_f32_32x32x16_bf16 v[184:199], v[224:227], v[84:87], v[184:199]
    s_waitcnt vmcnt(5)
    s_waitcnt lgkmcnt(0)
    s_barrier
    ds_read_b64_tr_b16 v[40:41], v244 offset:16384
    ds_read_b64_tr_b16 v[42:43], v244 offset:16896
    ds_read_b64_tr_b16 v[44:45], v245 offset:16384
    ds_read_b64_tr_b16 v[46:47], v245 offset:16896
    ds_read_b64_tr_b16 v[48:49], v244 offset:18432
    ds_read_b64_tr_b16 v[50:51], v244 offset:18944
    ds_read_b64_tr_b16 v[224:225], v245 offset:18432
    ds_read_b64_tr_b16 v[226:227], v245 offset:18944
    v_mfma_f32_32x32x16_bf16 v[200:215], v[228:231], v[84:87], v[200:215]
    ds_read_b64_tr_b16 v[228:229], v250 offset:16384
    ds_read_b64_tr_b16 v[230:231], v250 offset:16896
    v_mfma_f32_16x16x32_bf16 v[220:223], v[232:235], v[236:239], v[220:223]
    ds_read_b64_tr_b16 v[232:233], v244 offset:20480
    ds_read_b64_tr_b16 v[234:235], v244 offset:20992
    s_waitcnt lgkmcnt(10)
    v_mfma_f32_32x32x16_bf16 v[184:199], v[40:43], v[88:91], v[184:199]
    ds_read_b64_tr_b16 v[40:41], v245 offset:20480
    ds_read_b64_tr_b16 v[42:43], v245 offset:20992
    ds_read_b128 v[52:55], v241 offset:36864
    s_waitcnt lgkmcnt(11)
    v_mfma_f32_32x32x16_bf16 v[200:215], v[44:47], v[88:91], v[200:215]
    ds_read_b64_tr_b16 v[44:45], v244 offset:22528
    ds_read_b64_tr_b16 v[46:47], v244 offset:23040
    s_waitcnt lgkmcnt(11)
    v_mfma_f32_32x32x16_bf16 v[184:199], v[48:51], v[92:95], v[184:199]
    ds_read_b64_tr_b16 v[48:49], v245 offset:22528
    ds_read_b64_tr_b16 v[50:51], v245 offset:23040
    s_waitcnt lgkmcnt(11)
    v_mfma_f32_32x32x16_bf16 v[200:215], v[224:227], v[92:95], v[200:215]
    ds_read_b64_tr_b16 v[224:225], v250 offset:20480
    ds_read_b64_tr_b16 v[226:227], v250 offset:20992
    s_waitcnt lgkmcnt(6)
    v_mfma_f32_16x16x32_bf16 v[220:223], v[228:231], v[52:55], v[220:223]
    ds_read_b64_tr_b16 v[228:229], v244 offset:24576
    ds_read_b64_tr_b16 v[230:231], v244 offset:25088
    v_mfma_f32_32x32x16_bf16 v[184:199], v[232:235], v[96:99], v[184:199]
    ds_read_b64_tr_b16 v[232:233], v245 offset:24576
    ds_read_b64_tr_b16 v[234:235], v245 offset:25088
    ds_read_b128 v[236:239], v241 offset:37888
    v_mfma_f32_32x32x16_bf16 v[200:215], v[40:43], v[96:99], v[200:215]
    ds_read_b64_tr_b16 v[40:41], v244 offset:26624
    ds_read_b64_tr_b16 v[42:43], v244 offset:27136
    s_waitcnt lgkmcnt(11)
    v_mfma_f32_32x32x16_bf16 v[184:199], v[44:47], v[100:103], v[184:199]
    ds_read_b64_tr_b16 v[44:45], v245 offset:26624
    ds_read_b64_tr_b16 v[46:47], v245 offset:27136
    s_waitcnt lgkmcnt(11)
    v_mfma_f32_32x32x16_bf16 v[200:215], v[48:51], v[100:103], v[200:215]
    ds_read_b64_tr_b16 v[48:49], v250 offset:24576
    ds_read_b64_tr_b16 v[50:51], v250 offset:25088
    s_waitcnt lgkmcnt(6)
    v_mfma_f32_16x16x32_bf16 v[220:223], v[224:227], v[236:239], v[220:223]
    ds_read_b64_tr_b16 v[224:225], v244 offset:28672
    ds_read_b64_tr_b16 v[226:227], v244 offset:29184
    v_mfma_f32_32x32x16_bf16 v[184:199], v[228:231], v[104:107], v[184:199]
    ds_read_b64_tr_b16 v[228:229], v245 offset:28672
    ds_read_b64_tr_b16 v[230:231], v245 offset:29184
    ds_read_b128 v[52:55], v241 offset:38912
    v_mfma_f32_32x32x16_bf16 v[200:215], v[232:235], v[104:107], v[200:215]
    ds_read_b64_tr_b16 v[232:233], v244 offset:30720
    ds_read_b64_tr_b16 v[234:235], v244 offset:31232
    s_waitcnt lgkmcnt(11)
    v_mfma_f32_32x32x16_bf16 v[184:199], v[40:43], v[108:111], v[184:199]
    ds_read_b64_tr_b16 v[40:41], v245 offset:30720
    ds_read_b64_tr_b16 v[42:43], v245 offset:31232
    s_waitcnt lgkmcnt(11)
    v_mfma_f32_32x32x16_bf16 v[200:215], v[44:47], v[108:111], v[200:215]
    ds_read_b64_tr_b16 v[44:45], v250 offset:28672
    ds_read_b64_tr_b16 v[46:47], v250 offset:29184
    s_waitcnt lgkmcnt(6)
    v_mfma_f32_16x16x32_bf16 v[220:223], v[48:51], v[52:55], v[220:223]
    v_mfma_f32_32x32x16_bf16 v[184:199], v[224:227], v[112:115], v[184:199]
    ds_read_b128 v[236:239], v241 offset:39936
    v_mfma_f32_32x32x16_bf16 v[200:215], v[228:231], v[112:115], v[200:215]
    s_waitcnt lgkmcnt(5)
    v_mfma_f32_32x32x16_bf16 v[184:199], v[232:235], v[116:119], v[184:199]
    s_waitcnt lgkmcnt(3)
    v_mfma_f32_32x32x16_bf16 v[200:215], v[40:43], v[116:119], v[200:215]
    s_waitcnt lgkmcnt(0)
    v_mfma_f32_16x16x32_bf16 v[220:223], v[44:47], v[236:239], v[220:223]
    s_nop 7
    v_cvt_pk_bf16_f32 v184, v184, v185
    v_cvt_pk_bf16_f32 v185, v186, v187
    v_cvt_pk_bf16_f32 v186, v188, v189
    v_cvt_pk_bf16_f32 v187, v190, v191
    v_cvt_pk_bf16_f32 v188, v192, v193
    v_cvt_pk_bf16_f32 v189, v194, v195
    v_cvt_pk_bf16_f32 v190, v196, v197
    v_cvt_pk_bf16_f32 v191, v198, v199
    s_add_u32 s96, s13, 122880
    buffer_store_dwordx4 v[184:187], v1, s[64:67], s96 offen offset:0 sc1
    buffer_store_dwordx4 v[188:191], v1, s[64:67], s96 offen offset:1024 sc1
    v_cvt_pk_bf16_f32 v200, v200, v201
    v_cvt_pk_bf16_f32 v201, v202, v203
    v_cvt_pk_bf16_f32 v202, v204, v205
    v_cvt_pk_bf16_f32 v203, v206, v207
    v_cvt_pk_bf16_f32 v204, v208, v209
    v_cvt_pk_bf16_f32 v205, v210, v211
    v_cvt_pk_bf16_f32 v206, v212, v213
    v_cvt_pk_bf16_f32 v207, v214, v215
    buffer_store_dwordx4 v[200:203], v1, s[64:67], s96 offen offset:2048 sc1
    buffer_store_dwordx4 v[204:207], v1, s[64:67], s96 offen offset:3072 sc1
    v_cvt_pk_bf16_f32 v220, v220, v221
    v_cvt_pk_bf16_f32 v221, v222, v223
    s_add_u32 s75, s14, 122880
    buffer_store_dwordx2 v[220:221], v2, s[64:67], s75 offen offset:0 sc1
L_k1_end:
    s_endpgm
L_slow_A01:
    s_nop 15
    v_mov_b32 v248, v246
    s_nop 1
    v_permlane32_swap_b32 v246, v248
    v_max_f32 v246, v246, v248
    v_mov_b32 v248, v247
    s_nop 1
    v_permlane32_swap_b32 v247, v248
    v_max_f32 v247, v247, v248
    v_mov_b32 v248, v247
    s_nop 1
    v_permlane16_swap_b32 v247, v248
    v_max_f32 v247, v247, v248
    v_max_f32 v246, 0, v246
    v_ceil_f32 v246, v246
    v_max_f32 v247, 0, v247
    v_ceil_f32 v247, v247
    v_sub_f32 v152, v152, v246
    v_sub_f32 v153, v153, v246
    v_sub_f32 v154, v154, v246
    v_sub_f32 v155, v155, v246
    v_sub_f32 v156, v156, v246
    v_sub_f32 v157, v157, v246
    v_sub_f32 v158, v158, v246
    v_sub_f32 v159, v159, v246
    v_sub_f32 v160, v160, v246
    v_sub_f32 v161, v161, v246
    v_sub_f32 v162, v162, v246
    v_sub_f32 v163, v163, v246
    v_sub_f32 v164, v164, v246
    v_sub_f32 v165, v165, v246
    v_sub_f32 v166, v166, v246
    v_sub_f32 v167, v167, v246
    v_sub_f32 v168, v168, v246
    v_sub_f32 v169, v169, v246
    v_sub_f32 v170, v170, v246
    v_sub_f32 v171, v171, v246
    v_sub_f32 v172, v172, v246
    v_sub_f32 v173, v173, v246
    v_sub_f32 v174, v174, v246
    v_sub_f32 v175, v175, v246
    v_sub_f32 v176, v176, v246
    v_sub_f32 v177, v177, v246
    v_sub_f32 v178, v178, v246
    v_sub_f32 v179, v179, v246
    v_sub_f32 v180, v180, v246
    v_sub_f32 v181, v181, v246
    v_sub_f32 v182, v182, v246
    v_sub_f32 v183, v183, v246
    v_sub_f32 v184, v184, v247
    v_sub_f32 v185, v185, v247
    v_sub_f32 v186, v186, v247
    v_sub_f32 v187, v187, v247
    v_sub_f32 v188, v188, v246
    v_sub_f32 v189, v189, v246
    v_sub_f32 v190, v190, v246
    v_sub_f32 v191, v191, v246
    v_sub_f32 v192, v192, v246
    v_sub_f32 v193, v193, v246
    v_sub_f32 v194, v194, v246
    v_sub_f32 v195, v195, v246
    v_sub_f32 v196, v196, v246
    v_sub_f32 v197, v197, v246
    v_sub_f32 v198, v198, v246
    v_sub_f32 v199, v199, v246
    v_sub_f32 v200, v200, v246
    v_sub_f32 v201, v201, v246
    v_sub_f32 v202, v202, v246
    v_sub_f32 v203, v203, v246
    v_sub_f32 v204, v204, v247
    v_sub_f32 v205, v205, v247
    v_sub_f32 v206, v206, v247
    v_sub_f32 v207, v207, v247
    v_sub_f32 v246, 0, v246
    v_sub_f32 v247, 0, v247
    v_exp_f32 v246, v246
    v_exp_f32 v247, v247
    v_mul_f32 v56, v56, v246
    v_mul_f32 v57, v57, v246
    v_mul_f32 v58, v58, v246
    v_mul_f32 v59, v59, v246
    v_mul_f32 v60, v60, v246
    v_mul_f32 v61, v61, v246
    v_mul_f32 v62, v62, v246
    v_mul_f32 v63, v63, v246
    v_mul_f32 v64, v64, v246
    v_mul_f32 v65, v65, v246
    v_mul_f32 v66, v66, v246
    v_mul_f32 v67, v67, v246
    v_mul_f32 v68, v68, v246
    v_mul_f32 v69, v69, v246
    v_mul_f32 v70, v70, v246
    v_mul_f32 v71, v71, v246
    v_mul_f32 v72, v72, v246
    v_mul_f32 v73, v73, v246
    v_mul_f32 v74, v74, v246
    v_mul_f32 v75, v75, v246
    v_mul_f32 v76, v76, v246
    v_mul_f32 v77, v77, v246
    v_mul_f32 v78, v78, v246
    v_mul_f32 v79, v79, v246
    v_mul_f32 v80, v80, v246
    v_mul_f32 v81, v81, v246
    v_mul_f32 v82, v82, v246
    v_mul_f32 v83, v83, v246
    v_mul_f32 v84, v84, v246
    v_mul_f32 v85, v85, v246
    v_mul_f32 v86, v86, v246
    v_mul_f32 v87, v87, v246
    v_mul_f32 v88, v88, v246
    v_mul_f32 v89, v89, v246
    v_mul_f32 v90, v90, v246
    v_mul_f32 v91, v91, v246
    v_mul_f32 v92, v92, v246
    v_mul_f32 v93, v93, v246
    v_mul_f32 v94, v94, v246
    v_mul_f32 v95, v95, v246
    v_mul_f32 v96, v96, v246
    v_mul_f32 v97, v97, v246
    v_mul_f32 v98, v98, v246
    v_mul_f32 v99, v99, v246
    v_mul_f32 v100, v100, v246
    v_mul_f32 v101, v101, v246
    v_mul_f32 v102, v102, v246
    v_mul_f32 v103, v103, v246
    v_mul_f32 v104, v104, v246
    v_mul_f32 v105, v105, v246
    v_mul_f32 v106, v106, v246
    v_mul_f32 v107, v107, v246
    v_mul_f32 v108, v108, v246
    v_mul_f32 v109, v109, v246
    v_mul_f32 v110, v110, v246
    v_mul_f32 v111, v111, v246
    v_mul_f32 v112, v112, v246
    v_mul_f32 v113, v113, v246
    v_mul_f32 v114, v114, v246
    v_mul_f32 v115, v115, v246
    v_mul_f32 v116, v116, v246
    v_mul_f32 v117, v117, v246
    v_mul_f32 v118, v118, v246
    v_mul_f32 v119, v119, v246
    v_mul_f32 v120, v120, v247
    v_mul_f32 v121, v121, v247
    v_mul_f32 v122, v122, v247
    v_mul_f32 v123, v123, v247
    v_mul_f32 v124, v124, v247
    v_mul_f32 v125, v125, v247
    v_mul_f32 v126, v126, v247
    v_mul_f32 v127, v127, v247
    v_mul_f32 v128, v128, v247
    v_mul_f32 v129, v129, v247
    v_mul_f32 v130, v130, v247
    v_mul_f32 v131, v131, v247
    v_mul_f32 v132, v132, v247
    v_mul_f32 v133, v133, v247
    v_mul_f32 v134, v134, v247
    v_mul_f32 v135, v135, v247
    v_mul_f32 v136, v136, v247
    v_mul_f32 v137, v137, v247
    v_mul_f32 v138, v138, v247
    v_mul_f32 v139, v139, v247
    v_mul_f32 v140, v140, v247
    v_mul_f32 v141, v141, v247
    v_mul_f32 v142, v142, v247
    v_mul_f32 v143, v143, v247
    v_mul_f32 v144, v144, v247
    v_mul_f32 v145, v145, v247
    v_mul_f32 v146, v146, v247
    v_mul_f32 v147, v147, v247
    v_mul_f32 v148, v148, v247
    v_mul_f32 v149, v149, v247
    v_mul_f32 v150, v150, v247
    v_mul_f32 v151, v151, v247
    v_mul_f32 v244, v244, v246
    v_mul_f32 v245, v245, v247
    s_nop 7
    s_branch L_back_A01
L_slow_B01:
    s_nop 15
    v_mov_b32 v248, v246
    s_nop 1
    v_permlane32_swap_b32 v246, v248
    v_max_f32 v246, v246, v248
    v_max_f32 v246, 0, v246
    v_ceil_f32 v246, v246
    v_sub_f32 v168, v168, v246
    v_sub_f32 v169, v169, v246
    v_sub_f32 v170, v170, v246
    v_sub_f32 v171, v171, v246
    v_sub_f32 v172, v172, v246
    v_sub_f32 v173, v173, v246
    v_sub_f32 v174, v174, v246
    v_sub_f32 v175, v175, v246
    v_sub_f32 v176, v176, v246
    v_sub_f32 v177, v177, v246
    v_sub_f32 v178, v178, v246
    v_sub_f32 v179, v179, v246
    v_sub_f32 v180, v180, v246
    v_sub_f32 v181, v181, v246
    v_sub_f32 v182, v182, v246
    v_sub_f32 v183, v183, v246
    v_sub_f32 v188, v188, v246
    v_sub_f32 v189, v189, v246
    v_sub_f32 v190, v190, v246
    v_sub_f32 v191, v191, v246
    v_sub_f32 v192, v192, v246
    v_sub_f32 v193, v193, v246
    v_sub_f32 v194, v194, v246
    v_sub_f32 v195, v195, v246
    v_sub_f32 v196, v196, v246
    v_sub_f32 v197, v197, v246
    v_sub_f32 v198, v198, v246
    v_sub_f32 v199, v199, v246
    v_sub_f32 v200, v200, v246
    v_sub_f32 v201, v201, v246
    v_sub_f32 v202, v202, v246
    v_sub_f32 v203, v203, v246
    v_sub_f32 v246, 0, v246
    v_exp_f32 v246, v246
    s_nop 0
    v_mul_f32 v56, v56, v246
    v_mul_f32 v57, v57, v246
    v_mul_f32 v58, v58, v246
    v_mul_f32 v59, v59, v246
    v_mul_f32 v60, v60, v246
    v_mul_f32 v61, v61, v246
    v_mul_f32 v62, v62, v246
    v_mul_f32 v63, v63, v246
    v_mul_f32 v64, v64, v246
    v_mul_f32 v65, v65, v246
    v_mul_f32 v66, v66, v246
    v_mul_f32 v67, v67, v246
    v_mul_f32 v68, v68, v246
    v_mul_f32 v69, v69, v246
    v_mul_f32 v70, v70, v246
    v_mul_f32 v71, v71, v246
    v_mul_f32 v72, v72, v246
    v_mul_f32 v73, v73, v246
    v_mul_f32 v74, v74, v246
    v_mul_f32 v75, v75, v246
    v_mul_f32 v76, v76, v246
    v_mul_f32 v77, v77, v246
    v_mul_f32 v78, v78, v246
    v_mul_f32 v79, v79, v246
    v_mul_f32 v80, v80, v246
    v_mul_f32 v81, v81, v246
    v_mul_f32 v82, v82, v246
    v_mul_f32 v83, v83, v246
    v_mul_f32 v84, v84, v246
    v_mul_f32 v85, v85, v246
    v_mul_f32 v86, v86, v246
    v_mul_f32 v87, v87, v246
    v_mul_f32 v88, v88, v246
    v_mul_f32 v89, v89, v246
    v_mul_f32 v90, v90, v246
    v_mul_f32 v91, v91, v246
    v_mul_f32 v92, v92, v246
    v_mul_f32 v93, v93, v246
    v_mul_f32 v94, v94, v246
    v_mul_f32 v95, v95, v246
    v_mul_f32 v96, v96, v246
    v_mul_f32 v97, v97, v246
    v_mul_f32 v98, v98, v246
    v_mul_f32 v99, v99, v246
    v_mul_f32 v100, v100, v246
    v_mul_f32 v101, v101, v246
    v_mul_f32 v102, v102, v246
    v_mul_f32 v103, v103, v246
    v_mul_f32 v104, v104, v246
    v_mul_f32 v105, v105, v246
    v_mul_f32 v106, v106, v246
    v_mul_f32 v107, v107, v246
    v_mul_f32 v108, v108, v246
    v_mul_f32 v109, v109, v246
    v_mul_f32 v110, v110, v246
    v_mul_f32 v111, v111, v246
    v_mul_f32 v112, v112, v246
    v_mul_f32 v113, v113, v246
    v_mul_f32 v114, v114, v246
    v_mul_f32 v115, v115, v246
    v_mul_f32 v116, v116, v246
    v_mul_f32 v117, v117, v246
    v_mul_f32 v118, v118, v246
    v_mul_f32 v119, v119, v246
    v_mul_f32 v244, v244, v246
    v_lshlrev_b32 v247, 16, v152
    v_and_b32 v248, 0xffff0000, v152
    v_mul_f32 v247, v247, v246
    v_mul_f32 v248, v248, v246
    v_cvt_pk_bf16_f32 v152, v247, v248
    v_lshlrev_b32 v247, 16, v153
    v_and_b32 v248, 0xffff0000, v153
    v_mul_f32 v247, v247, v246
    v_mul_f32 v248, v248, v246
    v_cvt_pk_bf16_f32 v153, v247, v248
    v_lshlrev_b32 v247, 16, v154
    v_and_b32 v248, 0xffff0000, v154
    v_mul_f32 v247, v247, v246
    v_mul_f32 v248, v248, v246
    v_cvt_pk_bf16_f32 v154, v247, v248
    v_lshlrev_b32 v247, 16, v155
    v_and_b32 v248, 0xffff0000, v155
    v_mul_f32 v247, v247, v246
    v_mul_f32 v248, v248, v246
    v_cvt_pk_bf16_f32 v155, v247, v248
    v_lshlrev_b32 v247, 16, v156
    v_and_b32 v248, 0xffff0000, v156
    v_mul_f32 v247, v247, v246
    v_mul_f32 v248, v248, v246
    v_cvt_pk_bf16_f32 v156, v247, v248
    v_lshlrev_b32 v247, 16, v157
    v_and_b32 v248, 0xffff0000, v157
    v_mul_f32 v247, v247, v246
    v_mul_f32 v248, v248, v246
    v_cvt_pk_bf16_f32 v157, v247, v248
    v_lshlrev_b32 v247, 16, v158
    v_and_b32 v248, 0xffff0000, v158
    v_mul_f32 v247, v247, v246
    v_mul_f32 v248, v248, v246
    v_cvt_pk_bf16_f32 v158, v247, v248
    v_lshlrev_b32 v247, 16, v159
    v_and_b32 v248, 0xffff0000, v159
    v_mul_f32 v247, v247, v246
    v_mul_f32 v248, v248, v246
    v_cvt_pk_bf16_f32 v159, v247, v248
    s_nop 7
    s_branch L_back_B01
L_slow_A02:
    s_nop 15
    v_mov_b32 v248, v246
    s_nop 1
    v_permlane32_swap_b32 v246, v248
    v_max_f32 v246, v246, v248
    v_mov_b32 v248, v247
    s_nop 1
    v_permlane32_swap_b32 v247, v248
    v_max_f32 v247, v247, v248
    v_mov_b32 v248, v247
    s_nop 1
    v_permlane16_swap_b32 v247, v248
    v_max_f32 v247, v247, v248
    v_max_f32 v246, 0, v246
    v_ceil_f32 v246, v246
    v_max_f32 v247, 0, v247
    v_ceil_f32 v247, v247
    v_sub_f32 v152, v152, v246
    v_sub_f32 v153, v153, v246
    v_sub_f32 v154, v154, v246
    v_sub_f32 v155, v155, v246
    v_sub_f32 v156, v156, v246
    v_sub_f32 v157, v157, v246
    v_sub_f32 v158, v158, v246
    v_sub_f32 v159, v159, v246
    v_sub_f32 v160, v160, v246
    v_sub_f32 v161, v161, v246
    v_sub_f32 v162, v162, v246
    v_sub_f32 v163, v163, v246
    v_sub_f32 v164, v164, v246
    v_sub_f32 v165, v165, v246
    v_sub_f32 v166, v166, v246
    v_sub_f32 v167, v167, v246
    v_sub_f32 v168, v168, v246
    v_sub_f32 v169, v169, v246
    v_sub_f32 v170, v170, v246
    v_sub_f32 v171, v171, v246
    v_sub_f32 v172, v172, v246
    v_sub_f32 v173, v173, v246
    v_sub_f32 v174, v174, v246
    v_sub_f32 v175, v175, v246
    v_sub_f32 v176, v176, v246
    v_sub_f32 v177, v177, v246
    v_sub_f32 v178, v178, v246
    v_sub_f32 v179, v179, v246
    v_sub_f32 v180, v180, v246
    v_sub_f32 v181, v181, v246
    v_sub_f32 v182, v182, v246
    v_sub_f32 v183, v183, v246
    v_sub_f32 v184, v184, v247
    v_sub_f32 v185, v185, v247
    v_sub_f32 v186, v186, v247
    v_sub_f32 v187, v187, v247
    v_sub_f32 v188, v188, v246
    v_sub_f32 v189, v189, v246
    v_sub_f32 v190, v190, v246
    v_sub_f32 v191, v191, v246
    v_sub_f32 v192, v192, v246
    v_sub_f32 v193, v193, v246
    v_sub_f32 v194, v194, v246
    v_sub_f32 v195, v195, v246
    v_sub_f32 v196, v196, v246
    v_sub_f32 v197, v197, v246
    v_sub_f32 v198, v198, v246
    v_sub_f32 v199, v199, v246
    v_sub_f32 v200, v200, v246
    v_sub_f32 v201, v201, v246
    v_sub_f32 v202, v202, v246
    v_sub_f32 v203, v203, v246
    v_sub_f32 v204, v204, v247
    v_sub_f32 v205, v205, v247
    v_sub_f32 v206, v206, v247
    v_sub_f32 v207, v207, v247
    v_sub_f32 v246, 0, v246
    v_sub_f32 v247, 0, v247
    v_exp_f32 v246, v246
    v_exp_f32 v247, v247
    v_mul_f32 v56, v56, v246
    v_mul_f32 v57, v57, v246
    v_mul_f32 v58, v58, v246
    v_mul_f32 v59, v59, v246
    v_mul_f32 v60, v60, v246
    v_mul_f32 v61, v61, v246
    v_mul_f32 v62, v62, v246
    v_mul_f32 v63, v63, v246
    v_mul_f32 v64, v64, v246
    v_mul_f32 v65, v65, v246
    v_mul_f32 v66, v66, v246
    v_mul_f32 v67, v67, v246
    v_mul_f32 v68, v68, v246
    v_mul_f32 v69, v69, v246
    v_mul_f32 v70, v70, v246
    v_mul_f32 v71, v71, v246
    v_mul_f32 v72, v72, v246
    v_mul_f32 v73, v73, v246
    v_mul_f32 v74, v74, v246
    v_mul_f32 v75, v75, v246
    v_mul_f32 v76, v76, v246
    v_mul_f32 v77, v77, v246
    v_mul_f32 v78, v78, v246
    v_mul_f32 v79, v79, v246
    v_mul_f32 v80, v80, v246
    v_mul_f32 v81, v81, v246
    v_mul_f32 v82, v82, v246
    v_mul_f32 v83, v83, v246
    v_mul_f32 v84, v84, v246
    v_mul_f32 v85, v85, v246
    v_mul_f32 v86, v86, v246
    v_mul_f32 v87, v87, v246
    v_mul_f32 v88, v88, v246
    v_mul_f32 v89, v89, v246
    v_mul_f32 v90, v90, v246
    v_mul_f32 v91, v91, v246
    v_mul_f32 v92, v92, v246
    v_mul_f32 v93, v93, v246
    v_mul_f32 v94, v94, v246
    v_mul_f32 v95, v95, v246
    v_mul_f32 v96, v96, v246
    v_mul_f32 v97, v97, v246
    v_mul_f32 v98, v98, v246
    v_mul_f32 v99, v99, v246
    v_mul_f32 v100, v100, v246
    v_mul_f32 v101, v101, v246
    v_mul_f32 v102, v102, v246
    v_mul_f32 v103, v103, v246
    v_mul_f32 v104, v104, v246
    v_mul_f32 v105, v105, v246
    v_mul_f32 v106, v106, v246
    v_mul_f32 v107, v107, v246
    v_mul_f32 v108, v108, v246
    v_mul_f32 v109, v109, v246
    v_mul_f32 v110, v110, v246
    v_mul_f32 v111, v111, v246
    v_mul_f32 v112, v112, v246
    v_mul_f32 v113, v113, v246
    v_mul_f32 v114, v114, v246
    v_mul_f32 v115, v115, v246
    v_mul_f32 v116, v116, v246
    v_mul_f32 v117, v117, v246
    v_mul_f32 v118, v118, v246
    v_mul_f32 v119, v119, v246
    v_mul_f32 v120, v120, v247
    v_mul_f32 v121, v121, v247
    v_mul_f32 v122, v122, v247
    v_mul_f32 v123, v123, v247
    v_mul_f32 v124, v124, v247
    v_mul_f32 v125, v125, v247
    v_mul_f32 v126, v126, v247
    v_mul_f32 v127, v127, v247
    v_mul_f32 v128, v128, v247
    v_mul_f32 v129, v129, v247
    v_mul_f32 v130, v130, v247
    v_mul_f32 v131, v131, v247
    v_mul_f32 v132, v132, v247
    v_mul_f32 v133, v133, v247
    v_mul_f32 v134, v134, v247
    v_mul_f32 v135, v135, v247
    v_mul_f32 v136, v136, v247
    v_mul_f32 v137, v137, v247
    v_mul_f32 v138, v138, v247
    v_mul_f32 v139, v139, v247
    v_mul_f32 v140, v140, v247
    v_mul_f32 v141, v141, v247
    v_mul_f32 v142, v142, v247
    v_mul_f32 v143, v143, v247
    v_mul_f32 v144, v144, v247
    v_mul_f32 v145, v145, v247
    v_mul_f32 v146, v146, v247
    v_mul_f32 v147, v147, v247
    v_mul_f32 v148, v148, v247
    v_mul_f32 v149, v149, v247
    v_mul_f32 v150, v150, v247
    v_mul_f32 v151, v151, v247
    v_mul_f32 v244, v244, v246
    v_mul_f32 v245, v245, v247
    s_nop 7
    s_branch L_back_A02
L_slow_B02:
    s_nop 15
    v_mov_b32 v248, v246
    s_nop 1
    v_permlane32_swap_b32 v246, v248
    v_max_f32 v246, v246, v248
    v_max_f32 v246, 0, v246
    v_ceil_f32 v246, v246
    v_sub_f32 v168, v168, v246
    v_sub_f32 v169, v169, v246
    v_sub_f32 v170, v170, v246
    v_sub_f32 v171, v171, v246
    v_sub_f32 v172, v172, v246
    v_sub_f32 v173, v173, v246
    v_sub_f32 v174, v174, v246
    v_sub_f32 v175, v175, v246
    v_sub_f32 v176, v176, v246
    v_sub_f32 v177, v177, v246
    v_sub_f32 v178, v178, v246
    v_sub_f32 v179, v179, v246
    v_sub_f32 v180, v180, v246
    v_sub_f32 v181, v181, v246
    v_sub_f32 v182, v182, v246
    v_sub_f32 v183, v183, v246
    v_sub_f32 v188, v188, v246
    v_sub_f32 v189, v189, v246
    v_sub_f32 v190, v190, v246
    v_sub_f32 v191, v191, v246
    v_sub_f32 v192, v192, v246
    v_sub_f32 v193, v193, v246
    v_sub_f32 v194, v194, v246
    v_sub_f32 v195, v195, v246
    v_sub_f32 v196, v196, v246
    v_sub_f32 v197, v197, v246
    v_sub_f32 v198, v198, v246
    v_sub_f32 v199, v199, v246
    v_sub_f32 v200, v200, v246
    v_sub_f32 v201, v201, v246
    v_sub_f32 v202, v202, v246
    v_sub_f32 v203, v203, v246
    v_sub_f32 v246, 0, v246
    v_exp_f32 v246, v246
    s_nop 0
    v_mul_f32 v56, v56, v246
    v_mul_f32 v57, v57, v246
    v_mul_f32 v58, v58, v246
    v_mul_f32 v59, v59, v246
    v_mul_f32 v60, v60, v246
    v_mul_f32 v61, v61, v246
    v_mul_f32 v62, v62, v246
    v_mul_f32 v63, v63, v246
    v_mul_f32 v64, v64, v246
    v_mul_f32 v65, v65, v246
    v_mul_f32 v66, v66, v246
    v_mul_f32 v67, v67, v246
    v_mul_f32 v68, v68, v246
    v_mul_f32 v69, v69, v246
    v_mul_f32 v70, v70, v246
    v_mul_f32 v71, v71, v246
    v_mul_f32 v72, v72, v246
    v_mul_f32 v73, v73, v246
    v_mul_f32 v74, v74, v246
    v_mul_f32 v75, v75, v246
    v_mul_f32 v76, v76, v246
    v_mul_f32 v77, v77, v246
    v_mul_f32 v78, v78, v246
    v_mul_f32 v79, v79, v246
    v_mul_f32 v80, v80, v246
    v_mul_f32 v81, v81, v246
    v_mul_f32 v82, v82, v246
    v_mul_f32 v83, v83, v246
    v_mul_f32 v84, v84, v246
    v_mul_f32 v85, v85, v246
    v_mul_f32 v86, v86, v246
    v_mul_f32 v87, v87, v246
    v_mul_f32 v88, v88, v246
    v_mul_f32 v89, v89, v246
    v_mul_f32 v90, v90, v246
    v_mul_f32 v91, v91, v246
    v_mul_f32 v92, v92, v246
    v_mul_f32 v93, v93, v246
    v_mul_f32 v94, v94, v246
    v_mul_f32 v95, v95, v246
    v_mul_f32 v96, v96, v246
    v_mul_f32 v97, v97, v246
    v_mul_f32 v98, v98, v246
    v_mul_f32 v99, v99, v246
    v_mul_f32 v100, v100, v246
    v_mul_f32 v101, v101, v246
    v_mul_f32 v102, v102, v246
    v_mul_f32 v103, v103, v246
    v_mul_f32 v104, v104, v246
    v_mul_f32 v105, v105, v246
    v_mul_f32 v106, v106, v246
    v_mul_f32 v107, v107, v246
    v_mul_f32 v108, v108, v246
    v_mul_f32 v109, v109, v246
    v_mul_f32 v110, v110, v246
    v_mul_f32 v111, v111, v246
    v_mul_f32 v112, v112, v246
    v_mul_f32 v113, v113, v246
    v_mul_f32 v114, v114, v246
    v_mul_f32 v115, v115, v246
    v_mul_f32 v116, v116, v246
    v_mul_f32 v117, v117, v246
    v_mul_f32 v118, v118, v246
    v_mul_f32 v119, v119, v246
    v_mul_f32 v244, v244, v246
    v_lshlrev_b32 v247, 16, v152
    v_and_b32 v248, 0xffff0000, v152
    v_mul_f32 v247, v247, v246
    v_mul_f32 v248, v248, v246
    v_cvt_pk_bf16_f32 v152, v247, v248
    v_lshlrev_b32 v247, 16, v153
    v_and_b32 v248, 0xffff0000, v153
    v_mul_f32 v247, v247, v246
    v_mul_f32 v248, v248, v246
    v_cvt_pk_bf16_f32 v153, v247, v248
    v_lshlrev_b32 v247, 16, v154
    v_and_b32 v248, 0xffff0000, v154
    v_mul_f32 v247, v247, v246
    v_mul_f32 v248, v248, v246
    v_cvt_pk_bf16_f32 v154, v247, v248
    v_lshlrev_b32 v247, 16, v155
    v_and_b32 v248, 0xffff0000, v155
    v_mul_f32 v247, v247, v246
    v_mul_f32 v248, v248, v246
    v_cvt_pk_bf16_f32 v155, v247, v248
    v_lshlrev_b32 v247, 16, v156
    v_and_b32 v248, 0xffff0000, v156
    v_mul_f32 v247, v247, v246
    v_mul_f32 v248, v248, v246
    v_cvt_pk_bf16_f32 v156, v247, v248
    v_lshlrev_b32 v247, 16, v157
    v_and_b32 v248, 0xffff0000, v157
    v_mul_f32 v247, v247, v246
    v_mul_f32 v248, v248, v246
    v_cvt_pk_bf16_f32 v157, v247, v248
    v_lshlrev_b32 v247, 16, v158
    v_and_b32 v248, 0xffff0000, v158
    v_mul_f32 v247, v247, v246
    v_mul_f32 v248, v248, v246
    v_cvt_pk_bf16_f32 v158, v247, v248
    v_lshlrev_b32 v247, 16, v159
    v_and_b32 v248, 0xffff0000, v159
    v_mul_f32 v247, v247, v246
    v_mul_f32 v248, v248, v246
    v_cvt_pk_bf16_f32 v159, v247, v248
    s_nop 7
    s_branch L_back_B02
L_slow_A03:
    s_nop 15
    v_mov_b32 v248, v246
    s_nop 1
    v_permlane32_swap_b32 v246, v248
    v_max_f32 v246, v246, v248
    v_mov_b32 v248, v247
    s_nop 1
    v_permlane32_swap_b32 v247, v248
    v_max_f32 v247, v247, v248
    v_mov_b32 v248, v247
    s_nop 1
    v_permlane16_swap_b32 v247, v248
    v_max_f32 v247, v247, v248
    v_max_f32 v246, 0, v246
    v_ceil_f32 v246, v246
    v_max_f32 v247, 0, v247
    v_ceil_f32 v247, v247
    v_sub_f32 v152, v152, v246
    v_sub_f32 v153, v153, v246
    v_sub_f32 v154, v154, v246
    v_sub_f32 v155, v155, v246
    v_sub_f32 v156, v156, v246
    v_sub_f32 v157, v157, v246
    v_sub_f32 v158, v158, v246
    v_sub_f32 v159, v159, v246
    v_sub_f32 v160, v160, v246
    v_sub_f32 v161, v161, v246
    v_sub_f32 v162, v162, v246
    v_sub_f32 v163, v163, v246
    v_sub_f32 v164, v164, v246
    v_sub_f32 v165, v165, v246
    v_sub_f32 v166, v166, v246
    v_sub_f32 v167, v167, v246
    v_sub_f32 v168, v168, v246
    v_sub_f32 v169, v169, v246
    v_sub_f32 v170, v170, v246
    v_sub_f32 v171, v171, v246
    v_sub_f32 v172, v172, v246
    v_sub_f32 v173, v173, v246
    v_sub_f32 v174, v174, v246
    v_sub_f32 v175, v175, v246
    v_sub_f32 v176, v176, v246
    v_sub_f32 v177, v177, v246
    v_sub_f32 v178, v178, v246
    v_sub_f32 v179, v179, v246
    v_sub_f32 v180, v180, v246
    v_sub_f32 v181, v181, v246
    v_sub_f32 v182, v182, v246
    v_sub_f32 v183, v183, v246
    v_sub_f32 v184, v184, v247
    v_sub_f32 v185, v185, v247
    v_sub_f32 v186, v186, v247
    v_sub_f32 v187, v187, v247
    v_sub_f32 v188, v188, v246
    v_sub_f32 v189, v189, v246
    v_sub_f32 v190, v190, v246
    v_sub_f32 v191, v191, v246
    v_sub_f32 v192, v192, v246
    v_sub_f32 v193, v193, v246
    v_sub_f32 v194, v194, v246
    v_sub_f32 v195, v195, v246
    v_sub_f32 v196, v196, v246
    v_sub_f32 v197, v197, v246
    v_sub_f32 v198, v198, v246
    v_sub_f32 v199, v199, v246
    v_sub_f32 v200, v200, v246
    v_sub_f32 v201, v201, v246
    v_sub_f32 v202, v202, v246
    v_sub_f32 v203, v203, v246
    v_sub_f32 v204, v204, v247
    v_sub_f32 v205, v205, v247
    v_sub_f32 v206, v206, v247
    v_sub_f32 v207, v207, v247
    v_sub_f32 v246, 0, v246
    v_sub_f32 v247, 0, v247
    v_exp_f32 v246, v246
    v_exp_f32 v247, v247
    v_mul_f32 v56, v56, v246
    v_mul_f32 v57, v57, v246
    v_mul_f32 v58, v58, v246
    v_mul_f32 v59, v59, v246
    v_mul_f32 v60, v60, v246
    v_mul_f32 v61, v61, v246
    v_mul_f32 v62, v62, v246
    v_mul_f32 v63, v63, v246
    v_mul_f32 v64, v64, v246
    v_mul_f32 v65, v65, v246
    v_mul_f32 v66, v66, v246
    v_mul_f32 v67, v67, v246
    v_mul_f32 v68, v68, v246
    v_mul_f32 v69, v69, v246
    v_mul_f32 v70, v70, v246
    v_mul_f32 v71, v71, v246
    v_mul_f32 v72, v72, v246
    v_mul_f32 v73, v73, v246
    v_mul_f32 v74, v74, v246
    v_mul_f32 v75, v75, v246
    v_mul_f32 v76, v76, v246
    v_mul_f32 v77, v77, v246
    v_mul_f32 v78, v78, v246
    v_mul_f32 v79, v79, v246
    v_mul_f32 v80, v80, v246
    v_mul_f32 v81, v81, v246
    v_mul_f32 v82, v82, v246
    v_mul_f32 v83, v83, v246
    v_mul_f32 v84, v84, v246
    v_mul_f32 v85, v85, v246
    v_mul_f32 v86, v86, v246
    v_mul_f32 v87, v87, v246
    v_mul_f32 v88, v88, v246
    v_mul_f32 v89, v89, v246
    v_mul_f32 v90, v90, v246
    v_mul_f32 v91, v91, v246
    v_mul_f32 v92, v92, v246
    v_mul_f32 v93, v93, v246
    v_mul_f32 v94, v94, v246
    v_mul_f32 v95, v95, v246
    v_mul_f32 v96, v96, v246
    v_mul_f32 v97, v97, v246
    v_mul_f32 v98, v98, v246
    v_mul_f32 v99, v99, v246
    v_mul_f32 v100, v100, v246
    v_mul_f32 v101, v101, v246
    v_mul_f32 v102, v102, v246
    v_mul_f32 v103, v103, v246
    v_mul_f32 v104, v104, v246
    v_mul_f32 v105, v105, v246
    v_mul_f32 v106, v106, v246
    v_mul_f32 v107, v107, v246
    v_mul_f32 v108, v108, v246
    v_mul_f32 v109, v109, v246
    v_mul_f32 v110, v110, v246
    v_mul_f32 v111, v111, v246
    v_mul_f32 v112, v112, v246
    v_mul_f32 v113, v113, v246
    v_mul_f32 v114, v114, v246
    v_mul_f32 v115, v115, v246
    v_mul_f32 v116, v116, v246
    v_mul_f32 v117, v117, v246
    v_mul_f32 v118, v118, v246
    v_mul_f32 v119, v119, v246
    v_mul_f32 v120, v120, v247
    v_mul_f32 v121, v121, v247
    v_mul_f32 v122, v122, v247
    v_mul_f32 v123, v123, v247
    v_mul_f32 v124, v124, v247
    v_mul_f32 v125, v125, v247
    v_mul_f32 v126, v126, v247
    v_mul_f32 v127, v127, v247
    v_mul_f32 v128, v128, v247
    v_mul_f32 v129, v129, v247
    v_mul_f32 v130, v130, v247
    v_mul_f32 v131, v131, v247
    v_mul_f32 v132, v132, v247
    v_mul_f32 v133, v133, v247
    v_mul_f32 v134, v134, v247
    v_mul_f32 v135, v135, v247
    v_mul_f32 v136, v136, v247
    v_mul_f32 v137, v137, v247
    v_mul_f32 v138, v138, v247
    v_mul_f32 v139, v139, v247
    v_mul_f32 v140, v140, v247
    v_mul_f32 v141, v141, v247
    v_mul_f32 v142, v142, v247
    v_mul_f32 v143, v143, v247
    v_mul_f32 v144, v144, v247
    v_mul_f32 v145, v145, v247
    v_mul_f32 v146, v146, v247
    v_mul_f32 v147, v147, v247
    v_mul_f32 v148, v148, v247
    v_mul_f32 v149, v149, v247
    v_mul_f32 v150, v150, v247
    v_mul_f32 v151, v151, v247
    v_mul_f32 v244, v244, v246
    v_mul_f32 v245, v245, v247
    s_nop 7
    s_branch L_back_A03
L_slow_B03:
    s_nop 15
    v_mov_b32 v248, v246
    s_nop 1
    v_permlane32_swap_b32 v246, v248
    v_max_f32 v246, v246, v248
    v_max_f32 v246, 0, v246
    v_ceil_f32 v246, v246
    v_sub_f32 v168, v168, v246
    v_sub_f32 v169, v169, v246
    v_sub_f32 v170, v170, v246
    v_sub_f32 v171, v171, v246
    v_sub_f32 v172, v172, v246
    v_sub_f32 v173, v173, v246
    v_sub_f32 v174, v174, v246
    v_sub_f32 v175, v175, v246
    v_sub_f32 v176, v176, v246
    v_sub_f32 v177, v177, v246
    v_sub_f32 v178, v178, v246
    v_sub_f32 v179, v179, v246
    v_sub_f32 v180, v180, v246
    v_sub_f32 v181, v181, v246
    v_sub_f32 v182, v182, v246
    v_sub_f32 v183, v183, v246
    v_sub_f32 v188, v188, v246
    v_sub_f32 v189, v189, v246
    v_sub_f32 v190, v190, v246
    v_sub_f32 v191, v191, v246
    v_sub_f32 v192, v192, v246
    v_sub_f32 v193, v193, v246
    v_sub_f32 v194, v194, v246
    v_sub_f32 v195, v195, v246
    v_sub_f32 v196, v196, v246
    v_sub_f32 v197, v197, v246
    v_sub_f32 v198, v198, v246
    v_sub_f32 v199, v199, v246
    v_sub_f32 v200, v200, v246
    v_sub_f32 v201, v201, v246
    v_sub_f32 v202, v202, v246
    v_sub_f32 v203, v203, v246
    v_sub_f32 v246, 0, v246
    v_exp_f32 v246, v246
    s_nop 0
    v_mul_f32 v56, v56, v246
    v_mul_f32 v57, v57, v246
    v_mul_f32 v58, v58, v246
    v_mul_f32 v59, v59, v246
    v_mul_f32 v60, v60, v246
    v_mul_f32 v61, v61, v246
    v_mul_f32 v62, v62, v246
    v_mul_f32 v63, v63, v246
    v_mul_f32 v64, v64, v246
    v_mul_f32 v65, v65, v246
    v_mul_f32 v66, v66, v246
    v_mul_f32 v67, v67, v246
    v_mul_f32 v68, v68, v246
    v_mul_f32 v69, v69, v246
    v_mul_f32 v70, v70, v246
    v_mul_f32 v71, v71, v246
    v_mul_f32 v72, v72, v246
    v_mul_f32 v73, v73, v246
    v_mul_f32 v74, v74, v246
    v_mul_f32 v75, v75, v246
    v_mul_f32 v76, v76, v246
    v_mul_f32 v77, v77, v246
    v_mul_f32 v78, v78, v246
    v_mul_f32 v79, v79, v246
    v_mul_f32 v80, v80, v246
    v_mul_f32 v81, v81, v246
    v_mul_f32 v82, v82, v246
    v_mul_f32 v83, v83, v246
    v_mul_f32 v84, v84, v246
    v_mul_f32 v85, v85, v246
    v_mul_f32 v86, v86, v246
    v_mul_f32 v87, v87, v246
    v_mul_f32 v88, v88, v246
    v_mul_f32 v89, v89, v246
    v_mul_f32 v90, v90, v246
    v_mul_f32 v91, v91, v246
    v_mul_f32 v92, v92, v246
    v_mul_f32 v93, v93, v246
    v_mul_f32 v94, v94, v246
    v_mul_f32 v95, v95, v246
    v_mul_f32 v96, v96, v246
    v_mul_f32 v97, v97, v246
    v_mul_f32 v98, v98, v246
    v_mul_f32 v99, v99, v246
    v_mul_f32 v100, v100, v246
    v_mul_f32 v101, v101, v246
    v_mul_f32 v102, v102, v246
    v_mul_f32 v103, v103, v246
    v_mul_f32 v104, v104, v246
    v_mul_f32 v105, v105, v246
    v_mul_f32 v106, v106, v246
    v_mul_f32 v107, v107, v246
    v_mul_f32 v108, v108, v246
    v_mul_f32 v109, v109, v246
    v_mul_f32 v110, v110, v246
    v_mul_f32 v111, v111, v246
    v_mul_f32 v112, v112, v246
    v_mul_f32 v113, v113, v246
    v_mul_f32 v114, v114, v246
    v_mul_f32 v115, v115, v246
    v_mul_f32 v116, v116, v246
    v_mul_f32 v117, v117, v246
    v_mul_f32 v118, v118, v246
    v_mul_f32 v119, v119, v246
    v_mul_f32 v244, v244, v246
    v_lshlrev_b32 v247, 16, v152
    v_and_b32 v248, 0xffff0000, v152
    v_mul_f32 v247, v247, v246
    v_mul_f32 v248, v248, v246
    v_cvt_pk_bf16_f32 v152, v247, v248
    v_lshlrev_b32 v247, 16, v153
    v_and_b32 v248, 0xffff0000, v153
    v_mul_f32 v247, v247, v246
    v_mul_f32 v248, v248, v246
    v_cvt_pk_bf16_f32 v153, v247, v248
    v_lshlrev_b32 v247, 16, v154
    v_and_b32 v248, 0xffff0000, v154
    v_mul_f32 v247, v247, v246
    v_mul_f32 v248, v248, v246
    v_cvt_pk_bf16_f32 v154, v247, v248
    v_lshlrev_b32 v247, 16, v155
    v_and_b32 v248, 0xffff0000, v155
    v_mul_f32 v247, v247, v246
    v_mul_f32 v248, v248, v246
    v_cvt_pk_bf16_f32 v155, v247, v248
    v_lshlrev_b32 v247, 16, v156
    v_and_b32 v248, 0xffff0000, v156
    v_mul_f32 v247, v247, v246
    v_mul_f32 v248, v248, v246
    v_cvt_pk_bf16_f32 v156, v247, v248
    v_lshlrev_b32 v247, 16, v157
    v_and_b32 v248, 0xffff0000, v157
    v_mul_f32 v247, v247, v246
    v_mul_f32 v248, v248, v246
    v_cvt_pk_bf16_f32 v157, v247, v248
    v_lshlrev_b32 v247, 16, v158
    v_and_b32 v248, 0xffff0000, v158
    v_mul_f32 v247, v247, v246
    v_mul_f32 v248, v248, v246
    v_cvt_pk_bf16_f32 v158, v247, v248
    v_lshlrev_b32 v247, 16, v159
    v_and_b32 v248, 0xffff0000, v159
    v_mul_f32 v247, v247, v246
    v_mul_f32 v248, v248, v246
    v_cvt_pk_bf16_f32 v159, v247, v248
    s_nop 7
    s_branch L_back_B03
L_slow_A04:
    s_nop 15
    v_mov_b32 v248, v246
    s_nop 1
    v_permlane32_swap_b32 v246, v248
    v_max_f32 v246, v246, v248
    v_mov_b32 v248, v247
    s_nop 1
    v_permlane32_swap_b32 v247, v248
    v_max_f32 v247, v247, v248
    v_mov_b32 v248, v247
    s_nop 1
    v_permlane16_swap_b32 v247, v248
    v_max_f32 v247, v247, v248
    v_max_f32 v246, 0, v246
    v_ceil_f32 v246, v246
    v_max_f32 v247, 0, v247
    v_ceil_f32 v247, v247
    v_sub_f32 v152, v152, v246
    v_sub_f32 v153, v153, v246
    v_sub_f32 v154, v154, v246
    v_sub_f32 v155, v155, v246
    v_sub_f32 v156, v156, v246
    v_sub_f32 v157, v157, v246
    v_sub_f32 v158, v158, v246
    v_sub_f32 v159, v159, v246
    v_sub_f32 v160, v160, v246
    v_sub_f32 v161, v161, v246
    v_sub_f32 v162, v162, v246
    v_sub_f32 v163, v163, v246
    v_sub_f32 v164, v164, v246
    v_sub_f32 v165, v165, v246
    v_sub_f32 v166, v166, v246
    v_sub_f32 v167, v167, v246
    v_sub_f32 v168, v168, v246
    v_sub_f32 v169, v169, v246
    v_sub_f32 v170, v170, v246
    v_sub_f32 v171, v171, v246
    v_sub_f32 v172, v172, v246
    v_sub_f32 v173, v173, v246
    v_sub_f32 v174, v174, v246
    v_sub_f32 v175, v175, v246
    v_sub_f32 v176, v176, v246
    v_sub_f32 v177, v177, v246
    v_sub_f32 v178, v178, v246
    v_sub_f32 v179, v179, v246
    v_sub_f32 v180, v180, v246
    v_sub_f32 v181, v181, v246
    v_sub_f32 v182, v182, v246
    v_sub_f32 v183, v183, v246
    v_sub_f32 v184, v184, v247
    v_sub_f32 v185, v185, v247
    v_sub_f32 v186, v186, v247
    v_sub_f32 v187, v187, v247
    v_sub_f32 v188, v188, v246
    v_sub_f32 v189, v189, v246
    v_sub_f32 v190, v190, v246
    v_sub_f32 v191, v191, v246
    v_sub_f32 v192, v192, v246
    v_sub_f32 v193, v193, v246
    v_sub_f32 v194, v194, v246
    v_sub_f32 v195, v195, v246
    v_sub_f32 v196, v196, v246
    v_sub_f32 v197, v197, v246
    v_sub_f32 v198, v198, v246
    v_sub_f32 v199, v199, v246
    v_sub_f32 v200, v200, v246
    v_sub_f32 v201, v201, v246
    v_sub_f32 v202, v202, v246
    v_sub_f32 v203, v203, v246
    v_sub_f32 v204, v204, v247
    v_sub_f32 v205, v205, v247
    v_sub_f32 v206, v206, v247
    v_sub_f32 v207, v207, v247
    v_sub_f32 v246, 0, v246
    v_sub_f32 v247, 0, v247
    v_exp_f32 v246, v246
    v_exp_f32 v247, v247
    v_mul_f32 v56, v56, v246
    v_mul_f32 v57, v57, v246
    v_mul_f32 v58, v58, v246
    v_mul_f32 v59, v59, v246
    v_mul_f32 v60, v60, v246
    v_mul_f32 v61, v61, v246
    v_mul_f32 v62, v62, v246
    v_mul_f32 v63, v63, v246
    v_mul_f32 v64, v64, v246
    v_mul_f32 v65, v65, v246
    v_mul_f32 v66, v66, v246
    v_mul_f32 v67, v67, v246
    v_mul_f32 v68, v68, v246
    v_mul_f32 v69, v69, v246
    v_mul_f32 v70, v70, v246
    v_mul_f32 v71, v71, v246
    v_mul_f32 v72, v72, v246
    v_mul_f32 v73, v73, v246
    v_mul_f32 v74, v74, v246
    v_mul_f32 v75, v75, v246
    v_mul_f32 v76, v76, v246
    v_mul_f32 v77, v77, v246
    v_mul_f32 v78, v78, v246
    v_mul_f32 v79, v79, v246
    v_mul_f32 v80, v80, v246
    v_mul_f32 v81, v81, v246
    v_mul_f32 v82, v82, v246
    v_mul_f32 v83, v83, v246
    v_mul_f32 v84, v84, v246
    v_mul_f32 v85, v85, v246
    v_mul_f32 v86, v86, v246
    v_mul_f32 v87, v87, v246
    v_mul_f32 v88, v88, v246
    v_mul_f32 v89, v89, v246
    v_mul_f32 v90, v90, v246
    v_mul_f32 v91, v91, v246
    v_mul_f32 v92, v92, v246
    v_mul_f32 v93, v93, v246
    v_mul_f32 v94, v94, v246
    v_mul_f32 v95, v95, v246
    v_mul_f32 v96, v96, v246
    v_mul_f32 v97, v97, v246
    v_mul_f32 v98, v98, v246
    v_mul_f32 v99, v99, v246
    v_mul_f32 v100, v100, v246
    v_mul_f32 v101, v101, v246
    v_mul_f32 v102, v102, v246
    v_mul_f32 v103, v103, v246
    v_mul_f32 v104, v104, v246
    v_mul_f32 v105, v105, v246
    v_mul_f32 v106, v106, v246
    v_mul_f32 v107, v107, v246
    v_mul_f32 v108, v108, v246
    v_mul_f32 v109, v109, v246
    v_mul_f32 v110, v110, v246
    v_mul_f32 v111, v111, v246
    v_mul_f32 v112, v112, v246
    v_mul_f32 v113, v113, v246
    v_mul_f32 v114, v114, v246
    v_mul_f32 v115, v115, v246
    v_mul_f32 v116, v116, v246
    v_mul_f32 v117, v117, v246
    v_mul_f32 v118, v118, v246
    v_mul_f32 v119, v119, v246
    v_mul_f32 v120, v120, v247
    v_mul_f32 v121, v121, v247
    v_mul_f32 v122, v122, v247
    v_mul_f32 v123, v123, v247
    v_mul_f32 v124, v124, v247
    v_mul_f32 v125, v125, v247
    v_mul_f32 v126, v126, v247
    v_mul_f32 v127, v127, v247
    v_mul_f32 v128, v128, v247
    v_mul_f32 v129, v129, v247
    v_mul_f32 v130, v130, v247
    v_mul_f32 v131, v131, v247
    v_mul_f32 v132, v132, v247
    v_mul_f32 v133, v133, v247
    v_mul_f32 v134, v134, v247
    v_mul_f32 v135, v135, v247
    v_mul_f32 v136, v136, v247
    v_mul_f32 v137, v137, v247
    v_mul_f32 v138, v138, v247
    v_mul_f32 v139, v139, v247
    v_mul_f32 v140, v140, v247
    v_mul_f32 v141, v141, v247
    v_mul_f32 v142, v142, v247
    v_mul_f32 v143, v143, v247
    v_mul_f32 v144, v144, v247
    v_mul_f32 v145, v145, v247
    v_mul_f32 v146, v146, v247
    v_mul_f32 v147, v147, v247
    v_mul_f32 v148, v148, v247
    v_mul_f32 v149, v149, v247
    v_mul_f32 v150, v150, v247
    v_mul_f32 v151, v151, v247
    v_mul_f32 v244, v244, v246
    v_mul_f32 v245, v245, v247
    s_nop 7
    s_branch L_back_A04
L_slow_B04:
    s_nop 15
    v_mov_b32 v248, v246
    s_nop 1
    v_permlane32_swap_b32 v246, v248
    v_max_f32 v246, v246, v248
    v_max_f32 v246, 0, v246
    v_ceil_f32 v246, v246
    v_sub_f32 v168, v168, v246
    v_sub_f32 v169, v169, v246
    v_sub_f32 v170, v170, v246
    v_sub_f32 v171, v171, v246
    v_sub_f32 v172, v172, v246
    v_sub_f32 v173, v173, v246
    v_sub_f32 v174, v174, v246
    v_sub_f32 v175, v175, v246
    v_sub_f32 v176, v176, v246
    v_sub_f32 v177, v177, v246
    v_sub_f32 v178, v178, v246
    v_sub_f32 v179, v179, v246
    v_sub_f32 v180, v180, v246
    v_sub_f32 v181, v181, v246
    v_sub_f32 v182, v182, v246
    v_sub_f32 v183, v183, v246
    v_sub_f32 v188, v188, v246
    v_sub_f32 v189, v189, v246
    v_sub_f32 v190, v190, v246
    v_sub_f32 v191, v191, v246
    v_sub_f32 v192, v192, v246
    v_sub_f32 v193, v193, v246
    v_sub_f32 v194, v194, v246
    v_sub_f32 v195, v195, v246
    v_sub_f32 v196, v196, v246
    v_sub_f32 v197, v197, v246
    v_sub_f32 v198, v198, v246
    v_sub_f32 v199, v199, v246
    v_sub_f32 v200, v200, v246
    v_sub_f32 v201, v201, v246
    v_sub_f32 v202, v202, v246
    v_sub_f32 v203, v203, v246
    v_sub_f32 v246, 0, v246
    v_exp_f32 v246, v246
    s_nop 0
    v_mul_f32 v56, v56, v246
    v_mul_f32 v57, v57, v246
    v_mul_f32 v58, v58, v246
    v_mul_f32 v59, v59, v246
    v_mul_f32 v60, v60, v246
    v_mul_f32 v61, v61, v246
    v_mul_f32 v62, v62, v246
    v_mul_f32 v63, v63, v246
    v_mul_f32 v64, v64, v246
    v_mul_f32 v65, v65, v246
    v_mul_f32 v66, v66, v246
    v_mul_f32 v67, v67, v246
    v_mul_f32 v68, v68, v246
    v_mul_f32 v69, v69, v246
    v_mul_f32 v70, v70, v246
    v_mul_f32 v71, v71, v246
    v_mul_f32 v72, v72, v246
    v_mul_f32 v73, v73, v246
    v_mul_f32 v74, v74, v246
    v_mul_f32 v75, v75, v246
    v_mul_f32 v76, v76, v246
    v_mul_f32 v77, v77, v246
    v_mul_f32 v78, v78, v246
    v_mul_f32 v79, v79, v246
    v_mul_f32 v80, v80, v246
    v_mul_f32 v81, v81, v246
    v_mul_f32 v82, v82, v246
    v_mul_f32 v83, v83, v246
    v_mul_f32 v84, v84, v246
    v_mul_f32 v85, v85, v246
    v_mul_f32 v86, v86, v246
    v_mul_f32 v87, v87, v246
    v_mul_f32 v88, v88, v246
    v_mul_f32 v89, v89, v246
    v_mul_f32 v90, v90, v246
    v_mul_f32 v91, v91, v246
    v_mul_f32 v92, v92, v246
    v_mul_f32 v93, v93, v246
    v_mul_f32 v94, v94, v246
    v_mul_f32 v95, v95, v246
    v_mul_f32 v96, v96, v246
    v_mul_f32 v97, v97, v246
    v_mul_f32 v98, v98, v246
    v_mul_f32 v99, v99, v246
    v_mul_f32 v100, v100, v246
    v_mul_f32 v101, v101, v246
    v_mul_f32 v102, v102, v246
    v_mul_f32 v103, v103, v246
    v_mul_f32 v104, v104, v246
    v_mul_f32 v105, v105, v246
    v_mul_f32 v106, v106, v246
    v_mul_f32 v107, v107, v246
    v_mul_f32 v108, v108, v246
    v_mul_f32 v109, v109, v246
    v_mul_f32 v110, v110, v246
    v_mul_f32 v111, v111, v246
    v_mul_f32 v112, v112, v246
    v_mul_f32 v113, v113, v246
    v_mul_f32 v114, v114, v246
    v_mul_f32 v115, v115, v246
    v_mul_f32 v116, v116, v246
    v_mul_f32 v117, v117, v246
    v_mul_f32 v118, v118, v246
    v_mul_f32 v119, v119, v246
    v_mul_f32 v244, v244, v246
    v_lshlrev_b32 v247, 16, v152
    v_and_b32 v248, 0xffff0000, v152
    v_mul_f32 v247, v247, v246
    v_mul_f32 v248, v248, v246
    v_cvt_pk_bf16_f32 v152, v247, v248
    v_lshlrev_b32 v247, 16, v153
    v_and_b32 v248, 0xffff0000, v153
    v_mul_f32 v247, v247, v246
    v_mul_f32 v248, v248, v246
    v_cvt_pk_bf16_f32 v153, v247, v248
    v_lshlrev_b32 v247, 16, v154
    v_and_b32 v248, 0xffff0000, v154
    v_mul_f32 v247, v247, v246
    v_mul_f32 v248, v248, v246
    v_cvt_pk_bf16_f32 v154, v247, v248
    v_lshlrev_b32 v247, 16, v155
    v_and_b32 v248, 0xffff0000, v155
    v_mul_f32 v247, v247, v246
    v_mul_f32 v248, v248, v246
    v_cvt_pk_bf16_f32 v155, v247, v248
    v_lshlrev_b32 v247, 16, v156
    v_and_b32 v248, 0xffff0000, v156
    v_mul_f32 v247, v247, v246
    v_mul_f32 v248, v248, v246
    v_cvt_pk_bf16_f32 v156, v247, v248
    v_lshlrev_b32 v247, 16, v157
    v_and_b32 v248, 0xffff0000, v157
    v_mul_f32 v247, v247, v246
    v_mul_f32 v248, v248, v246
    v_cvt_pk_bf16_f32 v157, v247, v248
    v_lshlrev_b32 v247, 16, v158
    v_and_b32 v248, 0xffff0000, v158
    v_mul_f32 v247, v247, v246
    v_mul_f32 v248, v248, v246
    v_cvt_pk_bf16_f32 v158, v247, v248
    v_lshlrev_b32 v247, 16, v159
    v_and_b32 v248, 0xffff0000, v159
    v_mul_f32 v247, v247, v246
    v_mul_f32 v248, v248, v246
    v_cvt_pk_bf16_f32 v159, v247, v248
    s_nop 7
    s_branch L_back_B04
L_slow_A05:
    s_nop 15
    v_mov_b32 v248, v246
    s_nop 1
    v_permlane32_swap_b32 v246, v248
    v_max_f32 v246, v246, v248
    v_mov_b32 v248, v247
    s_nop 1
    v_permlane32_swap_b32 v247, v248
    v_max_f32 v247, v247, v248
    v_mov_b32 v248, v247
    s_nop 1
    v_permlane16_swap_b32 v247, v248
    v_max_f32 v247, v247, v248
    v_max_f32 v246, 0, v246
    v_ceil_f32 v246, v246
    v_max_f32 v247, 0, v247
    v_ceil_f32 v247, v247
    v_sub_f32 v152, v152, v246
    v_sub_f32 v153, v153, v246
    v_sub_f32 v154, v154, v246
    v_sub_f32 v155, v155, v246
    v_sub_f32 v156, v156, v246
    v_sub_f32 v157, v157, v246
    v_sub_f32 v158, v158, v246
    v_sub_f32 v159, v159, v246
    v_sub_f32 v160, v160, v246
    v_sub_f32 v161, v161, v246
    v_sub_f32 v162, v162, v246
    v_sub_f32 v163, v163, v246
    v_sub_f32 v164, v164, v246
    v_sub_f32 v165, v165, v246
    v_sub_f32 v166, v166, v246
    v_sub_f32 v167, v167, v246
    v_sub_f32 v168, v168, v246
    v_sub_f32 v169, v169, v246
    v_sub_f32 v170, v170, v246
    v_sub_f32 v171, v171, v246
    v_sub_f32 v172, v172, v246
    v_sub_f32 v173, v173, v246
    v_sub_f32 v174, v174, v246
    v_sub_f32 v175, v175, v246
    v_sub_f32 v176, v176, v246
    v_sub_f32 v177, v177, v246
    v_sub_f32 v178, v178, v246
    v_sub_f32 v179, v179, v246
    v_sub_f32 v180, v180, v246
    v_sub_f32 v181, v181, v246
    v_sub_f32 v182, v182, v246
    v_sub_f32 v183, v183, v246
    v_sub_f32 v184, v184, v247
    v_sub_f32 v185, v185, v247
    v_sub_f32 v186, v186, v247
    v_sub_f32 v187, v187, v247
    v_sub_f32 v188, v188, v246
    v_sub_f32 v189, v189, v246
    v_sub_f32 v190, v190, v246
    v_sub_f32 v191, v191, v246
    v_sub_f32 v192, v192, v246
    v_sub_f32 v193, v193, v246
    v_sub_f32 v194, v194, v246
    v_sub_f32 v195, v195, v246
    v_sub_f32 v196, v196, v246
    v_sub_f32 v197, v197, v246
    v_sub_f32 v198, v198, v246
    v_sub_f32 v199, v199, v246
    v_sub_f32 v200, v200, v246
    v_sub_f32 v201, v201, v246
    v_sub_f32 v202, v202, v246
    v_sub_f32 v203, v203, v246
    v_sub_f32 v204, v204, v247
    v_sub_f32 v205, v205, v247
    v_sub_f32 v206, v206, v247
    v_sub_f32 v207, v207, v247
    v_sub_f32 v246, 0, v246
    v_sub_f32 v247, 0, v247
    v_exp_f32 v246, v246
    v_exp_f32 v247, v247
    v_mul_f32 v56, v56, v246
    v_mul_f32 v57, v57, v246
    v_mul_f32 v58, v58, v246
    v_mul_f32 v59, v59, v246
    v_mul_f32 v60, v60, v246
    v_mul_f32 v61, v61, v246
    v_mul_f32 v62, v62, v246
    v_mul_f32 v63, v63, v246
    v_mul_f32 v64, v64, v246
    v_mul_f32 v65, v65, v246
    v_mul_f32 v66, v66, v246
    v_mul_f32 v67, v67, v246
    v_mul_f32 v68, v68, v246
    v_mul_f32 v69, v69, v246
    v_mul_f32 v70, v70, v246
    v_mul_f32 v71, v71, v246
    v_mul_f32 v72, v72, v246
    v_mul_f32 v73, v73, v246
    v_mul_f32 v74, v74, v246
    v_mul_f32 v75, v75, v246
    v_mul_f32 v76, v76, v246
    v_mul_f32 v77, v77, v246
    v_mul_f32 v78, v78, v246
    v_mul_f32 v79, v79, v246
    v_mul_f32 v80, v80, v246
    v_mul_f32 v81, v81, v246
    v_mul_f32 v82, v82, v246
    v_mul_f32 v83, v83, v246
    v_mul_f32 v84, v84, v246
    v_mul_f32 v85, v85, v246
    v_mul_f32 v86, v86, v246
    v_mul_f32 v87, v87, v246
    v_mul_f32 v88, v88, v246
    v_mul_f32 v89, v89, v246
    v_mul_f32 v90, v90, v246
    v_mul_f32 v91, v91, v246
    v_mul_f32 v92, v92, v246
    v_mul_f32 v93, v93, v246
    v_mul_f32 v94, v94, v246
    v_mul_f32 v95, v95, v246
    v_mul_f32 v96, v96, v246
    v_mul_f32 v97, v97, v246
    v_mul_f32 v98, v98, v246
    v_mul_f32 v99, v99, v246
    v_mul_f32 v100, v100, v246
    v_mul_f32 v101, v101, v246
    v_mul_f32 v102, v102, v246
    v_mul_f32 v103, v103, v246
    v_mul_f32 v104, v104, v246
    v_mul_f32 v105, v105, v246
    v_mul_f32 v106, v106, v246
    v_mul_f32 v107, v107, v246
    v_mul_f32 v108, v108, v246
    v_mul_f32 v109, v109, v246
    v_mul_f32 v110, v110, v246
    v_mul_f32 v111, v111, v246
    v_mul_f32 v112, v112, v246
    v_mul_f32 v113, v113, v246
    v_mul_f32 v114, v114, v246
    v_mul_f32 v115, v115, v246
    v_mul_f32 v116, v116, v246
    v_mul_f32 v117, v117, v246
    v_mul_f32 v118, v118, v246
    v_mul_f32 v119, v119, v246
    v_mul_f32 v120, v120, v247
    v_mul_f32 v121, v121, v247
    v_mul_f32 v122, v122, v247
    v_mul_f32 v123, v123, v247
    v_mul_f32 v124, v124, v247
    v_mul_f32 v125, v125, v247
    v_mul_f32 v126, v126, v247
    v_mul_f32 v127, v127, v247
    v_mul_f32 v128, v128, v247
    v_mul_f32 v129, v129, v247
    v_mul_f32 v130, v130, v247
    v_mul_f32 v131, v131, v247
    v_mul_f32 v132, v132, v247
    v_mul_f32 v133, v133, v247
    v_mul_f32 v134, v134, v247
    v_mul_f32 v135, v135, v247
    v_mul_f32 v136, v136, v247
    v_mul_f32 v137, v137, v247
    v_mul_f32 v138, v138, v247
    v_mul_f32 v139, v139, v247
    v_mul_f32 v140, v140, v247
    v_mul_f32 v141, v141, v247
    v_mul_f32 v142, v142, v247
    v_mul_f32 v143, v143, v247
    v_mul_f32 v144, v144, v247
    v_mul_f32 v145, v145, v247
    v_mul_f32 v146, v146, v247
    v_mul_f32 v147, v147, v247
    v_mul_f32 v148, v148, v247
    v_mul_f32 v149, v149, v247
    v_mul_f32 v150, v150, v247
    v_mul_f32 v151, v151, v247
    v_mul_f32 v244, v244, v246
    v_mul_f32 v245, v245, v247
    s_nop 7
    s_branch L_back_A05
L_slow_B05:
    s_nop 15
    v_mov_b32 v248, v246
    s_nop 1
    v_permlane32_swap_b32 v246, v248
    v_max_f32 v246, v246, v248
    v_max_f32 v246, 0, v246
    v_ceil_f32 v246, v246
    v_sub_f32 v168, v168, v246
    v_sub_f32 v169, v169, v246
    v_sub_f32 v170, v170, v246
    v_sub_f32 v171, v171, v246
    v_sub_f32 v172, v172, v246
    v_sub_f32 v173, v173, v246
    v_sub_f32 v174, v174, v246
    v_sub_f32 v175, v175, v246
    v_sub_f32 v176, v176, v246
    v_sub_f32 v177, v177, v246
    v_sub_f32 v178, v178, v246
    v_sub_f32 v179, v179, v246
    v_sub_f32 v180, v180, v246
    v_sub_f32 v181, v181, v246
    v_sub_f32 v182, v182, v246
    v_sub_f32 v183, v183, v246
    v_sub_f32 v188, v188, v246
    v_sub_f32 v189, v189, v246
    v_sub_f32 v190, v190, v246
    v_sub_f32 v191, v191, v246
    v_sub_f32 v192, v192, v246
    v_sub_f32 v193, v193, v246
    v_sub_f32 v194, v194, v246
    v_sub_f32 v195, v195, v246
    v_sub_f32 v196, v196, v246
    v_sub_f32 v197, v197, v246
    v_sub_f32 v198, v198, v246
    v_sub_f32 v199, v199, v246
    v_sub_f32 v200, v200, v246
    v_sub_f32 v201, v201, v246
    v_sub_f32 v202, v202, v246
    v_sub_f32 v203, v203, v246
    v_sub_f32 v246, 0, v246
    v_exp_f32 v246, v246
    s_nop 0
    v_mul_f32 v56, v56, v246
    v_mul_f32 v57, v57, v246
    v_mul_f32 v58, v58, v246
    v_mul_f32 v59, v59, v246
    v_mul_f32 v60, v60, v246
    v_mul_f32 v61, v61, v246
    v_mul_f32 v62, v62, v246
    v_mul_f32 v63, v63, v246
    v_mul_f32 v64, v64, v246
    v_mul_f32 v65, v65, v246
    v_mul_f32 v66, v66, v246
    v_mul_f32 v67, v67, v246
    v_mul_f32 v68, v68, v246
    v_mul_f32 v69, v69, v246
    v_mul_f32 v70, v70, v246
    v_mul_f32 v71, v71, v246
    v_mul_f32 v72, v72, v246
    v_mul_f32 v73, v73, v246
    v_mul_f32 v74, v74, v246
    v_mul_f32 v75, v75, v246
    v_mul_f32 v76, v76, v246
    v_mul_f32 v77, v77, v246
    v_mul_f32 v78, v78, v246
    v_mul_f32 v79, v79, v246
    v_mul_f32 v80, v80, v246
    v_mul_f32 v81, v81, v246
    v_mul_f32 v82, v82, v246
    v_mul_f32 v83, v83, v246
    v_mul_f32 v84, v84, v246
    v_mul_f32 v85, v85, v246
    v_mul_f32 v86, v86, v246
    v_mul_f32 v87, v87, v246
    v_mul_f32 v88, v88, v246
    v_mul_f32 v89, v89, v246
    v_mul_f32 v90, v90, v246
    v_mul_f32 v91, v91, v246
    v_mul_f32 v92, v92, v246
    v_mul_f32 v93, v93, v246
    v_mul_f32 v94, v94, v246
    v_mul_f32 v95, v95, v246
    v_mul_f32 v96, v96, v246
    v_mul_f32 v97, v97, v246
    v_mul_f32 v98, v98, v246
    v_mul_f32 v99, v99, v246
    v_mul_f32 v100, v100, v246
    v_mul_f32 v101, v101, v246
    v_mul_f32 v102, v102, v246
    v_mul_f32 v103, v103, v246
    v_mul_f32 v104, v104, v246
    v_mul_f32 v105, v105, v246
    v_mul_f32 v106, v106, v246
    v_mul_f32 v107, v107, v246
    v_mul_f32 v108, v108, v246
    v_mul_f32 v109, v109, v246
    v_mul_f32 v110, v110, v246
    v_mul_f32 v111, v111, v246
    v_mul_f32 v112, v112, v246
    v_mul_f32 v113, v113, v246
    v_mul_f32 v114, v114, v246
    v_mul_f32 v115, v115, v246
    v_mul_f32 v116, v116, v246
    v_mul_f32 v117, v117, v246
    v_mul_f32 v118, v118, v246
    v_mul_f32 v119, v119, v246
    v_mul_f32 v244, v244, v246
    v_lshlrev_b32 v247, 16, v152
    v_and_b32 v248, 0xffff0000, v152
    v_mul_f32 v247, v247, v246
    v_mul_f32 v248, v248, v246
    v_cvt_pk_bf16_f32 v152, v247, v248
    v_lshlrev_b32 v247, 16, v153
    v_and_b32 v248, 0xffff0000, v153
    v_mul_f32 v247, v247, v246
    v_mul_f32 v248, v248, v246
    v_cvt_pk_bf16_f32 v153, v247, v248
    v_lshlrev_b32 v247, 16, v154
    v_and_b32 v248, 0xffff0000, v154
    v_mul_f32 v247, v247, v246
    v_mul_f32 v248, v248, v246
    v_cvt_pk_bf16_f32 v154, v247, v248
    v_lshlrev_b32 v247, 16, v155
    v_and_b32 v248, 0xffff0000, v155
    v_mul_f32 v247, v247, v246
    v_mul_f32 v248, v248, v246
    v_cvt_pk_bf16_f32 v155, v247, v248
    v_lshlrev_b32 v247, 16, v156
    v_and_b32 v248, 0xffff0000, v156
    v_mul_f32 v247, v247, v246
    v_mul_f32 v248, v248, v246
    v_cvt_pk_bf16_f32 v156, v247, v248
    v_lshlrev_b32 v247, 16, v157
    v_and_b32 v248, 0xffff0000, v157
    v_mul_f32 v247, v247, v246
    v_mul_f32 v248, v248, v246
    v_cvt_pk_bf16_f32 v157, v247, v248
    v_lshlrev_b32 v247, 16, v158
    v_and_b32 v248, 0xffff0000, v158
    v_mul_f32 v247, v247, v246
    v_mul_f32 v248, v248, v246
    v_cvt_pk_bf16_f32 v158, v247, v248
    v_lshlrev_b32 v247, 16, v159
    v_and_b32 v248, 0xffff0000, v159
    v_mul_f32 v247, v247, v246
    v_mul_f32 v248, v248, v246
    v_cvt_pk_bf16_f32 v159, v247, v248
    s_nop 7
    s_branch L_back_B05
L_slow_A06:
    s_nop 15
    v_mov_b32 v248, v246
    s_nop 1
    v_permlane32_swap_b32 v246, v248
    v_max_f32 v246, v246, v248
    v_mov_b32 v248, v247
    s_nop 1
    v_permlane32_swap_b32 v247, v248
    v_max_f32 v247, v247, v248
    v_mov_b32 v248, v247
    s_nop 1
    v_permlane16_swap_b32 v247, v248
    v_max_f32 v247, v247, v248
    v_max_f32 v246, 0, v246
    v_ceil_f32 v246, v246
    v_max_f32 v247, 0, v247
    v_ceil_f32 v247, v247
    v_sub_f32 v152, v152, v246
    v_sub_f32 v153, v153, v246
    v_sub_f32 v154, v154, v246
    v_sub_f32 v155, v155, v246
    v_sub_f32 v156, v156, v246
    v_sub_f32 v157, v157, v246
    v_sub_f32 v158, v158, v246
    v_sub_f32 v159, v159, v246
    v_sub_f32 v160, v160, v246
    v_sub_f32 v161, v161, v246
    v_sub_f32 v162, v162, v246
    v_sub_f32 v163, v163, v246
    v_sub_f32 v164, v164, v246
    v_sub_f32 v165, v165, v246
    v_sub_f32 v166, v166, v246
    v_sub_f32 v167, v167, v246
    v_sub_f32 v168, v168, v246
    v_sub_f32 v169, v169, v246
    v_sub_f32 v170, v170, v246
    v_sub_f32 v171, v171, v246
    v_sub_f32 v172, v172, v246
    v_sub_f32 v173, v173, v246
    v_sub_f32 v174, v174, v246
    v_sub_f32 v175, v175, v246
    v_sub_f32 v176, v176, v246
    v_sub_f32 v177, v177, v246
    v_sub_f32 v178, v178, v246
    v_sub_f32 v179, v179, v246
    v_sub_f32 v180, v180, v246
    v_sub_f32 v181, v181, v246
    v_sub_f32 v182, v182, v246
    v_sub_f32 v183, v183, v246
    v_sub_f32 v184, v184, v247
    v_sub_f32 v185, v185, v247
    v_sub_f32 v186, v186, v247
    v_sub_f32 v187, v187, v247
    v_sub_f32 v188, v188, v246
    v_sub_f32 v189, v189, v246
    v_sub_f32 v190, v190, v246
    v_sub_f32 v191, v191, v246
    v_sub_f32 v192, v192, v246
    v_sub_f32 v193, v193, v246
    v_sub_f32 v194, v194, v246
    v_sub_f32 v195, v195, v246
    v_sub_f32 v196, v196, v246
    v_sub_f32 v197, v197, v246
    v_sub_f32 v198, v198, v246
    v_sub_f32 v199, v199, v246
    v_sub_f32 v200, v200, v246
    v_sub_f32 v201, v201, v246
    v_sub_f32 v202, v202, v246
    v_sub_f32 v203, v203, v246
    v_sub_f32 v204, v204, v247
    v_sub_f32 v205, v205, v247
    v_sub_f32 v206, v206, v247
    v_sub_f32 v207, v207, v247
    v_sub_f32 v246, 0, v246
    v_sub_f32 v247, 0, v247
    v_exp_f32 v246, v246
    v_exp_f32 v247, v247
    v_mul_f32 v56, v56, v246
    v_mul_f32 v57, v57, v246
    v_mul_f32 v58, v58, v246
    v_mul_f32 v59, v59, v246
    v_mul_f32 v60, v60, v246
    v_mul_f32 v61, v61, v246
    v_mul_f32 v62, v62, v246
    v_mul_f32 v63, v63, v246
    v_mul_f32 v64, v64, v246
    v_mul_f32 v65, v65, v246
    v_mul_f32 v66, v66, v246
    v_mul_f32 v67, v67, v246
    v_mul_f32 v68, v68, v246
    v_mul_f32 v69, v69, v246
    v_mul_f32 v70, v70, v246
    v_mul_f32 v71, v71, v246
    v_mul_f32 v72, v72, v246
    v_mul_f32 v73, v73, v246
    v_mul_f32 v74, v74, v246
    v_mul_f32 v75, v75, v246
    v_mul_f32 v76, v76, v246
    v_mul_f32 v77, v77, v246
    v_mul_f32 v78, v78, v246
    v_mul_f32 v79, v79, v246
    v_mul_f32 v80, v80, v246
    v_mul_f32 v81, v81, v246
    v_mul_f32 v82, v82, v246
    v_mul_f32 v83, v83, v246
    v_mul_f32 v84, v84, v246
    v_mul_f32 v85, v85, v246
    v_mul_f32 v86, v86, v246
    v_mul_f32 v87, v87, v246
    v_mul_f32 v88, v88, v246
    v_mul_f32 v89, v89, v246
    v_mul_f32 v90, v90, v246
    v_mul_f32 v91, v91, v246
    v_mul_f32 v92, v92, v246
    v_mul_f32 v93, v93, v246
    v_mul_f32 v94, v94, v246
    v_mul_f32 v95, v95, v246
    v_mul_f32 v96, v96, v246
    v_mul_f32 v97, v97, v246
    v_mul_f32 v98, v98, v246
    v_mul_f32 v99, v99, v246
    v_mul_f32 v100, v100, v246
    v_mul_f32 v101, v101, v246
    v_mul_f32 v102, v102, v246
    v_mul_f32 v103, v103, v246
    v_mul_f32 v104, v104, v246
    v_mul_f32 v105, v105, v246
    v_mul_f32 v106, v106, v246
    v_mul_f32 v107, v107, v246
    v_mul_f32 v108, v108, v246
    v_mul_f32 v109, v109, v246
    v_mul_f32 v110, v110, v246
    v_mul_f32 v111, v111, v246
    v_mul_f32 v112, v112, v246
    v_mul_f32 v113, v113, v246
    v_mul_f32 v114, v114, v246
    v_mul_f32 v115, v115, v246
    v_mul_f32 v116, v116, v246
    v_mul_f32 v117, v117, v246
    v_mul_f32 v118, v118, v246
    v_mul_f32 v119, v119, v246
    v_mul_f32 v120, v120, v247
    v_mul_f32 v121, v121, v247
    v_mul_f32 v122, v122, v247
    v_mul_f32 v123, v123, v247
    v_mul_f32 v124, v124, v247
    v_mul_f32 v125, v125, v247
    v_mul_f32 v126, v126, v247
    v_mul_f32 v127, v127, v247
    v_mul_f32 v128, v128, v247
    v_mul_f32 v129, v129, v247
    v_mul_f32 v130, v130, v247
    v_mul_f32 v131, v131, v247
    v_mul_f32 v132, v132, v247
    v_mul_f32 v133, v133, v247
    v_mul_f32 v134, v134, v247
    v_mul_f32 v135, v135, v247
    v_mul_f32 v136, v136, v247
    v_mul_f32 v137, v137, v247
    v_mul_f32 v138, v138, v247
    v_mul_f32 v139, v139, v247
    v_mul_f32 v140, v140, v247
    v_mul_f32 v141, v141, v247
    v_mul_f32 v142, v142, v247
    v_mul_f32 v143, v143, v247
    v_mul_f32 v144, v144, v247
    v_mul_f32 v145, v145, v247
    v_mul_f32 v146, v146, v247
    v_mul_f32 v147, v147, v247
    v_mul_f32 v148, v148, v247
    v_mul_f32 v149, v149, v247
    v_mul_f32 v150, v150, v247
    v_mul_f32 v151, v151, v247
    v_mul_f32 v244, v244, v246
    v_mul_f32 v245, v245, v247
    s_nop 7
    s_branch L_back_A06
L_slow_B06:
    s_nop 15
    v_mov_b32 v248, v246
    s_nop 1
    v_permlane32_swap_b32 v246, v248
    v_max_f32 v246, v246, v248
    v_max_f32 v246, 0, v246
    v_ceil_f32 v246, v246
    v_sub_f32 v168, v168, v246
    v_sub_f32 v169, v169, v246
    v_sub_f32 v170, v170, v246
    v_sub_f32 v171, v171, v246
    v_sub_f32 v172, v172, v246
    v_sub_f32 v173, v173, v246
    v_sub_f32 v174, v174, v246
    v_sub_f32 v175, v175, v246
    v_sub_f32 v176, v176, v246
    v_sub_f32 v177, v177, v246
    v_sub_f32 v178, v178, v246
    v_sub_f32 v179, v179, v246
    v_sub_f32 v180, v180, v246
    v_sub_f32 v181, v181, v246
    v_sub_f32 v182, v182, v246
    v_sub_f32 v183, v183, v246
    v_sub_f32 v188, v188, v246
    v_sub_f32 v189, v189, v246
    v_sub_f32 v190, v190, v246
    v_sub_f32 v191, v191, v246
    v_sub_f32 v192, v192, v246
    v_sub_f32 v193, v193, v246
    v_sub_f32 v194, v194, v246
    v_sub_f32 v195, v195, v246
    v_sub_f32 v196, v196, v246
    v_sub_f32 v197, v197, v246
    v_sub_f32 v198, v198, v246
    v_sub_f32 v199, v199, v246
    v_sub_f32 v200, v200, v246
    v_sub_f32 v201, v201, v246
    v_sub_f32 v202, v202, v246
    v_sub_f32 v203, v203, v246
    v_sub_f32 v246, 0, v246
    v_exp_f32 v246, v246
    s_nop 0
    v_mul_f32 v56, v56, v246
    v_mul_f32 v57, v57, v246
    v_mul_f32 v58, v58, v246
    v_mul_f32 v59, v59, v246
    v_mul_f32 v60, v60, v246
    v_mul_f32 v61, v61, v246
    v_mul_f32 v62, v62, v246
    v_mul_f32 v63, v63, v246
    v_mul_f32 v64, v64, v246
    v_mul_f32 v65, v65, v246
    v_mul_f32 v66, v66, v246
    v_mul_f32 v67, v67, v246
    v_mul_f32 v68, v68, v246
    v_mul_f32 v69, v69, v246
    v_mul_f32 v70, v70, v246
    v_mul_f32 v71, v71, v246
    v_mul_f32 v72, v72, v246
    v_mul_f32 v73, v73, v246
    v_mul_f32 v74, v74, v246
    v_mul_f32 v75, v75, v246
    v_mul_f32 v76, v76, v246
    v_mul_f32 v77, v77, v246
    v_mul_f32 v78, v78, v246
    v_mul_f32 v79, v79, v246
    v_mul_f32 v80, v80, v246
    v_mul_f32 v81, v81, v246
    v_mul_f32 v82, v82, v246
    v_mul_f32 v83, v83, v246
    v_mul_f32 v84, v84, v246
    v_mul_f32 v85, v85, v246
    v_mul_f32 v86, v86, v246
    v_mul_f32 v87, v87, v246
    v_mul_f32 v88, v88, v246
    v_mul_f32 v89, v89, v246
    v_mul_f32 v90, v90, v246
    v_mul_f32 v91, v91, v246
    v_mul_f32 v92, v92, v246
    v_mul_f32 v93, v93, v246
    v_mul_f32 v94, v94, v246
    v_mul_f32 v95, v95, v246
    v_mul_f32 v96, v96, v246
    v_mul_f32 v97, v97, v246
    v_mul_f32 v98, v98, v246
    v_mul_f32 v99, v99, v246
    v_mul_f32 v100, v100, v246
    v_mul_f32 v101, v101, v246
    v_mul_f32 v102, v102, v246
    v_mul_f32 v103, v103, v246
    v_mul_f32 v104, v104, v246
    v_mul_f32 v105, v105, v246
    v_mul_f32 v106, v106, v246
    v_mul_f32 v107, v107, v246
    v_mul_f32 v108, v108, v246
    v_mul_f32 v109, v109, v246
    v_mul_f32 v110, v110, v246
    v_mul_f32 v111, v111, v246
    v_mul_f32 v112, v112, v246
    v_mul_f32 v113, v113, v246
    v_mul_f32 v114, v114, v246
    v_mul_f32 v115, v115, v246
    v_mul_f32 v116, v116, v246
    v_mul_f32 v117, v117, v246
    v_mul_f32 v118, v118, v246
    v_mul_f32 v119, v119, v246
    v_mul_f32 v244, v244, v246
    v_lshlrev_b32 v247, 16, v152
    v_and_b32 v248, 0xffff0000, v152
    v_mul_f32 v247, v247, v246
    v_mul_f32 v248, v248, v246
    v_cvt_pk_bf16_f32 v152, v247, v248
    v_lshlrev_b32 v247, 16, v153
    v_and_b32 v248, 0xffff0000, v153
    v_mul_f32 v247, v247, v246
    v_mul_f32 v248, v248, v246
    v_cvt_pk_bf16_f32 v153, v247, v248
    v_lshlrev_b32 v247, 16, v154
    v_and_b32 v248, 0xffff0000, v154
    v_mul_f32 v247, v247, v246
    v_mul_f32 v248, v248, v246
    v_cvt_pk_bf16_f32 v154, v247, v248
    v_lshlrev_b32 v247, 16, v155
    v_and_b32 v248, 0xffff0000, v155
    v_mul_f32 v247, v247, v246
    v_mul_f32 v248, v248, v246
    v_cvt_pk_bf16_f32 v155, v247, v248
    v_lshlrev_b32 v247, 16, v156
    v_and_b32 v248, 0xffff0000, v156
    v_mul_f32 v247, v247, v246
    v_mul_f32 v248, v248, v246
    v_cvt_pk_bf16_f32 v156, v247, v248
    v_lshlrev_b32 v247, 16, v157
    v_and_b32 v248, 0xffff0000, v157
    v_mul_f32 v247, v247, v246
    v_mul_f32 v248, v248, v246
    v_cvt_pk_bf16_f32 v157, v247, v248
    v_lshlrev_b32 v247, 16, v158
    v_and_b32 v248, 0xffff0000, v158
    v_mul_f32 v247, v247, v246
    v_mul_f32 v248, v248, v246
    v_cvt_pk_bf16_f32 v158, v247, v248
    v_lshlrev_b32 v247, 16, v159
    v_and_b32 v248, 0xffff0000, v159
    v_mul_f32 v247, v247, v246
    v_mul_f32 v248, v248, v246
    v_cvt_pk_bf16_f32 v159, v247, v248
    s_nop 7
    s_branch L_back_B06
L_slow_A07:
    s_nop 15
    v_mov_b32 v248, v246
    s_nop 1
    v_permlane32_swap_b32 v246, v248
    v_max_f32 v246, v246, v248
    v_mov_b32 v248, v247
    s_nop 1
    v_permlane32_swap_b32 v247, v248
    v_max_f32 v247, v247, v248
    v_mov_b32 v248, v247
    s_nop 1
    v_permlane16_swap_b32 v247, v248
    v_max_f32 v247, v247, v248
    v_max_f32 v246, 0, v246
    v_ceil_f32 v246, v246
    v_max_f32 v247, 0, v247
    v_ceil_f32 v247, v247
    v_sub_f32 v152, v152, v246
    v_sub_f32 v153, v153, v246
    v_sub_f32 v154, v154, v246
    v_sub_f32 v155, v155, v246
    v_sub_f32 v156, v156, v246
    v_sub_f32 v157, v157, v246
    v_sub_f32 v158, v158, v246
    v_sub_f32 v159, v159, v246
    v_sub_f32 v160, v160, v246
    v_sub_f32 v161, v161, v246
    v_sub_f32 v162, v162, v246
    v_sub_f32 v163, v163, v246
    v_sub_f32 v164, v164, v246
    v_sub_f32 v165, v165, v246
    v_sub_f32 v166, v166, v246
    v_sub_f32 v167, v167, v246
    v_sub_f32 v168, v168, v246
    v_sub_f32 v169, v169, v246
    v_sub_f32 v170, v170, v246
    v_sub_f32 v171, v171, v246
    v_sub_f32 v172, v172, v246
    v_sub_f32 v173, v173, v246
    v_sub_f32 v174, v174, v246
    v_sub_f32 v175, v175, v246
    v_sub_f32 v176, v176, v246
    v_sub_f32 v177, v177, v246
    v_sub_f32 v178, v178, v246
    v_sub_f32 v179, v179, v246
    v_sub_f32 v180, v180, v246
    v_sub_f32 v181, v181, v246
    v_sub_f32 v182, v182, v246
    v_sub_f32 v183, v183, v246
    v_sub_f32 v184, v184, v247
    v_sub_f32 v185, v185, v247
    v_sub_f32 v186, v186, v247
    v_sub_f32 v187, v187, v247
    v_sub_f32 v188, v188, v246
    v_sub_f32 v189, v189, v246
    v_sub_f32 v190, v190, v246
    v_sub_f32 v191, v191, v246
    v_sub_f32 v192, v192, v246
    v_sub_f32 v193, v193, v246
    v_sub_f32 v194, v194, v246
    v_sub_f32 v195, v195, v246
    v_sub_f32 v196, v196, v246
    v_sub_f32 v197, v197, v246
    v_sub_f32 v198, v198, v246
    v_sub_f32 v199, v199, v246
    v_sub_f32 v200, v200, v246
    v_sub_f32 v201, v201, v246
    v_sub_f32 v202, v202, v246
    v_sub_f32 v203, v203, v246
    v_sub_f32 v204, v204, v247
    v_sub_f32 v205, v205, v247
    v_sub_f32 v206, v206, v247
    v_sub_f32 v207, v207, v247
    v_sub_f32 v246, 0, v246
    v_sub_f32 v247, 0, v247
    v_exp_f32 v246, v246
    v_exp_f32 v247, v247
    v_mul_f32 v56, v56, v246
    v_mul_f32 v57, v57, v246
    v_mul_f32 v58, v58, v246
    v_mul_f32 v59, v59, v246
    v_mul_f32 v60, v60, v246
    v_mul_f32 v61, v61, v246
    v_mul_f32 v62, v62, v246
    v_mul_f32 v63, v63, v246
    v_mul_f32 v64, v64, v246
    v_mul_f32 v65, v65, v246
    v_mul_f32 v66, v66, v246
    v_mul_f32 v67, v67, v246
    v_mul_f32 v68, v68, v246
    v_mul_f32 v69, v69, v246
    v_mul_f32 v70, v70, v246
    v_mul_f32 v71, v71, v246
    v_mul_f32 v72, v72, v246
    v_mul_f32 v73, v73, v246
    v_mul_f32 v74, v74, v246
    v_mul_f32 v75, v75, v246
    v_mul_f32 v76, v76, v246
    v_mul_f32 v77, v77, v246
    v_mul_f32 v78, v78, v246
    v_mul_f32 v79, v79, v246
    v_mul_f32 v80, v80, v246
    v_mul_f32 v81, v81, v246
    v_mul_f32 v82, v82, v246
    v_mul_f32 v83, v83, v246
    v_mul_f32 v84, v84, v246
    v_mul_f32 v85, v85, v246
    v_mul_f32 v86, v86, v246
    v_mul_f32 v87, v87, v246
    v_mul_f32 v88, v88, v246
    v_mul_f32 v89, v89, v246
    v_mul_f32 v90, v90, v246
    v_mul_f32 v91, v91, v246
    v_mul_f32 v92, v92, v246
    v_mul_f32 v93, v93, v246
    v_mul_f32 v94, v94, v246
    v_mul_f32 v95, v95, v246
    v_mul_f32 v96, v96, v246
    v_mul_f32 v97, v97, v246
    v_mul_f32 v98, v98, v246
    v_mul_f32 v99, v99, v246
    v_mul_f32 v100, v100, v246
    v_mul_f32 v101, v101, v246
    v_mul_f32 v102, v102, v246
    v_mul_f32 v103, v103, v246
    v_mul_f32 v104, v104, v246
    v_mul_f32 v105, v105, v246
    v_mul_f32 v106, v106, v246
    v_mul_f32 v107, v107, v246
    v_mul_f32 v108, v108, v246
    v_mul_f32 v109, v109, v246
    v_mul_f32 v110, v110, v246
    v_mul_f32 v111, v111, v246
    v_mul_f32 v112, v112, v246
    v_mul_f32 v113, v113, v246
    v_mul_f32 v114, v114, v246
    v_mul_f32 v115, v115, v246
    v_mul_f32 v116, v116, v246
    v_mul_f32 v117, v117, v246
    v_mul_f32 v118, v118, v246
    v_mul_f32 v119, v119, v246
    v_mul_f32 v120, v120, v247
    v_mul_f32 v121, v121, v247
    v_mul_f32 v122, v122, v247
    v_mul_f32 v123, v123, v247
    v_mul_f32 v124, v124, v247
    v_mul_f32 v125, v125, v247
    v_mul_f32 v126, v126, v247
    v_mul_f32 v127, v127, v247
    v_mul_f32 v128, v128, v247
    v_mul_f32 v129, v129, v247
    v_mul_f32 v130, v130, v247
    v_mul_f32 v131, v131, v247
    v_mul_f32 v132, v132, v247
    v_mul_f32 v133, v133, v247
    v_mul_f32 v134, v134, v247
    v_mul_f32 v135, v135, v247
    v_mul_f32 v136, v136, v247
    v_mul_f32 v137, v137, v247
    v_mul_f32 v138, v138, v247
    v_mul_f32 v139, v139, v247
    v_mul_f32 v140, v140, v247
    v_mul_f32 v141, v141, v247
    v_mul_f32 v142, v142, v247
    v_mul_f32 v143, v143, v247
    v_mul_f32 v144, v144, v247
    v_mul_f32 v145, v145, v247
    v_mul_f32 v146, v146, v247
    v_mul_f32 v147, v147, v247
    v_mul_f32 v148, v148, v247
    v_mul_f32 v149, v149, v247
    v_mul_f32 v150, v150, v247
    v_mul_f32 v151, v151, v247
    v_mul_f32 v244, v244, v246
    v_mul_f32 v245, v245, v247
    s_nop 7
    s_branch L_back_A07
L_slow_B07:
    s_nop 15
    v_mov_b32 v248, v246
    s_nop 1
    v_permlane32_swap_b32 v246, v248
    v_max_f32 v246, v246, v248
    v_max_f32 v246, 0, v246
    v_ceil_f32 v246, v246
    v_sub_f32 v168, v168, v246
    v_sub_f32 v169, v169, v246
    v_sub_f32 v170, v170, v246
    v_sub_f32 v171, v171, v246
    v_sub_f32 v172, v172, v246
    v_sub_f32 v173, v173, v246
    v_sub_f32 v174, v174, v246
    v_sub_f32 v175, v175, v246
    v_sub_f32 v176, v176, v246
    v_sub_f32 v177, v177, v246
    v_sub_f32 v178, v178, v246
    v_sub_f32 v179, v179, v246
    v_sub_f32 v180, v180, v246
    v_sub_f32 v181, v181, v246
    v_sub_f32 v182, v182, v246
    v_sub_f32 v183, v183, v246
    v_sub_f32 v188, v188, v246
    v_sub_f32 v189, v189, v246
    v_sub_f32 v190, v190, v246
    v_sub_f32 v191, v191, v246
    v_sub_f32 v192, v192, v246
    v_sub_f32 v193, v193, v246
    v_sub_f32 v194, v194, v246
    v_sub_f32 v195, v195, v246
    v_sub_f32 v196, v196, v246
    v_sub_f32 v197, v197, v246
    v_sub_f32 v198, v198, v246
    v_sub_f32 v199, v199, v246
    v_sub_f32 v200, v200, v246
    v_sub_f32 v201, v201, v246
    v_sub_f32 v202, v202, v246
    v_sub_f32 v203, v203, v246
    v_sub_f32 v246, 0, v246
    v_exp_f32 v246, v246
    s_nop 0
    v_mul_f32 v56, v56, v246
    v_mul_f32 v57, v57, v246
    v_mul_f32 v58, v58, v246
    v_mul_f32 v59, v59, v246
    v_mul_f32 v60, v60, v246
    v_mul_f32 v61, v61, v246
    v_mul_f32 v62, v62, v246
    v_mul_f32 v63, v63, v246
    v_mul_f32 v64, v64, v246
    v_mul_f32 v65, v65, v246
    v_mul_f32 v66, v66, v246
    v_mul_f32 v67, v67, v246
    v_mul_f32 v68, v68, v246
    v_mul_f32 v69, v69, v246
    v_mul_f32 v70, v70, v246
    v_mul_f32 v71, v71, v246
    v_mul_f32 v72, v72, v246
    v_mul_f32 v73, v73, v246
    v_mul_f32 v74, v74, v246
    v_mul_f32 v75, v75, v246
    v_mul_f32 v76, v76, v246
    v_mul_f32 v77, v77, v246
    v_mul_f32 v78, v78, v246
    v_mul_f32 v79, v79, v246
    v_mul_f32 v80, v80, v246
    v_mul_f32 v81, v81, v246
    v_mul_f32 v82, v82, v246
    v_mul_f32 v83, v83, v246
    v_mul_f32 v84, v84, v246
    v_mul_f32 v85, v85, v246
    v_mul_f32 v86, v86, v246
    v_mul_f32 v87, v87, v246
    v_mul_f32 v88, v88, v246
    v_mul_f32 v89, v89, v246
    v_mul_f32 v90, v90, v246
    v_mul_f32 v91, v91, v246
    v_mul_f32 v92, v92, v246
    v_mul_f32 v93, v93, v246
    v_mul_f32 v94, v94, v246
    v_mul_f32 v95, v95, v246
    v_mul_f32 v96, v96, v246
    v_mul_f32 v97, v97, v246
    v_mul_f32 v98, v98, v246
    v_mul_f32 v99, v99, v246
    v_mul_f32 v100, v100, v246
    v_mul_f32 v101, v101, v246
    v_mul_f32 v102, v102, v246
    v_mul_f32 v103, v103, v246
    v_mul_f32 v104, v104, v246
    v_mul_f32 v105, v105, v246
    v_mul_f32 v106, v106, v246
    v_mul_f32 v107, v107, v246
    v_mul_f32 v108, v108, v246
    v_mul_f32 v109, v109, v246
    v_mul_f32 v110, v110, v246
    v_mul_f32 v111, v111, v246
    v_mul_f32 v112, v112, v246
    v_mul_f32 v113, v113, v246
    v_mul_f32 v114, v114, v246
    v_mul_f32 v115, v115, v246
    v_mul_f32 v116, v116, v246
    v_mul_f32 v117, v117, v246
    v_mul_f32 v118, v118, v246
    v_mul_f32 v119, v119, v246
    v_mul_f32 v244, v244, v246
    v_lshlrev_b32 v247, 16, v152
    v_and_b32 v248, 0xffff0000, v152
    v_mul_f32 v247, v247, v246
    v_mul_f32 v248, v248, v246
    v_cvt_pk_bf16_f32 v152, v247, v248
    v_lshlrev_b32 v247, 16, v153
    v_and_b32 v248, 0xffff0000, v153
    v_mul_f32 v247, v247, v246
    v_mul_f32 v248, v248, v246
    v_cvt_pk_bf16_f32 v153, v247, v248
    v_lshlrev_b32 v247, 16, v154
    v_and_b32 v248, 0xffff0000, v154
    v_mul_f32 v247, v247, v246
    v_mul_f32 v248, v248, v246
    v_cvt_pk_bf16_f32 v154, v247, v248
    v_lshlrev_b32 v247, 16, v155
    v_and_b32 v248, 0xffff0000, v155
    v_mul_f32 v247, v247, v246
    v_mul_f32 v248, v248, v246
    v_cvt_pk_bf16_f32 v155, v247, v248
    v_lshlrev_b32 v247, 16, v156
    v_and_b32 v248, 0xffff0000, v156
    v_mul_f32 v247, v247, v246
    v_mul_f32 v248, v248, v246
    v_cvt_pk_bf16_f32 v156, v247, v248
    v_lshlrev_b32 v247, 16, v157
    v_and_b32 v248, 0xffff0000, v157
    v_mul_f32 v247, v247, v246
    v_mul_f32 v248, v248, v246
    v_cvt_pk_bf16_f32 v157, v247, v248
    v_lshlrev_b32 v247, 16, v158
    v_and_b32 v248, 0xffff0000, v158
    v_mul_f32 v247, v247, v246
    v_mul_f32 v248, v248, v246
    v_cvt_pk_bf16_f32 v158, v247, v248
    v_lshlrev_b32 v247, 16, v159
    v_and_b32 v248, 0xffff0000, v159
    v_mul_f32 v247, v247, v246
    v_mul_f32 v248, v248, v246
    v_cvt_pk_bf16_f32 v159, v247, v248
    s_nop 7
    s_branch L_back_B07
L_slow_A11:
    s_nop 15
    v_mov_b32 v248, v246
    s_nop 1
    v_permlane32_swap_b32 v246, v248
    v_max_f32 v246, v246, v248
    v_mov_b32 v248, v247
    s_nop 1
    v_permlane32_swap_b32 v247, v248
    v_max_f32 v247, v247, v248
    v_mov_b32 v248, v247
    s_nop 1
    v_permlane16_swap_b32 v247, v248
    v_max_f32 v247, v247, v248
    v_max_f32 v246, 0, v246
    v_ceil_f32 v246, v246
    v_max_f32 v247, 0, v247
    v_ceil_f32 v247, v247
    v_sub_f32 v152, v152, v246
    v_sub_f32 v153, v153, v246
    v_sub_f32 v154, v154, v246
    v_sub_f32 v155, v155, v246
    v_sub_f32 v156, v156, v246
    v_sub_f32 v157, v157, v246
    v_sub_f32 v158, v158, v246
    v_sub_f32 v159, v159, v246
    v_sub_f32 v160, v160, v246
    v_sub_f32 v161, v161, v246
    v_sub_f32 v162, v162, v246
    v_sub_f32 v163, v163, v246
    v_sub_f32 v164, v164, v246
    v_sub_f32 v165, v165, v246
    v_sub_f32 v166, v166, v246
    v_sub_f32 v167, v167, v246
    v_sub_f32 v168, v168, v246
    v_sub_f32 v169, v169, v246
    v_sub_f32 v170, v170, v246
    v_sub_f32 v171, v171, v246
    v_sub_f32 v172, v172, v246
    v_sub_f32 v173, v173, v246
    v_sub_f32 v174, v174, v246
    v_sub_f32 v175, v175, v246
    v_sub_f32 v176, v176, v246
    v_sub_f32 v177, v177, v246
    v_sub_f32 v178, v178, v246
    v_sub_f32 v179, v179, v246
    v_sub_f32 v180, v180, v246
    v_sub_f32 v181, v181, v246
    v_sub_f32 v182, v182, v246
    v_sub_f32 v183, v183, v246
    v_sub_f32 v184, v184, v247
    v_sub_f32 v185, v185, v247
    v_sub_f32 v186, v186, v247
    v_sub_f32 v187, v187, v247
    v_sub_f32 v188, v188, v246
    v_sub_f32 v189, v189, v246
    v_sub_f32 v190, v190, v246
    v_sub_f32 v191, v191, v246
    v_sub_f32 v192, v192, v246
    v_sub_f32 v193, v193, v246
    v_sub_f32 v194, v194, v246
    v_sub_f32 v195, v195, v246
    v_sub_f32 v196, v196, v246
    v_sub_f32 v197, v197, v246
    v_sub_f32 v198, v198, v246
    v_sub_f32 v199, v199, v246
    v_sub_f32 v200, v200, v246
    v_sub_f32 v201, v201, v246
    v_sub_f32 v202, v202, v246
    v_sub_f32 v203, v203, v246
    v_sub_f32 v204, v204, v247
    v_sub_f32 v205, v205, v247
    v_sub_f32 v206, v206, v247
    v_sub_f32 v207, v207, v247
    v_sub_f32 v246, 0, v246
    v_sub_f32 v247, 0, v247
    v_exp_f32 v246, v246
    v_exp_f32 v247, v247
    v_mul_f32 v56, v56, v246
    v_mul_f32 v57, v57, v246
    v_mul_f32 v58, v58, v246
    v_mul_f32 v59, v59, v246
    v_mul_f32 v60, v60, v246
    v_mul_f32 v61, v61, v246
    v_mul_f32 v62, v62, v246
    v_mul_f32 v63, v63, v246
    v_mul_f32 v64, v64, v246
    v_mul_f32 v65, v65, v246
    v_mul_f32 v66, v66, v246
    v_mul_f32 v67, v67, v246
    v_mul_f32 v68, v68, v246
    v_mul_f32 v69, v69, v246
    v_mul_f32 v70, v70, v246
    v_mul_f32 v71, v71, v246
    v_mul_f32 v72, v72, v246
    v_mul_f32 v73, v73, v246
    v_mul_f32 v74, v74, v246
    v_mul_f32 v75, v75, v246
    v_mul_f32 v76, v76, v246
    v_mul_f32 v77, v77, v246
    v_mul_f32 v78, v78, v246
    v_mul_f32 v79, v79, v246
    v_mul_f32 v80, v80, v246
    v_mul_f32 v81, v81, v246
    v_mul_f32 v82, v82, v246
    v_mul_f32 v83, v83, v246
    v_mul_f32 v84, v84, v246
    v_mul_f32 v85, v85, v246
    v_mul_f32 v86, v86, v246
    v_mul_f32 v87, v87, v246
    v_mul_f32 v88, v88, v246
    v_mul_f32 v89, v89, v246
    v_mul_f32 v90, v90, v246
    v_mul_f32 v91, v91, v246
    v_mul_f32 v92, v92, v246
    v_mul_f32 v93, v93, v246
    v_mul_f32 v94, v94, v246
    v_mul_f32 v95, v95, v246
    v_mul_f32 v96, v96, v246
    v_mul_f32 v97, v97, v246
    v_mul_f32 v98, v98, v246
    v_mul_f32 v99, v99, v246
    v_mul_f32 v100, v100, v246
    v_mul_f32 v101, v101, v246
    v_mul_f32 v102, v102, v246
    v_mul_f32 v103, v103, v246
    v_mul_f32 v104, v104, v246
    v_mul_f32 v105, v105, v246
    v_mul_f32 v106, v106, v246
    v_mul_f32 v107, v107, v246
    v_mul_f32 v108, v108, v246
    v_mul_f32 v109, v109, v246
    v_mul_f32 v110, v110, v246
    v_mul_f32 v111, v111, v246
    v_mul_f32 v112, v112, v246
    v_mul_f32 v113, v113, v246
    v_mul_f32 v114, v114, v246
    v_mul_f32 v115, v115, v246
    v_mul_f32 v116, v116, v246
    v_mul_f32 v117, v117, v246
    v_mul_f32 v118, v118, v246
    v_mul_f32 v119, v119, v246
    v_mul_f32 v120, v120, v247
    v_mul_f32 v121, v121, v247
    v_mul_f32 v122, v122, v247
    v_mul_f32 v123, v123, v247
    v_mul_f32 v124, v124, v247
    v_mul_f32 v125, v125, v247
    v_mul_f32 v126, v126, v247
    v_mul_f32 v127, v127, v247
    v_mul_f32 v128, v128, v247
    v_mul_f32 v129, v129, v247
    v_mul_f32 v130, v130, v247
    v_mul_f32 v131, v131, v247
    v_mul_f32 v132, v132, v247
    v_mul_f32 v133, v133, v247
    v_mul_f32 v134, v134, v247
    v_mul_f32 v135, v135, v247
    v_mul_f32 v136, v136, v247
    v_mul_f32 v137, v137, v247
    v_mul_f32 v138, v138, v247
    v_mul_f32 v139, v139, v247
    v_mul_f32 v140, v140, v247
    v_mul_f32 v141, v141, v247
    v_mul_f32 v142, v142, v247
    v_mul_f32 v143, v143, v247
    v_mul_f32 v144, v144, v247
    v_mul_f32 v145, v145, v247
    v_mul_f32 v146, v146, v247
    v_mul_f32 v147, v147, v247
    v_mul_f32 v148, v148, v247
    v_mul_f32 v149, v149, v247
    v_mul_f32 v150, v150, v247
    v_mul_f32 v151, v151, v247
    v_mul_f32 v244, v244, v246
    v_mul_f32 v245, v245, v247
    s_nop 7
    s_branch L_back_A11
L_slow_B11:
    s_nop 15
    v_mov_b32 v248, v246
    s_nop 1
    v_permlane32_swap_b32 v246, v248
    v_max_f32 v246, v246, v248
    v_max_f32 v246, 0, v246
    v_ceil_f32 v246, v246
    v_sub_f32 v168, v168, v246
    v_sub_f32 v169, v169, v246
    v_sub_f32 v170, v170, v246
    v_sub_f32 v171, v171, v246
    v_sub_f32 v172, v172, v246
    v_sub_f32 v173, v173, v246
    v_sub_f32 v174, v174, v246
    v_sub_f32 v175, v175, v246
    v_sub_f32 v176, v176, v246
    v_sub_f32 v177, v177, v246
    v_sub_f32 v178, v178, v246
    v_sub_f32 v179, v179, v246
    v_sub_f32 v180, v180, v246
    v_sub_f32 v181, v181, v246
    v_sub_f32 v182, v182, v246
    v_sub_f32 v183, v183, v246
    v_sub_f32 v188, v188, v246
    v_sub_f32 v189, v189, v246
    v_sub_f32 v190, v190, v246
    v_sub_f32 v191, v191, v246
    v_sub_f32 v192, v192, v246
    v_sub_f32 v193, v193, v246
    v_sub_f32 v194, v194, v246
    v_sub_f32 v195, v195, v246
    v_sub_f32 v196, v196, v246
    v_sub_f32 v197, v197, v246
    v_sub_f32 v198, v198, v246
    v_sub_f32 v199, v199, v246
    v_sub_f32 v200, v200, v246
    v_sub_f32 v201, v201, v246
    v_sub_f32 v202, v202, v246
    v_sub_f32 v203, v203, v246
    v_sub_f32 v246, 0, v246
    v_exp_f32 v246, v246
    s_nop 0
    v_mul_f32 v56, v56, v246
    v_mul_f32 v57, v57, v246
    v_mul_f32 v58, v58, v246
    v_mul_f32 v59, v59, v246
    v_mul_f32 v60, v60, v246
    v_mul_f32 v61, v61, v246
    v_mul_f32 v62, v62, v246
    v_mul_f32 v63, v63, v246
    v_mul_f32 v64, v64, v246
    v_mul_f32 v65, v65, v246
    v_mul_f32 v66, v66, v246
    v_mul_f32 v67, v67, v246
    v_mul_f32 v68, v68, v246
    v_mul_f32 v69, v69, v246
    v_mul_f32 v70, v70, v246
    v_mul_f32 v71, v71, v246
    v_mul_f32 v72, v72, v246
    v_mul_f32 v73, v73, v246
    v_mul_f32 v74, v74, v246
    v_mul_f32 v75, v75, v246
    v_mul_f32 v76, v76, v246
    v_mul_f32 v77, v77, v246
    v_mul_f32 v78, v78, v246
    v_mul_f32 v79, v79, v246
    v_mul_f32 v80, v80, v246
    v_mul_f32 v81, v81, v246
    v_mul_f32 v82, v82, v246
    v_mul_f32 v83, v83, v246
    v_mul_f32 v84, v84, v246
    v_mul_f32 v85, v85, v246
    v_mul_f32 v86, v86, v246
    v_mul_f32 v87, v87, v246
    v_mul_f32 v88, v88, v246
    v_mul_f32 v89, v89, v246
    v_mul_f32 v90, v90, v246
    v_mul_f32 v91, v91, v246
    v_mul_f32 v92, v92, v246
    v_mul_f32 v93, v93, v246
    v_mul_f32 v94, v94, v246
    v_mul_f32 v95, v95, v246
    v_mul_f32 v96, v96, v246
    v_mul_f32 v97, v97, v246
    v_mul_f32 v98, v98, v246
    v_mul_f32 v99, v99, v246
    v_mul_f32 v100, v100, v246
    v_mul_f32 v101, v101, v246
    v_mul_f32 v102, v102, v246
    v_mul_f32 v103, v103, v246
    v_mul_f32 v104, v104, v246
    v_mul_f32 v105, v105, v246
    v_mul_f32 v106, v106, v246
    v_mul_f32 v107, v107, v246
    v_mul_f32 v108, v108, v246
    v_mul_f32 v109, v109, v246
    v_mul_f32 v110, v110, v246
    v_mul_f32 v111, v111, v246
    v_mul_f32 v112, v112, v246
    v_mul_f32 v113, v113, v246
    v_mul_f32 v114, v114, v246
    v_mul_f32 v115, v115, v246
    v_mul_f32 v116, v116, v246
    v_mul_f32 v117, v117, v246
    v_mul_f32 v118, v118, v246
    v_mul_f32 v119, v119, v246
    v_mul_f32 v244, v244, v246
    v_lshlrev_b32 v247, 16, v152
    v_and_b32 v248, 0xffff0000, v152
    v_mul_f32 v247, v247, v246
    v_mul_f32 v248, v248, v246
    v_cvt_pk_bf16_f32 v152, v247, v248
    v_lshlrev_b32 v247, 16, v153
    v_and_b32 v248, 0xffff0000, v153
    v_mul_f32 v247, v247, v246
    v_mul_f32 v248, v248, v246
    v_cvt_pk_bf16_f32 v153, v247, v248
    v_lshlrev_b32 v247, 16, v154
    v_and_b32 v248, 0xffff0000, v154
    v_mul_f32 v247, v247, v246
    v_mul_f32 v248, v248, v246
    v_cvt_pk_bf16_f32 v154, v247, v248
    v_lshlrev_b32 v247, 16, v155
    v_and_b32 v248, 0xffff0000, v155
    v_mul_f32 v247, v247, v246
    v_mul_f32 v248, v248, v246
    v_cvt_pk_bf16_f32 v155, v247, v248
    v_lshlrev_b32 v247, 16, v156
    v_and_b32 v248, 0xffff0000, v156
    v_mul_f32 v247, v247, v246
    v_mul_f32 v248, v248, v246
    v_cvt_pk_bf16_f32 v156, v247, v248
    v_lshlrev_b32 v247, 16, v157
    v_and_b32 v248, 0xffff0000, v157
    v_mul_f32 v247, v247, v246
    v_mul_f32 v248, v248, v246
    v_cvt_pk_bf16_f32 v157, v247, v248
    v_lshlrev_b32 v247, 16, v158
    v_and_b32 v248, 0xffff0000, v158
    v_mul_f32 v247, v247, v246
    v_mul_f32 v248, v248, v246
    v_cvt_pk_bf16_f32 v158, v247, v248
    v_lshlrev_b32 v247, 16, v159
    v_and_b32 v248, 0xffff0000, v159
    v_mul_f32 v247, v247, v246
    v_mul_f32 v248, v248, v246
    v_cvt_pk_bf16_f32 v159, v247, v248
    s_nop 7
    s_branch L_back_B11
L_slow_A12:
    s_nop 15
    v_mov_b32 v248, v246
    s_nop 1
    v_permlane32_swap_b32 v246, v248
    v_max_f32 v246, v246, v248
    v_mov_b32 v248, v247
    s_nop 1
    v_permlane32_swap_b32 v247, v248
    v_max_f32 v247, v247, v248
    v_mov_b32 v248, v247
    s_nop 1
    v_permlane16_swap_b32 v247, v248
    v_max_f32 v247, v247, v248
    v_max_f32 v246, 0, v246
    v_ceil_f32 v246, v246
    v_max_f32 v247, 0, v247
    v_ceil_f32 v247, v247
    v_sub_f32 v152, v152, v246
    v_sub_f32 v153, v153, v246
    v_sub_f32 v154, v154, v246
    v_sub_f32 v155, v155, v246
    v_sub_f32 v156, v156, v246
    v_sub_f32 v157, v157, v246
    v_sub_f32 v158, v158, v246
    v_sub_f32 v159, v159, v246
    v_sub_f32 v160, v160, v246
    v_sub_f32 v161, v161, v246
    v_sub_f32 v162, v162, v246
    v_sub_f32 v163, v163, v246
    v_sub_f32 v164, v164, v246
    v_sub_f32 v165, v165, v246
    v_sub_f32 v166, v166, v246
    v_sub_f32 v167, v167, v246
    v_sub_f32 v168, v168, v246
    v_sub_f32 v169, v169, v246
    v_sub_f32 v170, v170, v246
    v_sub_f32 v171, v171, v246
    v_sub_f32 v172, v172, v246
    v_sub_f32 v173, v173, v246
    v_sub_f32 v174, v174, v246
    v_sub_f32 v175, v175, v246
    v_sub_f32 v176, v176, v246
    v_sub_f32 v177, v177, v246
    v_sub_f32 v178, v178, v246
    v_sub_f32 v179, v179, v246
    v_sub_f32 v180, v180, v246
    v_sub_f32 v181, v181, v246
    v_sub_f32 v182, v182, v246
    v_sub_f32 v183, v183, v246
    v_sub_f32 v184, v184, v247
    v_sub_f32 v185, v185, v247
    v_sub_f32 v186, v186, v247
    v_sub_f32 v187, v187, v247
    v_sub_f32 v188, v188, v246
    v_sub_f32 v189, v189, v246
    v_sub_f32 v190, v190, v246
    v_sub_f32 v191, v191, v246
    v_sub_f32 v192, v192, v246
    v_sub_f32 v193, v193, v246
    v_sub_f32 v194, v194, v246
    v_sub_f32 v195, v195, v246
    v_sub_f32 v196, v196, v246
    v_sub_f32 v197, v197, v246
    v_sub_f32 v198, v198, v246
    v_sub_f32 v199, v199, v246
    v_sub_f32 v200, v200, v246
    v_sub_f32 v201, v201, v246
    v_sub_f32 v202, v202, v246
    v_sub_f32 v203, v203, v246
    v_sub_f32 v204, v204, v247
    v_sub_f32 v205, v205, v247
    v_sub_f32 v206, v206, v247
    v_sub_f32 v207, v207, v247
    v_sub_f32 v246, 0, v246
    v_sub_f32 v247, 0, v247
    v_exp_f32 v246, v246
    v_exp_f32 v247, v247
    v_mul_f32 v56, v56, v246
    v_mul_f32 v57, v57, v246
    v_mul_f32 v58, v58, v246
    v_mul_f32 v59, v59, v246
    v_mul_f32 v60, v60, v246
    v_mul_f32 v61, v61, v246
    v_mul_f32 v62, v62, v246
    v_mul_f32 v63, v63, v246
    v_mul_f32 v64, v64, v246
    v_mul_f32 v65, v65, v246
    v_mul_f32 v66, v66, v246
    v_mul_f32 v67, v67, v246
    v_mul_f32 v68, v68, v246
    v_mul_f32 v69, v69, v246
    v_mul_f32 v70, v70, v246
    v_mul_f32 v71, v71, v246
    v_mul_f32 v72, v72, v246
    v_mul_f32 v73, v73, v246
    v_mul_f32 v74, v74, v246
    v_mul_f32 v75, v75, v246
    v_mul_f32 v76, v76, v246
    v_mul_f32 v77, v77, v246
    v_mul_f32 v78, v78, v246
    v_mul_f32 v79, v79, v246
    v_mul_f32 v80, v80, v246
    v_mul_f32 v81, v81, v246
    v_mul_f32 v82, v82, v246
    v_mul_f32 v83, v83, v246
    v_mul_f32 v84, v84, v246
    v_mul_f32 v85, v85, v246
    v_mul_f32 v86, v86, v246
    v_mul_f32 v87, v87, v246
    v_mul_f32 v88, v88, v246
    v_mul_f32 v89, v89, v246
    v_mul_f32 v90, v90, v246
    v_mul_f32 v91, v91, v246
    v_mul_f32 v92, v92, v246
    v_mul_f32 v93, v93, v246
    v_mul_f32 v94, v94, v246
    v_mul_f32 v95, v95, v246
    v_mul_f32 v96, v96, v246
    v_mul_f32 v97, v97, v246
    v_mul_f32 v98, v98, v246
    v_mul_f32 v99, v99, v246
    v_mul_f32 v100, v100, v246
    v_mul_f32 v101, v101, v246
    v_mul_f32 v102, v102, v246
    v_mul_f32 v103, v103, v246
    v_mul_f32 v104, v104, v246
    v_mul_f32 v105, v105, v246
    v_mul_f32 v106, v106, v246
    v_mul_f32 v107, v107, v246
    v_mul_f32 v108, v108, v246
    v_mul_f32 v109, v109, v246
    v_mul_f32 v110, v110, v246
    v_mul_f32 v111, v111, v246
    v_mul_f32 v112, v112, v246
    v_mul_f32 v113, v113, v246
    v_mul_f32 v114, v114, v246
    v_mul_f32 v115, v115, v246
    v_mul_f32 v116, v116, v246
    v_mul_f32 v117, v117, v246
    v_mul_f32 v118, v118, v246
    v_mul_f32 v119, v119, v246
    v_mul_f32 v120, v120, v247
    v_mul_f32 v121, v121, v247
    v_mul_f32 v122, v122, v247
    v_mul_f32 v123, v123, v247
    v_mul_f32 v124, v124, v247
    v_mul_f32 v125, v125, v247
    v_mul_f32 v126, v126, v247
    v_mul_f32 v127, v127, v247
    v_mul_f32 v128, v128, v247
    v_mul_f32 v129, v129, v247
    v_mul_f32 v130, v130, v247
    v_mul_f32 v131, v131, v247
    v_mul_f32 v132, v132, v247
    v_mul_f32 v133, v133, v247
    v_mul_f32 v134, v134, v247
    v_mul_f32 v135, v135, v247
    v_mul_f32 v136, v136, v247
    v_mul_f32 v137, v137, v247
    v_mul_f32 v138, v138, v247
    v_mul_f32 v139, v139, v247
    v_mul_f32 v140, v140, v247
    v_mul_f32 v141, v141, v247
    v_mul_f32 v142, v142, v247
    v_mul_f32 v143, v143, v247
    v_mul_f32 v144, v144, v247
    v_mul_f32 v145, v145, v247
    v_mul_f32 v146, v146, v247
    v_mul_f32 v147, v147, v247
    v_mul_f32 v148, v148, v247
    v_mul_f32 v149, v149, v247
    v_mul_f32 v150, v150, v247
    v_mul_f32 v151, v151, v247
    v_mul_f32 v244, v244, v246
    v_mul_f32 v245, v245, v247
    s_nop 7
    s_branch L_back_A12
L_slow_B12:
    s_nop 15
    v_mov_b32 v248, v246
    s_nop 1
    v_permlane32_swap_b32 v246, v248
    v_max_f32 v246, v246, v248
    v_max_f32 v246, 0, v246
    v_ceil_f32 v246, v246
    v_sub_f32 v168, v168, v246
    v_sub_f32 v169, v169, v246
    v_sub_f32 v170, v170, v246
    v_sub_f32 v171, v171, v246
    v_sub_f32 v172, v172, v246
    v_sub_f32 v173, v173, v246
    v_sub_f32 v174, v174, v246
    v_sub_f32 v175, v175, v246
    v_sub_f32 v176, v176, v246
    v_sub_f32 v177, v177, v246
    v_sub_f32 v178, v178, v246
    v_sub_f32 v179, v179, v246
    v_sub_f32 v180, v180, v246
    v_sub_f32 v181, v181, v246
    v_sub_f32 v182, v182, v246
    v_sub_f32 v183, v183, v246
    v_sub_f32 v188, v188, v246
    v_sub_f32 v189, v189, v246
    v_sub_f32 v190, v190, v246
    v_sub_f32 v191, v191, v246
    v_sub_f32 v192, v192, v246
    v_sub_f32 v193, v193, v246
    v_sub_f32 v194, v194, v246
    v_sub_f32 v195, v195, v246
    v_sub_f32 v196, v196, v246
    v_sub_f32 v197, v197, v246
    v_sub_f32 v198, v198, v246
    v_sub_f32 v199, v199, v246
    v_sub_f32 v200, v200, v246
    v_sub_f32 v201, v201, v246
    v_sub_f32 v202, v202, v246
    v_sub_f32 v203, v203, v246
    v_sub_f32 v246, 0, v246
    v_exp_f32 v246, v246
    s_nop 0
    v_mul_f32 v56, v56, v246
    v_mul_f32 v57, v57, v246
    v_mul_f32 v58, v58, v246
    v_mul_f32 v59, v59, v246
    v_mul_f32 v60, v60, v246
    v_mul_f32 v61, v61, v246
    v_mul_f32 v62, v62, v246
    v_mul_f32 v63, v63, v246
    v_mul_f32 v64, v64, v246
    v_mul_f32 v65, v65, v246
    v_mul_f32 v66, v66, v246
    v_mul_f32 v67, v67, v246
    v_mul_f32 v68, v68, v246
    v_mul_f32 v69, v69, v246
    v_mul_f32 v70, v70, v246
    v_mul_f32 v71, v71, v246
    v_mul_f32 v72, v72, v246
    v_mul_f32 v73, v73, v246
    v_mul_f32 v74, v74, v246
    v_mul_f32 v75, v75, v246
    v_mul_f32 v76, v76, v246
    v_mul_f32 v77, v77, v246
    v_mul_f32 v78, v78, v246
    v_mul_f32 v79, v79, v246
    v_mul_f32 v80, v80, v246
    v_mul_f32 v81, v81, v246
    v_mul_f32 v82, v82, v246
    v_mul_f32 v83, v83, v246
    v_mul_f32 v84, v84, v246
    v_mul_f32 v85, v85, v246
    v_mul_f32 v86, v86, v246
    v_mul_f32 v87, v87, v246
    v_mul_f32 v88, v88, v246
    v_mul_f32 v89, v89, v246
    v_mul_f32 v90, v90, v246
    v_mul_f32 v91, v91, v246
    v_mul_f32 v92, v92, v246
    v_mul_f32 v93, v93, v246
    v_mul_f32 v94, v94, v246
    v_mul_f32 v95, v95, v246
    v_mul_f32 v96, v96, v246
    v_mul_f32 v97, v97, v246
    v_mul_f32 v98, v98, v246
    v_mul_f32 v99, v99, v246
    v_mul_f32 v100, v100, v246
    v_mul_f32 v101, v101, v246
    v_mul_f32 v102, v102, v246
    v_mul_f32 v103, v103, v246
    v_mul_f32 v104, v104, v246
    v_mul_f32 v105, v105, v246
    v_mul_f32 v106, v106, v246
    v_mul_f32 v107, v107, v246
    v_mul_f32 v108, v108, v246
    v_mul_f32 v109, v109, v246
    v_mul_f32 v110, v110, v246
    v_mul_f32 v111, v111, v246
    v_mul_f32 v112, v112, v246
    v_mul_f32 v113, v113, v246
    v_mul_f32 v114, v114, v246
    v_mul_f32 v115, v115, v246
    v_mul_f32 v116, v116, v246
    v_mul_f32 v117, v117, v246
    v_mul_f32 v118, v118, v246
    v_mul_f32 v119, v119, v246
    v_mul_f32 v244, v244, v246
    v_lshlrev_b32 v247, 16, v152
    v_and_b32 v248, 0xffff0000, v152
    v_mul_f32 v247, v247, v246
    v_mul_f32 v248, v248, v246
    v_cvt_pk_bf16_f32 v152, v247, v248
    v_lshlrev_b32 v247, 16, v153
    v_and_b32 v248, 0xffff0000, v153
    v_mul_f32 v247, v247, v246
    v_mul_f32 v248, v248, v246
    v_cvt_pk_bf16_f32 v153, v247, v248
    v_lshlrev_b32 v247, 16, v154
    v_and_b32 v248, 0xffff0000, v154
    v_mul_f32 v247, v247, v246
    v_mul_f32 v248, v248, v246
    v_cvt_pk_bf16_f32 v154, v247, v248
    v_lshlrev_b32 v247, 16, v155
    v_and_b32 v248, 0xffff0000, v155
    v_mul_f32 v247, v247, v246
    v_mul_f32 v248, v248, v246
    v_cvt_pk_bf16_f32 v155, v247, v248
    v_lshlrev_b32 v247, 16, v156
    v_and_b32 v248, 0xffff0000, v156
    v_mul_f32 v247, v247, v246
    v_mul_f32 v248, v248, v246
    v_cvt_pk_bf16_f32 v156, v247, v248
    v_lshlrev_b32 v247, 16, v157
    v_and_b32 v248, 0xffff0000, v157
    v_mul_f32 v247, v247, v246
    v_mul_f32 v248, v248, v246
    v_cvt_pk_bf16_f32 v157, v247, v248
    v_lshlrev_b32 v247, 16, v158
    v_and_b32 v248, 0xffff0000, v158
    v_mul_f32 v247, v247, v246
    v_mul_f32 v248, v248, v246
    v_cvt_pk_bf16_f32 v158, v247, v248
    v_lshlrev_b32 v247, 16, v159
    v_and_b32 v248, 0xffff0000, v159
    v_mul_f32 v247, v247, v246
    v_mul_f32 v248, v248, v246
    v_cvt_pk_bf16_f32 v159, v247, v248
    s_nop 7
    s_branch L_back_B12
L_slow_A13:
    s_nop 15
    v_mov_b32 v248, v246
    s_nop 1
    v_permlane32_swap_b32 v246, v248
    v_max_f32 v246, v246, v248
    v_mov_b32 v248, v247
    s_nop 1
    v_permlane32_swap_b32 v247, v248
    v_max_f32 v247, v247, v248
    v_mov_b32 v248, v247
    s_nop 1
    v_permlane16_swap_b32 v247, v248
    v_max_f32 v247, v247, v248
    v_max_f32 v246, 0, v246
    v_ceil_f32 v246, v246
    v_max_f32 v247, 0, v247
    v_ceil_f32 v247, v247
    v_sub_f32 v152, v152, v246
    v_sub_f32 v153, v153, v246
    v_sub_f32 v154, v154, v246
    v_sub_f32 v155, v155, v246
    v_sub_f32 v156, v156, v246
    v_sub_f32 v157, v157, v246
    v_sub_f32 v158, v158, v246
    v_sub_f32 v159, v159, v246
    v_sub_f32 v160, v160, v246
    v_sub_f32 v161, v161, v246
    v_sub_f32 v162, v162, v246
    v_sub_f32 v163, v163, v246
    v_sub_f32 v164, v164, v246
    v_sub_f32 v165, v165, v246
    v_sub_f32 v166, v166, v246
    v_sub_f32 v167, v167, v246
    v_sub_f32 v168, v168, v246
    v_sub_f32 v169, v169, v246
    v_sub_f32 v170, v170, v246
    v_sub_f32 v171, v171, v246
    v_sub_f32 v172, v172, v246
    v_sub_f32 v173, v173, v246
    v_sub_f32 v174, v174, v246
    v_sub_f32 v175, v175, v246
    v_sub_f32 v176, v176, v246
    v_sub_f32 v177, v177, v246
    v_sub_f32 v178, v178, v246
    v_sub_f32 v179, v179, v246
    v_sub_f32 v180, v180, v246
    v_sub_f32 v181, v181, v246
    v_sub_f32 v182, v182, v246
    v_sub_f32 v183, v183, v246
    v_sub_f32 v184, v184, v247
    v_sub_f32 v185, v185, v247
    v_sub_f32 v186, v186, v247
    v_sub_f32 v187, v187, v247
    v_sub_f32 v188, v188, v246
    v_sub_f32 v189, v189, v246
    v_sub_f32 v190, v190, v246
    v_sub_f32 v191, v191, v246
    v_sub_f32 v192, v192, v246
    v_sub_f32 v193, v193, v246
    v_sub_f32 v194, v194, v246
    v_sub_f32 v195, v195, v246
    v_sub_f32 v196, v196, v246
    v_sub_f32 v197, v197, v246
    v_sub_f32 v198, v198, v246
    v_sub_f32 v199, v199, v246
    v_sub_f32 v200, v200, v246
    v_sub_f32 v201, v201, v246
    v_sub_f32 v202, v202, v246
    v_sub_f32 v203, v203, v246
    v_sub_f32 v204, v204, v247
    v_sub_f32 v205, v205, v247
    v_sub_f32 v206, v206, v247
    v_sub_f32 v207, v207, v247
    v_sub_f32 v246, 0, v246
    v_sub_f32 v247, 0, v247
    v_exp_f32 v246, v246
    v_exp_f32 v247, v247
    v_mul_f32 v56, v56, v246
    v_mul_f32 v57, v57, v246
    v_mul_f32 v58, v58, v246
    v_mul_f32 v59, v59, v246
    v_mul_f32 v60, v60, v246
    v_mul_f32 v61, v61, v246
    v_mul_f32 v62, v62, v246
    v_mul_f32 v63, v63, v246
    v_mul_f32 v64, v64, v246
    v_mul_f32 v65, v65, v246
    v_mul_f32 v66, v66, v246
    v_mul_f32 v67, v67, v246
    v_mul_f32 v68, v68, v246
    v_mul_f32 v69, v69, v246
    v_mul_f32 v70, v70, v246
    v_mul_f32 v71, v71, v246
    v_mul_f32 v72, v72, v246
    v_mul_f32 v73, v73, v246
    v_mul_f32 v74, v74, v246
    v_mul_f32 v75, v75, v246
    v_mul_f32 v76, v76, v246
    v_mul_f32 v77, v77, v246
    v_mul_f32 v78, v78, v246
    v_mul_f32 v79, v79, v246
    v_mul_f32 v80, v80, v246
    v_mul_f32 v81, v81, v246
    v_mul_f32 v82, v82, v246
    v_mul_f32 v83, v83, v246
    v_mul_f32 v84, v84, v246
    v_mul_f32 v85, v85, v246
    v_mul_f32 v86, v86, v246
    v_mul_f32 v87, v87, v246
    v_mul_f32 v88, v88, v246
    v_mul_f32 v89, v89, v246
    v_mul_f32 v90, v90, v246
    v_mul_f32 v91, v91, v246
    v_mul_f32 v92, v92, v246
    v_mul_f32 v93, v93, v246
    v_mul_f32 v94, v94, v246
    v_mul_f32 v95, v95, v246
    v_mul_f32 v96, v96, v246
    v_mul_f32 v97, v97, v246
    v_mul_f32 v98, v98, v246
    v_mul_f32 v99, v99, v246
    v_mul_f32 v100, v100, v246
    v_mul_f32 v101, v101, v246
    v_mul_f32 v102, v102, v246
    v_mul_f32 v103, v103, v246
    v_mul_f32 v104, v104, v246
    v_mul_f32 v105, v105, v246
    v_mul_f32 v106, v106, v246
    v_mul_f32 v107, v107, v246
    v_mul_f32 v108, v108, v246
    v_mul_f32 v109, v109, v246
    v_mul_f32 v110, v110, v246
    v_mul_f32 v111, v111, v246
    v_mul_f32 v112, v112, v246
    v_mul_f32 v113, v113, v246
    v_mul_f32 v114, v114, v246
    v_mul_f32 v115, v115, v246
    v_mul_f32 v116, v116, v246
    v_mul_f32 v117, v117, v246
    v_mul_f32 v118, v118, v246
    v_mul_f32 v119, v119, v246
    v_mul_f32 v120, v120, v247
    v_mul_f32 v121, v121, v247
    v_mul_f32 v122, v122, v247
    v_mul_f32 v123, v123, v247
    v_mul_f32 v124, v124, v247
    v_mul_f32 v125, v125, v247
    v_mul_f32 v126, v126, v247
    v_mul_f32 v127, v127, v247
    v_mul_f32 v128, v128, v247
    v_mul_f32 v129, v129, v247
    v_mul_f32 v130, v130, v247
    v_mul_f32 v131, v131, v247
    v_mul_f32 v132, v132, v247
    v_mul_f32 v133, v133, v247
    v_mul_f32 v134, v134, v247
    v_mul_f32 v135, v135, v247
    v_mul_f32 v136, v136, v247
    v_mul_f32 v137, v137, v247
    v_mul_f32 v138, v138, v247
    v_mul_f32 v139, v139, v247
    v_mul_f32 v140, v140, v247
    v_mul_f32 v141, v141, v247
    v_mul_f32 v142, v142, v247
    v_mul_f32 v143, v143, v247
    v_mul_f32 v144, v144, v247
    v_mul_f32 v145, v145, v247
    v_mul_f32 v146, v146, v247
    v_mul_f32 v147, v147, v247
    v_mul_f32 v148, v148, v247
    v_mul_f32 v149, v149, v247
    v_mul_f32 v150, v150, v247
    v_mul_f32 v151, v151, v247
    v_mul_f32 v244, v244, v246
    v_mul_f32 v245, v245, v247
    s_nop 7
    s_branch L_back_A13
L_slow_B13:
    s_nop 15
    v_mov_b32 v248, v246
    s_nop 1
    v_permlane32_swap_b32 v246, v248
    v_max_f32 v246, v246, v248
    v_max_f32 v246, 0, v246
    v_ceil_f32 v246, v246
    v_sub_f32 v168, v168, v246
    v_sub_f32 v169, v169, v246
    v_sub_f32 v170, v170, v246
    v_sub_f32 v171, v171, v246
    v_sub_f32 v172, v172, v246
    v_sub_f32 v173, v173, v246
    v_sub_f32 v174, v174, v246
    v_sub_f32 v175, v175, v246
    v_sub_f32 v176, v176, v246
    v_sub_f32 v177, v177, v246
    v_sub_f32 v178, v178, v246
    v_sub_f32 v179, v179, v246
    v_sub_f32 v180, v180, v246
    v_sub_f32 v181, v181, v246
    v_sub_f32 v182, v182, v246
    v_sub_f32 v183, v183, v246
    v_sub_f32 v188, v188, v246
    v_sub_f32 v189, v189, v246
    v_sub_f32 v190, v190, v246
    v_sub_f32 v191, v191, v246
    v_sub_f32 v192, v192, v246
    v_sub_f32 v193, v193, v246
    v_sub_f32 v194, v194, v246
    v_sub_f32 v195, v195, v246
    v_sub_f32 v196, v196, v246
    v_sub_f32 v197, v197, v246
    v_sub_f32 v198, v198, v246
    v_sub_f32 v199, v199, v246
    v_sub_f32 v200, v200, v246
    v_sub_f32 v201, v201, v246
    v_sub_f32 v202, v202, v246
    v_sub_f32 v203, v203, v246
    v_sub_f32 v246, 0, v246
    v_exp_f32 v246, v246
    s_nop 0
    v_mul_f32 v56, v56, v246
    v_mul_f32 v57, v57, v246
    v_mul_f32 v58, v58, v246
    v_mul_f32 v59, v59, v246
    v_mul_f32 v60, v60, v246
    v_mul_f32 v61, v61, v246
    v_mul_f32 v62, v62, v246
    v_mul_f32 v63, v63, v246
    v_mul_f32 v64, v64, v246
    v_mul_f32 v65, v65, v246
    v_mul_f32 v66, v66, v246
    v_mul_f32 v67, v67, v246
    v_mul_f32 v68, v68, v246
    v_mul_f32 v69, v69, v246
    v_mul_f32 v70, v70, v246
    v_mul_f32 v71, v71, v246
    v_mul_f32 v72, v72, v246
    v_mul_f32 v73, v73, v246
    v_mul_f32 v74, v74, v246
    v_mul_f32 v75, v75, v246
    v_mul_f32 v76, v76, v246
    v_mul_f32 v77, v77, v246
    v_mul_f32 v78, v78, v246
    v_mul_f32 v79, v79, v246
    v_mul_f32 v80, v80, v246
    v_mul_f32 v81, v81, v246
    v_mul_f32 v82, v82, v246
    v_mul_f32 v83, v83, v246
    v_mul_f32 v84, v84, v246
    v_mul_f32 v85, v85, v246
    v_mul_f32 v86, v86, v246
    v_mul_f32 v87, v87, v246
    v_mul_f32 v88, v88, v246
    v_mul_f32 v89, v89, v246
    v_mul_f32 v90, v90, v246
    v_mul_f32 v91, v91, v246
    v_mul_f32 v92, v92, v246
    v_mul_f32 v93, v93, v246
    v_mul_f32 v94, v94, v246
    v_mul_f32 v95, v95, v246
    v_mul_f32 v96, v96, v246
    v_mul_f32 v97, v97, v246
    v_mul_f32 v98, v98, v246
    v_mul_f32 v99, v99, v246
    v_mul_f32 v100, v100, v246
    v_mul_f32 v101, v101, v246
    v_mul_f32 v102, v102, v246
    v_mul_f32 v103, v103, v246
    v_mul_f32 v104, v104, v246
    v_mul_f32 v105, v105, v246
    v_mul_f32 v106, v106, v246
    v_mul_f32 v107, v107, v246
    v_mul_f32 v108, v108, v246
    v_mul_f32 v109, v109, v246
    v_mul_f32 v110, v110, v246
    v_mul_f32 v111, v111, v246
    v_mul_f32 v112, v112, v246
    v_mul_f32 v113, v113, v246
    v_mul_f32 v114, v114, v246
    v_mul_f32 v115, v115, v246
    v_mul_f32 v116, v116, v246
    v_mul_f32 v117, v117, v246
    v_mul_f32 v118, v118, v246
    v_mul_f32 v119, v119, v246
    v_mul_f32 v244, v244, v246
    v_lshlrev_b32 v247, 16, v152
    v_and_b32 v248, 0xffff0000, v152
    v_mul_f32 v247, v247, v246
    v_mul_f32 v248, v248, v246
    v_cvt_pk_bf16_f32 v152, v247, v248
    v_lshlrev_b32 v247, 16, v153
    v_and_b32 v248, 0xffff0000, v153
    v_mul_f32 v247, v247, v246
    v_mul_f32 v248, v248, v246
    v_cvt_pk_bf16_f32 v153, v247, v248
    v_lshlrev_b32 v247, 16, v154
    v_and_b32 v248, 0xffff0000, v154
    v_mul_f32 v247, v247, v246
    v_mul_f32 v248, v248, v246
    v_cvt_pk_bf16_f32 v154, v247, v248
    v_lshlrev_b32 v247, 16, v155
    v_and_b32 v248, 0xffff0000, v155
    v_mul_f32 v247, v247, v246
    v_mul_f32 v248, v248, v246
    v_cvt_pk_bf16_f32 v155, v247, v248
    v_lshlrev_b32 v247, 16, v156
    v_and_b32 v248, 0xffff0000, v156
    v_mul_f32 v247, v247, v246
    v_mul_f32 v248, v248, v246
    v_cvt_pk_bf16_f32 v156, v247, v248
    v_lshlrev_b32 v247, 16, v157
    v_and_b32 v248, 0xffff0000, v157
    v_mul_f32 v247, v247, v246
    v_mul_f32 v248, v248, v246
    v_cvt_pk_bf16_f32 v157, v247, v248
    v_lshlrev_b32 v247, 16, v158
    v_and_b32 v248, 0xffff0000, v158
    v_mul_f32 v247, v247, v246
    v_mul_f32 v248, v248, v246
    v_cvt_pk_bf16_f32 v158, v247, v248
    v_lshlrev_b32 v247, 16, v159
    v_and_b32 v248, 0xffff0000, v159
    v_mul_f32 v247, v247, v246
    v_mul_f32 v248, v248, v246
    v_cvt_pk_bf16_f32 v159, v247, v248
    s_nop 7
    s_branch L_back_B13
L_slow_A14:
    s_nop 15
    v_mov_b32 v248, v246
    s_nop 1
    v_permlane32_swap_b32 v246, v248
    v_max_f32 v246, v246, v248
    v_mov_b32 v248, v247
    s_nop 1
    v_permlane32_swap_b32 v247, v248
    v_max_f32 v247, v247, v248
    v_mov_b32 v248, v247
    s_nop 1
    v_permlane16_swap_b32 v247, v248
    v_max_f32 v247, v247, v248
    v_max_f32 v246, 0, v246
    v_ceil_f32 v246, v246
    v_max_f32 v247, 0, v247
    v_ceil_f32 v247, v247
    v_sub_f32 v152, v152, v246
    v_sub_f32 v153, v153, v246
    v_sub_f32 v154, v154, v246
    v_sub_f32 v155, v155, v246
    v_sub_f32 v156, v156, v246
    v_sub_f32 v157, v157, v246
    v_sub_f32 v158, v158, v246
    v_sub_f32 v159, v159, v246
    v_sub_f32 v160, v160, v246
    v_sub_f32 v161, v161, v246
    v_sub_f32 v162, v162, v246
    v_sub_f32 v163, v163, v246
    v_sub_f32 v164, v164, v246
    v_sub_f32 v165, v165, v246
    v_sub_f32 v166, v166, v246
    v_sub_f32 v167, v167, v246
    v_sub_f32 v168, v168, v246
    v_sub_f32 v169, v169, v246
    v_sub_f32 v170, v170, v246
    v_sub_f32 v171, v171, v246
    v_sub_f32 v172, v172, v246
    v_sub_f32 v173, v173, v246
    v_sub_f32 v174, v174, v246
    v_sub_f32 v175, v175, v246
    v_sub_f32 v176, v176, v246
    v_sub_f32 v177, v177, v246
    v_sub_f32 v178, v178, v246
    v_sub_f32 v179, v179, v246
    v_sub_f32 v180, v180, v246
    v_sub_f32 v181, v181, v246
    v_sub_f32 v182, v182, v246
    v_sub_f32 v183, v183, v246
    v_sub_f32 v184, v184, v247
    v_sub_f32 v185, v185, v247
    v_sub_f32 v186, v186, v247
    v_sub_f32 v187, v187, v247
    v_sub_f32 v188, v188, v246
    v_sub_f32 v189, v189, v246
    v_sub_f32 v190, v190, v246
    v_sub_f32 v191, v191, v246
    v_sub_f32 v192, v192, v246
    v_sub_f32 v193, v193, v246
    v_sub_f32 v194, v194, v246
    v_sub_f32 v195, v195, v246
    v_sub_f32 v196, v196, v246
    v_sub_f32 v197, v197, v246
    v_sub_f32 v198, v198, v246
    v_sub_f32 v199, v199, v246
    v_sub_f32 v200, v200, v246
    v_sub_f32 v201, v201, v246
    v_sub_f32 v202, v202, v246
    v_sub_f32 v203, v203, v246
    v_sub_f32 v204, v204, v247
    v_sub_f32 v205, v205, v247
    v_sub_f32 v206, v206, v247
    v_sub_f32 v207, v207, v247
    v_sub_f32 v246, 0, v246
    v_sub_f32 v247, 0, v247
    v_exp_f32 v246, v246
    v_exp_f32 v247, v247
    v_mul_f32 v56, v56, v246
    v_mul_f32 v57, v57, v246
    v_mul_f32 v58, v58, v246
    v_mul_f32 v59, v59, v246
    v_mul_f32 v60, v60, v246
    v_mul_f32 v61, v61, v246
    v_mul_f32 v62, v62, v246
    v_mul_f32 v63, v63, v246
    v_mul_f32 v64, v64, v246
    v_mul_f32 v65, v65, v246
    v_mul_f32 v66, v66, v246
    v_mul_f32 v67, v67, v246
    v_mul_f32 v68, v68, v246
    v_mul_f32 v69, v69, v246
    v_mul_f32 v70, v70, v246
    v_mul_f32 v71, v71, v246
    v_mul_f32 v72, v72, v246
    v_mul_f32 v73, v73, v246
    v_mul_f32 v74, v74, v246
    v_mul_f32 v75, v75, v246
    v_mul_f32 v76, v76, v246
    v_mul_f32 v77, v77, v246
    v_mul_f32 v78, v78, v246
    v_mul_f32 v79, v79, v246
    v_mul_f32 v80, v80, v246
    v_mul_f32 v81, v81, v246
    v_mul_f32 v82, v82, v246
    v_mul_f32 v83, v83, v246
    v_mul_f32 v84, v84, v246
    v_mul_f32 v85, v85, v246
    v_mul_f32 v86, v86, v246
    v_mul_f32 v87, v87, v246
    v_mul_f32 v88, v88, v246
    v_mul_f32 v89, v89, v246
    v_mul_f32 v90, v90, v246
    v_mul_f32 v91, v91, v246
    v_mul_f32 v92, v92, v246
    v_mul_f32 v93, v93, v246
    v_mul_f32 v94, v94, v246
    v_mul_f32 v95, v95, v246
    v_mul_f32 v96, v96, v246
    v_mul_f32 v97, v97, v246
    v_mul_f32 v98, v98, v246
    v_mul_f32 v99, v99, v246
    v_mul_f32 v100, v100, v246
    v_mul_f32 v101, v101, v246
    v_mul_f32 v102, v102, v246
    v_mul_f32 v103, v103, v246
    v_mul_f32 v104, v104, v246
    v_mul_f32 v105, v105, v246
    v_mul_f32 v106, v106, v246
    v_mul_f32 v107, v107, v246
    v_mul_f32 v108, v108, v246
    v_mul_f32 v109, v109, v246
    v_mul_f32 v110, v110, v246
    v_mul_f32 v111, v111, v246
    v_mul_f32 v112, v112, v246
    v_mul_f32 v113, v113, v246
    v_mul_f32 v114, v114, v246
    v_mul_f32 v115, v115, v246
    v_mul_f32 v116, v116, v246
    v_mul_f32 v117, v117, v246
    v_mul_f32 v118, v118, v246
    v_mul_f32 v119, v119, v246
    v_mul_f32 v120, v120, v247
    v_mul_f32 v121, v121, v247
    v_mul_f32 v122, v122, v247
    v_mul_f32 v123, v123, v247
    v_mul_f32 v124, v124, v247
    v_mul_f32 v125, v125, v247
    v_mul_f32 v126, v126, v247
    v_mul_f32 v127, v127, v247
    v_mul_f32 v128, v128, v247
    v_mul_f32 v129, v129, v247
    v_mul_f32 v130, v130, v247
    v_mul_f32 v131, v131, v247
    v_mul_f32 v132, v132, v247
    v_mul_f32 v133, v133, v247
    v_mul_f32 v134, v134, v247
    v_mul_f32 v135, v135, v247
    v_mul_f32 v136, v136, v247
    v_mul_f32 v137, v137, v247
    v_mul_f32 v138, v138, v247
    v_mul_f32 v139, v139, v247
    v_mul_f32 v140, v140, v247
    v_mul_f32 v141, v141, v247
    v_mul_f32 v142, v142, v247
    v_mul_f32 v143, v143, v247
    v_mul_f32 v144, v144, v247
    v_mul_f32 v145, v145, v247
    v_mul_f32 v146, v146, v247
    v_mul_f32 v147, v147, v247
    v_mul_f32 v148, v148, v247
    v_mul_f32 v149, v149, v247
    v_mul_f32 v150, v150, v247
    v_mul_f32 v151, v151, v247
    v_mul_f32 v244, v244, v246
    v_mul_f32 v245, v245, v247
    s_nop 7
    s_branch L_back_A14
L_slow_B14:
    s_nop 15
    v_mov_b32 v248, v246
    s_nop 1
    v_permlane32_swap_b32 v246, v248
    v_max_f32 v246, v246, v248
    v_max_f32 v246, 0, v246
    v_ceil_f32 v246, v246
    v_sub_f32 v168, v168, v246
    v_sub_f32 v169, v169, v246
    v_sub_f32 v170, v170, v246
    v_sub_f32 v171, v171, v246
    v_sub_f32 v172, v172, v246
    v_sub_f32 v173, v173, v246
    v_sub_f32 v174, v174, v246
    v_sub_f32 v175, v175, v246
    v_sub_f32 v176, v176, v246
    v_sub_f32 v177, v177, v246
    v_sub_f32 v178, v178, v246
    v_sub_f32 v179, v179, v246
    v_sub_f32 v180, v180, v246
    v_sub_f32 v181, v181, v246
    v_sub_f32 v182, v182, v246
    v_sub_f32 v183, v183, v246
    v_sub_f32 v188, v188, v246
    v_sub_f32 v189, v189, v246
    v_sub_f32 v190, v190, v246
    v_sub_f32 v191, v191, v246
    v_sub_f32 v192, v192, v246
    v_sub_f32 v193, v193, v246
    v_sub_f32 v194, v194, v246
    v_sub_f32 v195, v195, v246
    v_sub_f32 v196, v196, v246
    v_sub_f32 v197, v197, v246
    v_sub_f32 v198, v198, v246
    v_sub_f32 v199, v199, v246
    v_sub_f32 v200, v200, v246
    v_sub_f32 v201, v201, v246
    v_sub_f32 v202, v202, v246
    v_sub_f32 v203, v203, v246
    v_sub_f32 v246, 0, v246
    v_exp_f32 v246, v246
    s_nop 0
    v_mul_f32 v56, v56, v246
    v_mul_f32 v57, v57, v246
    v_mul_f32 v58, v58, v246
    v_mul_f32 v59, v59, v246
    v_mul_f32 v60, v60, v246
    v_mul_f32 v61, v61, v246
    v_mul_f32 v62, v62, v246
    v_mul_f32 v63, v63, v246
    v_mul_f32 v64, v64, v246
    v_mul_f32 v65, v65, v246
    v_mul_f32 v66, v66, v246
    v_mul_f32 v67, v67, v246
    v_mul_f32 v68, v68, v246
    v_mul_f32 v69, v69, v246
    v_mul_f32 v70, v70, v246
    v_mul_f32 v71, v71, v246
    v_mul_f32 v72, v72, v246
    v_mul_f32 v73, v73, v246
    v_mul_f32 v74, v74, v246
    v_mul_f32 v75, v75, v246
    v_mul_f32 v76, v76, v246
    v_mul_f32 v77, v77, v246
    v_mul_f32 v78, v78, v246
    v_mul_f32 v79, v79, v246
    v_mul_f32 v80, v80, v246
    v_mul_f32 v81, v81, v246
    v_mul_f32 v82, v82, v246
    v_mul_f32 v83, v83, v246
    v_mul_f32 v84, v84, v246
    v_mul_f32 v85, v85, v246
    v_mul_f32 v86, v86, v246
    v_mul_f32 v87, v87, v246
    v_mul_f32 v88, v88, v246
    v_mul_f32 v89, v89, v246
    v_mul_f32 v90, v90, v246
    v_mul_f32 v91, v91, v246
    v_mul_f32 v92, v92, v246
    v_mul_f32 v93, v93, v246
    v_mul_f32 v94, v94, v246
    v_mul_f32 v95, v95, v246
    v_mul_f32 v96, v96, v246
    v_mul_f32 v97, v97, v246
    v_mul_f32 v98, v98, v246
    v_mul_f32 v99, v99, v246
    v_mul_f32 v100, v100, v246
    v_mul_f32 v101, v101, v246
    v_mul_f32 v102, v102, v246
    v_mul_f32 v103, v103, v246
    v_mul_f32 v104, v104, v246
    v_mul_f32 v105, v105, v246
    v_mul_f32 v106, v106, v246
    v_mul_f32 v107, v107, v246
    v_mul_f32 v108, v108, v246
    v_mul_f32 v109, v109, v246
    v_mul_f32 v110, v110, v246
    v_mul_f32 v111, v111, v246
    v_mul_f32 v112, v112, v246
    v_mul_f32 v113, v113, v246
    v_mul_f32 v114, v114, v246
    v_mul_f32 v115, v115, v246
    v_mul_f32 v116, v116, v246
    v_mul_f32 v117, v117, v246
    v_mul_f32 v118, v118, v246
    v_mul_f32 v119, v119, v246
    v_mul_f32 v244, v244, v246
    v_lshlrev_b32 v247, 16, v152
    v_and_b32 v248, 0xffff0000, v152
    v_mul_f32 v247, v247, v246
    v_mul_f32 v248, v248, v246
    v_cvt_pk_bf16_f32 v152, v247, v248
    v_lshlrev_b32 v247, 16, v153
    v_and_b32 v248, 0xffff0000, v153
    v_mul_f32 v247, v247, v246
    v_mul_f32 v248, v248, v246
    v_cvt_pk_bf16_f32 v153, v247, v248
    v_lshlrev_b32 v247, 16, v154
    v_and_b32 v248, 0xffff0000, v154
    v_mul_f32 v247, v247, v246
    v_mul_f32 v248, v248, v246
    v_cvt_pk_bf16_f32 v154, v247, v248
    v_lshlrev_b32 v247, 16, v155
    v_and_b32 v248, 0xffff0000, v155
    v_mul_f32 v247, v247, v246
    v_mul_f32 v248, v248, v246
    v_cvt_pk_bf16_f32 v155, v247, v248
    v_lshlrev_b32 v247, 16, v156
    v_and_b32 v248, 0xffff0000, v156
    v_mul_f32 v247, v247, v246
    v_mul_f32 v248, v248, v246
    v_cvt_pk_bf16_f32 v156, v247, v248
    v_lshlrev_b32 v247, 16, v157
    v_and_b32 v248, 0xffff0000, v157
    v_mul_f32 v247, v247, v246
    v_mul_f32 v248, v248, v246
    v_cvt_pk_bf16_f32 v157, v247, v248
    v_lshlrev_b32 v247, 16, v158
    v_and_b32 v248, 0xffff0000, v158
    v_mul_f32 v247, v247, v246
    v_mul_f32 v248, v248, v246
    v_cvt_pk_bf16_f32 v158, v247, v248
    v_lshlrev_b32 v247, 16, v159
    v_and_b32 v248, 0xffff0000, v159
    v_mul_f32 v247, v247, v246
    v_mul_f32 v248, v248, v246
    v_cvt_pk_bf16_f32 v159, v247, v248
    s_nop 7
    s_branch L_back_B14
L_slow_A15:
    s_nop 15
    v_mov_b32 v248, v246
    s_nop 1
    v_permlane32_swap_b32 v246, v248
    v_max_f32 v246, v246, v248
    v_mov_b32 v248, v247
    s_nop 1
    v_permlane32_swap_b32 v247, v248
    v_max_f32 v247, v247, v248
    v_mov_b32 v248, v247
    s_nop 1
    v_permlane16_swap_b32 v247, v248
    v_max_f32 v247, v247, v248
    v_max_f32 v246, 0, v246
    v_ceil_f32 v246, v246
    v_max_f32 v247, 0, v247
    v_ceil_f32 v247, v247
    v_sub_f32 v152, v152, v246
    v_sub_f32 v153, v153, v246
    v_sub_f32 v154, v154, v246
    v_sub_f32 v155, v155, v246
    v_sub_f32 v156, v156, v246
    v_sub_f32 v157, v157, v246
    v_sub_f32 v158, v158, v246
    v_sub_f32 v159, v159, v246
    v_sub_f32 v160, v160, v246
    v_sub_f32 v161, v161, v246
    v_sub_f32 v162, v162, v246
    v_sub_f32 v163, v163, v246
    v_sub_f32 v164, v164, v246
    v_sub_f32 v165, v165, v246
    v_sub_f32 v166, v166, v246
    v_sub_f32 v167, v167, v246
    v_sub_f32 v168, v168, v246
    v_sub_f32 v169, v169, v246
    v_sub_f32 v170, v170, v246
    v_sub_f32 v171, v171, v246
    v_sub_f32 v172, v172, v246
    v_sub_f32 v173, v173, v246
    v_sub_f32 v174, v174, v246
    v_sub_f32 v175, v175, v246
    v_sub_f32 v176, v176, v246
    v_sub_f32 v177, v177, v246
    v_sub_f32 v178, v178, v246
    v_sub_f32 v179, v179, v246
    v_sub_f32 v180, v180, v246
    v_sub_f32 v181, v181, v246
    v_sub_f32 v182, v182, v246
    v_sub_f32 v183, v183, v246
    v_sub_f32 v184, v184, v247
    v_sub_f32 v185, v185, v247
    v_sub_f32 v186, v186, v247
    v_sub_f32 v187, v187, v247
    v_sub_f32 v188, v188, v246
    v_sub_f32 v189, v189, v246
    v_sub_f32 v190, v190, v246
    v_sub_f32 v191, v191, v246
    v_sub_f32 v192, v192, v246
    v_sub_f32 v193, v193, v246
    v_sub_f32 v194, v194, v246
    v_sub_f32 v195, v195, v246
    v_sub_f32 v196, v196, v246
    v_sub_f32 v197, v197, v246
    v_sub_f32 v198, v198, v246
    v_sub_f32 v199, v199, v246
    v_sub_f32 v200, v200, v246
    v_sub_f32 v201, v201, v246
    v_sub_f32 v202, v202, v246
    v_sub_f32 v203, v203, v246
    v_sub_f32 v204, v204, v247
    v_sub_f32 v205, v205, v247
    v_sub_f32 v206, v206, v247
    v_sub_f32 v207, v207, v247
    v_sub_f32 v246, 0, v246
    v_sub_f32 v247, 0, v247
    v_exp_f32 v246, v246
    v_exp_f32 v247, v247
    v_mul_f32 v56, v56, v246
    v_mul_f32 v57, v57, v246
    v_mul_f32 v58, v58, v246
    v_mul_f32 v59, v59, v246
    v_mul_f32 v60, v60, v246
    v_mul_f32 v61, v61, v246
    v_mul_f32 v62, v62, v246
    v_mul_f32 v63, v63, v246
    v_mul_f32 v64, v64, v246
    v_mul_f32 v65, v65, v246
    v_mul_f32 v66, v66, v246
    v_mul_f32 v67, v67, v246
    v_mul_f32 v68, v68, v246
    v_mul_f32 v69, v69, v246
    v_mul_f32 v70, v70, v246
    v_mul_f32 v71, v71, v246
    v_mul_f32 v72, v72, v246
    v_mul_f32 v73, v73, v246
    v_mul_f32 v74, v74, v246
    v_mul_f32 v75, v75, v246
    v_mul_f32 v76, v76, v246
    v_mul_f32 v77, v77, v246
    v_mul_f32 v78, v78, v246
    v_mul_f32 v79, v79, v246
    v_mul_f32 v80, v80, v246
    v_mul_f32 v81, v81, v246
    v_mul_f32 v82, v82, v246
    v_mul_f32 v83, v83, v246
    v_mul_f32 v84, v84, v246
    v_mul_f32 v85, v85, v246
    v_mul_f32 v86, v86, v246
    v_mul_f32 v87, v87, v246
    v_mul_f32 v88, v88, v246
    v_mul_f32 v89, v89, v246
    v_mul_f32 v90, v90, v246
    v_mul_f32 v91, v91, v246
    v_mul_f32 v92, v92, v246
    v_mul_f32 v93, v93, v246
    v_mul_f32 v94, v94, v246
    v_mul_f32 v95, v95, v246
    v_mul_f32 v96, v96, v246
    v_mul_f32 v97, v97, v246
    v_mul_f32 v98, v98, v246
    v_mul_f32 v99, v99, v246
    v_mul_f32 v100, v100, v246
    v_mul_f32 v101, v101, v246
    v_mul_f32 v102, v102, v246
    v_mul_f32 v103, v103, v246
    v_mul_f32 v104, v104, v246
    v_mul_f32 v105, v105, v246
    v_mul_f32 v106, v106, v246
    v_mul_f32 v107, v107, v246
    v_mul_f32 v108, v108, v246
    v_mul_f32 v109, v109, v246
    v_mul_f32 v110, v110, v246
    v_mul_f32 v111, v111, v246
    v_mul_f32 v112, v112, v246
    v_mul_f32 v113, v113, v246
    v_mul_f32 v114, v114, v246
    v_mul_f32 v115, v115, v246
    v_mul_f32 v116, v116, v246
    v_mul_f32 v117, v117, v246
    v_mul_f32 v118, v118, v246
    v_mul_f32 v119, v119, v246
    v_mul_f32 v120, v120, v247
    v_mul_f32 v121, v121, v247
    v_mul_f32 v122, v122, v247
    v_mul_f32 v123, v123, v247
    v_mul_f32 v124, v124, v247
    v_mul_f32 v125, v125, v247
    v_mul_f32 v126, v126, v247
    v_mul_f32 v127, v127, v247
    v_mul_f32 v128, v128, v247
    v_mul_f32 v129, v129, v247
    v_mul_f32 v130, v130, v247
    v_mul_f32 v131, v131, v247
    v_mul_f32 v132, v132, v247
    v_mul_f32 v133, v133, v247
    v_mul_f32 v134, v134, v247
    v_mul_f32 v135, v135, v247
    v_mul_f32 v136, v136, v247
    v_mul_f32 v137, v137, v247
    v_mul_f32 v138, v138, v247
    v_mul_f32 v139, v139, v247
    v_mul_f32 v140, v140, v247
    v_mul_f32 v141, v141, v247
    v_mul_f32 v142, v142, v247
    v_mul_f32 v143, v143, v247
    v_mul_f32 v144, v144, v247
    v_mul_f32 v145, v145, v247
    v_mul_f32 v146, v146, v247
    v_mul_f32 v147, v147, v247
    v_mul_f32 v148, v148, v247
    v_mul_f32 v149, v149, v247
    v_mul_f32 v150, v150, v247
    v_mul_f32 v151, v151, v247
    v_mul_f32 v244, v244, v246
    v_mul_f32 v245, v245, v247
    s_nop 7
    s_branch L_back_A15
L_slow_B15:
    s_nop 15
    v_mov_b32 v248, v246
    s_nop 1
    v_permlane32_swap_b32 v246, v248
    v_max_f32 v246, v246, v248
    v_max_f32 v246, 0, v246
    v_ceil_f32 v246, v246
    v_sub_f32 v168, v168, v246
    v_sub_f32 v169, v169, v246
    v_sub_f32 v170, v170, v246
    v_sub_f32 v171, v171, v246
    v_sub_f32 v172, v172, v246
    v_sub_f32 v173, v173, v246
    v_sub_f32 v174, v174, v246
    v_sub_f32 v175, v175, v246
    v_sub_f32 v176, v176, v246
    v_sub_f32 v177, v177, v246
    v_sub_f32 v178, v178, v246
    v_sub_f32 v179, v179, v246
    v_sub_f32 v180, v180, v246
    v_sub_f32 v181, v181, v246
    v_sub_f32 v182, v182, v246
    v_sub_f32 v183, v183, v246
    v_sub_f32 v188, v188, v246
    v_sub_f32 v189, v189, v246
    v_sub_f32 v190, v190, v246
    v_sub_f32 v191, v191, v246
    v_sub_f32 v192, v192, v246
    v_sub_f32 v193, v193, v246
    v_sub_f32 v194, v194, v246
    v_sub_f32 v195, v195, v246
    v_sub_f32 v196, v196, v246
    v_sub_f32 v197, v197, v246
    v_sub_f32 v198, v198, v246
    v_sub_f32 v199, v199, v246
    v_sub_f32 v200, v200, v246
    v_sub_f32 v201, v201, v246
    v_sub_f32 v202, v202, v246
    v_sub_f32 v203, v203, v246
    v_sub_f32 v246, 0, v246
    v_exp_f32 v246, v246
    s_nop 0
    v_mul_f32 v56, v56, v246
    v_mul_f32 v57, v57, v246
    v_mul_f32 v58, v58, v246
    v_mul_f32 v59, v59, v246
    v_mul_f32 v60, v60, v246
    v_mul_f32 v61, v61, v246
    v_mul_f32 v62, v62, v246
    v_mul_f32 v63, v63, v246
    v_mul_f32 v64, v64, v246
    v_mul_f32 v65, v65, v246
    v_mul_f32 v66, v66, v246
    v_mul_f32 v67, v67, v246
    v_mul_f32 v68, v68, v246
    v_mul_f32 v69, v69, v246
    v_mul_f32 v70, v70, v246
    v_mul_f32 v71, v71, v246
    v_mul_f32 v72, v72, v246
    v_mul_f32 v73, v73, v246
    v_mul_f32 v74, v74, v246
    v_mul_f32 v75, v75, v246
    v_mul_f32 v76, v76, v246
    v_mul_f32 v77, v77, v246
    v_mul_f32 v78, v78, v246
    v_mul_f32 v79, v79, v246
    v_mul_f32 v80, v80, v246
    v_mul_f32 v81, v81, v246
    v_mul_f32 v82, v82, v246
    v_mul_f32 v83, v83, v246
    v_mul_f32 v84, v84, v246
    v_mul_f32 v85, v85, v246
    v_mul_f32 v86, v86, v246
    v_mul_f32 v87, v87, v246
    v_mul_f32 v88, v88, v246
    v_mul_f32 v89, v89, v246
    v_mul_f32 v90, v90, v246
    v_mul_f32 v91, v91, v246
    v_mul_f32 v92, v92, v246
    v_mul_f32 v93, v93, v246
    v_mul_f32 v94, v94, v246
    v_mul_f32 v95, v95, v246
    v_mul_f32 v96, v96, v246
    v_mul_f32 v97, v97, v246
    v_mul_f32 v98, v98, v246
    v_mul_f32 v99, v99, v246
    v_mul_f32 v100, v100, v246
    v_mul_f32 v101, v101, v246
    v_mul_f32 v102, v102, v246
    v_mul_f32 v103, v103, v246
    v_mul_f32 v104, v104, v246
    v_mul_f32 v105, v105, v246
    v_mul_f32 v106, v106, v246
    v_mul_f32 v107, v107, v246
    v_mul_f32 v108, v108, v246
    v_mul_f32 v109, v109, v246
    v_mul_f32 v110, v110, v246
    v_mul_f32 v111, v111, v246
    v_mul_f32 v112, v112, v246
    v_mul_f32 v113, v113, v246
    v_mul_f32 v114, v114, v246
    v_mul_f32 v115, v115, v246
    v_mul_f32 v116, v116, v246
    v_mul_f32 v117, v117, v246
    v_mul_f32 v118, v118, v246
    v_mul_f32 v119, v119, v246
    v_mul_f32 v244, v244, v246
    v_lshlrev_b32 v247, 16, v152
    v_and_b32 v248, 0xffff0000, v152
    v_mul_f32 v247, v247, v246
    v_mul_f32 v248, v248, v246
    v_cvt_pk_bf16_f32 v152, v247, v248
    v_lshlrev_b32 v247, 16, v153
    v_and_b32 v248, 0xffff0000, v153
    v_mul_f32 v247, v247, v246
    v_mul_f32 v248, v248, v246
    v_cvt_pk_bf16_f32 v153, v247, v248
    v_lshlrev_b32 v247, 16, v154
    v_and_b32 v248, 0xffff0000, v154
    v_mul_f32 v247, v247, v246
    v_mul_f32 v248, v248, v246
    v_cvt_pk_bf16_f32 v154, v247, v248
    v_lshlrev_b32 v247, 16, v155
    v_and_b32 v248, 0xffff0000, v155
    v_mul_f32 v247, v247, v246
    v_mul_f32 v248, v248, v246
    v_cvt_pk_bf16_f32 v155, v247, v248
    v_lshlrev_b32 v247, 16, v156
    v_and_b32 v248, 0xffff0000, v156
    v_mul_f32 v247, v247, v246
    v_mul_f32 v248, v248, v246
    v_cvt_pk_bf16_f32 v156, v247, v248
    v_lshlrev_b32 v247, 16, v157
    v_and_b32 v248, 0xffff0000, v157
    v_mul_f32 v247, v247, v246
    v_mul_f32 v248, v248, v246
    v_cvt_pk_bf16_f32 v157, v247, v248
    v_lshlrev_b32 v247, 16, v158
    v_and_b32 v248, 0xffff0000, v158
    v_mul_f32 v247, v247, v246
    v_mul_f32 v248, v248, v246
    v_cvt_pk_bf16_f32 v158, v247, v248
    v_lshlrev_b32 v247, 16, v159
    v_and_b32 v248, 0xffff0000, v159
    v_mul_f32 v247, v247, v246
    v_mul_f32 v248, v248, v246
    v_cvt_pk_bf16_f32 v159, v247, v248
    s_nop 7
    s_branch L_back_B15
L_slow_A16:
    s_nop 15
    v_mov_b32 v248, v246
    s_nop 1
    v_permlane32_swap_b32 v246, v248
    v_max_f32 v246, v246, v248
    v_mov_b32 v248, v247
    s_nop 1
    v_permlane32_swap_b32 v247, v248
    v_max_f32 v247, v247, v248
    v_mov_b32 v248, v247
    s_nop 1
    v_permlane16_swap_b32 v247, v248
    v_max_f32 v247, v247, v248
    v_max_f32 v246, 0, v246
    v_ceil_f32 v246, v246
    v_max_f32 v247, 0, v247
    v_ceil_f32 v247, v247
    v_sub_f32 v152, v152, v246
    v_sub_f32 v153, v153, v246
    v_sub_f32 v154, v154, v246
    v_sub_f32 v155, v155, v246
    v_sub_f32 v156, v156, v246
    v_sub_f32 v157, v157, v246
    v_sub_f32 v158, v158, v246
    v_sub_f32 v159, v159, v246
    v_sub_f32 v160, v160, v246
    v_sub_f32 v161, v161, v246
    v_sub_f32 v162, v162, v246
    v_sub_f32 v163, v163, v246
    v_sub_f32 v164, v164, v246
    v_sub_f32 v165, v165, v246
    v_sub_f32 v166, v166, v246
    v_sub_f32 v167, v167, v246
    v_sub_f32 v168, v168, v246
    v_sub_f32 v169, v169, v246
    v_sub_f32 v170, v170, v246
    v_sub_f32 v171, v171, v246
    v_sub_f32 v172, v172, v246
    v_sub_f32 v173, v173, v246
    v_sub_f32 v174, v174, v246
    v_sub_f32 v175, v175, v246
    v_sub_f32 v176, v176, v246
    v_sub_f32 v177, v177, v246
    v_sub_f32 v178, v178, v246
    v_sub_f32 v179, v179, v246
    v_sub_f32 v180, v180, v246
    v_sub_f32 v181, v181, v246
    v_sub_f32 v182, v182, v246
    v_sub_f32 v183, v183, v246
    v_sub_f32 v184, v184, v247
    v_sub_f32 v185, v185, v247
    v_sub_f32 v186, v186, v247
    v_sub_f32 v187, v187, v247
    v_sub_f32 v188, v188, v246
    v_sub_f32 v189, v189, v246
    v_sub_f32 v190, v190, v246
    v_sub_f32 v191, v191, v246
    v_sub_f32 v192, v192, v246
    v_sub_f32 v193, v193, v246
    v_sub_f32 v194, v194, v246
    v_sub_f32 v195, v195, v246
    v_sub_f32 v196, v196, v246
    v_sub_f32 v197, v197, v246
    v_sub_f32 v198, v198, v246
    v_sub_f32 v199, v199, v246
    v_sub_f32 v200, v200, v246
    v_sub_f32 v201, v201, v246
    v_sub_f32 v202, v202, v246
    v_sub_f32 v203, v203, v246
    v_sub_f32 v204, v204, v247
    v_sub_f32 v205, v205, v247
    v_sub_f32 v206, v206, v247
    v_sub_f32 v207, v207, v247
    v_sub_f32 v246, 0, v246
    v_sub_f32 v247, 0, v247
    v_exp_f32 v246, v246
    v_exp_f32 v247, v247
    v_mul_f32 v56, v56, v246
    v_mul_f32 v57, v57, v246
    v_mul_f32 v58, v58, v246
    v_mul_f32 v59, v59, v246
    v_mul_f32 v60, v60, v246
    v_mul_f32 v61, v61, v246
    v_mul_f32 v62, v62, v246
    v_mul_f32 v63, v63, v246
    v_mul_f32 v64, v64, v246
    v_mul_f32 v65, v65, v246
    v_mul_f32 v66, v66, v246
    v_mul_f32 v67, v67, v246
    v_mul_f32 v68, v68, v246
    v_mul_f32 v69, v69, v246
    v_mul_f32 v70, v70, v246
    v_mul_f32 v71, v71, v246
    v_mul_f32 v72, v72, v246
    v_mul_f32 v73, v73, v246
    v_mul_f32 v74, v74, v246
    v_mul_f32 v75, v75, v246
    v_mul_f32 v76, v76, v246
    v_mul_f32 v77, v77, v246
    v_mul_f32 v78, v78, v246
    v_mul_f32 v79, v79, v246
    v_mul_f32 v80, v80, v246
    v_mul_f32 v81, v81, v246
    v_mul_f32 v82, v82, v246
    v_mul_f32 v83, v83, v246
    v_mul_f32 v84, v84, v246
    v_mul_f32 v85, v85, v246
    v_mul_f32 v86, v86, v246
    v_mul_f32 v87, v87, v246
    v_mul_f32 v88, v88, v246
    v_mul_f32 v89, v89, v246
    v_mul_f32 v90, v90, v246
    v_mul_f32 v91, v91, v246
    v_mul_f32 v92, v92, v246
    v_mul_f32 v93, v93, v246
    v_mul_f32 v94, v94, v246
    v_mul_f32 v95, v95, v246
    v_mul_f32 v96, v96, v246
    v_mul_f32 v97, v97, v246
    v_mul_f32 v98, v98, v246
    v_mul_f32 v99, v99, v246
    v_mul_f32 v100, v100, v246
    v_mul_f32 v101, v101, v246
    v_mul_f32 v102, v102, v246
    v_mul_f32 v103, v103, v246
    v_mul_f32 v104, v104, v246
    v_mul_f32 v105, v105, v246
    v_mul_f32 v106, v106, v246
    v_mul_f32 v107, v107, v246
    v_mul_f32 v108, v108, v246
    v_mul_f32 v109, v109, v246
    v_mul_f32 v110, v110, v246
    v_mul_f32 v111, v111, v246
    v_mul_f32 v112, v112, v246
    v_mul_f32 v113, v113, v246
    v_mul_f32 v114, v114, v246
    v_mul_f32 v115, v115, v246
    v_mul_f32 v116, v116, v246
    v_mul_f32 v117, v117, v246
    v_mul_f32 v118, v118, v246
    v_mul_f32 v119, v119, v246
    v_mul_f32 v120, v120, v247
    v_mul_f32 v121, v121, v247
    v_mul_f32 v122, v122, v247
    v_mul_f32 v123, v123, v247
    v_mul_f32 v124, v124, v247
    v_mul_f32 v125, v125, v247
    v_mul_f32 v126, v126, v247
    v_mul_f32 v127, v127, v247
    v_mul_f32 v128, v128, v247
    v_mul_f32 v129, v129, v247
    v_mul_f32 v130, v130, v247
    v_mul_f32 v131, v131, v247
    v_mul_f32 v132, v132, v247
    v_mul_f32 v133, v133, v247
    v_mul_f32 v134, v134, v247
    v_mul_f32 v135, v135, v247
    v_mul_f32 v136, v136, v247
    v_mul_f32 v137, v137, v247
    v_mul_f32 v138, v138, v247
    v_mul_f32 v139, v139, v247
    v_mul_f32 v140, v140, v247
    v_mul_f32 v141, v141, v247
    v_mul_f32 v142, v142, v247
    v_mul_f32 v143, v143, v247
    v_mul_f32 v144, v144, v247
    v_mul_f32 v145, v145, v247
    v_mul_f32 v146, v146, v247
    v_mul_f32 v147, v147, v247
    v_mul_f32 v148, v148, v247
    v_mul_f32 v149, v149, v247
    v_mul_f32 v150, v150, v247
    v_mul_f32 v151, v151, v247
    v_mul_f32 v244, v244, v246
    v_mul_f32 v245, v245, v247
    s_nop 7
    s_branch L_back_A16
L_slow_B16:
    s_nop 15
    v_mov_b32 v248, v246
    s_nop 1
    v_permlane32_swap_b32 v246, v248
    v_max_f32 v246, v246, v248
    v_max_f32 v246, 0, v246
    v_ceil_f32 v246, v246
    v_sub_f32 v168, v168, v246
    v_sub_f32 v169, v169, v246
    v_sub_f32 v170, v170, v246
    v_sub_f32 v171, v171, v246
    v_sub_f32 v172, v172, v246
    v_sub_f32 v173, v173, v246
    v_sub_f32 v174, v174, v246
    v_sub_f32 v175, v175, v246
    v_sub_f32 v176, v176, v246
    v_sub_f32 v177, v177, v246
    v_sub_f32 v178, v178, v246
    v_sub_f32 v179, v179, v246
    v_sub_f32 v180, v180, v246
    v_sub_f32 v181, v181, v246
    v_sub_f32 v182, v182, v246
    v_sub_f32 v183, v183, v246
    v_sub_f32 v188, v188, v246
    v_sub_f32 v189, v189, v246
    v_sub_f32 v190, v190, v246
    v_sub_f32 v191, v191, v246
    v_sub_f32 v192, v192, v246
    v_sub_f32 v193, v193, v246
    v_sub_f32 v194, v194, v246
    v_sub_f32 v195, v195, v246
    v_sub_f32 v196, v196, v246
    v_sub_f32 v197, v197, v246
    v_sub_f32 v198, v198, v246
    v_sub_f32 v199, v199, v246
    v_sub_f32 v200, v200, v246
    v_sub_f32 v201, v201, v246
    v_sub_f32 v202, v202, v246
    v_sub_f32 v203, v203, v246
    v_sub_f32 v246, 0, v246
    v_exp_f32 v246, v246
    s_nop 0
    v_mul_f32 v56, v56, v246
    v_mul_f32 v57, v57, v246
    v_mul_f32 v58, v58, v246
    v_mul_f32 v59, v59, v246
    v_mul_f32 v60, v60, v246
    v_mul_f32 v61, v61, v246
    v_mul_f32 v62, v62, v246
    v_mul_f32 v63, v63, v246
    v_mul_f32 v64, v64, v246
    v_mul_f32 v65, v65, v246
    v_mul_f32 v66, v66, v246
    v_mul_f32 v67, v67, v246
    v_mul_f32 v68, v68, v246
    v_mul_f32 v69, v69, v246
    v_mul_f32 v70, v70, v246
    v_mul_f32 v71, v71, v246
    v_mul_f32 v72, v72, v246
    v_mul_f32 v73, v73, v246
    v_mul_f32 v74, v74, v246
    v_mul_f32 v75, v75, v246
    v_mul_f32 v76, v76, v246
    v_mul_f32 v77, v77, v246
    v_mul_f32 v78, v78, v246
    v_mul_f32 v79, v79, v246
    v_mul_f32 v80, v80, v246
    v_mul_f32 v81, v81, v246
    v_mul_f32 v82, v82, v246
    v_mul_f32 v83, v83, v246
    v_mul_f32 v84, v84, v246
    v_mul_f32 v85, v85, v246
    v_mul_f32 v86, v86, v246
    v_mul_f32 v87, v87, v246
    v_mul_f32 v88, v88, v246
    v_mul_f32 v89, v89, v246
    v_mul_f32 v90, v90, v246
    v_mul_f32 v91, v91, v246
    v_mul_f32 v92, v92, v246
    v_mul_f32 v93, v93, v246
    v_mul_f32 v94, v94, v246
    v_mul_f32 v95, v95, v246
    v_mul_f32 v96, v96, v246
    v_mul_f32 v97, v97, v246
    v_mul_f32 v98, v98, v246
    v_mul_f32 v99, v99, v246
    v_mul_f32 v100, v100, v246
    v_mul_f32 v101, v101, v246
    v_mul_f32 v102, v102, v246
    v_mul_f32 v103, v103, v246
    v_mul_f32 v104, v104, v246
    v_mul_f32 v105, v105, v246
    v_mul_f32 v106, v106, v246
    v_mul_f32 v107, v107, v246
    v_mul_f32 v108, v108, v246
    v_mul_f32 v109, v109, v246
    v_mul_f32 v110, v110, v246
    v_mul_f32 v111, v111, v246
    v_mul_f32 v112, v112, v246
    v_mul_f32 v113, v113, v246
    v_mul_f32 v114, v114, v246
    v_mul_f32 v115, v115, v246
    v_mul_f32 v116, v116, v246
    v_mul_f32 v117, v117, v246
    v_mul_f32 v118, v118, v246
    v_mul_f32 v119, v119, v246
    v_mul_f32 v244, v244, v246
    v_lshlrev_b32 v247, 16, v152
    v_and_b32 v248, 0xffff0000, v152
    v_mul_f32 v247, v247, v246
    v_mul_f32 v248, v248, v246
    v_cvt_pk_bf16_f32 v152, v247, v248
    v_lshlrev_b32 v247, 16, v153
    v_and_b32 v248, 0xffff0000, v153
    v_mul_f32 v247, v247, v246
    v_mul_f32 v248, v248, v246
    v_cvt_pk_bf16_f32 v153, v247, v248
    v_lshlrev_b32 v247, 16, v154
    v_and_b32 v248, 0xffff0000, v154
    v_mul_f32 v247, v247, v246
    v_mul_f32 v248, v248, v246
    v_cvt_pk_bf16_f32 v154, v247, v248
    v_lshlrev_b32 v247, 16, v155
    v_and_b32 v248, 0xffff0000, v155
    v_mul_f32 v247, v247, v246
    v_mul_f32 v248, v248, v246
    v_cvt_pk_bf16_f32 v155, v247, v248
    v_lshlrev_b32 v247, 16, v156
    v_and_b32 v248, 0xffff0000, v156
    v_mul_f32 v247, v247, v246
    v_mul_f32 v248, v248, v246
    v_cvt_pk_bf16_f32 v156, v247, v248
    v_lshlrev_b32 v247, 16, v157
    v_and_b32 v248, 0xffff0000, v157
    v_mul_f32 v247, v247, v246
    v_mul_f32 v248, v248, v246
    v_cvt_pk_bf16_f32 v157, v247, v248
    v_lshlrev_b32 v247, 16, v158
    v_and_b32 v248, 0xffff0000, v158
    v_mul_f32 v247, v247, v246
    v_mul_f32 v248, v248, v246
    v_cvt_pk_bf16_f32 v158, v247, v248
    v_lshlrev_b32 v247, 16, v159
    v_and_b32 v248, 0xffff0000, v159
    v_mul_f32 v247, v247, v246
    v_mul_f32 v248, v248, v246
    v_cvt_pk_bf16_f32 v159, v247, v248
    s_nop 7
    s_branch L_back_B16
L_slow_A17:
    s_nop 15
    v_mov_b32 v248, v246
    s_nop 1
    v_permlane32_swap_b32 v246, v248
    v_max_f32 v246, v246, v248
    v_mov_b32 v248, v247
    s_nop 1
    v_permlane32_swap_b32 v247, v248
    v_max_f32 v247, v247, v248
    v_mov_b32 v248, v247
    s_nop 1
    v_permlane16_swap_b32 v247, v248
    v_max_f32 v247, v247, v248
    v_max_f32 v246, 0, v246
    v_ceil_f32 v246, v246
    v_max_f32 v247, 0, v247
    v_ceil_f32 v247, v247
    v_sub_f32 v152, v152, v246
    v_sub_f32 v153, v153, v246
    v_sub_f32 v154, v154, v246
    v_sub_f32 v155, v155, v246
    v_sub_f32 v156, v156, v246
    v_sub_f32 v157, v157, v246
    v_sub_f32 v158, v158, v246
    v_sub_f32 v159, v159, v246
    v_sub_f32 v160, v160, v246
    v_sub_f32 v161, v161, v246
    v_sub_f32 v162, v162, v246
    v_sub_f32 v163, v163, v246
    v_sub_f32 v164, v164, v246
    v_sub_f32 v165, v165, v246
    v_sub_f32 v166, v166, v246
    v_sub_f32 v167, v167, v246
    v_sub_f32 v168, v168, v246
    v_sub_f32 v169, v169, v246
    v_sub_f32 v170, v170, v246
    v_sub_f32 v171, v171, v246
    v_sub_f32 v172, v172, v246
    v_sub_f32 v173, v173, v246
    v_sub_f32 v174, v174, v246
    v_sub_f32 v175, v175, v246
    v_sub_f32 v176, v176, v246
    v_sub_f32 v177, v177, v246
    v_sub_f32 v178, v178, v246
    v_sub_f32 v179, v179, v246
    v_sub_f32 v180, v180, v246
    v_sub_f32 v181, v181, v246
    v_sub_f32 v182, v182, v246
    v_sub_f32 v183, v183, v246
    v_sub_f32 v184, v184, v247
    v_sub_f32 v185, v185, v247
    v_sub_f32 v186, v186, v247
    v_sub_f32 v187, v187, v247
    v_sub_f32 v188, v188, v246
    v_sub_f32 v189, v189, v246
    v_sub_f32 v190, v190, v246
    v_sub_f32 v191, v191, v246
    v_sub_f32 v192, v192, v246
    v_sub_f32 v193, v193, v246
    v_sub_f32 v194, v194, v246
    v_sub_f32 v195, v195, v246
    v_sub_f32 v196, v196, v246
    v_sub_f32 v197, v197, v246
    v_sub_f32 v198, v198, v246
    v_sub_f32 v199, v199, v246
    v_sub_f32 v200, v200, v246
    v_sub_f32 v201, v201, v246
    v_sub_f32 v202, v202, v246
    v_sub_f32 v203, v203, v246
    v_sub_f32 v204, v204, v247
    v_sub_f32 v205, v205, v247
    v_sub_f32 v206, v206, v247
    v_sub_f32 v207, v207, v247
    v_sub_f32 v246, 0, v246
    v_sub_f32 v247, 0, v247
    v_exp_f32 v246, v246
    v_exp_f32 v247, v247
    v_mul_f32 v56, v56, v246
    v_mul_f32 v57, v57, v246
    v_mul_f32 v58, v58, v246
    v_mul_f32 v59, v59, v246
    v_mul_f32 v60, v60, v246
    v_mul_f32 v61, v61, v246
    v_mul_f32 v62, v62, v246
    v_mul_f32 v63, v63, v246
    v_mul_f32 v64, v64, v246
    v_mul_f32 v65, v65, v246
    v_mul_f32 v66, v66, v246
    v_mul_f32 v67, v67, v246
    v_mul_f32 v68, v68, v246
    v_mul_f32 v69, v69, v246
    v_mul_f32 v70, v70, v246
    v_mul_f32 v71, v71, v246
    v_mul_f32 v72, v72, v246
    v_mul_f32 v73, v73, v246
    v_mul_f32 v74, v74, v246
    v_mul_f32 v75, v75, v246
    v_mul_f32 v76, v76, v246
    v_mul_f32 v77, v77, v246
    v_mul_f32 v78, v78, v246
    v_mul_f32 v79, v79, v246
    v_mul_f32 v80, v80, v246
    v_mul_f32 v81, v81, v246
    v_mul_f32 v82, v82, v246
    v_mul_f32 v83, v83, v246
    v_mul_f32 v84, v84, v246
    v_mul_f32 v85, v85, v246
    v_mul_f32 v86, v86, v246
    v_mul_f32 v87, v87, v246
    v_mul_f32 v88, v88, v246
    v_mul_f32 v89, v89, v246
    v_mul_f32 v90, v90, v246
    v_mul_f32 v91, v91, v246
    v_mul_f32 v92, v92, v246
    v_mul_f32 v93, v93, v246
    v_mul_f32 v94, v94, v246
    v_mul_f32 v95, v95, v246
    v_mul_f32 v96, v96, v246
    v_mul_f32 v97, v97, v246
    v_mul_f32 v98, v98, v246
    v_mul_f32 v99, v99, v246
    v_mul_f32 v100, v100, v246
    v_mul_f32 v101, v101, v246
    v_mul_f32 v102, v102, v246
    v_mul_f32 v103, v103, v246
    v_mul_f32 v104, v104, v246
    v_mul_f32 v105, v105, v246
    v_mul_f32 v106, v106, v246
    v_mul_f32 v107, v107, v246
    v_mul_f32 v108, v108, v246
    v_mul_f32 v109, v109, v246
    v_mul_f32 v110, v110, v246
    v_mul_f32 v111, v111, v246
    v_mul_f32 v112, v112, v246
    v_mul_f32 v113, v113, v246
    v_mul_f32 v114, v114, v246
    v_mul_f32 v115, v115, v246
    v_mul_f32 v116, v116, v246
    v_mul_f32 v117, v117, v246
    v_mul_f32 v118, v118, v246
    v_mul_f32 v119, v119, v246
    v_mul_f32 v120, v120, v247
    v_mul_f32 v121, v121, v247
    v_mul_f32 v122, v122, v247
    v_mul_f32 v123, v123, v247
    v_mul_f32 v124, v124, v247
    v_mul_f32 v125, v125, v247
    v_mul_f32 v126, v126, v247
    v_mul_f32 v127, v127, v247
    v_mul_f32 v128, v128, v247
    v_mul_f32 v129, v129, v247
    v_mul_f32 v130, v130, v247
    v_mul_f32 v131, v131, v247
    v_mul_f32 v132, v132, v247
    v_mul_f32 v133, v133, v247
    v_mul_f32 v134, v134, v247
    v_mul_f32 v135, v135, v247
    v_mul_f32 v136, v136, v247
    v_mul_f32 v137, v137, v247
    v_mul_f32 v138, v138, v247
    v_mul_f32 v139, v139, v247
    v_mul_f32 v140, v140, v247
    v_mul_f32 v141, v141, v247
    v_mul_f32 v142, v142, v247
    v_mul_f32 v143, v143, v247
    v_mul_f32 v144, v144, v247
    v_mul_f32 v145, v145, v247
    v_mul_f32 v146, v146, v247
    v_mul_f32 v147, v147, v247
    v_mul_f32 v148, v148, v247
    v_mul_f32 v149, v149, v247
    v_mul_f32 v150, v150, v247
    v_mul_f32 v151, v151, v247
    v_mul_f32 v244, v244, v246
    v_mul_f32 v245, v245, v247
    s_nop 7
    s_branch L_back_A17
L_slow_B17:
    s_nop 15
    v_mov_b32 v248, v246
    s_nop 1
    v_permlane32_swap_b32 v246, v248
    v_max_f32 v246, v246, v248
    v_max_f32 v246, 0, v246
    v_ceil_f32 v246, v246
    v_sub_f32 v168, v168, v246
    v_sub_f32 v169, v169, v246
    v_sub_f32 v170, v170, v246
    v_sub_f32 v171, v171, v246
    v_sub_f32 v172, v172, v246
    v_sub_f32 v173, v173, v246
    v_sub_f32 v174, v174, v246
    v_sub_f32 v175, v175, v246
    v_sub_f32 v176, v176, v246
    v_sub_f32 v177, v177, v246
    v_sub_f32 v178, v178, v246
    v_sub_f32 v179, v179, v246
    v_sub_f32 v180, v180, v246
    v_sub_f32 v181, v181, v246
    v_sub_f32 v182, v182, v246
    v_sub_f32 v183, v183, v246
    v_sub_f32 v188, v188, v246
    v_sub_f32 v189, v189, v246
    v_sub_f32 v190, v190, v246
    v_sub_f32 v191, v191, v246
    v_sub_f32 v192, v192, v246
    v_sub_f32 v193, v193, v246
    v_sub_f32 v194, v194, v246
    v_sub_f32 v195, v195, v246
    v_sub_f32 v196, v196, v246
    v_sub_f32 v197, v197, v246
    v_sub_f32 v198, v198, v246
    v_sub_f32 v199, v199, v246
    v_sub_f32 v200, v200, v246
    v_sub_f32 v201, v201, v246
    v_sub_f32 v202, v202, v246
    v_sub_f32 v203, v203, v246
    v_sub_f32 v246, 0, v246
    v_exp_f32 v246, v246
    s_nop 0
    v_mul_f32 v56, v56, v246
    v_mul_f32 v57, v57, v246
    v_mul_f32 v58, v58, v246
    v_mul_f32 v59, v59, v246
    v_mul_f32 v60, v60, v246
    v_mul_f32 v61, v61, v246
    v_mul_f32 v62, v62, v246
    v_mul_f32 v63, v63, v246
    v_mul_f32 v64, v64, v246
    v_mul_f32 v65, v65, v246
    v_mul_f32 v66, v66, v246
    v_mul_f32 v67, v67, v246
    v_mul_f32 v68, v68, v246
    v_mul_f32 v69, v69, v246
    v_mul_f32 v70, v70, v246
    v_mul_f32 v71, v71, v246
    v_mul_f32 v72, v72, v246
    v_mul_f32 v73, v73, v246
    v_mul_f32 v74, v74, v246
    v_mul_f32 v75, v75, v246
    v_mul_f32 v76, v76, v246
    v_mul_f32 v77, v77, v246
    v_mul_f32 v78, v78, v246
    v_mul_f32 v79, v79, v246
    v_mul_f32 v80, v80, v246
    v_mul_f32 v81, v81, v246
    v_mul_f32 v82, v82, v246
    v_mul_f32 v83, v83, v246
    v_mul_f32 v84, v84, v246
    v_mul_f32 v85, v85, v246
    v_mul_f32 v86, v86, v246
    v_mul_f32 v87, v87, v246
    v_mul_f32 v88, v88, v246
    v_mul_f32 v89, v89, v246
    v_mul_f32 v90, v90, v246
    v_mul_f32 v91, v91, v246
    v_mul_f32 v92, v92, v246
    v_mul_f32 v93, v93, v246
    v_mul_f32 v94, v94, v246
    v_mul_f32 v95, v95, v246
    v_mul_f32 v96, v96, v246
    v_mul_f32 v97, v97, v246
    v_mul_f32 v98, v98, v246
    v_mul_f32 v99, v99, v246
    v_mul_f32 v100, v100, v246
    v_mul_f32 v101, v101, v246
    v_mul_f32 v102, v102, v246
    v_mul_f32 v103, v103, v246
    v_mul_f32 v104, v104, v246
    v_mul_f32 v105, v105, v246
    v_mul_f32 v106, v106, v246
    v_mul_f32 v107, v107, v246
    v_mul_f32 v108, v108, v246
    v_mul_f32 v109, v109, v246
    v_mul_f32 v110, v110, v246
    v_mul_f32 v111, v111, v246
    v_mul_f32 v112, v112, v246
    v_mul_f32 v113, v113, v246
    v_mul_f32 v114, v114, v246
    v_mul_f32 v115, v115, v246
    v_mul_f32 v116, v116, v246
    v_mul_f32 v117, v117, v246
    v_mul_f32 v118, v118, v246
    v_mul_f32 v119, v119, v246
    v_mul_f32 v244, v244, v246
    v_lshlrev_b32 v247, 16, v152
    v_and_b32 v248, 0xffff0000, v152
    v_mul_f32 v247, v247, v246
    v_mul_f32 v248, v248, v246
    v_cvt_pk_bf16_f32 v152, v247, v248
    v_lshlrev_b32 v247, 16, v153
    v_and_b32 v248, 0xffff0000, v153
    v_mul_f32 v247, v247, v246
    v_mul_f32 v248, v248, v246
    v_cvt_pk_bf16_f32 v153, v247, v248
    v_lshlrev_b32 v247, 16, v154
    v_and_b32 v248, 0xffff0000, v154
    v_mul_f32 v247, v247, v246
    v_mul_f32 v248, v248, v246
    v_cvt_pk_bf16_f32 v154, v247, v248
    v_lshlrev_b32 v247, 16, v155
    v_and_b32 v248, 0xffff0000, v155
    v_mul_f32 v247, v247, v246
    v_mul_f32 v248, v248, v246
    v_cvt_pk_bf16_f32 v155, v247, v248
    v_lshlrev_b32 v247, 16, v156
    v_and_b32 v248, 0xffff0000, v156
    v_mul_f32 v247, v247, v246
    v_mul_f32 v248, v248, v246
    v_cvt_pk_bf16_f32 v156, v247, v248
    v_lshlrev_b32 v247, 16, v157
    v_and_b32 v248, 0xffff0000, v157
    v_mul_f32 v247, v247, v246
    v_mul_f32 v248, v248, v246
    v_cvt_pk_bf16_f32 v157, v247, v248
    v_lshlrev_b32 v247, 16, v158
    v_and_b32 v248, 0xffff0000, v158
    v_mul_f32 v247, v247, v246
    v_mul_f32 v248, v248, v246
    v_cvt_pk_bf16_f32 v158, v247, v248
    v_lshlrev_b32 v247, 16, v159
    v_and_b32 v248, 0xffff0000, v159
    v_mul_f32 v247, v247, v246
    v_mul_f32 v248, v248, v246
    v_cvt_pk_bf16_f32 v159, v247, v248
    s_nop 7
    s_branch L_back_B17
.globl oproj_kernel
.p2align 8
.type oproj_kernel,@function
oproj_kernel:
    s_cmp_ge_u32 s2, 640
    s_cbranch_scc1 L_k3_end
    s_load_dwordx2 s[36:37], s[0:1], 80
    s_load_dwordx2 s[40:41], s[0:1], 96
    v_lshrrev_b32 v1, 6, v0
    v_and_b32 v2, 63, v0
    v_readfirstlane_b32 s20, v1
    s_nop 3
    v_lshlrev_b32 v3, 4, v2
    s_lshl_b32 s21, s2, 2
    s_add_u32 s21, s21, s20
    s_lshr_b32 s23, s21, 4
    s_and_b32 s24, s21, 15
    s_mul_hi_u32 s25, s23, 0x33333334
    s_mul_i32 s26, s25, 5
    s_sub_u32 s26, s23, s26
    s_mul_i32 s22, s25, 1280
    s_bfe_u32 s28, s24, 0x20001
    s_mul_i32 s28, s28, 40
    s_add_u32 s22, s22, s28
    s_lshr_b32 s28, s24, 3
    s_mul_i32 s28, s28, 20
    s_add_u32 s22, s22, s28
    s_lshl_b32 s28, s26, 2
    s_add_u32 s22, s22, s28
    s_and_b32 s28, s24, 1
    s_lshl_b32 s28, s28, 1
    s_add_u32 s22, s22, s28
    s_lshl_b32 s22, s22, 10
    v_and_b32 v4, 31, v2
    v_lshrrev_b32 v5, 5, v2
    v_lshlrev_b32 v6, 11, v4
    v_lshl_add_u32 v6, v5, 4, v6
    s_and_b32 s27, s25, 15
    s_mul_i32 s27, s27, 144
    s_lshl_b32 s28, s26, 5
    s_add_u32 s27, s27, s28
    s_lshl_b32 s27, s27, 11
    s_lshr_b32 s28, s25, 4
    s_lshl_b32 s28, s28, 10
    s_add_u32 s27, s27, s28
    s_lshl_b32 s28, s24, 6
    s_add_u32 s27, s27, s28
    s_cmp_eq_u32 s26, 4
    s_cselect_b32 s29, 16, 32
    v_cmp_gt_u32 vcc, s29, v4
    s_nop 1
    v_mov_b32 v7, 1879048192
    v_cndmask_b32 v6, v7, v6, vcc
    v_cndmask_b32 v3, v7, v3, vcc
    s_waitcnt lgkmcnt(0)
    s_mov_b32 s64, s40
    s_mov_b32 s65, s41
    s_mov_b32 s66, 289931264
    s_mov_b32 s67, 0x00020000
    s_mov_b32 s60, s36
    s_mov_b32 s61, s37
    s_mov_b32 s62, 4718592
    s_mov_b32 s63, 0x00020000
    buffer_load_dwordx4 v[16:19], v3, s[64:67], s22 offen offset:0
    buffer_load_dwordx4 v[20:23], v3, s[64:67], s22 offen offset:1024
    s_add_u32 s22, s22, 163840
    buffer_load_dwordx4 v[24:27], v3, s[64:67], s22 offen offset:0
    buffer_load_dwordx4 v[28:31], v3, s[64:67], s22 offen offset:1024
    s_add_u32 s22, s22, 163840
    buffer_load_dwordx4 v[32:35], v3, s[64:67], s22 offen offset:0
    buffer_load_dwordx4 v[36:39], v3, s[64:67], s22 offen offset:1024
    s_add_u32 s22, s22, 163840
    buffer_load_dwordx4 v[40:43], v3, s[64:67], s22 offen offset:0
    buffer_load_dwordx4 v[44:47], v3, s[64:67], s22 offen offset:1024
    s_add_u32 s22, s22, 163840
    buffer_load_dwordx4 v[48:51], v3, s[64:67], s22 offen offset:0
    buffer_load_dwordx4 v[52:55], v3, s[64:67], s22 offen offset:1024
    s_add_u32 s22, s22, 163840
    buffer_load_dwordx4 v[56:59], v3, s[64:67], s22 offen offset:0
    buffer_load_dwordx4 v[60:63], v3, s[64:67], s22 offen offset:1024
    s_add_u32 s22, s22, 163840
    buffer_load_dwordx4 v[64:67], v3, s[64:67], s22 offen offset:0
    buffer_load_dwordx4 v[68:71], v3, s[64:67], s22 offen offset:1024
    s_add_u32 s22, s22, 163840
    buffer_load_dwordx4 v[72:75], v3, s[64:67], s22 offen offset:0
    buffer_load_dwordx4 v[76:79], v3, s[64:67], s22 offen offset:1024
    s_add_u32 s22, s22, 163840
    s_waitcnt vmcnt(15)
    v_lshlrev_b32 v96, 16, v16
    v_and_b32 v97, 0xffff0000, v16
    v_lshlrev_b32 v98, 16, v17
    v_and_b32 v99, 0xffff0000, v17
    v_lshlrev_b32 v100, 16, v18
    v_and_b32 v101, 0xffff0000, v18
    v_lshlrev_b32 v102, 16, v19
    v_and_b32 v103, 0xffff0000, v19
    s_waitcnt vmcnt(14)
    v_lshlrev_b32 v104, 16, v20
    v_and_b32 v105, 0xffff0000, v20
    v_lshlrev_b32 v106, 16, v21
    v_and_b32 v107, 0xffff0000, v21
    v_lshlrev_b32 v108, 16, v22
    v_and_b32 v109, 0xffff0000, v22
    v_lshlrev_b32 v110, 16, v23
    v_and_b32 v111, 0xffff0000, v23
    s_waitcnt vmcnt(13)
    v_lshlrev_b32 v8, 16, v24
    v_and_b32 v9, 0xffff0000, v24
    v_add_f32 v96, v96, v8
    v_add_f32 v97, v97, v9
    v_lshlrev_b32 v8, 16, v25
    v_and_b32 v9, 0xffff0000, v25
    v_add_f32 v98, v98, v8
    v_add_f32 v99, v99, v9
    v_lshlrev_b32 v8, 16, v26
    v_and_b32 v9, 0xffff0000, v26
    v_add_f32 v100, v100, v8
    v_add_f32 v101, v101, v9
    v_lshlrev_b32 v8, 16, v27
    v_and_b32 v9, 0xffff0000, v27
    v_add_f32 v102, v102, v8
    v_add_f32 v103, v103, v9
    s_waitcnt vmcnt(12)
    v_lshlrev_b32 v8, 16, v28
    v_and_b32 v9, 0xffff0000, v28
    v_add_f32 v104, v104, v8
    v_add_f32 v105, v105, v9
    v_lshlrev_b32 v8, 16, v29
    v_and_b32 v9, 0xffff0000, v29
    v_add_f32 v106, v106, v8
    v_add_f32 v107, v107, v9
    v_lshlrev_b32 v8, 16, v30
    v_and_b32 v9, 0xffff0000, v30
    v_add_f32 v108, v108, v8
    v_add_f32 v109, v109, v9
    v_lshlrev_b32 v8, 16, v31
    v_and_b32 v9, 0xffff0000, v31
    v_add_f32 v110, v110, v8
    v_add_f32 v111, v111, v9
    s_waitcnt vmcnt(11)
    v_lshlrev_b32 v8, 16, v32
    v_and_b32 v9, 0xffff0000, v32
    v_add_f32 v96, v96, v8
    v_add_f32 v97, v97, v9
    v_lshlrev_b32 v8, 16, v33
    v_and_b32 v9, 0xffff0000, v33
    v_add_f32 v98, v98, v8
    v_add_f32 v99, v99, v9
    v_lshlrev_b32 v8, 16, v34
    v_and_b32 v9, 0xffff0000, v34
    v_add_f32 v100, v100, v8
    v_add_f32 v101, v101, v9
    v_lshlrev_b32 v8, 16, v35
    v_and_b32 v9, 0xffff0000, v35
    v_add_f32 v102, v102, v8
    v_add_f32 v103, v103, v9
    s_waitcnt vmcnt(10)
    v_lshlrev_b32 v8, 16, v36
    v_and_b32 v9, 0xffff0000, v36
    v_add_f32 v104, v104, v8
    v_add_f32 v105, v105, v9
    v_lshlrev_b32 v8, 16, v37
    v_and_b32 v9, 0xffff0000, v37
    v_add_f32 v106, v106, v8
    v_add_f32 v107, v107, v9
    v_lshlrev_b32 v8, 16, v38
    v_and_b32 v9, 0xffff0000, v38
    v_add_f32 v108, v108, v8
    v_add_f32 v109, v109, v9
    v_lshlrev_b32 v8, 16, v39
    v_and_b32 v9, 0xffff0000, v39
    v_add_f32 v110, v110, v8
    v_add_f32 v111, v111, v9
    s_waitcnt vmcnt(9)
    v_lshlrev_b32 v8, 16, v40
    v_and_b32 v9, 0xffff0000, v40
    v_add_f32 v96, v96, v8
    v_add_f32 v97, v97, v9
    v_lshlrev_b32 v8, 16, v41
    v_and_b32 v9, 0xffff0000, v41
    v_add_f32 v98, v98, v8
    v_add_f32 v99, v99, v9
    v_lshlrev_b32 v8, 16, v42
    v_and_b32 v9, 0xffff0000, v42
    v_add_f32 v100, v100, v8
    v_add_f32 v101, v101, v9
    v_lshlrev_b32 v8, 16, v43
    v_and_b32 v9, 0xffff0000, v43
    v_add_f32 v102, v102, v8
    v_add_f32 v103, v103, v9
    s_waitcnt vmcnt(8)
    v_lshlrev_b32 v8, 16, v44
    v_and_b32 v9, 0xffff0000, v44
    v_add_f32 v104, v104, v8
    v_add_f32 v105, v105, v9
    v_lshlrev_b32 v8, 16, v45
    v_and_b32 v9, 0xffff0000, v45
    v_add_f32 v106, v106, v8
    v_add_f32 v107, v107, v9
    v_lshlrev_b32 v8, 16, v46
    v_and_b32 v9, 0xffff0000, v46
    v_add_f32 v108, v108, v8
    v_add_f32 v109, v109, v9
    v_lshlrev_b32 v8, 16, v47
    v_and_b32 v9, 0xffff0000, v47
    v_add_f32 v110, v110, v8
    v_add_f32 v111, v111, v9
    s_waitcnt vmcnt(7)
    v_lshlrev_b32 v8, 16, v48
    v_and_b32 v9, 0xffff0000, v48
    v_add_f32 v96, v96, v8
    v_add_f32 v97, v97, v9
    v_lshlrev_b32 v8, 16, v49
    v_and_b32 v9, 0xffff0000, v49
    v_add_f32 v98, v98, v8
    v_add_f32 v99, v99, v9
    v_lshlrev_b32 v8, 16, v50
    v_and_b32 v9, 0xffff0000, v50
    v_add_f32 v100, v100, v8
    v_add_f32 v101, v101, v9
    v_lshlrev_b32 v8, 16, v51
    v_and_b32 v9, 0xffff0000, v51
    v_add_f32 v102, v102, v8
    v_add_f32 v103, v103, v9
    s_waitcnt vmcnt(6)
    v_lshlrev_b32 v8, 16, v52
    v_and_b32 v9, 0xffff0000, v52
    v_add_f32 v104, v104, v8
    v_add_f32 v105, v105, v9
    v_lshlrev_b32 v8, 16, v53
    v_and_b32 v9, 0xffff0000, v53
    v_add_f32 v106, v106, v8
    v_add_f32 v107, v107, v9
    v_lshlrev_b32 v8, 16, v54
    v_and_b32 v9, 0xffff0000, v54
    v_add_f32 v108, v108, v8
    v_add_f32 v109, v109, v9
    v_lshlrev_b32 v8, 16, v55
    v_and_b32 v9, 0xffff0000, v55
    v_add_f32 v110, v110, v8
    v_add_f32 v111, v111, v9
    s_waitcnt vmcnt(5)
    v_lshlrev_b32 v8, 16, v56
    v_and_b32 v9, 0xffff0000, v56
    v_add_f32 v96, v96, v8
    v_add_f32 v97, v97, v9
    v_lshlrev_b32 v8, 16, v57
    v_and_b32 v9, 0xffff0000, v57
    v_add_f32 v98, v98, v8
    v_add_f32 v99, v99, v9
    v_lshlrev_b32 v8, 16, v58
    v_and_b32 v9, 0xffff0000, v58
    v_add_f32 v100, v100, v8
    v_add_f32 v101, v101, v9
    v_lshlrev_b32 v8, 16, v59
    v_and_b32 v9, 0xffff0000, v59
    v_add_f32 v102, v102, v8
    v_add_f32 v103, v103, v9
    s_waitcnt vmcnt(4)
    v_lshlrev_b32 v8, 16, v60
    v_and_b32 v9, 0xffff0000, v60
    v_add_f32 v104, v104, v8
    v_add_f32 v105, v105, v9
    v_lshlrev_b32 v8, 16, v61
    v_and_b32 v9, 0xffff0000, v61
    v_add_f32 v106, v106, v8
    v_add_f32 v107, v107, v9
    v_lshlrev_b32 v8, 16, v62
    v_and_b32 v9, 0xffff0000, v62
    v_add_f32 v108, v108, v8
    v_add_f32 v109, v109, v9
    v_lshlrev_b32 v8, 16, v63
    v_and_b32 v9, 0xffff0000, v63
    v_add_f32 v110, v110, v8
    v_add_f32 v111, v111, v9
    s_waitcnt vmcnt(3)
    v_lshlrev_b32 v8, 16, v64
    v_and_b32 v9, 0xffff0000, v64
    v_add_f32 v96, v96, v8
    v_add_f32 v97, v97, v9
    v_lshlrev_b32 v8, 16, v65
    v_and_b32 v9, 0xffff0000, v65
    v_add_f32 v98, v98, v8
    v_add_f32 v99, v99, v9
    v_lshlrev_b32 v8, 16, v66
    v_and_b32 v9, 0xffff0000, v66
    v_add_f32 v100, v100, v8
    v_add_f32 v101, v101, v9
    v_lshlrev_b32 v8, 16, v67
    v_and_b32 v9, 0xffff0000, v67
    v_add_f32 v102, v102, v8
    v_add_f32 v103, v103, v9
    s_waitcnt vmcnt(2)
    v_lshlrev_b32 v8, 16, v68
    v_and_b32 v9, 0xffff0000, v68
    v_add_f32 v104, v104, v8
    v_add_f32 v105, v105, v9
    v_lshlrev_b32 v8, 16, v69
    v_and_b32 v9, 0xffff0000, v69
    v_add_f32 v106, v106, v8
    v_add_f32 v107, v107, v9
    v_lshlrev_b32 v8, 16, v70
    v_and_b32 v9, 0xffff0000, v70
    v_add_f32 v108, v108, v8
    v_add_f32 v109, v109, v9
    v_lshlrev_b32 v8, 16, v71
    v_and_b32 v9, 0xffff0000, v71
    v_add_f32 v110, v110, v8
    v_add_f32 v111, v111, v9
    s_waitcnt vmcnt(1)
    v_lshlrev_b32 v8, 16, v72
    v_and_b32 v9, 0xffff0000, v72
    v_add_f32 v96, v96, v8
    v_add_f32 v97, v97, v9
    v_lshlrev_b32 v8, 16, v73
    v_and_b32 v9, 0xffff0000, v73
    v_add_f32 v98, v98, v8
    v_add_f32 v99, v99, v9
    v_lshlrev_b32 v8, 16, v74
    v_and_b32 v9, 0xffff0000, v74
    v_add_f32 v100, v100, v8
    v_add_f32 v101, v101, v9
    v_lshlrev_b32 v8, 16, v75
    v_and_b32 v9, 0xffff0000, v75
    v_add_f32 v102, v102, v8
    v_add_f32 v103, v103, v9
    s_waitcnt vmcnt(0)
    v_lshlrev_b32 v8, 16, v76
    v_and_b32 v9, 0xffff0000, v76
    v_add_f32 v104, v104, v8
    v_add_f32 v105, v105, v9
    v_lshlrev_b32 v8, 16, v77
    v_and_b32 v9, 0xffff0000, v77
    v_add_f32 v106, v106, v8
    v_add_f32 v107, v107, v9
    v_lshlrev_b32 v8, 16, v78
    v_and_b32 v9, 0xffff0000, v78
    v_add_f32 v108, v108, v8
    v_add_f32 v109, v109, v9
    v_lshlrev_b32 v8, 16, v79
    v_and_b32 v9, 0xffff0000, v79
    v_add_f32 v110, v110, v8
    v_add_f32 v111, v111, v9
    v_cvt_pk_bf16_f32 v16, v96, v97
    v_cvt_pk_bf16_f32 v17, v98, v99
    v_cvt_pk_bf16_f32 v18, v100, v101
    v_cvt_pk_bf16_f32 v19, v102, v103
    v_cvt_pk_bf16_f32 v20, v104, v105
    v_cvt_pk_bf16_f32 v21, v106, v107
    v_cvt_pk_bf16_f32 v22, v108, v109
    v_cvt_pk_bf16_f32 v23, v110, v111
    buffer_store_dwordx4 v[16:19], v6, s[60:63], s27 offen offset:0
    buffer_store_dwordx4 v[20:23], v6, s[60:63], s27 offen offset:32
L_k3_end:
    s_endpgm
.section .rodata,"a"
.p2align 6
.amdhsa_kernel concat_heads__gqa_block_cached__gqa_block_cached__near_ridge_kernel
  .amdhsa_next_free_vgpr 256
  .amdhsa_next_free_sgpr 102
  .amdhsa_accum_offset 256
  .amdhsa_group_segment_fixed_size 0
  .amdhsa_kernarg_size 104
  .amdhsa_user_sgpr_count 2
  .amdhsa_user_sgpr_kernarg_segment_ptr 1
  .amdhsa_system_sgpr_workgroup_id_x 1
.end_amdhsa_kernel
.p2align 6
.amdhsa_kernel oproj_kernel
  .amdhsa_next_free_vgpr 112
  .amdhsa_next_free_sgpr 102
  .amdhsa_accum_offset 112
  .amdhsa_group_segment_fixed_size 0
  .amdhsa_kernarg_size 104
  .amdhsa_user_sgpr_count 2
  .amdhsa_user_sgpr_kernarg_segment_ptr 1
  .amdhsa_system_sgpr_workgroup_id_x 1
.end_amdhsa_kernel
```
